```python
import torch

def _softmax(x, axis=-1):
    return torch.softmax(x, dim=axis)
def _gelu(x):
    return torch.nn.functional.gelu(x, approximate="tanh")
def _silu(x):
    return torch.nn.functional.silu(x)
def _sigmoid(x):
    return torch.sigmoid(x)
def _layernorm(x, axis=-1, eps=1e-5):
    m = x.mean(dim=axis, keepdim=True)
    v = x.var(dim=axis, keepdim=True, unbiased=False)
    return (x - m) / torch.sqrt(v + eps)
def _scatter_add(tgt, idx, src, axis=0):
    return tgt.clone().index_add_(axis, idx, src)
def _segment_sum(src, seg, n):
    out = torch.zeros((n,) + src.shape[1:], dtype=src.dtype)
    return out.index_add_(0, seg, src)
def _pad(x, pw):
    flat = tuple(v for pair in reversed(pw) for v in pair)
    return torch.nn.functional.pad(x, flat)

kernel_name = 'concat_heads__mha_block_cached__gqa_block_cached__near_ridge'

def setup_inputs():

    _w = (lambda a: (lambda t: t.to(torch.bfloat16) if t.is_floating_point() else t)(torch.as_tensor(a)))
    def _A_setup():
        B, Sq, D = 8, 96, 512
        H, Sk, Dh = 32, 1024, 128
        return {
            "x": _w((lambda *s: torch.randn(*s, dtype=torch.bfloat16) * 0.8)(B, Sq, D)),
            "k_cache": _w((lambda *s: torch.randn(*s, dtype=torch.bfloat16) * 0.8)(B, H, Sk, Dh)),
            "v_cache": _w((lambda *s: torch.randn(*s, dtype=torch.bfloat16) * 0.05)(B, H, Sk, Dh)),
            "wq": _w((lambda *s: torch.randn(*s, dtype=torch.bfloat16) * 0.8)(D, H * Dh) * (D ** -0.5)),
            "wo": _w((lambda *s: torch.randn(*s, dtype=torch.bfloat16) * 0.05)(H * Dh, D) * ((H * Dh) ** -0.5)),
        }
    _A_in = _A_setup()

    def _B_setup():
        B, Sq, D = 8, 96, 512
        Hq, Hkv, Sk, Dh = 32, 32, 1024, 128
        assert Hq % Hkv == 0, (Hq, Hkv)
        return {
            "x": _w((lambda *s: torch.randn(*s, dtype=torch.bfloat16) * 0.8)(B, Sq, D)),
            "k_cache": _w((lambda *s: torch.randn(*s, dtype=torch.bfloat16) * 0.8)(B, Hkv, Sk, Dh)),
            "v_cache": _w((lambda *s: torch.randn(*s, dtype=torch.bfloat16) * 0.05)(B, Hkv, Sk, Dh)),
            "wq": _w((lambda *s: torch.randn(*s, dtype=torch.bfloat16) * 0.8)(D, Hq * Dh) * (D ** -0.5)),
            "wo": _w((lambda *s: torch.randn(*s, dtype=torch.bfloat16) * 0.05)(Hq * Dh, D) * ((Hq * Dh) ** -0.5)),
        }
    _B_in = _B_setup()

    return {
        "A_x": _A_in["x"],
        "A_k_cache": _A_in["k_cache"],
        "A_v_cache": _A_in["v_cache"],
        "A_wq": _A_in["wq"],
        "A_wo": _A_in["wo"],
        "B_x": _B_in["x"],
        "B_k_cache": _B_in["k_cache"],
        "B_v_cache": _B_in["v_cache"],
        "B_wq": _B_in["wq"],
        "B_wo": _B_in["wo"],
    }

def reference(A_x, A_k_cache, A_v_cache, A_wq, A_wo, B_x, B_k_cache, B_v_cache, B_wq, B_wo):
    def _A_ref(x, k_cache, v_cache, wq, wo):
        B, Sq, D = x.shape
        H, Dh = 32, 128
        q = (lambda x, *d: x.permute(*d))((x @ wq).reshape(B, Sq, H, Dh), 0, 2, 1, 3)
        scores = torch.einsum("bhqd,bhkd->bhqk", q, k_cache) * (Dh ** -0.5)
        p = _softmax(scores, axis=-1)
        o = torch.einsum("bhqk,bhkd->bhqd", p, v_cache)
        return (lambda x, *d: x.permute(*d))(o, 0, 2, 1, 3).reshape(B, Sq, H * Dh) @ wo

    def _B_ref(x, k_cache, v_cache, wq, wo):
        B, Sq, D = x.shape
        Hq, Dh = 32, 128
        Hkv = k_cache.shape[1]
        rep = Hq // Hkv
        q = (lambda x, *d: x.permute(*d))((x @ wq).reshape(B, Sq, Hq, Dh), 0, 2, 1, 3)
        k = (lambda x, n, axis: torch.repeat_interleave(x, n, dim=axis))(k_cache, rep, axis=1)
        v = (lambda x, n, axis: torch.repeat_interleave(x, n, dim=axis))(v_cache, rep, axis=1)
        scores = torch.einsum("bhqd,bhkd->bhqk", q, k) * (Dh ** -0.5)
        p = _softmax(scores, axis=-1)
        o = torch.einsum("bhqk,bhkd->bhqd", p, v)
        return (lambda x, *d: x.permute(*d))(o, 0, 2, 1, 3).reshape(B, Sq, Hq * Dh) @ wo

    a = _A_ref(A_x, A_k_cache, A_v_cache, A_wq, A_wo)
    b = _B_ref(B_x, B_k_cache, B_v_cache, B_wq, B_wo)
    return torch.concatenate([a, b], axis=-1)
```

```asm
; @launch grid=(256,1,1) block=(256,1,1) lds=156736
.amdgcn_target "amdgcn-amd-amdhsa--gfx950"
.text
.globl concat_heads__mha_block_cached__gqa_block_cached__near_ridge_kernel
.p2align 8
.type concat_heads__mha_block_cached__gqa_block_cached__near_ridge_kernel,@function
concat_heads__mha_block_cached__gqa_block_cached__near_ridge_kernel:
  s_cmp_ge_u32 s2, 256
  s_cbranch_scc1 L_end
  s_load_dwordx16 s[36:51], s[0:1], 0
  s_load_dwordx4 s[52:55], s[0:1], 64
  s_load_dwordx4 s[56:59], s[0:1], 80
  s_load_dwordx2 s[60:61], s[0:1], 96
  v_lshrrev_b32 v1, 6, v0
  v_and_b32 v0, 63, v0
  s_and_b32 s20, s2, 7
  v_readfirstlane_b32 s3, v1
  s_lshr_b32 s28, s2, 3
  s_and_b32 s21, s28, 3
  s_lshr_b32 s22, s28, 2
  s_lshl_b32 s25, s20, 2
  s_add_u32 s25, s25, s21
  s_lshl_b32 s24, s22, 3
  s_add_u32 s24, s24, s20
  s_mov_b32 s26, 0x80000
  s_lshl_b32 s27, s21, 1
  s_and_b32 s29, s20, 1
  s_add_u32 s27, s27, s29
  s_mul_i32 s27, s27, 4
  s_lshr_b32 s27, s27, 3
  s_add_u32 s27, s27, 10
  s_cmp_lt_u32 s22, 4
  s_waitcnt lgkmcnt(0)
  s_cselect_b32 s36, s36, s46
  s_cselect_b32 s37, s37, s47
  s_cselect_b32 s38, s38, s48
  s_cselect_b32 s39, s39, s49
  s_cselect_b32 s40, s40, s50
  s_cselect_b32 s41, s41, s51
  s_cselect_b32 s42, s42, s52
  s_cselect_b32 s43, s43, s53
  s_cselect_b32 s44, s44, s54
  s_cselect_b32 s45, s45, s55
  s_and_b32 s46, s22, 3
  s_lshr_b32 s47, s22, 2
  s_cmp_eq_u32 s3, 3
  s_cbranch_scc0 L_compute
L_loader:
  s_setprio 3
  v_lshrrev_b32 v1, 4, v0
  v_and_b32 v2, 15, v0
  v_xor_b32 v3, v2, v1
  v_lshlrev_b32 v3, 4, v3
  v_lshlrev_b32 v2, 4, v2
  v_lshlrev_b32 v4, 12, v1
  v_lshlrev_b32 v5, 15, v1
  v_lshlrev_b32 v6, 10, v1
  s_sub_u32 s64, s36, 4096
  s_subb_u32 s65, s37, 0
  s_mov_b32 s66, 0xc1000
  s_mov_b32 s67, 0x20000
  s_sub_u32 s76, s42, 4096
  s_subb_u32 s77, s43, 0
  s_mov_b32 s78, 0x401000
  s_mov_b32 s79, 0x20000
  v_add_u32 v16, v4, v3
  v_add_u32 v19, 3904, v16
  v_add_u32 v18, 3968, v16
  v_add_u32 v17, 4032, v16
  v_add_u32 v16, 4096, v16
  v_add_u32 v20, v5, v2
  v_add_u32 v23, 25408, v20
  v_add_u32 v22, 18304, v20
  v_add_u32 v21, 11200, v20
  v_add_u32 v20, 4096, v20
  s_getreg_b32 s50, hwreg(HW_REG_XCC_ID)
  s_and_b32 s50, s50, 1
  v_mov_b32 v29, 156672
  v_mov_b32 v30, 156688
  v_mov_b32 v28, 0
  ds_write_b32 v29, v28
  s_mov_b32 s4, 0
  s_mov_b32 s5, 0
  s_mov_b32 s6, 0
  s_mov_b32 s7, 0
  s_mov_b32 s8, -1
  s_mov_b32 s51, 0
  s_add_u32 s15, s46, s21
  s_and_b32 s15, s15, 3
  s_mov_b32 s23, 10
  s_mov_b32 s11, 0
  s_add_u32 s29, s15, s11
  s_and_b32 s29, s29, 3
  s_lshl_b32 s30, s29, 8
  s_mul_i32 s18, s46, 98304
  s_add_u32 s18, s18, s30
  s_lshl_b32 s30, s29, 20
  s_lshl_b32 s19, s25, 8
  s_add_u32 s19, s19, s30
  s_add_u32 s9, s18, 0
  s_cmp_ge_i32 s6, s8
  s_cbranch_scc0 Llslow_1
Lok_2:
  s_mov_b32 m0, s7
  s_add_u32 s10, s9, 16384
  buffer_load_dwordx4 v16, s[64:67], s9 offen offset:0  lds
  buffer_load_dwordx4 v17, s[64:67], s9 offen offset:1088  lds
  buffer_load_dwordx4 v18, s[64:67], s9 offen offset:2176  lds
  s_add_u32 s4, s4, 1
  buffer_load_dwordx4 v19, s[64:67], s9 offen offset:3264  lds
  s_add_u32 m0, s7, 4352
  s_add_u32 s7, s7, 8704
  buffer_load_dwordx4 v16, s[64:67], s10 offen offset:0  lds
  s_cmp_lt_u32 s7, 95744
  s_cselect_b32 s7, s7, 0
  buffer_load_dwordx4 v17, s[64:67], s10 offen offset:1088  lds
  s_sub_i32 s8, s4, s23
  buffer_load_dwordx4 v18, s[64:67], s10 offen offset:2176  lds
  buffer_load_dwordx4 v19, s[64:67], s10 offen offset:3264  lds
  s_add_u32 s9, s18, 32768
  s_cmp_ge_i32 s6, s8
  s_cbranch_scc0 Llslow_3
Lok_4:
  s_mov_b32 m0, s7
  s_add_u32 s10, s9, 16384
  buffer_load_dwordx4 v16, s[64:67], s9 offen offset:0  lds
  buffer_load_dwordx4 v17, s[64:67], s9 offen offset:1088  lds
  buffer_load_dwordx4 v18, s[64:67], s9 offen offset:2176  lds
  s_add_u32 s4, s4, 1
  buffer_load_dwordx4 v19, s[64:67], s9 offen offset:3264  lds
  s_add_u32 m0, s7, 4352
  s_add_u32 s7, s7, 8704
  buffer_load_dwordx4 v16, s[64:67], s10 offen offset:0  lds
  s_cmp_lt_u32 s7, 95744
  s_cselect_b32 s7, s7, 0
  buffer_load_dwordx4 v17, s[64:67], s10 offen offset:1088  lds
  s_sub_i32 s8, s4, s23
  buffer_load_dwordx4 v18, s[64:67], s10 offen offset:2176  lds
  buffer_load_dwordx4 v19, s[64:67], s10 offen offset:3264  lds
  s_add_u32 s9, s18, 65536
  s_cmp_ge_i32 s6, s8
  s_cbranch_scc0 Llslow_5
Lok_6:
  s_mov_b32 m0, s7
  s_add_u32 s10, s9, 16384
  buffer_load_dwordx4 v16, s[64:67], s9 offen offset:0  lds
  buffer_load_dwordx4 v17, s[64:67], s9 offen offset:1088  lds
  buffer_load_dwordx4 v18, s[64:67], s9 offen offset:2176  lds
  s_add_u32 s4, s4, 1
  buffer_load_dwordx4 v19, s[64:67], s9 offen offset:3264  lds
  s_add_u32 m0, s7, 4352
  s_add_u32 s7, s7, 8704
  buffer_load_dwordx4 v16, s[64:67], s10 offen offset:0  lds
  s_cmp_lt_u32 s7, 95744
  s_cselect_b32 s7, s7, 0
  buffer_load_dwordx4 v17, s[64:67], s10 offen offset:1088  lds
  s_sub_i32 s8, s4, s23
  buffer_load_dwordx4 v18, s[64:67], s10 offen offset:2176  lds
  buffer_load_dwordx4 v19, s[64:67], s10 offen offset:3264  lds
  s_add_u32 s9, s19, 0
  s_cmp_ge_i32 s6, s8
  s_cbranch_scc0 Llslow_7
Lok_8:
  s_mov_b32 m0, s7
  s_add_u32 s10, s9, 131072
  buffer_load_dwordx4 v20, s[76:79], s9 offen offset:0  lds
  buffer_load_dwordx4 v21, s[76:79], s9 offen offset:1088  lds
  buffer_load_dwordx4 v22, s[76:79], s9 offen offset:2176  lds
  s_add_u32 s4, s4, 1
  buffer_load_dwordx4 v23, s[76:79], s9 offen offset:3264  lds
  s_add_u32 m0, s7, 4352
  s_add_u32 s7, s7, 8704
  buffer_load_dwordx4 v20, s[76:79], s10 offen offset:0  lds
  s_cmp_lt_u32 s7, 95744
  s_cselect_b32 s7, s7, 0
  buffer_load_dwordx4 v21, s[76:79], s10 offen offset:1088  lds
  s_sub_i32 s8, s4, s23
  buffer_load_dwordx4 v22, s[76:79], s10 offen offset:2176  lds
  buffer_load_dwordx4 v23, s[76:79], s10 offen offset:3264  lds
  s_add_u32 s9, s19, 262144
  s_cmp_ge_i32 s6, s8
  s_cbranch_scc0 Llslow_9
Lok_10:
  s_mov_b32 m0, s7
  s_add_u32 s10, s9, 131072
  buffer_load_dwordx4 v20, s[76:79], s9 offen offset:0  lds
  buffer_load_dwordx4 v21, s[76:79], s9 offen offset:1088  lds
  buffer_load_dwordx4 v22, s[76:79], s9 offen offset:2176  lds
  s_add_u32 s4, s4, 1
  buffer_load_dwordx4 v23, s[76:79], s9 offen offset:3264  lds
  s_add_u32 m0, s7, 4352
  s_add_u32 s7, s7, 8704
  buffer_load_dwordx4 v20, s[76:79], s10 offen offset:0  lds
  s_cmp_lt_u32 s7, 95744
  s_cselect_b32 s7, s7, 0
  buffer_load_dwordx4 v21, s[76:79], s10 offen offset:1088  lds
  s_sub_i32 s8, s4, s23
  buffer_load_dwordx4 v22, s[76:79], s10 offen offset:2176  lds
  buffer_load_dwordx4 v23, s[76:79], s10 offen offset:3264  lds
  s_waitcnt lgkmcnt(0)
  s_barrier
  s_add_u32 s9, s19, 524288
  s_cmp_ge_i32 s6, s8
  s_cbranch_scc0 Llslow_11
Lok_12:
  s_mov_b32 m0, s7
  s_add_u32 s10, s9, 131072
  buffer_load_dwordx4 v20, s[76:79], s9 offen offset:0  lds
  buffer_load_dwordx4 v21, s[76:79], s9 offen offset:1088  lds
  buffer_load_dwordx4 v22, s[76:79], s9 offen offset:2176  lds
  s_add_u32 s4, s4, 1
  buffer_load_dwordx4 v23, s[76:79], s9 offen offset:3264  lds
  s_add_u32 m0, s7, 4352
  s_add_u32 s7, s7, 8704
  buffer_load_dwordx4 v20, s[76:79], s10 offen offset:0  lds
  s_cmp_lt_u32 s7, 95744
  s_cselect_b32 s7, s7, 0
  buffer_load_dwordx4 v21, s[76:79], s10 offen offset:1088  lds
  s_sub_i32 s8, s4, s23
  buffer_load_dwordx4 v22, s[76:79], s10 offen offset:2176  lds
  buffer_load_dwordx4 v23, s[76:79], s10 offen offset:3264  lds
  s_waitcnt vmcnt(40)
  s_getreg_b32 s28, hwreg(HW_REG_IB_STS)
  s_lshr_b32 s29, s28, 18
  s_and_b32 s28, s28, 15
  s_and_b32 s29, s29, 0x30
  s_add_u32 s28, s28, s29
  s_add_u32 s28, s28, 7
  s_lshr_b32 s28, s28, 3
  s_sub_i32 s5, s4, s28
  v_mov_b32 v28, s5
  ds_write_b32 v29, v28
  s_add_u32 s9, s19, 786432
  s_cmp_ge_i32 s6, s8
  s_cbranch_scc0 Llslow_13
Lok_14:
  s_mov_b32 m0, s7
  s_add_u32 s10, s9, 131072
  buffer_load_dwordx4 v20, s[76:79], s9 offen offset:0  lds
  buffer_load_dwordx4 v21, s[76:79], s9 offen offset:1088  lds
  buffer_load_dwordx4 v22, s[76:79], s9 offen offset:2176  lds
  s_add_u32 s4, s4, 1
  buffer_load_dwordx4 v23, s[76:79], s9 offen offset:3264  lds
  s_add_u32 m0, s7, 4352
  s_add_u32 s7, s7, 8704
  buffer_load_dwordx4 v20, s[76:79], s10 offen offset:0  lds
  s_cmp_lt_u32 s7, 95744
  s_cselect_b32 s7, s7, 0
  buffer_load_dwordx4 v21, s[76:79], s10 offen offset:1088  lds
  s_sub_i32 s8, s4, s23
  buffer_load_dwordx4 v22, s[76:79], s10 offen offset:2176  lds
  buffer_load_dwordx4 v23, s[76:79], s10 offen offset:3264  lds
  s_waitcnt vmcnt(40)
  s_getreg_b32 s28, hwreg(HW_REG_IB_STS)
  s_lshr_b32 s29, s28, 18
  s_and_b32 s28, s28, 15
  s_and_b32 s29, s29, 0x30
  s_add_u32 s28, s28, s29
  s_add_u32 s28, s28, 7
  s_lshr_b32 s28, s28, 3
  s_sub_i32 s5, s4, s28
  v_mov_b32 v28, s5
  ds_write_b32 v29, v28
  s_sub_u32 s68, s38, 4096
  s_subb_u32 s69, s39, 0
  s_mov_b32 s70, 0x4001000
  s_mov_b32 s71, 0x20000
  s_sub_u32 s72, s40, 4096
  s_subb_u32 s73, s41, 0
  s_mov_b32 s74, 0x4001000
  s_mov_b32 s75, 0x20000
  s_sub_u32 s80, s44, 4096
  s_subb_u32 s81, s45, 0
  s_mov_b32 s82, 0x401000
  s_mov_b32 s83, 0x20000
  v_add_u32 v8, v6, v3
  v_add_u32 v11, 1600, v8
  v_add_u32 v10, 2432, v8
  v_add_u32 v9, 3264, v8
  v_add_u32 v8, 4096, v8
  v_add_u32 v12, v6, v2
  v_add_u32 v15, 1600, v12
  v_add_u32 v14, 2432, v12
  v_add_u32 v13, 3264, v12
  v_add_u32 v12, 4096, v12
  v_add_u32 v24, v4, v2
  v_add_u32 v27, 3904, v24
  v_add_u32 v26, 3968, v24
  v_add_u32 v25, 4032, v24
  v_add_u32 v24, 4096, v24
  v_lshlrev_b32 v7, 4, v0
  v_add_u32 v39, 3904, v7
  v_add_u32 v38, 3968, v7
  v_add_u32 v37, 4032, v7
  v_add_u32 v36, 4096, v7
  v_min_u32 v7, 11, v0
  v_lshrrev_b32 v204, 2, v7
  v_lshlrev_b32 v204, 7, v204
  v_and_b32 v7, 3, v7
  v_lshlrev_b32 v7, 3, v7
  v_add_u32 v204, v204, v7
  v_add_u32 v204, 4096, v204
  s_lshl_b32 s29, s46, 5
  s_add_u32 s29, s29, s25
  s_lshl_b32 s13, s29, 18
  s_mul_i32 s62, s2, 0
  s_and_b32 s62, s62, 31
  s_lshl_b32 s62, s62, 13
  s_and_b32 s31, s21, 1
  s_cmp_eq_u32 s31, 0
  s_cbranch_scc1 L_ld_x1
  s_mov_b32 s48, s7
  s_mov_b32 s7, 95744
  s_add_u32 s9, s62, 0
  s_and_b32 s9, s9, 0x3ffff
  s_add_u32 s9, s9, s13
  s_mov_b32 m0, s7
  s_add_u32 s10, s9, 4096
  buffer_load_dwordx4 v8, s[68:71], s9 offen offset:0 nt lds
  buffer_load_dwordx4 v9, s[68:71], s9 offen offset:1088 nt lds
  buffer_load_dwordx4 v10, s[68:71], s9 offen offset:2176 nt lds
  s_add_u32 s4, s4, 1
  buffer_load_dwordx4 v11, s[68:71], s9 offen offset:3264 nt lds
  s_add_u32 m0, s7, 4352
  s_add_u32 s7, s7, 8704
  buffer_load_dwordx4 v8, s[68:71], s10 offen offset:0 nt lds
  s_cmp_lt_u32 s7, 156672
  s_cselect_b32 s7, s7, 0
  buffer_load_dwordx4 v9, s[68:71], s10 offen offset:1088 nt lds
  s_sub_i32 s8, s4, s23
  buffer_load_dwordx4 v10, s[68:71], s10 offen offset:2176 nt lds
  buffer_load_dwordx4 v11, s[68:71], s10 offen offset:3264 nt lds
  s_waitcnt vmcnt(40)
  s_getreg_b32 s28, hwreg(HW_REG_IB_STS)
  s_lshr_b32 s29, s28, 18
  s_and_b32 s28, s28, 15
  s_and_b32 s29, s29, 0x30
  s_add_u32 s28, s28, s29
  s_add_u32 s28, s28, 7
  s_lshr_b32 s28, s28, 3
  s_sub_i32 s5, s4, s28
  v_mov_b32 v28, s5
  ds_write_b32 v29, v28
  s_add_u32 s9, s62, 8192
  s_and_b32 s9, s9, 0x3ffff
  s_add_u32 s9, s9, s13
  s_mov_b32 m0, s7
  s_add_u32 s10, s9, 4096
  buffer_load_dwordx4 v8, s[68:71], s9 offen offset:0 nt lds
  buffer_load_dwordx4 v9, s[68:71], s9 offen offset:1088 nt lds
  buffer_load_dwordx4 v10, s[68:71], s9 offen offset:2176 nt lds
  s_add_u32 s4, s4, 1
  buffer_load_dwordx4 v11, s[68:71], s9 offen offset:3264 nt lds
  s_add_u32 m0, s7, 4352
  s_add_u32 s7, s7, 8704
  buffer_load_dwordx4 v8, s[68:71], s10 offen offset:0 nt lds
  s_cmp_lt_u32 s7, 156672
  s_cselect_b32 s7, s7, 0
  buffer_load_dwordx4 v9, s[68:71], s10 offen offset:1088 nt lds
  s_sub_i32 s8, s4, s23
  buffer_load_dwordx4 v10, s[68:71], s10 offen offset:2176 nt lds
  buffer_load_dwordx4 v11, s[68:71], s10 offen offset:3264 nt lds
  s_waitcnt vmcnt(40)
  s_getreg_b32 s28, hwreg(HW_REG_IB_STS)
  s_lshr_b32 s29, s28, 18
  s_and_b32 s28, s28, 15
  s_and_b32 s29, s29, 0x30
  s_add_u32 s28, s28, s29
  s_add_u32 s28, s28, 7
  s_lshr_b32 s28, s28, 3
  s_sub_i32 s5, s4, s28
  v_mov_b32 v28, s5
  ds_write_b32 v29, v28
  s_add_u32 s9, s62, 0
  s_and_b32 s9, s9, 0x3ffff
  s_add_u32 s9, s9, s13
  s_mov_b32 m0, s7
  s_add_u32 s10, s9, 4096
  buffer_load_dwordx4 v12, s[72:75], s9 offen offset:0 nt lds
  buffer_load_dwordx4 v13, s[72:75], s9 offen offset:1088 nt lds
  buffer_load_dwordx4 v14, s[72:75], s9 offen offset:2176 nt lds
  s_add_u32 s4, s4, 1
  buffer_load_dwordx4 v15, s[72:75], s9 offen offset:3264 nt lds
  s_add_u32 m0, s7, 4352
  s_add_u32 s7, s7, 8704
  buffer_load_dwordx4 v12, s[72:75], s10 offen offset:0 nt lds
  s_cmp_lt_u32 s7, 156672
  s_cselect_b32 s7, s7, 0
  buffer_load_dwordx4 v13, s[72:75], s10 offen offset:1088 nt lds
  s_sub_i32 s8, s4, s23
  buffer_load_dwordx4 v14, s[72:75], s10 offen offset:2176 nt lds
  buffer_load_dwordx4 v15, s[72:75], s10 offen offset:3264 nt lds
  s_waitcnt vmcnt(40)
  s_getreg_b32 s28, hwreg(HW_REG_IB_STS)
  s_lshr_b32 s29, s28, 18
  s_and_b32 s28, s28, 15
  s_and_b32 s29, s29, 0x30
  s_add_u32 s28, s28, s29
  s_add_u32 s28, s28, 7
  s_lshr_b32 s28, s28, 3
  s_sub_i32 s5, s4, s28
  v_mov_b32 v28, s5
  ds_write_b32 v29, v28
  s_add_u32 s9, s62, 16384
  s_and_b32 s9, s9, 0x3ffff
  s_add_u32 s9, s9, s13
  s_mov_b32 m0, s7
  s_add_u32 s10, s9, 4096
  buffer_load_dwordx4 v8, s[68:71], s9 offen offset:0 nt lds
  buffer_load_dwordx4 v9, s[68:71], s9 offen offset:1088 nt lds
  buffer_load_dwordx4 v10, s[68:71], s9 offen offset:2176 nt lds
  s_add_u32 s4, s4, 1
  buffer_load_dwordx4 v11, s[68:71], s9 offen offset:3264 nt lds
  s_add_u32 m0, s7, 4352
  s_add_u32 s7, s7, 8704
  buffer_load_dwordx4 v8, s[68:71], s10 offen offset:0 nt lds
  s_cmp_lt_u32 s7, 156672
  s_cselect_b32 s7, s7, 0
  buffer_load_dwordx4 v9, s[68:71], s10 offen offset:1088 nt lds
  s_sub_i32 s8, s4, s23
  buffer_load_dwordx4 v10, s[68:71], s10 offen offset:2176 nt lds
  buffer_load_dwordx4 v11, s[68:71], s10 offen offset:3264 nt lds
  s_waitcnt vmcnt(40)
  s_getreg_b32 s28, hwreg(HW_REG_IB_STS)
  s_lshr_b32 s29, s28, 18
  s_and_b32 s28, s28, 15
  s_and_b32 s29, s29, 0x30
  s_add_u32 s28, s28, s29
  s_add_u32 s28, s28, 7
  s_lshr_b32 s28, s28, 3
  s_sub_i32 s5, s4, s28
  v_mov_b32 v28, s5
  ds_write_b32 v29, v28
  s_add_u32 s9, s62, 8192
  s_and_b32 s9, s9, 0x3ffff
  s_add_u32 s9, s9, s13
  s_mov_b32 m0, s7
  s_add_u32 s10, s9, 4096
  buffer_load_dwordx4 v12, s[72:75], s9 offen offset:0 nt lds
  buffer_load_dwordx4 v13, s[72:75], s9 offen offset:1088 nt lds
  buffer_load_dwordx4 v14, s[72:75], s9 offen offset:2176 nt lds
  s_add_u32 s4, s4, 1
  buffer_load_dwordx4 v15, s[72:75], s9 offen offset:3264 nt lds
  s_add_u32 m0, s7, 4352
  s_add_u32 s7, s7, 8704
  buffer_load_dwordx4 v12, s[72:75], s10 offen offset:0 nt lds
  s_cmp_lt_u32 s7, 156672
  s_cselect_b32 s7, s7, 0
  buffer_load_dwordx4 v13, s[72:75], s10 offen offset:1088 nt lds
  s_sub_i32 s8, s4, s23
  buffer_load_dwordx4 v14, s[72:75], s10 offen offset:2176 nt lds
  buffer_load_dwordx4 v15, s[72:75], s10 offen offset:3264 nt lds
  s_waitcnt vmcnt(40)
  s_getreg_b32 s28, hwreg(HW_REG_IB_STS)
  s_lshr_b32 s29, s28, 18
  s_and_b32 s28, s28, 15
  s_and_b32 s29, s29, 0x30
  s_add_u32 s28, s28, s29
  s_add_u32 s28, s28, 7
  s_lshr_b32 s28, s28, 3
  s_sub_i32 s5, s4, s28
  v_mov_b32 v28, s5
  ds_write_b32 v29, v28
  s_add_u32 s9, s62, 24576
  s_and_b32 s9, s9, 0x3ffff
  s_add_u32 s9, s9, s13
  s_mov_b32 m0, s7
  s_add_u32 s10, s9, 4096
  buffer_load_dwordx4 v8, s[68:71], s9 offen offset:0 nt lds
  buffer_load_dwordx4 v9, s[68:71], s9 offen offset:1088 nt lds
  buffer_load_dwordx4 v10, s[68:71], s9 offen offset:2176 nt lds
  s_add_u32 s4, s4, 1
  buffer_load_dwordx4 v11, s[68:71], s9 offen offset:3264 nt lds
  s_add_u32 m0, s7, 4352
  s_add_u32 s7, s7, 8704
  buffer_load_dwordx4 v8, s[68:71], s10 offen offset:0 nt lds
  s_cmp_lt_u32 s7, 156672
  s_cselect_b32 s7, s7, 0
  buffer_load_dwordx4 v9, s[68:71], s10 offen offset:1088 nt lds
  s_sub_i32 s8, s4, s23
  buffer_load_dwordx4 v10, s[68:71], s10 offen offset:2176 nt lds
  buffer_load_dwordx4 v11, s[68:71], s10 offen offset:3264 nt lds
  s_waitcnt vmcnt(40)
  s_getreg_b32 s28, hwreg(HW_REG_IB_STS)
  s_lshr_b32 s29, s28, 18
  s_and_b32 s28, s28, 15
  s_and_b32 s29, s29, 0x30
  s_add_u32 s28, s28, s29
  s_add_u32 s28, s28, 7
  s_lshr_b32 s28, s28, 3
  s_sub_i32 s5, s4, s28
  v_mov_b32 v28, s5
  ds_write_b32 v29, v28
  s_add_u32 s9, s62, 16384
  s_and_b32 s9, s9, 0x3ffff
  s_add_u32 s9, s9, s13
  s_mov_b32 m0, s7
  s_add_u32 s10, s9, 4096
  buffer_load_dwordx4 v12, s[72:75], s9 offen offset:0 nt lds
  buffer_load_dwordx4 v13, s[72:75], s9 offen offset:1088 nt lds
  buffer_load_dwordx4 v14, s[72:75], s9 offen offset:2176 nt lds
  s_add_u32 s4, s4, 1
  buffer_load_dwordx4 v15, s[72:75], s9 offen offset:3264 nt lds
  s_add_u32 m0, s7, 4352
  s_add_u32 s7, s7, 8704
  buffer_load_dwordx4 v12, s[72:75], s10 offen offset:0 nt lds
  s_cmp_lt_u32 s7, 156672
  s_cselect_b32 s7, s7, 0
  buffer_load_dwordx4 v13, s[72:75], s10 offen offset:1088 nt lds
  s_sub_i32 s8, s4, s23
  buffer_load_dwordx4 v14, s[72:75], s10 offen offset:2176 nt lds
  buffer_load_dwordx4 v15, s[72:75], s10 offen offset:3264 nt lds
  s_waitcnt vmcnt(40)
  s_getreg_b32 s28, hwreg(HW_REG_IB_STS)
  s_lshr_b32 s29, s28, 18
  s_and_b32 s28, s28, 15
  s_and_b32 s29, s29, 0x30
  s_add_u32 s28, s28, s29
  s_add_u32 s28, s28, 7
  s_lshr_b32 s28, s28, 3
  s_sub_i32 s5, s4, s28
  v_mov_b32 v28, s5
  ds_write_b32 v29, v28
  s_mov_b32 s7, s48
  s_mov_b32 s23, 17
  s_sub_i32 s8, s4, s23
L_ld_x1:
  s_mov_b32 s11, 1
L_ld_qp1:
  s_add_u32 s29, s15, s11
  s_and_b32 s29, s29, 3
  s_lshl_b32 s30, s29, 8
  s_mul_i32 s18, s46, 98304
  s_add_u32 s18, s18, s30
  s_lshl_b32 s30, s29, 20
  s_lshl_b32 s19, s25, 8
  s_add_u32 s19, s19, s30
  s_add_u32 s9, s18, 0
  s_cmp_ge_i32 s6, s8
  s_cbranch_scc0 Llslow_15
Lok_16:
  s_mov_b32 m0, s7
  s_add_u32 s10, s9, 16384
  buffer_load_dwordx4 v16, s[64:67], s9 offen offset:0  lds
  buffer_load_dwordx4 v17, s[64:67], s9 offen offset:1088  lds
  buffer_load_dwordx4 v18, s[64:67], s9 offen offset:2176  lds
  s_add_u32 s4, s4, 1
  buffer_load_dwordx4 v19, s[64:67], s9 offen offset:3264  lds
  s_add_u32 m0, s7, 4352
  s_add_u32 s7, s7, 8704
  buffer_load_dwordx4 v16, s[64:67], s10 offen offset:0  lds
  s_cmp_lt_u32 s7, 95744
  s_cselect_b32 s7, s7, 0
  buffer_load_dwordx4 v17, s[64:67], s10 offen offset:1088  lds
  s_sub_i32 s8, s4, s23
  buffer_load_dwordx4 v18, s[64:67], s10 offen offset:2176  lds
  buffer_load_dwordx4 v19, s[64:67], s10 offen offset:3264  lds
  s_waitcnt vmcnt(40)
  s_getreg_b32 s28, hwreg(HW_REG_IB_STS)
  s_lshr_b32 s29, s28, 18
  s_and_b32 s28, s28, 15
  s_and_b32 s29, s29, 0x30
  s_add_u32 s28, s28, s29
  s_add_u32 s28, s28, 7
  s_lshr_b32 s28, s28, 3
  s_sub_i32 s5, s4, s28
  v_mov_b32 v28, s5
  ds_write_b32 v29, v28
  s_add_u32 s9, s18, 32768
  s_cmp_ge_i32 s6, s8
  s_cbranch_scc0 Llslow_17
Lok_18:
  s_mov_b32 m0, s7
  s_add_u32 s10, s9, 16384
  buffer_load_dwordx4 v16, s[64:67], s9 offen offset:0  lds
  buffer_load_dwordx4 v17, s[64:67], s9 offen offset:1088  lds
  buffer_load_dwordx4 v18, s[64:67], s9 offen offset:2176  lds
  s_add_u32 s4, s4, 1
  buffer_load_dwordx4 v19, s[64:67], s9 offen offset:3264  lds
  s_add_u32 m0, s7, 4352
  s_add_u32 s7, s7, 8704
  buffer_load_dwordx4 v16, s[64:67], s10 offen offset:0  lds
  s_cmp_lt_u32 s7, 95744
  s_cselect_b32 s7, s7, 0
  buffer_load_dwordx4 v17, s[64:67], s10 offen offset:1088  lds
  s_sub_i32 s8, s4, s23
  buffer_load_dwordx4 v18, s[64:67], s10 offen offset:2176  lds
  buffer_load_dwordx4 v19, s[64:67], s10 offen offset:3264  lds
  s_waitcnt vmcnt(40)
  s_getreg_b32 s28, hwreg(HW_REG_IB_STS)
  s_lshr_b32 s29, s28, 18
  s_and_b32 s28, s28, 15
  s_and_b32 s29, s29, 0x30
  s_add_u32 s28, s28, s29
  s_add_u32 s28, s28, 7
  s_lshr_b32 s28, s28, 3
  s_sub_i32 s5, s4, s28
  v_mov_b32 v28, s5
  ds_write_b32 v29, v28
  s_add_u32 s9, s18, 65536
  s_cmp_ge_i32 s6, s8
  s_cbranch_scc0 Llslow_19
Lok_20:
  s_mov_b32 m0, s7
  s_add_u32 s10, s9, 16384
  buffer_load_dwordx4 v16, s[64:67], s9 offen offset:0  lds
  buffer_load_dwordx4 v17, s[64:67], s9 offen offset:1088  lds
  buffer_load_dwordx4 v18, s[64:67], s9 offen offset:2176  lds
  s_add_u32 s4, s4, 1
  buffer_load_dwordx4 v19, s[64:67], s9 offen offset:3264  lds
  s_add_u32 m0, s7, 4352
  s_add_u32 s7, s7, 8704
  buffer_load_dwordx4 v16, s[64:67], s10 offen offset:0  lds
  s_cmp_lt_u32 s7, 95744
  s_cselect_b32 s7, s7, 0
  buffer_load_dwordx4 v17, s[64:67], s10 offen offset:1088  lds
  s_sub_i32 s8, s4, s23
  buffer_load_dwordx4 v18, s[64:67], s10 offen offset:2176  lds
  buffer_load_dwordx4 v19, s[64:67], s10 offen offset:3264  lds
  s_waitcnt vmcnt(40)
  s_getreg_b32 s28, hwreg(HW_REG_IB_STS)
  s_lshr_b32 s29, s28, 18
  s_and_b32 s28, s28, 15
  s_and_b32 s29, s29, 0x30
  s_add_u32 s28, s28, s29
  s_add_u32 s28, s28, 7
  s_lshr_b32 s28, s28, 3
  s_sub_i32 s5, s4, s28
  v_mov_b32 v28, s5
  ds_write_b32 v29, v28
  s_add_u32 s9, s19, 0
  s_cmp_ge_i32 s6, s8
  s_cbranch_scc0 Llslow_21
Lok_22:
  s_mov_b32 m0, s7
  s_add_u32 s10, s9, 131072
  buffer_load_dwordx4 v20, s[76:79], s9 offen offset:0  lds
  buffer_load_dwordx4 v21, s[76:79], s9 offen offset:1088  lds
  buffer_load_dwordx4 v22, s[76:79], s9 offen offset:2176  lds
  s_add_u32 s4, s4, 1
  buffer_load_dwordx4 v23, s[76:79], s9 offen offset:3264  lds
  s_add_u32 m0, s7, 4352
  s_add_u32 s7, s7, 8704
  buffer_load_dwordx4 v20, s[76:79], s10 offen offset:0  lds
  s_cmp_lt_u32 s7, 95744
  s_cselect_b32 s7, s7, 0
  buffer_load_dwordx4 v21, s[76:79], s10 offen offset:1088  lds
  s_sub_i32 s8, s4, s23
  buffer_load_dwordx4 v22, s[76:79], s10 offen offset:2176  lds
  buffer_load_dwordx4 v23, s[76:79], s10 offen offset:3264  lds
  s_waitcnt vmcnt(40)
  s_getreg_b32 s28, hwreg(HW_REG_IB_STS)
  s_lshr_b32 s29, s28, 18
  s_and_b32 s28, s28, 15
  s_and_b32 s29, s29, 0x30
  s_add_u32 s28, s28, s29
  s_add_u32 s28, s28, 7
  s_lshr_b32 s28, s28, 3
  s_sub_i32 s5, s4, s28
  v_mov_b32 v28, s5
  ds_write_b32 v29, v28
  s_add_u32 s9, s19, 262144
  s_cmp_ge_i32 s6, s8
  s_cbranch_scc0 Llslow_23
Lok_24:
  s_mov_b32 m0, s7
  s_add_u32 s10, s9, 131072
  buffer_load_dwordx4 v20, s[76:79], s9 offen offset:0  lds
  buffer_load_dwordx4 v21, s[76:79], s9 offen offset:1088  lds
  buffer_load_dwordx4 v22, s[76:79], s9 offen offset:2176  lds
  s_add_u32 s4, s4, 1
  buffer_load_dwordx4 v23, s[76:79], s9 offen offset:3264  lds
  s_add_u32 m0, s7, 4352
  s_add_u32 s7, s7, 8704
  buffer_load_dwordx4 v20, s[76:79], s10 offen offset:0  lds
  s_cmp_lt_u32 s7, 95744
  s_cselect_b32 s7, s7, 0
  buffer_load_dwordx4 v21, s[76:79], s10 offen offset:1088  lds
  s_sub_i32 s8, s4, s23
  buffer_load_dwordx4 v22, s[76:79], s10 offen offset:2176  lds
  buffer_load_dwordx4 v23, s[76:79], s10 offen offset:3264  lds
  s_waitcnt vmcnt(40)
  s_getreg_b32 s28, hwreg(HW_REG_IB_STS)
  s_lshr_b32 s29, s28, 18
  s_and_b32 s28, s28, 15
  s_and_b32 s29, s29, 0x30
  s_add_u32 s28, s28, s29
  s_add_u32 s28, s28, 7
  s_lshr_b32 s28, s28, 3
  s_sub_i32 s5, s4, s28
  v_mov_b32 v28, s5
  ds_write_b32 v29, v28
  s_add_u32 s9, s19, 524288
  s_cmp_ge_i32 s6, s8
  s_cbranch_scc0 Llslow_25
Lok_26:
  s_mov_b32 m0, s7
  s_add_u32 s10, s9, 131072
  buffer_load_dwordx4 v20, s[76:79], s9 offen offset:0  lds
  buffer_load_dwordx4 v21, s[76:79], s9 offen offset:1088  lds
  buffer_load_dwordx4 v22, s[76:79], s9 offen offset:2176  lds
  s_add_u32 s4, s4, 1
  buffer_load_dwordx4 v23, s[76:79], s9 offen offset:3264  lds
  s_add_u32 m0, s7, 4352
  s_add_u32 s7, s7, 8704
  buffer_load_dwordx4 v20, s[76:79], s10 offen offset:0  lds
  s_cmp_lt_u32 s7, 95744
  s_cselect_b32 s7, s7, 0
  buffer_load_dwordx4 v21, s[76:79], s10 offen offset:1088  lds
  s_sub_i32 s8, s4, s23
  buffer_load_dwordx4 v22, s[76:79], s10 offen offset:2176  lds
  buffer_load_dwordx4 v23, s[76:79], s10 offen offset:3264  lds
  s_waitcnt vmcnt(40)
  s_getreg_b32 s28, hwreg(HW_REG_IB_STS)
  s_lshr_b32 s29, s28, 18
  s_and_b32 s28, s28, 15
  s_and_b32 s29, s29, 0x30
  s_add_u32 s28, s28, s29
  s_add_u32 s28, s28, 7
  s_lshr_b32 s28, s28, 3
  s_sub_i32 s5, s4, s28
  v_mov_b32 v28, s5
  ds_write_b32 v29, v28
  s_add_u32 s9, s19, 786432
  s_cmp_ge_i32 s6, s8
  s_cbranch_scc0 Llslow_27
Lok_28:
  s_mov_b32 m0, s7
  s_add_u32 s10, s9, 131072
  buffer_load_dwordx4 v20, s[76:79], s9 offen offset:0  lds
  buffer_load_dwordx4 v21, s[76:79], s9 offen offset:1088  lds
  buffer_load_dwordx4 v22, s[76:79], s9 offen offset:2176  lds
  s_add_u32 s4, s4, 1
  buffer_load_dwordx4 v23, s[76:79], s9 offen offset:3264  lds
  s_add_u32 m0, s7, 4352
  s_add_u32 s7, s7, 8704
  buffer_load_dwordx4 v20, s[76:79], s10 offen offset:0  lds
  s_cmp_lt_u32 s7, 95744
  s_cselect_b32 s7, s7, 0
  buffer_load_dwordx4 v21, s[76:79], s10 offen offset:1088  lds
  s_sub_i32 s8, s4, s23
  buffer_load_dwordx4 v22, s[76:79], s10 offen offset:2176  lds
  buffer_load_dwordx4 v23, s[76:79], s10 offen offset:3264  lds
  s_waitcnt vmcnt(40)
  s_getreg_b32 s28, hwreg(HW_REG_IB_STS)
  s_lshr_b32 s29, s28, 18
  s_and_b32 s28, s28, 15
  s_and_b32 s29, s29, 0x30
  s_add_u32 s28, s28, s29
  s_add_u32 s28, s28, 7
  s_lshr_b32 s28, s28, 3
  s_sub_i32 s5, s4, s28
  v_mov_b32 v28, s5
  ds_write_b32 v29, v28
  s_add_u32 s11, s11, 1
  s_cmp_lt_u32 s11, 4
  s_cbranch_scc1 L_ld_qp1
  s_and_b32 s31, s21, 1
  s_cmp_eq_u32 s31, 0
  s_cbranch_scc0 L_ld_y2
  s_mov_b32 s48, s7
  s_mov_b32 s7, 95744
  s_add_u32 s9, s62, 0
  s_and_b32 s9, s9, 0x3ffff
  s_add_u32 s9, s9, s13
  s_mov_b32 m0, s7
  s_add_u32 s10, s9, 4096
  buffer_load_dwordx4 v8, s[68:71], s9 offen offset:0 nt lds
  buffer_load_dwordx4 v9, s[68:71], s9 offen offset:1088 nt lds
  buffer_load_dwordx4 v10, s[68:71], s9 offen offset:2176 nt lds
  s_add_u32 s4, s4, 1
  buffer_load_dwordx4 v11, s[68:71], s9 offen offset:3264 nt lds
  s_add_u32 m0, s7, 4352
  s_add_u32 s7, s7, 8704
  buffer_load_dwordx4 v8, s[68:71], s10 offen offset:0 nt lds
  s_cmp_lt_u32 s7, 156672
  s_cselect_b32 s7, s7, 0
  buffer_load_dwordx4 v9, s[68:71], s10 offen offset:1088 nt lds
  s_sub_i32 s8, s4, s23
  buffer_load_dwordx4 v10, s[68:71], s10 offen offset:2176 nt lds
  buffer_load_dwordx4 v11, s[68:71], s10 offen offset:3264 nt lds
  s_waitcnt vmcnt(40)
  s_getreg_b32 s28, hwreg(HW_REG_IB_STS)
  s_lshr_b32 s29, s28, 18
  s_and_b32 s28, s28, 15
  s_and_b32 s29, s29, 0x30
  s_add_u32 s28, s28, s29
  s_add_u32 s28, s28, 7
  s_lshr_b32 s28, s28, 3
  s_sub_i32 s5, s4, s28
  v_mov_b32 v28, s5
  ds_write_b32 v29, v28
  s_add_u32 s9, s62, 8192
  s_and_b32 s9, s9, 0x3ffff
  s_add_u32 s9, s9, s13
  s_mov_b32 m0, s7
  s_add_u32 s10, s9, 4096
  buffer_load_dwordx4 v8, s[68:71], s9 offen offset:0 nt lds
  buffer_load_dwordx4 v9, s[68:71], s9 offen offset:1088 nt lds
  buffer_load_dwordx4 v10, s[68:71], s9 offen offset:2176 nt lds
  s_add_u32 s4, s4, 1
  buffer_load_dwordx4 v11, s[68:71], s9 offen offset:3264 nt lds
  s_add_u32 m0, s7, 4352
  s_add_u32 s7, s7, 8704
  buffer_load_dwordx4 v8, s[68:71], s10 offen offset:0 nt lds
  s_cmp_lt_u32 s7, 156672
  s_cselect_b32 s7, s7, 0
  buffer_load_dwordx4 v9, s[68:71], s10 offen offset:1088 nt lds
  s_sub_i32 s8, s4, s23
  buffer_load_dwordx4 v10, s[68:71], s10 offen offset:2176 nt lds
  buffer_load_dwordx4 v11, s[68:71], s10 offen offset:3264 nt lds
  s_waitcnt vmcnt(40)
  s_getreg_b32 s28, hwreg(HW_REG_IB_STS)
  s_lshr_b32 s29, s28, 18
  s_and_b32 s28, s28, 15
  s_and_b32 s29, s29, 0x30
  s_add_u32 s28, s28, s29
  s_add_u32 s28, s28, 7
  s_lshr_b32 s28, s28, 3
  s_sub_i32 s5, s4, s28
  v_mov_b32 v28, s5
  ds_write_b32 v29, v28
  s_add_u32 s9, s62, 0
  s_and_b32 s9, s9, 0x3ffff
  s_add_u32 s9, s9, s13
  s_mov_b32 m0, s7
  s_add_u32 s10, s9, 4096
  buffer_load_dwordx4 v12, s[72:75], s9 offen offset:0 nt lds
  buffer_load_dwordx4 v13, s[72:75], s9 offen offset:1088 nt lds
  buffer_load_dwordx4 v14, s[72:75], s9 offen offset:2176 nt lds
  s_add_u32 s4, s4, 1
  buffer_load_dwordx4 v15, s[72:75], s9 offen offset:3264 nt lds
  s_add_u32 m0, s7, 4352
  s_add_u32 s7, s7, 8704
  buffer_load_dwordx4 v12, s[72:75], s10 offen offset:0 nt lds
  s_cmp_lt_u32 s7, 156672
  s_cselect_b32 s7, s7, 0
  buffer_load_dwordx4 v13, s[72:75], s10 offen offset:1088 nt lds
  s_sub_i32 s8, s4, s23
  buffer_load_dwordx4 v14, s[72:75], s10 offen offset:2176 nt lds
  buffer_load_dwordx4 v15, s[72:75], s10 offen offset:3264 nt lds
  s_waitcnt vmcnt(40)
  s_getreg_b32 s28, hwreg(HW_REG_IB_STS)
  s_lshr_b32 s29, s28, 18
  s_and_b32 s28, s28, 15
  s_and_b32 s29, s29, 0x30
  s_add_u32 s28, s28, s29
  s_add_u32 s28, s28, 7
  s_lshr_b32 s28, s28, 3
  s_sub_i32 s5, s4, s28
  v_mov_b32 v28, s5
  ds_write_b32 v29, v28
  s_add_u32 s9, s62, 16384
  s_and_b32 s9, s9, 0x3ffff
  s_add_u32 s9, s9, s13
  s_mov_b32 m0, s7
  s_add_u32 s10, s9, 4096
  buffer_load_dwordx4 v8, s[68:71], s9 offen offset:0 nt lds
  buffer_load_dwordx4 v9, s[68:71], s9 offen offset:1088 nt lds
  buffer_load_dwordx4 v10, s[68:71], s9 offen offset:2176 nt lds
  s_add_u32 s4, s4, 1
  buffer_load_dwordx4 v11, s[68:71], s9 offen offset:3264 nt lds
  s_add_u32 m0, s7, 4352
  s_add_u32 s7, s7, 8704
  buffer_load_dwordx4 v8, s[68:71], s10 offen offset:0 nt lds
  s_cmp_lt_u32 s7, 156672
  s_cselect_b32 s7, s7, 0
  buffer_load_dwordx4 v9, s[68:71], s10 offen offset:1088 nt lds
  s_sub_i32 s8, s4, s23
  buffer_load_dwordx4 v10, s[68:71], s10 offen offset:2176 nt lds
  buffer_load_dwordx4 v11, s[68:71], s10 offen offset:3264 nt lds
  s_waitcnt vmcnt(40)
  s_getreg_b32 s28, hwreg(HW_REG_IB_STS)
  s_lshr_b32 s29, s28, 18
  s_and_b32 s28, s28, 15
  s_and_b32 s29, s29, 0x30
  s_add_u32 s28, s28, s29
  s_add_u32 s28, s28, 7
  s_lshr_b32 s28, s28, 3
  s_sub_i32 s5, s4, s28
  v_mov_b32 v28, s5
  ds_write_b32 v29, v28
  s_add_u32 s9, s62, 8192
  s_and_b32 s9, s9, 0x3ffff
  s_add_u32 s9, s9, s13
  s_mov_b32 m0, s7
  s_add_u32 s10, s9, 4096
  buffer_load_dwordx4 v12, s[72:75], s9 offen offset:0 nt lds
  buffer_load_dwordx4 v13, s[72:75], s9 offen offset:1088 nt lds
  buffer_load_dwordx4 v14, s[72:75], s9 offen offset:2176 nt lds
  s_add_u32 s4, s4, 1
  buffer_load_dwordx4 v15, s[72:75], s9 offen offset:3264 nt lds
  s_add_u32 m0, s7, 4352
  s_add_u32 s7, s7, 8704
  buffer_load_dwordx4 v12, s[72:75], s10 offen offset:0 nt lds
  s_cmp_lt_u32 s7, 156672
  s_cselect_b32 s7, s7, 0
  buffer_load_dwordx4 v13, s[72:75], s10 offen offset:1088 nt lds
  s_sub_i32 s8, s4, s23
  buffer_load_dwordx4 v14, s[72:75], s10 offen offset:2176 nt lds
  buffer_load_dwordx4 v15, s[72:75], s10 offen offset:3264 nt lds
  s_waitcnt vmcnt(40)
  s_getreg_b32 s28, hwreg(HW_REG_IB_STS)
  s_lshr_b32 s29, s28, 18
  s_and_b32 s28, s28, 15
  s_and_b32 s29, s29, 0x30
  s_add_u32 s28, s28, s29
  s_add_u32 s28, s28, 7
  s_lshr_b32 s28, s28, 3
  s_sub_i32 s5, s4, s28
  v_mov_b32 v28, s5
  ds_write_b32 v29, v28
  s_add_u32 s9, s62, 24576
  s_and_b32 s9, s9, 0x3ffff
  s_add_u32 s9, s9, s13
  s_mov_b32 m0, s7
  s_add_u32 s10, s9, 4096
  buffer_load_dwordx4 v8, s[68:71], s9 offen offset:0 nt lds
  buffer_load_dwordx4 v9, s[68:71], s9 offen offset:1088 nt lds
  buffer_load_dwordx4 v10, s[68:71], s9 offen offset:2176 nt lds
  s_add_u32 s4, s4, 1
  buffer_load_dwordx4 v11, s[68:71], s9 offen offset:3264 nt lds
  s_add_u32 m0, s7, 4352
  s_add_u32 s7, s7, 8704
  buffer_load_dwordx4 v8, s[68:71], s10 offen offset:0 nt lds
  s_cmp_lt_u32 s7, 156672
  s_cselect_b32 s7, s7, 0
  buffer_load_dwordx4 v9, s[68:71], s10 offen offset:1088 nt lds
  s_sub_i32 s8, s4, s23
  buffer_load_dwordx4 v10, s[68:71], s10 offen offset:2176 nt lds
  buffer_load_dwordx4 v11, s[68:71], s10 offen offset:3264 nt lds
  s_waitcnt vmcnt(40)
  s_getreg_b32 s28, hwreg(HW_REG_IB_STS)
  s_lshr_b32 s29, s28, 18
  s_and_b32 s28, s28, 15
  s_and_b32 s29, s29, 0x30
  s_add_u32 s28, s28, s29
  s_add_u32 s28, s28, 7
  s_lshr_b32 s28, s28, 3
  s_sub_i32 s5, s4, s28
  v_mov_b32 v28, s5
  ds_write_b32 v29, v28
  s_add_u32 s9, s62, 16384
  s_and_b32 s9, s9, 0x3ffff
  s_add_u32 s9, s9, s13
  s_mov_b32 m0, s7
  s_add_u32 s10, s9, 4096
  buffer_load_dwordx4 v12, s[72:75], s9 offen offset:0 nt lds
  buffer_load_dwordx4 v13, s[72:75], s9 offen offset:1088 nt lds
  buffer_load_dwordx4 v14, s[72:75], s9 offen offset:2176 nt lds
  s_add_u32 s4, s4, 1
  buffer_load_dwordx4 v15, s[72:75], s9 offen offset:3264 nt lds
  s_add_u32 m0, s7, 4352
  s_add_u32 s7, s7, 8704
  buffer_load_dwordx4 v12, s[72:75], s10 offen offset:0 nt lds
  s_cmp_lt_u32 s7, 156672
  s_cselect_b32 s7, s7, 0
  buffer_load_dwordx4 v13, s[72:75], s10 offen offset:1088 nt lds
  s_sub_i32 s8, s4, s23
  buffer_load_dwordx4 v14, s[72:75], s10 offen offset:2176 nt lds
  buffer_load_dwordx4 v15, s[72:75], s10 offen offset:3264 nt lds
  s_waitcnt vmcnt(40)
  s_getreg_b32 s28, hwreg(HW_REG_IB_STS)
  s_lshr_b32 s29, s28, 18
  s_and_b32 s28, s28, 15
  s_and_b32 s29, s29, 0x30
  s_add_u32 s28, s28, s29
  s_add_u32 s28, s28, 7
  s_lshr_b32 s28, s28, 3
  s_sub_i32 s5, s4, s28
  v_mov_b32 v28, s5
  ds_write_b32 v29, v28
  s_mov_b32 s7, s48
L_ld_y2:
  s_mov_b32 s7, 0
  s_mov_b32 s23, 17
  s_mov_b32 s8, 28
  v_mov_b32 v7, 0
  global_load_dwordx2 v[202:203], v7, s[58:59] sc1
  s_mov_b32 s49, 0x55555554
  s_mov_b32 s12, 0
  s_add_u32 s14, s62, 16384
  s_mov_b32 s11, 2
  s_branch L_ld_disp
L_ld_head:
  s_add_u32 s9, s62, 0
  s_and_b32 s9, s9, 0x3ffff
  s_add_u32 s9, s9, s13
  s_cmp_ge_i32 s6, s8
  s_cbranch_scc0 Llslow_29
Lok_30:
  s_mov_b32 m0, s7
  s_add_u32 s10, s9, 4096
  buffer_load_dwordx4 v8, s[68:71], s9 offen offset:0 nt lds
  buffer_load_dwordx4 v9, s[68:71], s9 offen offset:1088 nt lds
  buffer_load_dwordx4 v10, s[68:71], s9 offen offset:2176 nt lds
  s_add_u32 s4, s4, 1
  buffer_load_dwordx4 v11, s[68:71], s9 offen offset:3264 nt lds
  s_add_u32 m0, s7, 4352
  s_add_u32 s7, s7, 8704
  buffer_load_dwordx4 v8, s[68:71], s10 offen offset:0 nt lds
  s_cmp_lt_u32 s7, 156672
  s_cselect_b32 s7, s7, 0
  buffer_load_dwordx4 v9, s[68:71], s10 offen offset:1088 nt lds
  s_sub_i32 s8, s4, s23
  buffer_load_dwordx4 v10, s[68:71], s10 offen offset:2176 nt lds
  buffer_load_dwordx4 v11, s[68:71], s10 offen offset:3264 nt lds
  s_waitcnt vmcnt(40)
  s_getreg_b32 s28, hwreg(HW_REG_IB_STS)
  s_lshr_b32 s29, s28, 18
  s_and_b32 s28, s28, 15
  s_and_b32 s29, s29, 0x30
  s_add_u32 s28, s28, s29
  s_add_u32 s28, s28, 7
  s_lshr_b32 s28, s28, 3
  s_sub_i32 s5, s4, s28
  v_mov_b32 v28, s5
  ds_write_b32 v29, v28
  s_add_u32 s9, s62, 8192
  s_and_b32 s9, s9, 0x3ffff
  s_add_u32 s9, s9, s13
  s_cmp_ge_i32 s6, s8
  s_cbranch_scc0 Llslow_31
Lok_32:
  s_mov_b32 m0, s7
  s_add_u32 s10, s9, 4096
  buffer_load_dwordx4 v8, s[68:71], s9 offen offset:0 nt lds
  buffer_load_dwordx4 v9, s[68:71], s9 offen offset:1088 nt lds
  buffer_load_dwordx4 v10, s[68:71], s9 offen offset:2176 nt lds
  s_add_u32 s4, s4, 1
  buffer_load_dwordx4 v11, s[68:71], s9 offen offset:3264 nt lds
  s_add_u32 m0, s7, 4352
  s_add_u32 s7, s7, 8704
  buffer_load_dwordx4 v8, s[68:71], s10 offen offset:0 nt lds
  s_cmp_lt_u32 s7, 156672
  s_cselect_b32 s7, s7, 0
  buffer_load_dwordx4 v9, s[68:71], s10 offen offset:1088 nt lds
  s_sub_i32 s8, s4, s23
  buffer_load_dwordx4 v10, s[68:71], s10 offen offset:2176 nt lds
  buffer_load_dwordx4 v11, s[68:71], s10 offen offset:3264 nt lds
  s_waitcnt vmcnt(40)
  s_getreg_b32 s28, hwreg(HW_REG_IB_STS)
  s_lshr_b32 s29, s28, 18
  s_and_b32 s28, s28, 15
  s_and_b32 s29, s29, 0x30
  s_add_u32 s28, s28, s29
  s_add_u32 s28, s28, 7
  s_lshr_b32 s28, s28, 3
  s_sub_i32 s5, s4, s28
  v_mov_b32 v28, s5
  ds_write_b32 v29, v28
  s_add_u32 s9, s62, 0
  s_and_b32 s9, s9, 0x3ffff
  s_add_u32 s9, s9, s13
  s_cmp_ge_i32 s6, s8
  s_cbranch_scc0 Llslow_33
Lok_34:
  s_mov_b32 m0, s7
  s_add_u32 s10, s9, 4096
  buffer_load_dwordx4 v12, s[72:75], s9 offen offset:0 nt lds
  buffer_load_dwordx4 v13, s[72:75], s9 offen offset:1088 nt lds
  buffer_load_dwordx4 v14, s[72:75], s9 offen offset:2176 nt lds
  s_add_u32 s4, s4, 1
  buffer_load_dwordx4 v15, s[72:75], s9 offen offset:3264 nt lds
  s_add_u32 m0, s7, 4352
  s_add_u32 s7, s7, 8704
  buffer_load_dwordx4 v12, s[72:75], s10 offen offset:0 nt lds
  s_cmp_lt_u32 s7, 156672
  s_cselect_b32 s7, s7, 0
  buffer_load_dwordx4 v13, s[72:75], s10 offen offset:1088 nt lds
  s_sub_i32 s8, s4, s23
  buffer_load_dwordx4 v14, s[72:75], s10 offen offset:2176 nt lds
  buffer_load_dwordx4 v15, s[72:75], s10 offen offset:3264 nt lds
  s_waitcnt vmcnt(40)
  s_getreg_b32 s28, hwreg(HW_REG_IB_STS)
  s_lshr_b32 s29, s28, 18
  s_and_b32 s28, s28, 15
  s_and_b32 s29, s29, 0x30
  s_add_u32 s28, s28, s29
  s_add_u32 s28, s28, 7
  s_lshr_b32 s28, s28, 3
  s_sub_i32 s5, s4, s28
  v_mov_b32 v28, s5
  ds_write_b32 v29, v28
  s_mov_b32 s14, s62
  s_mov_b32 s11, 0
L_ld_kv:
  s_add_u32 s9, s14, 16384
  s_and_b32 s9, s9, 0x3ffff
  s_add_u32 s9, s9, s13
  s_cmp_ge_i32 s6, s8
  s_cbranch_scc0 Llslow_35
Lok_36:
  s_mov_b32 m0, s7
  s_add_u32 s10, s9, 4096
  buffer_load_dwordx4 v8, s[68:71], s9 offen offset:0 nt lds
  buffer_load_dwordx4 v9, s[68:71], s9 offen offset:1088 nt lds
  buffer_load_dwordx4 v10, s[68:71], s9 offen offset:2176 nt lds
  s_add_u32 s4, s4, 1
  buffer_load_dwordx4 v11, s[68:71], s9 offen offset:3264 nt lds
  s_add_u32 m0, s7, 4352
  s_add_u32 s7, s7, 8704
  buffer_load_dwordx4 v8, s[68:71], s10 offen offset:0 nt lds
  s_cmp_lt_u32 s7, 156672
  s_cselect_b32 s7, s7, 0
  buffer_load_dwordx4 v9, s[68:71], s10 offen offset:1088 nt lds
  s_sub_i32 s8, s4, s23
  buffer_load_dwordx4 v10, s[68:71], s10 offen offset:2176 nt lds
  buffer_load_dwordx4 v11, s[68:71], s10 offen offset:3264 nt lds
  s_waitcnt vmcnt(40)
  s_getreg_b32 s28, hwreg(HW_REG_IB_STS)
  s_lshr_b32 s29, s28, 18
  s_and_b32 s28, s28, 15
  s_and_b32 s29, s29, 0x30
  s_add_u32 s28, s28, s29
  s_add_u32 s28, s28, 7
  s_lshr_b32 s28, s28, 3
  s_sub_i32 s5, s4, s28
  v_mov_b32 v28, s5
  ds_write_b32 v29, v28
  s_add_u32 s9, s14, 8192
  s_and_b32 s9, s9, 0x3ffff
  s_add_u32 s9, s9, s13
  s_cmp_ge_i32 s6, s8
  s_cbranch_scc0 Llslow_37
Lok_38:
  s_mov_b32 m0, s7
  s_add_u32 s10, s9, 4096
  buffer_load_dwordx4 v12, s[72:75], s9 offen offset:0 nt lds
  buffer_load_dwordx4 v13, s[72:75], s9 offen offset:1088 nt lds
  buffer_load_dwordx4 v14, s[72:75], s9 offen offset:2176 nt lds
  s_add_u32 s4, s4, 1
  buffer_load_dwordx4 v15, s[72:75], s9 offen offset:3264 nt lds
  s_add_u32 m0, s7, 4352
  s_add_u32 s7, s7, 8704
  buffer_load_dwordx4 v12, s[72:75], s10 offen offset:0 nt lds
  s_cmp_lt_u32 s7, 156672
  s_cselect_b32 s7, s7, 0
  buffer_load_dwordx4 v13, s[72:75], s10 offen offset:1088 nt lds
  s_sub_i32 s8, s4, s23
  buffer_load_dwordx4 v14, s[72:75], s10 offen offset:2176 nt lds
  buffer_load_dwordx4 v15, s[72:75], s10 offen offset:3264 nt lds
  s_waitcnt vmcnt(40)
  s_getreg_b32 s28, hwreg(HW_REG_IB_STS)
  s_lshr_b32 s29, s28, 18
  s_and_b32 s28, s28, 15
  s_and_b32 s29, s29, 0x30
  s_add_u32 s28, s28, s29
  s_add_u32 s28, s28, 7
  s_lshr_b32 s28, s28, 3
  s_sub_i32 s5, s4, s28
  v_mov_b32 v28, s5
  ds_write_b32 v29, v28
  s_add_u32 s14, s14, 8192
  s_add_u32 s11, s11, 1
  s_bitcmp1_b32 s49, s11
  s_cbranch_scc1 L_ld_disp
L_ld_evret:
  s_cmp_lt_u32 s11, 30
  s_cbranch_scc1 L_ld_kv
  s_add_u32 s9, s14, 8192
  s_and_b32 s9, s9, 0x3ffff
  s_add_u32 s9, s9, s13
  s_cmp_ge_i32 s6, s8
  s_cbranch_scc0 Llslow_39
Lok_40:
  s_mov_b32 m0, s7
  s_add_u32 s10, s9, 4096
  buffer_load_dwordx4 v12, s[72:75], s9 offen offset:0 nt lds
  buffer_load_dwordx4 v13, s[72:75], s9 offen offset:1088 nt lds
  buffer_load_dwordx4 v14, s[72:75], s9 offen offset:2176 nt lds
  s_add_u32 s4, s4, 1
  buffer_load_dwordx4 v15, s[72:75], s9 offen offset:3264 nt lds
  s_add_u32 m0, s7, 4352
  s_add_u32 s7, s7, 8704
  buffer_load_dwordx4 v12, s[72:75], s10 offen offset:0 nt lds
  s_cmp_lt_u32 s7, 156672
  s_cselect_b32 s7, s7, 0
  buffer_load_dwordx4 v13, s[72:75], s10 offen offset:1088 nt lds
  s_sub_i32 s8, s4, s23
  buffer_load_dwordx4 v14, s[72:75], s10 offen offset:2176 nt lds
  buffer_load_dwordx4 v15, s[72:75], s10 offen offset:3264 nt lds
  s_waitcnt vmcnt(40)
  s_getreg_b32 s28, hwreg(HW_REG_IB_STS)
  s_lshr_b32 s29, s28, 18
  s_and_b32 s28, s28, 15
  s_and_b32 s29, s29, 0x30
  s_add_u32 s28, s28, s29
  s_add_u32 s28, s28, 7
  s_lshr_b32 s28, s28, 3
  s_sub_i32 s5, s4, s28
  v_mov_b32 v28, s5
  ds_write_b32 v29, v28
  s_cmp_eq_u32 s12, 0
  s_cbranch_scc0 L_ld_tail
  s_add_u32 s13, s13, 33554432
  s_sub_u32 s64, s60, 4096
  s_subb_u32 s65, s61, 0
  s_mov_b32 s66, 0x2001000
  s_mov_b32 s67, 0x20000
  v_readfirstlane_b32 s34, v202
  v_readfirstlane_b32 s35, v203
  s_nop 3
  s_cmp_lg_u32 s34, 0
  s_cbranch_scc1 Llnok_41
Llnlp_42:
  v_mov_b32 v7, 0
  global_load_dwordx2 v[202:203], v7, s[58:59] sc1
  s_waitcnt vmcnt(0)
  v_readfirstlane_b32 s34, v202
  v_readfirstlane_b32 s35, v203
  s_sub_u32 s26, s26, 1
  s_cmp_eq_u32 s26, 0
  s_cbranch_scc1 L_end
  s_cmp_eq_u32 s34, 0
  s_cbranch_scc1 Llnlp_42
Llnok_41:
  s_mov_b32 s12, 1
  s_branch L_ld_head
L_ld_tail:
  s_mov_b32 s18, 0
L_ld_wo_r:
  s_add_u32 s29, s21, s18
  s_and_b32 s29, s29, 3
  s_lshl_b32 s29, s29, 17
  s_lshl_b32 s19, s20, 19
  s_add_u32 s19, s19, s29
  s_lshl_b32 s29, s21, 8
  s_add_u32 s19, s19, s29
  s_add_u32 s9, s19, 0
  s_cmp_ge_i32 s6, s8
  s_cbranch_scc0 Llslow_43
Lok_44:
  s_mov_b32 m0, s7
  s_add_u32 s10, s9, 16384
  buffer_load_dwordx4 v24, s[80:83], s9 offen offset:0 nt lds
  buffer_load_dwordx4 v25, s[80:83], s9 offen offset:1088 nt lds
  buffer_load_dwordx4 v26, s[80:83], s9 offen offset:2176 nt lds
  s_add_u32 s4, s4, 1
  buffer_load_dwordx4 v27, s[80:83], s9 offen offset:3264 nt lds
  s_add_u32 m0, s7, 4352
  s_add_u32 s7, s7, 8704
  buffer_load_dwordx4 v24, s[80:83], s10 offen offset:0 nt lds
  s_cmp_lt_u32 s7, 156672
  s_cselect_b32 s7, s7, 0
  buffer_load_dwordx4 v25, s[80:83], s10 offen offset:1088 nt lds
  s_sub_i32 s8, s4, s23
  buffer_load_dwordx4 v26, s[80:83], s10 offen offset:2176 nt lds
  buffer_load_dwordx4 v27, s[80:83], s10 offen offset:3264 nt lds
  s_waitcnt vmcnt(40)
  s_getreg_b32 s28, hwreg(HW_REG_IB_STS)
  s_lshr_b32 s29, s28, 18
  s_and_b32 s28, s28, 15
  s_and_b32 s29, s29, 0x30
  s_add_u32 s28, s28, s29
  s_add_u32 s28, s28, 7
  s_lshr_b32 s28, s28, 3
  s_sub_i32 s5, s4, s28
  v_mov_b32 v28, s5
  ds_write_b32 v29, v28
  s_add_u32 s9, s19, 32768
  s_cmp_ge_i32 s6, s8
  s_cbranch_scc0 Llslow_45
Lok_46:
  s_mov_b32 m0, s7
  s_add_u32 s10, s9, 16384
  buffer_load_dwordx4 v24, s[80:83], s9 offen offset:0 nt lds
  buffer_load_dwordx4 v25, s[80:83], s9 offen offset:1088 nt lds
  buffer_load_dwordx4 v26, s[80:83], s9 offen offset:2176 nt lds
  s_add_u32 s4, s4, 1
  buffer_load_dwordx4 v27, s[80:83], s9 offen offset:3264 nt lds
  s_add_u32 m0, s7, 4352
  s_add_u32 s7, s7, 8704
  buffer_load_dwordx4 v24, s[80:83], s10 offen offset:0 nt lds
  s_cmp_lt_u32 s7, 156672
  s_cselect_b32 s7, s7, 0
  buffer_load_dwordx4 v25, s[80:83], s10 offen offset:1088 nt lds
  s_sub_i32 s8, s4, s23
  buffer_load_dwordx4 v26, s[80:83], s10 offen offset:2176 nt lds
  buffer_load_dwordx4 v27, s[80:83], s10 offen offset:3264 nt lds
  s_waitcnt vmcnt(40)
  s_getreg_b32 s28, hwreg(HW_REG_IB_STS)
  s_lshr_b32 s29, s28, 18
  s_and_b32 s28, s28, 15
  s_and_b32 s29, s29, 0x30
  s_add_u32 s28, s28, s29
  s_add_u32 s28, s28, 7
  s_lshr_b32 s28, s28, 3
  s_sub_i32 s5, s4, s28
  v_mov_b32 v28, s5
  ds_write_b32 v29, v28
  s_add_u32 s9, s19, 65536
  s_cmp_ge_i32 s6, s8
  s_cbranch_scc0 Llslow_47
Lok_48:
  s_mov_b32 m0, s7
  s_add_u32 s10, s9, 16384
  buffer_load_dwordx4 v24, s[80:83], s9 offen offset:0 nt lds
  buffer_load_dwordx4 v25, s[80:83], s9 offen offset:1088 nt lds
  buffer_load_dwordx4 v26, s[80:83], s9 offen offset:2176 nt lds
  s_add_u32 s4, s4, 1
  buffer_load_dwordx4 v27, s[80:83], s9 offen offset:3264 nt lds
  s_add_u32 m0, s7, 4352
  s_add_u32 s7, s7, 8704
  buffer_load_dwordx4 v24, s[80:83], s10 offen offset:0 nt lds
  s_cmp_lt_u32 s7, 156672
  s_cselect_b32 s7, s7, 0
  buffer_load_dwordx4 v25, s[80:83], s10 offen offset:1088 nt lds
  s_sub_i32 s8, s4, s23
  buffer_load_dwordx4 v26, s[80:83], s10 offen offset:2176 nt lds
  buffer_load_dwordx4 v27, s[80:83], s10 offen offset:3264 nt lds
  s_waitcnt vmcnt(40)
  s_getreg_b32 s28, hwreg(HW_REG_IB_STS)
  s_lshr_b32 s29, s28, 18
  s_and_b32 s28, s28, 15
  s_and_b32 s29, s29, 0x30
  s_add_u32 s28, s28, s29
  s_add_u32 s28, s28, 7
  s_lshr_b32 s28, s28, 3
  s_sub_i32 s5, s4, s28
  v_mov_b32 v28, s5
  ds_write_b32 v29, v28
  s_add_u32 s9, s19, 98304
  s_cmp_ge_i32 s6, s8
  s_cbranch_scc0 Llslow_49
Lok_50:
  s_mov_b32 m0, s7
  s_add_u32 s10, s9, 16384
  buffer_load_dwordx4 v24, s[80:83], s9 offen offset:0 nt lds
  buffer_load_dwordx4 v25, s[80:83], s9 offen offset:1088 nt lds
  buffer_load_dwordx4 v26, s[80:83], s9 offen offset:2176 nt lds
  s_add_u32 s4, s4, 1
  buffer_load_dwordx4 v27, s[80:83], s9 offen offset:3264 nt lds
  s_add_u32 m0, s7, 4352
  s_add_u32 s7, s7, 8704
  buffer_load_dwordx4 v24, s[80:83], s10 offen offset:0 nt lds
  s_cmp_lt_u32 s7, 156672
  s_cselect_b32 s7, s7, 0
  buffer_load_dwordx4 v25, s[80:83], s10 offen offset:1088 nt lds
  s_sub_i32 s8, s4, s23
  buffer_load_dwordx4 v26, s[80:83], s10 offen offset:2176 nt lds
  buffer_load_dwordx4 v27, s[80:83], s10 offen offset:3264 nt lds
  s_waitcnt vmcnt(40)
  s_getreg_b32 s28, hwreg(HW_REG_IB_STS)
  s_lshr_b32 s29, s28, 18
  s_and_b32 s28, s28, 15
  s_and_b32 s29, s29, 0x30
  s_add_u32 s28, s28, s29
  s_add_u32 s28, s28, 7
  s_lshr_b32 s28, s28, 3
  s_sub_i32 s5, s4, s28
  v_mov_b32 v28, s5
  ds_write_b32 v29, v28
  s_add_u32 s18, s18, 1
  s_cmp_lt_u32 s18, 4
  s_cbranch_scc1 L_ld_wo_r
L_ld_drain:
  s_getreg_b32 s28, hwreg(HW_REG_IB_STS)
  s_lshr_b32 s29, s28, 18
  s_and_b32 s28, s28, 15
  s_and_b32 s29, s29, 0x30
  s_add_u32 s28, s28, s29
  s_add_u32 s28, s28, 7
  s_lshr_b32 s28, s28, 3
  s_sub_i32 s5, s4, s28
  v_mov_b32 v28, s5
  ds_write_b32 v29, v28
  s_cmp_lt_i32 s5, s4
  s_cbranch_scc1 L_ld_drain
  s_waitcnt lgkmcnt(0)
  s_branch L_fin
L_ld_disp:
  s_lshr_b32 s53, s11, 1
  s_sub_u32 s53, s53, 1
  s_lshr_b32 s52, s53, 2
  s_and_b32 s54, s53, 3
  s_cmp_eq_u32 s12, 0
  s_cbranch_scc0 L_ld_x2
  s_cmp_eq_u32 s54, 0
  s_cbranch_scc0 L_ld_w1
  s_add_u32 s29, s15, s52
  s_and_b32 s29, s29, 3
  s_lshl_b32 s30, s29, 8
  s_mul_i32 s18, s46, 98304
  s_add_u32 s18, s18, s30
  s_add_u32 s18, s18, 393216
  s_lshl_b32 s30, s29, 20
  s_lshl_b32 s19, s25, 8
  s_add_u32 s19, s19, s30
  s_add_u32 s9, s18, 0
  s_cmp_ge_i32 s6, s8
  s_cbranch_scc0 Llslow_51
Lok_52:
  s_mov_b32 m0, s7
  s_add_u32 s10, s9, 16384
  buffer_load_dwordx4 v16, s[64:67], s9 offen offset:0  lds
  buffer_load_dwordx4 v17, s[64:67], s9 offen offset:1088  lds
  buffer_load_dwordx4 v18, s[64:67], s9 offen offset:2176  lds
  s_add_u32 s4, s4, 1
  buffer_load_dwordx4 v19, s[64:67], s9 offen offset:3264  lds
  s_add_u32 m0, s7, 4352
  s_add_u32 s7, s7, 8704
  buffer_load_dwordx4 v16, s[64:67], s10 offen offset:0  lds
  s_cmp_lt_u32 s7, 156672
  s_cselect_b32 s7, s7, 0
  buffer_load_dwordx4 v17, s[64:67], s10 offen offset:1088  lds
  s_sub_i32 s8, s4, s23
  buffer_load_dwordx4 v18, s[64:67], s10 offen offset:2176  lds
  buffer_load_dwordx4 v19, s[64:67], s10 offen offset:3264  lds
  s_waitcnt vmcnt(40)
  s_getreg_b32 s28, hwreg(HW_REG_IB_STS)
  s_lshr_b32 s29, s28, 18
  s_and_b32 s28, s28, 15
  s_and_b32 s29, s29, 0x30
  s_add_u32 s28, s28, s29
  s_add_u32 s28, s28, 7
  s_lshr_b32 s28, s28, 3
  s_sub_i32 s5, s4, s28
  v_mov_b32 v28, s5
  ds_write_b32 v29, v28
  s_add_u32 s9, s18, 32768
  s_cmp_ge_i32 s6, s8
  s_cbranch_scc0 Llslow_53
Lok_54:
  s_mov_b32 m0, s7
  s_add_u32 s10, s9, 16384
  buffer_load_dwordx4 v16, s[64:67], s9 offen offset:0  lds
  buffer_load_dwordx4 v17, s[64:67], s9 offen offset:1088  lds
  buffer_load_dwordx4 v18, s[64:67], s9 offen offset:2176  lds
  s_add_u32 s4, s4, 1
  buffer_load_dwordx4 v19, s[64:67], s9 offen offset:3264  lds
  s_add_u32 m0, s7, 4352
  s_add_u32 s7, s7, 8704
  buffer_load_dwordx4 v16, s[64:67], s10 offen offset:0  lds
  s_cmp_lt_u32 s7, 156672
  s_cselect_b32 s7, s7, 0
  buffer_load_dwordx4 v17, s[64:67], s10 offen offset:1088  lds
  s_sub_i32 s8, s4, s23
  buffer_load_dwordx4 v18, s[64:67], s10 offen offset:2176  lds
  buffer_load_dwordx4 v19, s[64:67], s10 offen offset:3264  lds
  s_waitcnt vmcnt(40)
  s_getreg_b32 s28, hwreg(HW_REG_IB_STS)
  s_lshr_b32 s29, s28, 18
  s_and_b32 s28, s28, 15
  s_and_b32 s29, s29, 0x30
  s_add_u32 s28, s28, s29
  s_add_u32 s28, s28, 7
  s_lshr_b32 s28, s28, 3
  s_sub_i32 s5, s4, s28
  v_mov_b32 v28, s5
  ds_write_b32 v29, v28
  s_add_u32 s9, s18, 65536
  s_cmp_ge_i32 s6, s8
  s_cbranch_scc0 Llslow_55
Lok_56:
  s_mov_b32 m0, s7
  s_add_u32 s10, s9, 16384
  buffer_load_dwordx4 v16, s[64:67], s9 offen offset:0  lds
  buffer_load_dwordx4 v17, s[64:67], s9 offen offset:1088  lds
  buffer_load_dwordx4 v18, s[64:67], s9 offen offset:2176  lds
  s_add_u32 s4, s4, 1
  buffer_load_dwordx4 v19, s[64:67], s9 offen offset:3264  lds
  s_add_u32 m0, s7, 4352
  s_add_u32 s7, s7, 8704
  buffer_load_dwordx4 v16, s[64:67], s10 offen offset:0  lds
  s_cmp_lt_u32 s7, 156672
  s_cselect_b32 s7, s7, 0
  buffer_load_dwordx4 v17, s[64:67], s10 offen offset:1088  lds
  s_sub_i32 s8, s4, s23
  buffer_load_dwordx4 v18, s[64:67], s10 offen offset:2176  lds
  buffer_load_dwordx4 v19, s[64:67], s10 offen offset:3264  lds
  s_waitcnt vmcnt(40)
  s_getreg_b32 s28, hwreg(HW_REG_IB_STS)
  s_lshr_b32 s29, s28, 18
  s_and_b32 s28, s28, 15
  s_and_b32 s29, s29, 0x30
  s_add_u32 s28, s28, s29
  s_add_u32 s28, s28, 7
  s_lshr_b32 s28, s28, 3
  s_sub_i32 s5, s4, s28
  v_mov_b32 v28, s5
  ds_write_b32 v29, v28
L_ld_w1:
  s_lshl_b32 s9, s54, 18
  s_add_u32 s9, s9, s19
  s_cmp_ge_i32 s6, s8
  s_cbranch_scc0 Llslow_57
Lok_58:
  s_mov_b32 m0, s7
  s_add_u32 s10, s9, 131072
  buffer_load_dwordx4 v20, s[76:79], s9 offen offset:0  lds
  buffer_load_dwordx4 v21, s[76:79], s9 offen offset:1088  lds
  buffer_load_dwordx4 v22, s[76:79], s9 offen offset:2176  lds
  s_add_u32 s4, s4, 1
  buffer_load_dwordx4 v23, s[76:79], s9 offen offset:3264  lds
  s_add_u32 m0, s7, 4352
  s_add_u32 s7, s7, 8704
  buffer_load_dwordx4 v20, s[76:79], s10 offen offset:0  lds
  s_cmp_lt_u32 s7, 156672
  s_cselect_b32 s7, s7, 0
  buffer_load_dwordx4 v21, s[76:79], s10 offen offset:1088  lds
  s_sub_i32 s8, s4, s23
  buffer_load_dwordx4 v22, s[76:79], s10 offen offset:2176  lds
  buffer_load_dwordx4 v23, s[76:79], s10 offen offset:3264  lds
  s_waitcnt vmcnt(40)
  s_getreg_b32 s28, hwreg(HW_REG_IB_STS)
  s_lshr_b32 s29, s28, 18
  s_and_b32 s28, s28, 15
  s_and_b32 s29, s29, 0x30
  s_add_u32 s28, s28, s29
  s_add_u32 s28, s28, 7
  s_lshr_b32 s28, s28, 3
  s_sub_i32 s5, s4, s28
  v_mov_b32 v28, s5
  ds_write_b32 v29, v28
  s_cmp_eq_u32 s53, 14
  s_cbranch_scc0 L_ld_evret
  s_add_u32 s9, s19, 786432
  s_cmp_ge_i32 s6, s8
  s_cbranch_scc0 Llslow_59
Lok_60:
  s_mov_b32 m0, s7
  s_add_u32 s10, s9, 131072
  buffer_load_dwordx4 v20, s[76:79], s9 offen offset:0  lds
  buffer_load_dwordx4 v21, s[76:79], s9 offen offset:1088  lds
  buffer_load_dwordx4 v22, s[76:79], s9 offen offset:2176  lds
  s_add_u32 s4, s4, 1
  buffer_load_dwordx4 v23, s[76:79], s9 offen offset:3264  lds
  s_add_u32 m0, s7, 4352
  s_add_u32 s7, s7, 8704
  buffer_load_dwordx4 v20, s[76:79], s10 offen offset:0  lds
  s_cmp_lt_u32 s7, 156672
  s_cselect_b32 s7, s7, 0
  buffer_load_dwordx4 v21, s[76:79], s10 offen offset:1088  lds
  s_sub_i32 s8, s4, s23
  buffer_load_dwordx4 v22, s[76:79], s10 offen offset:2176  lds
  buffer_load_dwordx4 v23, s[76:79], s10 offen offset:3264  lds
  s_waitcnt vmcnt(40)
  s_getreg_b32 s28, hwreg(HW_REG_IB_STS)
  s_lshr_b32 s29, s28, 18
  s_and_b32 s28, s28, 15
  s_and_b32 s29, s29, 0x30
  s_add_u32 s28, s28, s29
  s_add_u32 s28, s28, 7
  s_lshr_b32 s28, s28, 3
  s_sub_i32 s5, s4, s28
  v_mov_b32 v28, s5
  ds_write_b32 v29, v28
  s_branch L_ld_evret
L_ld_x2:
  s_cmp_eq_u32 s54, 2
  s_cbranch_scc0 Lskp_61
  s_lshl_b32 s29, s24, 9
  buffer_load_dwordx2 v[200:201], v204, s[64:67], s29 offen sc1
Lskp_61:
  s_cmp_eq_u32 s54, 0
  s_cbranch_scc0 L_ld_w2
  s_brev_b32 s30, s52
  s_lshr_b32 s30, s30, 30
  s_add_u32 s30, s21, s30
  s_and_b32 s30, s30, 3
  s_mov_b32 s55, s30
  s_lshl_b32 s29, s30, 17
  s_lshl_b32 s19, s20, 19
  s_add_u32 s19, s19, s29
  s_lshl_b32 s29, s21, 8
  s_add_u32 s19, s19, s29
  s_lshl_b32 s31, s24, 2
  s_add_u32 s30, s30, s31
  s_mul_i32 s30, s30, 24576
  s_add_u32 s18, s30, 1048576
  s_cmp_eq_u32 s52, 0
  s_cbranch_scc1 L_ld_w2
  v_cmp_ne_u32 vcc, s34, v200
  v_cmp_ne_u32 s[28:29], s35, v201
  s_nop 3
  s_or_b64 vcc, vcc, s[28:29]
  s_lshl_b32 s28, 0x111, s55
  s_and_b32 s28, s28, vcc_lo
  s_cbranch_scc0 Llfok_62
Llfl_63:
  s_lshl_b32 s29, s24, 9
  buffer_load_dwordx2 v[200:201], v204, s[64:67], s29 offen sc1
  s_waitcnt vmcnt(0)
  s_sub_u32 s26, s26, 1
  s_cmp_eq_u32 s26, 0
  s_cbranch_scc1 L_end
  v_cmp_ne_u32 vcc, s34, v200
  v_cmp_ne_u32 s[28:29], s35, v201
  s_nop 3
  s_or_b64 vcc, vcc, s[28:29]
  s_lshl_b32 s28, 0x111, s55
  s_and_b32 s28, s28, vcc_lo
  s_cbranch_scc0 Llfok_62
  s_branch Llfl_63
Llfok_62:
  s_add_u32 s9, s18, 0
  s_cmp_ge_i32 s6, s8
  s_cbranch_scc0 Llslow_64
Lok_65:
  s_mov_b32 m0, s7
  s_add_u32 s10, s9, 4096
  buffer_load_dwordx4 v36, s[64:67], s9 offen offset:0 sc1 lds
  buffer_load_dwordx4 v37, s[64:67], s9 offen offset:1088 sc1 lds
  buffer_load_dwordx4 v38, s[64:67], s9 offen offset:2176 sc1 lds
  s_add_u32 s4, s4, 1
  buffer_load_dwordx4 v39, s[64:67], s9 offen offset:3264 sc1 lds
  s_add_u32 m0, s7, 4352
  s_add_u32 s7, s7, 8704
  buffer_load_dwordx4 v36, s[64:67], s10 offen offset:0 sc1 lds
  s_cmp_lt_u32 s7, 156672
  s_cselect_b32 s7, s7, 0
  buffer_load_dwordx4 v37, s[64:67], s10 offen offset:1088 sc1 lds
  s_sub_i32 s8, s4, s23
  buffer_load_dwordx4 v38, s[64:67], s10 offen offset:2176 sc1 lds
  buffer_load_dwordx4 v39, s[64:67], s10 offen offset:3264 sc1 lds
  s_waitcnt vmcnt(40)
  s_getreg_b32 s28, hwreg(HW_REG_IB_STS)
  s_lshr_b32 s29, s28, 18
  s_and_b32 s28, s28, 15
  s_and_b32 s29, s29, 0x30
  s_add_u32 s28, s28, s29
  s_add_u32 s28, s28, 7
  s_lshr_b32 s28, s28, 3
  s_sub_i32 s5, s4, s28
  v_mov_b32 v28, s5
  ds_write_b32 v29, v28
  s_add_u32 s9, s18, 8192
  s_cmp_ge_i32 s6, s8
  s_cbranch_scc0 Llslow_66
Lok_67:
  s_mov_b32 m0, s7
  s_add_u32 s10, s9, 4096
  buffer_load_dwordx4 v36, s[64:67], s9 offen offset:0 sc1 lds
  buffer_load_dwordx4 v37, s[64:67], s9 offen offset:1088 sc1 lds
  buffer_load_dwordx4 v38, s[64:67], s9 offen offset:2176 sc1 lds
  s_add_u32 s4, s4, 1
  buffer_load_dwordx4 v39, s[64:67], s9 offen offset:3264 sc1 lds
  s_add_u32 m0, s7, 4352
  s_add_u32 s7, s7, 8704
  buffer_load_dwordx4 v36, s[64:67], s10 offen offset:0 sc1 lds
  s_cmp_lt_u32 s7, 156672
  s_cselect_b32 s7, s7, 0
  buffer_load_dwordx4 v37, s[64:67], s10 offen offset:1088 sc1 lds
  s_sub_i32 s8, s4, s23
  buffer_load_dwordx4 v38, s[64:67], s10 offen offset:2176 sc1 lds
  buffer_load_dwordx4 v39, s[64:67], s10 offen offset:3264 sc1 lds
  s_waitcnt vmcnt(40)
  s_getreg_b32 s28, hwreg(HW_REG_IB_STS)
  s_lshr_b32 s29, s28, 18
  s_and_b32 s28, s28, 15
  s_and_b32 s29, s29, 0x30
  s_add_u32 s28, s28, s29
  s_add_u32 s28, s28, 7
  s_lshr_b32 s28, s28, 3
  s_sub_i32 s5, s4, s28
  v_mov_b32 v28, s5
  ds_write_b32 v29, v28
  s_add_u32 s9, s18, 16384
  s_cmp_ge_i32 s6, s8
  s_cbranch_scc0 Llslow_68
Lok_69:
  s_mov_b32 m0, s7
  s_add_u32 s10, s9, 4096
  buffer_load_dwordx4 v36, s[64:67], s9 offen offset:0 sc1 lds
  buffer_load_dwordx4 v37, s[64:67], s9 offen offset:1088 sc1 lds
  buffer_load_dwordx4 v38, s[64:67], s9 offen offset:2176 sc1 lds
  s_add_u32 s4, s4, 1
  buffer_load_dwordx4 v39, s[64:67], s9 offen offset:3264 sc1 lds
  s_add_u32 m0, s7, 4352
  s_add_u32 s7, s7, 8704
  buffer_load_dwordx4 v36, s[64:67], s10 offen offset:0 sc1 lds
  s_cmp_lt_u32 s7, 156672
  s_cselect_b32 s7, s7, 0
  buffer_load_dwordx4 v37, s[64:67], s10 offen offset:1088 sc1 lds
  s_sub_i32 s8, s4, s23
  buffer_load_dwordx4 v38, s[64:67], s10 offen offset:2176 sc1 lds
  buffer_load_dwordx4 v39, s[64:67], s10 offen offset:3264 sc1 lds
  s_waitcnt vmcnt(40)
  s_getreg_b32 s28, hwreg(HW_REG_IB_STS)
  s_lshr_b32 s29, s28, 18
  s_and_b32 s28, s28, 15
  s_and_b32 s29, s29, 0x30
  s_add_u32 s28, s28, s29
  s_add_u32 s28, s28, 7
  s_lshr_b32 s28, s28, 3
  s_sub_i32 s5, s4, s28
  v_mov_b32 v28, s5
  ds_write_b32 v29, v28
L_ld_w2:
  s_lshl_b32 s9, s54, 15
  s_add_u32 s9, s9, s19
  s_cmp_ge_i32 s6, s8
  s_cbranch_scc0 Llslow_70
Lok_71:
  s_mov_b32 m0, s7
  s_add_u32 s10, s9, 16384
  buffer_load_dwordx4 v24, s[80:83], s9 offen offset:0 nt lds
  buffer_load_dwordx4 v25, s[80:83], s9 offen offset:1088 nt lds
  buffer_load_dwordx4 v26, s[80:83], s9 offen offset:2176 nt lds
  s_add_u32 s4, s4, 1
  buffer_load_dwordx4 v27, s[80:83], s9 offen offset:3264 nt lds
  s_add_u32 m0, s7, 4352
  s_add_u32 s7, s7, 8704
  buffer_load_dwordx4 v24, s[80:83], s10 offen offset:0 nt lds
  s_cmp_lt_u32 s7, 156672
  s_cselect_b32 s7, s7, 0
  buffer_load_dwordx4 v25, s[80:83], s10 offen offset:1088 nt lds
  s_sub_i32 s8, s4, s23
  buffer_load_dwordx4 v26, s[80:83], s10 offen offset:2176 nt lds
  buffer_load_dwordx4 v27, s[80:83], s10 offen offset:3264 nt lds
  s_waitcnt vmcnt(40)
  s_getreg_b32 s28, hwreg(HW_REG_IB_STS)
  s_lshr_b32 s29, s28, 18
  s_and_b32 s28, s28, 15
  s_and_b32 s29, s29, 0x30
  s_add_u32 s28, s28, s29
  s_add_u32 s28, s28, 7
  s_lshr_b32 s28, s28, 3
  s_sub_i32 s5, s4, s28
  v_mov_b32 v28, s5
  ds_write_b32 v29, v28
  s_cmp_eq_u32 s53, 14
  s_cbranch_scc0 L_ld_evret
  s_add_u32 s9, s19, 98304
  s_cmp_ge_i32 s6, s8
  s_cbranch_scc0 Llslow_72
Lok_73:
  s_mov_b32 m0, s7
  s_add_u32 s10, s9, 16384
  buffer_load_dwordx4 v24, s[80:83], s9 offen offset:0 nt lds
  buffer_load_dwordx4 v25, s[80:83], s9 offen offset:1088 nt lds
  buffer_load_dwordx4 v26, s[80:83], s9 offen offset:2176 nt lds
  s_add_u32 s4, s4, 1
  buffer_load_dwordx4 v27, s[80:83], s9 offen offset:3264 nt lds
  s_add_u32 m0, s7, 4352
  s_add_u32 s7, s7, 8704
  buffer_load_dwordx4 v24, s[80:83], s10 offen offset:0 nt lds
  s_cmp_lt_u32 s7, 156672
  s_cselect_b32 s7, s7, 0
  buffer_load_dwordx4 v25, s[80:83], s10 offen offset:1088 nt lds
  s_sub_i32 s8, s4, s23
  buffer_load_dwordx4 v26, s[80:83], s10 offen offset:2176 nt lds
  buffer_load_dwordx4 v27, s[80:83], s10 offen offset:3264 nt lds
  s_waitcnt vmcnt(40)
  s_getreg_b32 s28, hwreg(HW_REG_IB_STS)
  s_lshr_b32 s29, s28, 18
  s_and_b32 s28, s28, 15
  s_and_b32 s29, s29, 0x30
  s_add_u32 s28, s28, s29
  s_add_u32 s28, s28, 7
  s_lshr_b32 s28, s28, 3
  s_sub_i32 s5, s4, s28
  v_mov_b32 v28, s5
  ds_write_b32 v29, v28
  s_branch L_ld_evret
Llslow_1:
  s_call_b64 s[32:33], L_waitfree
  s_branch Lok_2
Llslow_3:
  s_call_b64 s[32:33], L_waitfree
  s_branch Lok_4
Llslow_5:
  s_call_b64 s[32:33], L_waitfree
  s_branch Lok_6
Llslow_7:
  s_call_b64 s[32:33], L_waitfree
  s_branch Lok_8
Llslow_9:
  s_call_b64 s[32:33], L_waitfree
  s_branch Lok_10
Llslow_11:
  s_call_b64 s[32:33], L_waitfree
  s_branch Lok_12
Llslow_13:
  s_call_b64 s[32:33], L_waitfree
  s_branch Lok_14
Llslow_15:
  s_call_b64 s[32:33], L_waitfree
  s_branch Lok_16
Llslow_17:
  s_call_b64 s[32:33], L_waitfree
  s_branch Lok_18
Llslow_19:
  s_call_b64 s[32:33], L_waitfree
  s_branch Lok_20
Llslow_21:
  s_call_b64 s[32:33], L_waitfree
  s_branch Lok_22
Llslow_23:
  s_call_b64 s[32:33], L_waitfree
  s_branch Lok_24
Llslow_25:
  s_call_b64 s[32:33], L_waitfree
  s_branch Lok_26
Llslow_27:
  s_call_b64 s[32:33], L_waitfree
  s_branch Lok_28
Llslow_29:
  s_call_b64 s[32:33], L_waitfree
  s_branch Lok_30
Llslow_31:
  s_call_b64 s[32:33], L_waitfree
  s_branch Lok_32
Llslow_33:
  s_call_b64 s[32:33], L_waitfree
  s_branch Lok_34
Llslow_35:
  s_call_b64 s[32:33], L_waitfree
  s_branch Lok_36
Llslow_37:
  s_call_b64 s[32:33], L_waitfree
  s_branch Lok_38
Llslow_39:
  s_call_b64 s[32:33], L_waitfree
  s_branch Lok_40
Llslow_43:
  s_call_b64 s[32:33], L_waitfree
  s_branch Lok_44
Llslow_45:
  s_call_b64 s[32:33], L_waitfree
  s_branch Lok_46
Llslow_47:
  s_call_b64 s[32:33], L_waitfree
  s_branch Lok_48
Llslow_49:
  s_call_b64 s[32:33], L_waitfree
  s_branch Lok_50
Llslow_51:
  s_call_b64 s[32:33], L_waitfree
  s_branch Lok_52
Llslow_53:
  s_call_b64 s[32:33], L_waitfree
  s_branch Lok_54
Llslow_55:
  s_call_b64 s[32:33], L_waitfree
  s_branch Lok_56
Llslow_57:
  s_call_b64 s[32:33], L_waitfree
  s_branch Lok_58
Llslow_59:
  s_call_b64 s[32:33], L_waitfree
  s_branch Lok_60
Llslow_64:
  s_call_b64 s[32:33], L_waitfree
  s_branch Lok_65
Llslow_66:
  s_call_b64 s[32:33], L_waitfree
  s_branch Lok_67
Llslow_68:
  s_call_b64 s[32:33], L_waitfree
  s_branch Lok_69
Llslow_70:
  s_call_b64 s[32:33], L_waitfree
  s_branch Lok_71
Llslow_72:
  s_call_b64 s[32:33], L_waitfree
  s_branch Lok_73
L_waitfree:
  ds_read_b96 v[32:34], v30
  s_getreg_b32 s28, hwreg(HW_REG_IB_STS)
  s_lshr_b32 s29, s28, 18
  s_and_b32 s28, s28, 15
  s_and_b32 s29, s29, 0x30
  s_add_u32 s28, s28, s29
  s_add_u32 s28, s28, 7
  s_lshr_b32 s28, s28, 3
  s_sub_i32 s5, s4, s28
  v_mov_b32 v28, s5
  ds_write_b32 v29, v28
  s_waitcnt lgkmcnt(1)
  v_min3_u32 v32, v32, v33, v34
  s_sub_u32 s26, s26, 1
  v_readfirstlane_b32 s6, v32
  s_cmp_eq_u32 s26, 0
  s_cbranch_scc1 L_end
  s_nop 1
  s_cmp_ge_i32 s6, s8
  s_cbranch_scc0 L_waitfree
  s_setpc_b64 s[32:33]
L_compute:
  v_and_b32 v1, 3, v0
  v_lshrrev_b32 v2, 5, v0
  v_lshrrev_b32 v3, 4, v0
  v_and_b32 v3, 1, v3
  v_lshrrev_b32 v4, 2, v0
  v_and_b32 v4, 3, v4
  v_lshlrev_b32 v5, 2, v3
  v_add_u32 v5, v5, v1
  s_movk_i32 s28, 1088
  v_mul_lo_u32 v5, v5, s28
  v_lshlrev_b32 v6, 8, v4
  v_add_u32 v5, v5, v6
  v_add_u32 v6, 0, v2
  v_xor_b32 v6, v6, v4
  v_lshlrev_b32 v6, 4, v6
  v_add_u32 v8, v5, v6
  v_add_u32 v6, 2, v2
  v_xor_b32 v6, v6, v4
  v_lshlrev_b32 v6, 4, v6
  v_add_u32 v9, v5, v6
  v_lshrrev_b32 v6, 1, v1
  v_and_b32 v7, 1, v1
  v_lshlrev_b32 v7, 1, v7
  v_or_b32 v6, v6, v7
  v_lshlrev_b32 v6, 3, v6
  v_lshlrev_b32 v7, 5, v3
  v_add_u32 v6, v6, v7
  v_mul_lo_u32 v7, v4, s28
  v_add_u32 v6, v6, v7
  v_lshlrev_b32 v7, 8, v2
  v_add_u32 v10, v6, v7
  v_add_u32 v11, v10, v7
  v_add_u32 v25, 8704, v10
  v_mov_b32 v22, 156672
  s_lshl_b32 s28, s3, 2
  s_add_u32 s28, s28, 156688
  v_mov_b32 v23, s28
  v_mov_b32 v21, 0
  ds_write_b32 v23, v21
  v_lshlrev_b32 v15, 4, v0
  s_mov_b32 s4, 0
  s_mov_b32 s79, 0
  s_mov_b32 s8, 0x41000000
  s_mov_b32 s6, 0
  s_mov_b32 s5, 0
  s_mov_b32 s72, 95744
  s_and_b32 s29, s21, 1
  s_mul_i32 s77, s29, 7
  s_mov_b32 s11, 0
  s_mov_b32 s64, s60
  s_mov_b32 s65, s61
  s_mov_b32 s66, 0x2000000
  s_mov_b32 s67, 0x20000
  s_mov_b32 s68, s56
  s_mov_b32 s69, s57
  s_mov_b32 s70, 0x180000
  s_mov_b32 s71, 0x20000
  s_or_b32 s28, s2, s3
  s_cmp_eq_u32 s28, 0
  s_cbranch_scc0 L_nononce
  s_memrealtime s[16:17]
  s_waitcnt lgkmcnt(0)
  s_or_b32 s16, s16, 1
  v_mov_b32 v2, s16
  v_mov_b32 v3, s17
  v_mov_b32 v1, 0
  global_store_dwordx2 v1, v[2:3], s[58:59] sc1
L_nononce:
  s_waitcnt lgkmcnt(0)
  s_barrier
  s_add_u32 s9, s6, 4
  s_add_u32 s9, s9, s11
  s_cmp_lt_u32 s4, s9
  s_cbranch_scc1 Llw_slow_74
Llw_back_75:
  s_mul_i32 s29, s3, 8704
  s_add_u32 s10, s5, s29
  s_add_u32 s10, s10, 0
  s_sub_u32 s28, s10, s72
  s_cmp_lt_u32 s10, s72
  s_cselect_b32 s10, s10, s28
  v_add_u32 v12, s10, v8
  v_add_u32 v13, s10, v9
  ds_read_b128 a[160:163], v12 offset:0
  ds_read_b128 a[164:167], v13 offset:0
  ds_read_b128 a[168:171], v12 offset:64
  ds_read_b128 a[172:175], v13 offset:64
  ds_read_b128 a[176:179], v12 offset:128
  ds_read_b128 a[180:183], v13 offset:128
  ds_read_b128 a[184:187], v12 offset:192
  ds_read_b128 a[188:191], v13 offset:192
  s_add_u32 s5, s5, 26112
  s_sub_u32 s28, s5, s72
  s_cmp_lt_u32 s5, s72
  s_cselect_b32 s5, s5, s28
  v_add_u32 v14, s5, v11
  ds_read_b64_tr_b16 a[0:1], v14 offset:0
  ds_read_b64_tr_b16 a[2:3], v14 offset:256
  ds_read_b64_tr_b16 a[4:5], v14 offset:64
  ds_read_b64_tr_b16 a[6:7], v14 offset:320
  ds_read_b64_tr_b16 a[8:9], v14 offset:128
  ds_read_b64_tr_b16 a[10:11], v14 offset:384
  ds_read_b64_tr_b16 a[12:13], v14 offset:192
  ds_read_b64_tr_b16 a[14:15], v14 offset:448
  ds_read_b64_tr_b16 a[16:17], v14 offset:4352
  ds_read_b64_tr_b16 a[18:19], v14 offset:4608
  ds_read_b64_tr_b16 a[20:21], v14 offset:4416
  ds_read_b64_tr_b16 a[22:23], v14 offset:4672
  ds_read_b64_tr_b16 a[24:25], v14 offset:4480
  ds_read_b64_tr_b16 a[26:27], v14 offset:4736
  ds_read_b64_tr_b16 a[28:29], v14 offset:4544
  ds_read_b64_tr_b16 a[30:31], v14 offset:4800
  s_add_u32 s6, s6, 4
  s_add_u32 s5, s5, 8704
  s_sub_u32 s28, s5, s72
  s_cmp_lt_u32 s5, s72
  s_cselect_b32 s5, s5, s28
  s_waitcnt lgkmcnt(0)
  v_mfma_f32_32x32x16_bf16 v[160:175], a[0:3], a[160:163], 0
  s_add_u32 s9, s6, 1
  s_add_u32 s9, s9, s11
  s_cmp_lt_u32 s4, s9
  s_cbranch_scc1 Llw_slow_76
Llw_back_77:
  v_mfma_f32_32x32x16_bf16 v[176:191], a[4:7], a[160:163], 0
  v_add_u32 v14, s5, v11
  ds_read_b64_tr_b16 a[32:33], v14 offset:0
  ds_read_b64_tr_b16 a[34:35], v14 offset:256
  ds_read_b64_tr_b16 a[36:37], v14 offset:64
  v_mfma_f32_32x32x16_bf16 v[192:207], a[8:11], a[160:163], 0
  ds_read_b64_tr_b16 a[38:39], v14 offset:320
  ds_read_b64_tr_b16 a[40:41], v14 offset:128
  ds_read_b64_tr_b16 a[42:43], v14 offset:384
  ds_read_b64_tr_b16 a[44:45], v14 offset:192
  ds_read_b64_tr_b16 a[46:47], v14 offset:448
  v_mfma_f32_32x32x16_bf16 v[208:223], a[12:15], a[160:163], 0
  ds_read_b64_tr_b16 a[48:49], v14 offset:4352
  ds_read_b64_tr_b16 a[50:51], v14 offset:4608
  ds_read_b64_tr_b16 a[52:53], v14 offset:4416
  ds_read_b64_tr_b16 a[54:55], v14 offset:4672
  ds_read_b64_tr_b16 a[56:57], v14 offset:4480
  v_mfma_f32_32x32x16_bf16 v[160:175], a[16:19], a[164:167], v[160:175]
  ds_read_b64_tr_b16 a[58:59], v14 offset:4736
  ds_read_b64_tr_b16 a[60:61], v14 offset:4544
  ds_read_b64_tr_b16 a[62:63], v14 offset:4800
  v_mov_b32 v21, s6
  ds_write_b32 v23, v21
  v_mfma_f32_32x32x16_bf16 v[176:191], a[20:23], a[164:167], v[176:191]
  s_add_u32 s6, s6, 1
  s_add_u32 s5, s5, 8704
  s_sub_u32 s28, s5, s72
  s_cmp_lt_u32 s5, s72
  s_cselect_b32 s5, s5, s28
  v_mfma_f32_32x32x16_bf16 v[192:207], a[24:27], a[164:167], v[192:207]
  v_mfma_f32_32x32x16_bf16 v[208:223], a[28:31], a[164:167], v[208:223]
  s_waitcnt lgkmcnt(0)
  v_mfma_f32_32x32x16_bf16 v[160:175], a[32:35], a[168:171], v[160:175]
  s_add_u32 s9, s6, 1
  s_add_u32 s9, s9, s11
  s_cmp_lt_u32 s4, s9
  s_cbranch_scc1 Llw_slow_78
Llw_back_79:
  v_mfma_f32_32x32x16_bf16 v[176:191], a[36:39], a[168:171], v[176:191]
  v_add_u32 v14, s5, v11
  ds_read_b64_tr_b16 a[0:1], v14 offset:0
  ds_read_b64_tr_b16 a[2:3], v14 offset:256
  ds_read_b64_tr_b16 a[4:5], v14 offset:64
  v_mfma_f32_32x32x16_bf16 v[192:207], a[40:43], a[168:171], v[192:207]
  ds_read_b64_tr_b16 a[6:7], v14 offset:320
  ds_read_b64_tr_b16 a[8:9], v14 offset:128
  ds_read_b64_tr_b16 a[10:11], v14 offset:384
  ds_read_b64_tr_b16 a[12:13], v14 offset:192
  ds_read_b64_tr_b16 a[14:15], v14 offset:448
  v_mfma_f32_32x32x16_bf16 v[208:223], a[44:47], a[168:171], v[208:223]
  ds_read_b64_tr_b16 a[16:17], v14 offset:4352
  ds_read_b64_tr_b16 a[18:19], v14 offset:4608
  ds_read_b64_tr_b16 a[20:21], v14 offset:4416
  ds_read_b64_tr_b16 a[22:23], v14 offset:4672
  ds_read_b64_tr_b16 a[24:25], v14 offset:4480
  v_mfma_f32_32x32x16_bf16 v[160:175], a[48:51], a[172:175], v[160:175]
  ds_read_b64_tr_b16 a[26:27], v14 offset:4736
  ds_read_b64_tr_b16 a[28:29], v14 offset:4544
  ds_read_b64_tr_b16 a[30:31], v14 offset:4800
  v_mov_b32 v21, s6
  ds_write_b32 v23, v21
  v_mfma_f32_32x32x16_bf16 v[176:191], a[52:55], a[172:175], v[176:191]
  s_add_u32 s6, s6, 1
  s_add_u32 s5, s5, 8704
  s_sub_u32 s28, s5, s72
  s_cmp_lt_u32 s5, s72
  s_cselect_b32 s5, s5, s28
  v_mfma_f32_32x32x16_bf16 v[192:207], a[56:59], a[172:175], v[192:207]
  v_mfma_f32_32x32x16_bf16 v[208:223], a[60:63], a[172:175], v[208:223]
  s_waitcnt lgkmcnt(0)
  v_mfma_f32_32x32x16_bf16 v[160:175], a[0:3], a[176:179], v[160:175]
  s_add_u32 s9, s6, 1
  s_add_u32 s9, s9, s11
  s_cmp_lt_u32 s4, s9
  s_cbranch_scc1 Llw_slow_80
Llw_back_81:
  v_mfma_f32_32x32x16_bf16 v[176:191], a[4:7], a[176:179], v[176:191]
  v_add_u32 v14, s5, v11
  ds_read_b64_tr_b16 a[32:33], v14 offset:0
  ds_read_b64_tr_b16 a[34:35], v14 offset:256
  ds_read_b64_tr_b16 a[36:37], v14 offset:64
  v_mfma_f32_32x32x16_bf16 v[192:207], a[8:11], a[176:179], v[192:207]
  ds_read_b64_tr_b16 a[38:39], v14 offset:320
  ds_read_b64_tr_b16 a[40:41], v14 offset:128
  ds_read_b64_tr_b16 a[42:43], v14 offset:384
  ds_read_b64_tr_b16 a[44:45], v14 offset:192
  ds_read_b64_tr_b16 a[46:47], v14 offset:448
  v_mfma_f32_32x32x16_bf16 v[208:223], a[12:15], a[176:179], v[208:223]
  ds_read_b64_tr_b16 a[48:49], v14 offset:4352
  ds_read_b64_tr_b16 a[50:51], v14 offset:4608
  ds_read_b64_tr_b16 a[52:53], v14 offset:4416
  ds_read_b64_tr_b16 a[54:55], v14 offset:4672
  ds_read_b64_tr_b16 a[56:57], v14 offset:4480
  v_mfma_f32_32x32x16_bf16 v[160:175], a[16:19], a[180:183], v[160:175]
  ds_read_b64_tr_b16 a[58:59], v14 offset:4736
  ds_read_b64_tr_b16 a[60:61], v14 offset:4544
  ds_read_b64_tr_b16 a[62:63], v14 offset:4800
  v_mov_b32 v21, s6
  ds_write_b32 v23, v21
  v_mfma_f32_32x32x16_bf16 v[176:191], a[20:23], a[180:183], v[176:191]
  s_add_u32 s6, s6, 1
  s_add_u32 s5, s5, 8704
  s_sub_u32 s28, s5, s72
  s_cmp_lt_u32 s5, s72
  s_cselect_b32 s5, s5, s28
  v_mfma_f32_32x32x16_bf16 v[192:207], a[24:27], a[180:183], v[192:207]
  v_mfma_f32_32x32x16_bf16 v[208:223], a[28:31], a[180:183], v[208:223]
  s_waitcnt lgkmcnt(0)
  v_mfma_f32_32x32x16_bf16 v[160:175], a[32:35], a[184:187], v[160:175]
  s_mov_b32 s11, s77
  s_add_u32 s9, s6, 4
  s_add_u32 s9, s9, s11
  s_cmp_lt_u32 s4, s9
  s_cbranch_scc1 Llw_slow_82
Llw_back_83:
  s_mul_i32 s29, s3, 8704
  s_add_u32 s10, s5, s29
  v_mfma_f32_32x32x16_bf16 v[176:191], a[36:39], a[184:187], v[176:191]
  s_add_u32 s10, s10, 0
  s_sub_u32 s28, s10, s72
  s_cmp_lt_u32 s10, s72
  s_cselect_b32 s10, s10, s28
  v_add_u32 v12, s10, v8
  v_add_u32 v13, s10, v9
  ds_read_b128 a[192:195], v12 offset:0
  ds_read_b128 a[196:199], v13 offset:0
  v_mfma_f32_32x32x16_bf16 v[192:207], a[40:43], a[184:187], v[192:207]
  ds_read_b128 a[200:203], v12 offset:64
  ds_read_b128 a[204:207], v13 offset:64
  ds_read_b128 a[208:211], v12 offset:128
  ds_read_b128 a[212:215], v13 offset:128
  ds_read_b128 a[216:219], v12 offset:192
  ds_read_b128 a[220:223], v13 offset:192
  s_add_u32 s5, s5, 26112
  s_sub_u32 s28, s5, s72
  s_cmp_lt_u32 s5, s72
  v_mfma_f32_32x32x16_bf16 v[208:223], a[44:47], a[184:187], v[208:223]
  s_cselect_b32 s5, s5, s28
  v_add_u32 v14, s5, v11
  ds_read_b64_tr_b16 a[0:1], v14 offset:0
  ds_read_b64_tr_b16 a[2:3], v14 offset:256
  ds_read_b64_tr_b16 a[4:5], v14 offset:64
  ds_read_b64_tr_b16 a[6:7], v14 offset:320
  ds_read_b64_tr_b16 a[8:9], v14 offset:128
  ds_read_b64_tr_b16 a[10:11], v14 offset:384
  v_mfma_f32_32x32x16_bf16 v[160:175], a[48:51], a[188:191], v[160:175]
  ds_read_b64_tr_b16 a[12:13], v14 offset:192
  ds_read_b64_tr_b16 a[14:15], v14 offset:448
  ds_read_b64_tr_b16 a[16:17], v14 offset:4352
  ds_read_b64_tr_b16 a[18:19], v14 offset:4608
  ds_read_b64_tr_b16 a[20:21], v14 offset:4416
  ds_read_b64_tr_b16 a[22:23], v14 offset:4672
  ds_read_b64_tr_b16 a[24:25], v14 offset:4480
  ds_read_b64_tr_b16 a[26:27], v14 offset:4736
  v_mfma_f32_32x32x16_bf16 v[176:191], a[52:55], a[188:191], v[176:191]
  ds_read_b64_tr_b16 a[28:29], v14 offset:4544
  ds_read_b64_tr_b16 a[30:31], v14 offset:4800
  v_mov_b32 v21, s6
  ds_write_b32 v23, v21
  s_add_u32 s6, s6, 4
  s_add_u32 s5, s5, 8704
  s_sub_u32 s28, s5, s72
  s_cmp_lt_u32 s5, s72
  s_cselect_b32 s5, s5, s28
  v_mfma_f32_32x32x16_bf16 v[192:207], a[56:59], a[188:191], v[192:207]
  v_mfma_f32_32x32x16_bf16 v[208:223], a[60:63], a[188:191], v[208:223]
  s_waitcnt lgkmcnt(0)
  v_mfma_f32_32x32x16_bf16 v[160:175], a[0:3], a[192:195], v[160:175]
  s_add_u32 s9, s6, 1
  s_add_u32 s9, s9, s11
  s_cmp_lt_u32 s4, s9
  s_cbranch_scc1 Llw_slow_84
Llw_back_85:
  v_mfma_f32_32x32x16_bf16 v[176:191], a[4:7], a[192:195], v[176:191]
  v_add_u32 v14, s5, v11
  ds_read_b64_tr_b16 a[32:33], v14 offset:0
  ds_read_b64_tr_b16 a[34:35], v14 offset:256
  ds_read_b64_tr_b16 a[36:37], v14 offset:64
  v_mfma_f32_32x32x16_bf16 v[192:207], a[8:11], a[192:195], v[192:207]
  ds_read_b64_tr_b16 a[38:39], v14 offset:320
  ds_read_b64_tr_b16 a[40:41], v14 offset:128
  ds_read_b64_tr_b16 a[42:43], v14 offset:384
  ds_read_b64_tr_b16 a[44:45], v14 offset:192
  ds_read_b64_tr_b16 a[46:47], v14 offset:448
  v_mfma_f32_32x32x16_bf16 v[208:223], a[12:15], a[192:195], v[208:223]
  ds_read_b64_tr_b16 a[48:49], v14 offset:4352
  ds_read_b64_tr_b16 a[50:51], v14 offset:4608
  ds_read_b64_tr_b16 a[52:53], v14 offset:4416
  ds_read_b64_tr_b16 a[54:55], v14 offset:4672
  ds_read_b64_tr_b16 a[56:57], v14 offset:4480
  v_mfma_f32_32x32x16_bf16 v[160:175], a[16:19], a[196:199], v[160:175]
  ds_read_b64_tr_b16 a[58:59], v14 offset:4736
  ds_read_b64_tr_b16 a[60:61], v14 offset:4544
  ds_read_b64_tr_b16 a[62:63], v14 offset:4800
  v_mov_b32 v21, s6
  ds_write_b32 v23, v21
  v_mfma_f32_32x32x16_bf16 v[176:191], a[20:23], a[196:199], v[176:191]
  s_add_u32 s6, s6, 1
  s_add_u32 s5, s5, 8704
  s_sub_u32 s28, s5, s72
  s_cmp_lt_u32 s5, s72
  s_cselect_b32 s5, s5, s28
  v_mfma_f32_32x32x16_bf16 v[192:207], a[24:27], a[196:199], v[192:207]
  v_mfma_f32_32x32x16_bf16 v[208:223], a[28:31], a[196:199], v[208:223]
  s_waitcnt lgkmcnt(0)
  v_mfma_f32_32x32x16_bf16 v[160:175], a[32:35], a[200:203], v[160:175]
  s_add_u32 s9, s6, 1
  s_add_u32 s9, s9, s11
  s_cmp_lt_u32 s4, s9
  s_cbranch_scc1 Llw_slow_86
Llw_back_87:
  v_mfma_f32_32x32x16_bf16 v[176:191], a[36:39], a[200:203], v[176:191]
  v_add_u32 v14, s5, v11
  ds_read_b64_tr_b16 a[0:1], v14 offset:0
  ds_read_b64_tr_b16 a[2:3], v14 offset:256
  ds_read_b64_tr_b16 a[4:5], v14 offset:64
  v_mfma_f32_32x32x16_bf16 v[192:207], a[40:43], a[200:203], v[192:207]
  ds_read_b64_tr_b16 a[6:7], v14 offset:320
  ds_read_b64_tr_b16 a[8:9], v14 offset:128
  ds_read_b64_tr_b16 a[10:11], v14 offset:384
  ds_read_b64_tr_b16 a[12:13], v14 offset:192
  ds_read_b64_tr_b16 a[14:15], v14 offset:448
  v_mfma_f32_32x32x16_bf16 v[208:223], a[44:47], a[200:203], v[208:223]
  ds_read_b64_tr_b16 a[16:17], v14 offset:4352
  ds_read_b64_tr_b16 a[18:19], v14 offset:4608
  ds_read_b64_tr_b16 a[20:21], v14 offset:4416
  ds_read_b64_tr_b16 a[22:23], v14 offset:4672
  ds_read_b64_tr_b16 a[24:25], v14 offset:4480
  v_mfma_f32_32x32x16_bf16 v[160:175], a[48:51], a[204:207], v[160:175]
  ds_read_b64_tr_b16 a[26:27], v14 offset:4736
  ds_read_b64_tr_b16 a[28:29], v14 offset:4544
  ds_read_b64_tr_b16 a[30:31], v14 offset:4800
  v_mov_b32 v21, s6
  ds_write_b32 v23, v21
  v_mfma_f32_32x32x16_bf16 v[176:191], a[52:55], a[204:207], v[176:191]
  s_add_u32 s6, s6, 1
  s_add_u32 s5, s5, 8704
  s_sub_u32 s28, s5, s72
  s_cmp_lt_u32 s5, s72
  s_cselect_b32 s5, s5, s28
  v_mfma_f32_32x32x16_bf16 v[192:207], a[56:59], a[204:207], v[192:207]
  v_mfma_f32_32x32x16_bf16 v[208:223], a[60:63], a[204:207], v[208:223]
  s_waitcnt lgkmcnt(0)
  v_mfma_f32_32x32x16_bf16 v[160:175], a[0:3], a[208:211], v[160:175]
  s_add_u32 s9, s6, 1
  s_add_u32 s9, s9, s11
  s_cmp_lt_u32 s4, s9
  s_cbranch_scc1 Llw_slow_88
Llw_back_89:
  v_mfma_f32_32x32x16_bf16 v[176:191], a[4:7], a[208:211], v[176:191]
  v_add_u32 v14, s5, v11
  ds_read_b64_tr_b16 a[32:33], v14 offset:0
  ds_read_b64_tr_b16 a[34:35], v14 offset:256
  ds_read_b64_tr_b16 a[36:37], v14 offset:64
  v_mfma_f32_32x32x16_bf16 v[192:207], a[8:11], a[208:211], v[192:207]
  ds_read_b64_tr_b16 a[38:39], v14 offset:320
  ds_read_b64_tr_b16 a[40:41], v14 offset:128
  ds_read_b64_tr_b16 a[42:43], v14 offset:384
  ds_read_b64_tr_b16 a[44:45], v14 offset:192
  ds_read_b64_tr_b16 a[46:47], v14 offset:448
  v_mfma_f32_32x32x16_bf16 v[208:223], a[12:15], a[208:211], v[208:223]
  ds_read_b64_tr_b16 a[48:49], v14 offset:4352
  ds_read_b64_tr_b16 a[50:51], v14 offset:4608
  ds_read_b64_tr_b16 a[52:53], v14 offset:4416
  ds_read_b64_tr_b16 a[54:55], v14 offset:4672
  ds_read_b64_tr_b16 a[56:57], v14 offset:4480
  v_mfma_f32_32x32x16_bf16 v[160:175], a[16:19], a[212:215], v[160:175]
  ds_read_b64_tr_b16 a[58:59], v14 offset:4736
  ds_read_b64_tr_b16 a[60:61], v14 offset:4544
  ds_read_b64_tr_b16 a[62:63], v14 offset:4800
  v_mov_b32 v21, s6
  ds_write_b32 v23, v21
  v_mfma_f32_32x32x16_bf16 v[176:191], a[20:23], a[212:215], v[176:191]
  s_add_u32 s6, s6, 1
  s_add_u32 s5, s5, 8704
  s_sub_u32 s28, s5, s72
  s_cmp_lt_u32 s5, s72
  s_cselect_b32 s5, s5, s28
  v_mfma_f32_32x32x16_bf16 v[192:207], a[24:27], a[212:215], v[192:207]
  v_mfma_f32_32x32x16_bf16 v[208:223], a[28:31], a[212:215], v[208:223]
  s_waitcnt lgkmcnt(0)
  v_mfma_f32_32x32x16_bf16 v[160:175], a[32:35], a[216:219], v[160:175]
  s_add_u32 s9, s6, 4
  s_add_u32 s9, s9, s11
  s_cmp_lt_u32 s4, s9
  s_cbranch_scc1 Llw_slow_90
Llw_back_91:
  s_mul_i32 s29, s3, 8704
  s_add_u32 s10, s5, s29
  s_add_u32 s10, s10, 0
  v_mfma_f32_32x32x16_bf16 v[176:191], a[36:39], a[216:219], v[176:191]
  s_sub_u32 s28, s10, s72
  s_cmp_lt_u32 s10, s72
  s_cselect_b32 s10, s10, s28
  v_add_u32 v12, s10, v8
  v_add_u32 v13, s10, v9
  ds_read_b128 a[160:163], v12 offset:0
  ds_read_b128 a[164:167], v13 offset:0
  ds_read_b128 a[168:171], v12 offset:64
  v_mfma_f32_32x32x16_bf16 v[192:207], a[40:43], a[216:219], v[192:207]
  ds_read_b128 a[172:175], v13 offset:64
  ds_read_b128 a[176:179], v12 offset:128
  ds_read_b128 a[180:183], v13 offset:128
  ds_read_b128 a[184:187], v12 offset:192
  ds_read_b128 a[188:191], v13 offset:192
  s_add_u32 s5, s5, 26112
  s_sub_u32 s28, s5, s72
  s_cmp_lt_u32 s5, s72
  v_mfma_f32_32x32x16_bf16 v[208:223], a[44:47], a[216:219], v[208:223]
  s_cselect_b32 s5, s5, s28
  v_add_u32 v14, s5, v11
  ds_read_b64_tr_b16 a[0:1], v14 offset:0
  ds_read_b64_tr_b16 a[2:3], v14 offset:256
  ds_read_b64_tr_b16 a[4:5], v14 offset:64
  ds_read_b64_tr_b16 a[6:7], v14 offset:320
  ds_read_b64_tr_b16 a[8:9], v14 offset:128
  ds_read_b64_tr_b16 a[10:11], v14 offset:384
  v_mfma_f32_32x32x16_bf16 v[160:175], a[48:51], a[220:223], v[160:175]
  ds_read_b64_tr_b16 a[12:13], v14 offset:192
  ds_read_b64_tr_b16 a[14:15], v14 offset:448
  ds_read_b64_tr_b16 a[16:17], v14 offset:4352
  ds_read_b64_tr_b16 a[18:19], v14 offset:4608
  ds_read_b64_tr_b16 a[20:21], v14 offset:4416
  ds_read_b64_tr_b16 a[22:23], v14 offset:4672
  ds_read_b64_tr_b16 a[24:25], v14 offset:4480
  ds_read_b64_tr_b16 a[26:27], v14 offset:4736
  v_mfma_f32_32x32x16_bf16 v[176:191], a[52:55], a[220:223], v[176:191]
  ds_read_b64_tr_b16 a[28:29], v14 offset:4544
  ds_read_b64_tr_b16 a[30:31], v14 offset:4800
  v_mov_b32 v21, s6
  ds_write_b32 v23, v21
  s_add_u32 s6, s6, 4
  s_add_u32 s5, s5, 8704
  s_sub_u32 s28, s5, s72
  s_cmp_lt_u32 s5, s72
  s_cselect_b32 s5, s5, s28
  v_mfma_f32_32x32x16_bf16 v[192:207], a[56:59], a[220:223], v[192:207]
  v_mfma_f32_32x32x16_bf16 v[208:223], a[60:63], a[220:223], v[208:223]
  s_waitcnt lgkmcnt(0)
  v_mfma_f32_32x32x16_bf16 v[160:175], a[0:3], a[160:163], v[160:175]
  s_add_u32 s9, s6, 1
  s_add_u32 s9, s9, s11
  s_cmp_lt_u32 s4, s9
  s_cbranch_scc1 Llw_slow_92
Llw_back_93:
  v_mfma_f32_32x32x16_bf16 v[176:191], a[4:7], a[160:163], v[176:191]
  v_add_u32 v14, s5, v11
  ds_read_b64_tr_b16 a[32:33], v14 offset:0
  ds_read_b64_tr_b16 a[34:35], v14 offset:256
  ds_read_b64_tr_b16 a[36:37], v14 offset:64
  v_mfma_f32_32x32x16_bf16 v[192:207], a[8:11], a[160:163], v[192:207]
  ds_read_b64_tr_b16 a[38:39], v14 offset:320
  ds_read_b64_tr_b16 a[40:41], v14 offset:128
  ds_read_b64_tr_b16 a[42:43], v14 offset:384
  ds_read_b64_tr_b16 a[44:45], v14 offset:192
  ds_read_b64_tr_b16 a[46:47], v14 offset:448
  v_mfma_f32_32x32x16_bf16 v[208:223], a[12:15], a[160:163], v[208:223]
  ds_read_b64_tr_b16 a[48:49], v14 offset:4352
  ds_read_b64_tr_b16 a[50:51], v14 offset:4608
  ds_read_b64_tr_b16 a[52:53], v14 offset:4416
  ds_read_b64_tr_b16 a[54:55], v14 offset:4672
  ds_read_b64_tr_b16 a[56:57], v14 offset:4480
  v_mfma_f32_32x32x16_bf16 v[160:175], a[16:19], a[164:167], v[160:175]
  ds_read_b64_tr_b16 a[58:59], v14 offset:4736
  ds_read_b64_tr_b16 a[60:61], v14 offset:4544
  ds_read_b64_tr_b16 a[62:63], v14 offset:4800
  v_mov_b32 v21, s6
  ds_write_b32 v23, v21
  v_mfma_f32_32x32x16_bf16 v[176:191], a[20:23], a[164:167], v[176:191]
  s_add_u32 s6, s6, 1
  s_add_u32 s5, s5, 8704
  s_sub_u32 s28, s5, s72
  s_cmp_lt_u32 s5, s72
  s_cselect_b32 s5, s5, s28
  v_mfma_f32_32x32x16_bf16 v[192:207], a[24:27], a[164:167], v[192:207]
  v_mfma_f32_32x32x16_bf16 v[208:223], a[28:31], a[164:167], v[208:223]
  s_waitcnt lgkmcnt(0)
  v_mfma_f32_32x32x16_bf16 v[160:175], a[32:35], a[168:171], v[160:175]
  s_add_u32 s9, s6, 1
  s_add_u32 s9, s9, s11
  s_cmp_lt_u32 s4, s9
  s_cbranch_scc1 Llw_slow_94
Llw_back_95:
  v_mfma_f32_32x32x16_bf16 v[176:191], a[36:39], a[168:171], v[176:191]
  v_add_u32 v14, s5, v11
  ds_read_b64_tr_b16 a[0:1], v14 offset:0
  ds_read_b64_tr_b16 a[2:3], v14 offset:256
  ds_read_b64_tr_b16 a[4:5], v14 offset:64
  v_mfma_f32_32x32x16_bf16 v[192:207], a[40:43], a[168:171], v[192:207]
  ds_read_b64_tr_b16 a[6:7], v14 offset:320
  ds_read_b64_tr_b16 a[8:9], v14 offset:128
  ds_read_b64_tr_b16 a[10:11], v14 offset:384
  ds_read_b64_tr_b16 a[12:13], v14 offset:192
  ds_read_b64_tr_b16 a[14:15], v14 offset:448
  v_mfma_f32_32x32x16_bf16 v[208:223], a[44:47], a[168:171], v[208:223]
  ds_read_b64_tr_b16 a[16:17], v14 offset:4352
  ds_read_b64_tr_b16 a[18:19], v14 offset:4608
  ds_read_b64_tr_b16 a[20:21], v14 offset:4416
  ds_read_b64_tr_b16 a[22:23], v14 offset:4672
  ds_read_b64_tr_b16 a[24:25], v14 offset:4480
  v_mfma_f32_32x32x16_bf16 v[160:175], a[48:51], a[172:175], v[160:175]
  ds_read_b64_tr_b16 a[26:27], v14 offset:4736
  ds_read_b64_tr_b16 a[28:29], v14 offset:4544
  ds_read_b64_tr_b16 a[30:31], v14 offset:4800
  v_mov_b32 v21, s6
  ds_write_b32 v23, v21
  v_mfma_f32_32x32x16_bf16 v[176:191], a[52:55], a[172:175], v[176:191]
  s_add_u32 s6, s6, 1
  s_add_u32 s5, s5, 8704
  s_sub_u32 s28, s5, s72
  s_cmp_lt_u32 s5, s72
  s_cselect_b32 s5, s5, s28
  v_mfma_f32_32x32x16_bf16 v[192:207], a[56:59], a[172:175], v[192:207]
  v_mfma_f32_32x32x16_bf16 v[208:223], a[60:63], a[172:175], v[208:223]
  s_waitcnt lgkmcnt(0)
  v_mfma_f32_32x32x16_bf16 v[160:175], a[0:3], a[176:179], v[160:175]
  s_add_u32 s9, s6, 1
  s_add_u32 s9, s9, s11
  s_cmp_lt_u32 s4, s9
  s_cbranch_scc1 Llw_slow_96
Llw_back_97:
  v_mfma_f32_32x32x16_bf16 v[176:191], a[4:7], a[176:179], v[176:191]
  v_add_u32 v14, s5, v11
  ds_read_b64_tr_b16 a[32:33], v14 offset:0
  ds_read_b64_tr_b16 a[34:35], v14 offset:256
  ds_read_b64_tr_b16 a[36:37], v14 offset:64
  v_mfma_f32_32x32x16_bf16 v[192:207], a[8:11], a[176:179], v[192:207]
  ds_read_b64_tr_b16 a[38:39], v14 offset:320
  ds_read_b64_tr_b16 a[40:41], v14 offset:128
  ds_read_b64_tr_b16 a[42:43], v14 offset:384
  ds_read_b64_tr_b16 a[44:45], v14 offset:192
  ds_read_b64_tr_b16 a[46:47], v14 offset:448
  v_mfma_f32_32x32x16_bf16 v[208:223], a[12:15], a[176:179], v[208:223]
  ds_read_b64_tr_b16 a[48:49], v14 offset:4352
  ds_read_b64_tr_b16 a[50:51], v14 offset:4608
  ds_read_b64_tr_b16 a[52:53], v14 offset:4416
  ds_read_b64_tr_b16 a[54:55], v14 offset:4672
  ds_read_b64_tr_b16 a[56:57], v14 offset:4480
  v_mfma_f32_32x32x16_bf16 v[160:175], a[16:19], a[180:183], v[160:175]
  ds_read_b64_tr_b16 a[58:59], v14 offset:4736
  ds_read_b64_tr_b16 a[60:61], v14 offset:4544
  ds_read_b64_tr_b16 a[62:63], v14 offset:4800
  v_mov_b32 v21, s6
  ds_write_b32 v23, v21
  v_mfma_f32_32x32x16_bf16 v[176:191], a[20:23], a[180:183], v[176:191]
  s_add_u32 s6, s6, 1
  s_add_u32 s5, s5, 8704
  s_sub_u32 s28, s5, s72
  s_cmp_lt_u32 s5, s72
  s_cselect_b32 s5, s5, s28
  v_mfma_f32_32x32x16_bf16 v[192:207], a[24:27], a[180:183], v[192:207]
  v_mfma_f32_32x32x16_bf16 v[208:223], a[28:31], a[180:183], v[208:223]
  s_waitcnt lgkmcnt(0)
  v_mfma_f32_32x32x16_bf16 v[160:175], a[32:35], a[184:187], v[160:175]
  s_add_u32 s9, s6, 4
  s_add_u32 s9, s9, s11
  s_cmp_lt_u32 s4, s9
  s_cbranch_scc1 Llw_slow_98
Llw_back_99:
  s_mul_i32 s29, s3, 8704
  s_add_u32 s10, s5, s29
  s_add_u32 s10, s10, 0
  v_mfma_f32_32x32x16_bf16 v[176:191], a[36:39], a[184:187], v[176:191]
  s_sub_u32 s28, s10, s72
  s_cmp_lt_u32 s10, s72
  s_cselect_b32 s10, s10, s28
  v_add_u32 v12, s10, v8
  v_add_u32 v13, s10, v9
  ds_read_b128 a[192:195], v12 offset:0
  ds_read_b128 a[196:199], v13 offset:0
  ds_read_b128 a[200:203], v12 offset:64
  v_mfma_f32_32x32x16_bf16 v[192:207], a[40:43], a[184:187], v[192:207]
  ds_read_b128 a[204:207], v13 offset:64
  ds_read_b128 a[208:211], v12 offset:128
  ds_read_b128 a[212:215], v13 offset:128
  ds_read_b128 a[216:219], v12 offset:192
  ds_read_b128 a[220:223], v13 offset:192
  s_add_u32 s5, s5, 26112
  s_sub_u32 s28, s5, s72
  s_cmp_lt_u32 s5, s72
  v_mfma_f32_32x32x16_bf16 v[208:223], a[44:47], a[184:187], v[208:223]
  s_cselect_b32 s5, s5, s28
  v_add_u32 v14, s5, v11
  ds_read_b64_tr_b16 a[0:1], v14 offset:0
  ds_read_b64_tr_b16 a[2:3], v14 offset:256
  ds_read_b64_tr_b16 a[4:5], v14 offset:64
  ds_read_b64_tr_b16 a[6:7], v14 offset:320
  ds_read_b64_tr_b16 a[8:9], v14 offset:128
  ds_read_b64_tr_b16 a[10:11], v14 offset:384
  v_mfma_f32_32x32x16_bf16 v[160:175], a[48:51], a[188:191], v[160:175]
  ds_read_b64_tr_b16 a[12:13], v14 offset:192
  ds_read_b64_tr_b16 a[14:15], v14 offset:448
  ds_read_b64_tr_b16 a[16:17], v14 offset:4352
  ds_read_b64_tr_b16 a[18:19], v14 offset:4608
  ds_read_b64_tr_b16 a[20:21], v14 offset:4416
  ds_read_b64_tr_b16 a[22:23], v14 offset:4672
  ds_read_b64_tr_b16 a[24:25], v14 offset:4480
  ds_read_b64_tr_b16 a[26:27], v14 offset:4736
  v_mfma_f32_32x32x16_bf16 v[176:191], a[52:55], a[188:191], v[176:191]
  ds_read_b64_tr_b16 a[28:29], v14 offset:4544
  ds_read_b64_tr_b16 a[30:31], v14 offset:4800
  v_mov_b32 v21, s6
  ds_write_b32 v23, v21
  s_add_u32 s6, s6, 4
  s_add_u32 s5, s5, 8704
  s_sub_u32 s28, s5, s72
  s_cmp_lt_u32 s5, s72
  s_cselect_b32 s5, s5, s28
  v_mfma_f32_32x32x16_bf16 v[192:207], a[56:59], a[188:191], v[192:207]
  v_mfma_f32_32x32x16_bf16 v[208:223], a[60:63], a[188:191], v[208:223]
  s_waitcnt lgkmcnt(0)
  v_mfma_f32_32x32x16_bf16 v[160:175], a[0:3], a[192:195], v[160:175]
  s_add_u32 s9, s6, 1
  s_add_u32 s9, s9, s11
  s_cmp_lt_u32 s4, s9
  s_cbranch_scc1 Llw_slow_100
Llw_back_101:
  v_mfma_f32_32x32x16_bf16 v[176:191], a[4:7], a[192:195], v[176:191]
  v_add_u32 v14, s5, v11
  ds_read_b64_tr_b16 a[32:33], v14 offset:0
  ds_read_b64_tr_b16 a[34:35], v14 offset:256
  ds_read_b64_tr_b16 a[36:37], v14 offset:64
  v_mfma_f32_32x32x16_bf16 v[192:207], a[8:11], a[192:195], v[192:207]
  ds_read_b64_tr_b16 a[38:39], v14 offset:320
  ds_read_b64_tr_b16 a[40:41], v14 offset:128
  ds_read_b64_tr_b16 a[42:43], v14 offset:384
  ds_read_b64_tr_b16 a[44:45], v14 offset:192
  ds_read_b64_tr_b16 a[46:47], v14 offset:448
  v_mfma_f32_32x32x16_bf16 v[208:223], a[12:15], a[192:195], v[208:223]
  ds_read_b64_tr_b16 a[48:49], v14 offset:4352
  ds_read_b64_tr_b16 a[50:51], v14 offset:4608
  ds_read_b64_tr_b16 a[52:53], v14 offset:4416
  ds_read_b64_tr_b16 a[54:55], v14 offset:4672
  ds_read_b64_tr_b16 a[56:57], v14 offset:4480
  v_mfma_f32_32x32x16_bf16 v[160:175], a[16:19], a[196:199], v[160:175]
  ds_read_b64_tr_b16 a[58:59], v14 offset:4736
  ds_read_b64_tr_b16 a[60:61], v14 offset:4544
  ds_read_b64_tr_b16 a[62:63], v14 offset:4800
  v_mov_b32 v21, s6
  ds_write_b32 v23, v21
  v_mfma_f32_32x32x16_bf16 v[176:191], a[20:23], a[196:199], v[176:191]
  s_add_u32 s6, s6, 1
  s_add_u32 s5, s5, 8704
  s_sub_u32 s28, s5, s72
  s_cmp_lt_u32 s5, s72
  s_cselect_b32 s5, s5, s28
  v_mfma_f32_32x32x16_bf16 v[192:207], a[24:27], a[196:199], v[192:207]
  v_mfma_f32_32x32x16_bf16 v[208:223], a[28:31], a[196:199], v[208:223]
  s_waitcnt lgkmcnt(0)
  v_mfma_f32_32x32x16_bf16 v[160:175], a[32:35], a[200:203], v[160:175]
  s_add_u32 s9, s6, 1
  s_add_u32 s9, s9, s11
  s_cmp_lt_u32 s4, s9
  s_cbranch_scc1 Llw_slow_102
Llw_back_103:
  v_mfma_f32_32x32x16_bf16 v[176:191], a[36:39], a[200:203], v[176:191]
  v_add_u32 v14, s5, v11
  ds_read_b64_tr_b16 a[0:1], v14 offset:0
  ds_read_b64_tr_b16 a[2:3], v14 offset:256
  ds_read_b64_tr_b16 a[4:5], v14 offset:64
  v_mfma_f32_32x32x16_bf16 v[192:207], a[40:43], a[200:203], v[192:207]
  ds_read_b64_tr_b16 a[6:7], v14 offset:320
  ds_read_b64_tr_b16 a[8:9], v14 offset:128
  ds_read_b64_tr_b16 a[10:11], v14 offset:384
  ds_read_b64_tr_b16 a[12:13], v14 offset:192
  ds_read_b64_tr_b16 a[14:15], v14 offset:448
  v_mfma_f32_32x32x16_bf16 v[208:223], a[44:47], a[200:203], v[208:223]
  ds_read_b64_tr_b16 a[16:17], v14 offset:4352
  ds_read_b64_tr_b16 a[18:19], v14 offset:4608
  ds_read_b64_tr_b16 a[20:21], v14 offset:4416
  ds_read_b64_tr_b16 a[22:23], v14 offset:4672
  ds_read_b64_tr_b16 a[24:25], v14 offset:4480
  v_mfma_f32_32x32x16_bf16 v[160:175], a[48:51], a[204:207], v[160:175]
  ds_read_b64_tr_b16 a[26:27], v14 offset:4736
  ds_read_b64_tr_b16 a[28:29], v14 offset:4544
  ds_read_b64_tr_b16 a[30:31], v14 offset:4800
  v_mov_b32 v21, s6
  ds_write_b32 v23, v21
  v_mfma_f32_32x32x16_bf16 v[176:191], a[52:55], a[204:207], v[176:191]
  s_add_u32 s6, s6, 1
  s_add_u32 s5, s5, 8704
  s_sub_u32 s28, s5, s72
  s_cmp_lt_u32 s5, s72
  s_cselect_b32 s5, s5, s28
  v_mfma_f32_32x32x16_bf16 v[192:207], a[56:59], a[204:207], v[192:207]
  v_mfma_f32_32x32x16_bf16 v[208:223], a[60:63], a[204:207], v[208:223]
  s_waitcnt lgkmcnt(0)
  v_mfma_f32_32x32x16_bf16 v[160:175], a[0:3], a[208:211], v[160:175]
  s_add_u32 s9, s6, 1
  s_add_u32 s9, s9, s11
  s_cmp_lt_u32 s4, s9
  s_cbranch_scc1 Llw_slow_104
Llw_back_105:
  v_mfma_f32_32x32x16_bf16 v[176:191], a[4:7], a[208:211], v[176:191]
  v_add_u32 v14, s5, v11
  ds_read_b64_tr_b16 a[32:33], v14 offset:0
  ds_read_b64_tr_b16 a[34:35], v14 offset:256
  ds_read_b64_tr_b16 a[36:37], v14 offset:64
  v_mfma_f32_32x32x16_bf16 v[192:207], a[8:11], a[208:211], v[192:207]
  ds_read_b64_tr_b16 a[38:39], v14 offset:320
  ds_read_b64_tr_b16 a[40:41], v14 offset:128
  ds_read_b64_tr_b16 a[42:43], v14 offset:384
  ds_read_b64_tr_b16 a[44:45], v14 offset:192
  ds_read_b64_tr_b16 a[46:47], v14 offset:448
  v_mfma_f32_32x32x16_bf16 v[208:223], a[12:15], a[208:211], v[208:223]
  ds_read_b64_tr_b16 a[48:49], v14 offset:4352
  ds_read_b64_tr_b16 a[50:51], v14 offset:4608
  ds_read_b64_tr_b16 a[52:53], v14 offset:4416
  ds_read_b64_tr_b16 a[54:55], v14 offset:4672
  ds_read_b64_tr_b16 a[56:57], v14 offset:4480
  v_mfma_f32_32x32x16_bf16 v[160:175], a[16:19], a[212:215], v[160:175]
  ds_read_b64_tr_b16 a[58:59], v14 offset:4736
  ds_read_b64_tr_b16 a[60:61], v14 offset:4544
  ds_read_b64_tr_b16 a[62:63], v14 offset:4800
  v_mov_b32 v21, s6
  ds_write_b32 v23, v21
  v_mfma_f32_32x32x16_bf16 v[176:191], a[20:23], a[212:215], v[176:191]
  s_add_u32 s6, s6, 1
  s_add_u32 s5, s5, 8704
  s_sub_u32 s28, s5, s72
  s_cmp_lt_u32 s5, s72
  s_cselect_b32 s5, s5, s28
  v_mfma_f32_32x32x16_bf16 v[192:207], a[24:27], a[212:215], v[192:207]
  v_mfma_f32_32x32x16_bf16 v[208:223], a[28:31], a[212:215], v[208:223]
  s_waitcnt lgkmcnt(0)
  v_mfma_f32_32x32x16_bf16 v[160:175], a[32:35], a[216:219], v[160:175]
  v_mfma_f32_32x32x16_bf16 v[176:191], a[36:39], a[216:219], v[176:191]
  v_mfma_f32_32x32x16_bf16 v[192:207], a[40:43], a[216:219], v[192:207]
  v_mov_b32 v21, s6
  v_mfma_f32_32x32x16_bf16 v[208:223], a[44:47], a[216:219], v[208:223]
  v_mfma_f32_32x32x16_bf16 v[160:175], a[48:51], a[220:223], v[160:175]
  v_mfma_f32_32x32x16_bf16 v[176:191], a[52:55], a[220:223], v[176:191]
  ds_write_b32 v23, v21
  v_mfma_f32_32x32x16_bf16 v[192:207], a[56:59], a[220:223], v[192:207]
  v_mfma_f32_32x32x16_bf16 v[208:223], a[60:63], a[220:223], v[208:223]
  s_nop 7
  s_nop 3
  s_mov_b32 s29, 0x3e0293ee
  v_mul_f32 v160, s29, v160
  v_mul_f32 v161, s29, v161
  v_cvt_pk_bf16_f32 v224, v160, v161
  v_mul_f32 v162, s29, v162
  v_mul_f32 v163, s29, v163
  v_cvt_pk_bf16_f32 v225, v162, v163
  v_mul_f32 v164, s29, v164
  v_mul_f32 v165, s29, v165
  v_cvt_pk_bf16_f32 v226, v164, v165
  v_mul_f32 v166, s29, v166
  v_mul_f32 v167, s29, v167
  v_cvt_pk_bf16_f32 v227, v166, v167
  v_mul_f32 v168, s29, v168
  v_mul_f32 v169, s29, v169
  v_cvt_pk_bf16_f32 v228, v168, v169
  v_mul_f32 v170, s29, v170
  v_mul_f32 v171, s29, v171
  v_cvt_pk_bf16_f32 v229, v170, v171
  v_mul_f32 v172, s29, v172
  v_mul_f32 v173, s29, v173
  v_cvt_pk_bf16_f32 v230, v172, v173
  v_mul_f32 v174, s29, v174
  v_mul_f32 v175, s29, v175
  v_cvt_pk_bf16_f32 v231, v174, v175
  v_mul_f32 v176, s29, v176
  v_mul_f32 v177, s29, v177
  v_cvt_pk_bf16_f32 v232, v176, v177
  v_mul_f32 v178, s29, v178
  v_mul_f32 v179, s29, v179
  v_cvt_pk_bf16_f32 v233, v178, v179
  v_mul_f32 v180, s29, v180
  v_mul_f32 v181, s29, v181
  v_cvt_pk_bf16_f32 v234, v180, v181
  v_mul_f32 v182, s29, v182
  v_mul_f32 v183, s29, v183
  v_cvt_pk_bf16_f32 v235, v182, v183
  v_mul_f32 v184, s29, v184
  v_mul_f32 v185, s29, v185
  v_cvt_pk_bf16_f32 v236, v184, v185
  v_mul_f32 v186, s29, v186
  v_mul_f32 v187, s29, v187
  v_cvt_pk_bf16_f32 v237, v186, v187
  v_mul_f32 v188, s29, v188
  v_mul_f32 v189, s29, v189
  v_cvt_pk_bf16_f32 v238, v188, v189
  v_mul_f32 v190, s29, v190
  v_mul_f32 v191, s29, v191
  v_cvt_pk_bf16_f32 v239, v190, v191
  v_mul_f32 v192, s29, v192
  v_mul_f32 v193, s29, v193
  v_cvt_pk_bf16_f32 v240, v192, v193
  v_mul_f32 v194, s29, v194
  v_mul_f32 v195, s29, v195
  v_cvt_pk_bf16_f32 v241, v194, v195
  v_mul_f32 v196, s29, v196
  v_mul_f32 v197, s29, v197
  v_cvt_pk_bf16_f32 v242, v196, v197
  v_mul_f32 v198, s29, v198
  v_mul_f32 v199, s29, v199
  v_cvt_pk_bf16_f32 v243, v198, v199
  v_mul_f32 v200, s29, v200
  v_mul_f32 v201, s29, v201
  v_cvt_pk_bf16_f32 v244, v200, v201
  v_mul_f32 v202, s29, v202
  v_mul_f32 v203, s29, v203
  v_cvt_pk_bf16_f32 v245, v202, v203
  v_mul_f32 v204, s29, v204
  v_mul_f32 v205, s29, v205
  v_cvt_pk_bf16_f32 v246, v204, v205
  v_mul_f32 v206, s29, v206
  v_mul_f32 v207, s29, v207
  v_cvt_pk_bf16_f32 v247, v206, v207
  v_mul_f32 v208, s29, v208
  v_mul_f32 v209, s29, v209
  v_cvt_pk_bf16_f32 v248, v208, v209
  v_mul_f32 v210, s29, v210
  v_mul_f32 v211, s29, v211
  v_cvt_pk_bf16_f32 v249, v210, v211
  v_mul_f32 v212, s29, v212
  v_mul_f32 v213, s29, v213
  v_cvt_pk_bf16_f32 v250, v212, v213
  v_mul_f32 v214, s29, v214
  v_mul_f32 v215, s29, v215
  v_cvt_pk_bf16_f32 v251, v214, v215
  v_mul_f32 v216, s29, v216
  v_mul_f32 v217, s29, v217
  v_cvt_pk_bf16_f32 v252, v216, v217
  v_mul_f32 v218, s29, v218
  v_mul_f32 v219, s29, v219
  v_cvt_pk_bf16_f32 v253, v218, v219
  v_mul_f32 v220, s29, v220
  v_mul_f32 v221, s29, v221
  v_cvt_pk_bf16_f32 v254, v220, v221
  v_mul_f32 v222, s29, v222
  v_mul_f32 v223, s29, v223
  v_cvt_pk_bf16_f32 v255, v222, v223
  s_mov_b32 s5, 95744
  s_mov_b32 s72, 156672
  v_mov_b32 v17, 0
  v_mov_b32 v18, 0
  s_add_u32 s9, s6, 1
  s_cmp_lt_u32 s4, s9
  s_cbranch_scc1 Llw_slow_106
Llw_back_107:
  v_add_u32 v12, s5, v8
  v_add_u32 v13, s5, v9
  ds_read_b128 a[64:67], v12 offset:0
  ds_read_b128 a[68:71], v13 offset:0
  ds_read_b128 a[72:75], v12 offset:64
  ds_read_b128 a[76:79], v13 offset:64
  ds_read_b128 a[80:83], v12 offset:128
  ds_read_b128 a[84:87], v13 offset:128
  ds_read_b128 a[88:91], v12 offset:192
  ds_read_b128 a[92:95], v13 offset:192
  s_waitcnt lgkmcnt(0)
  v_mfma_f32_32x32x16_bf16 v[128:143], a[64:67], v[224:227], 0
  v_mov_b32 v64, 0
  v_mov_b32 v65, 0
  v_mov_b32 v66, 0
  v_mov_b32 v67, 0
  v_mov_b32 v68, 0
  v_mov_b32 v69, 0
  v_mov_b32 v70, 0
  v_mov_b32 v71, 0
  v_mfma_f32_32x32x16_bf16 v[128:143], a[68:71], v[228:231], v[128:143]
  v_mov_b32 v72, 0
  v_mov_b32 v73, 0
  v_mov_b32 v74, 0
  v_mov_b32 v75, 0
  v_mov_b32 v76, 0
  v_mov_b32 v77, 0
  v_mov_b32 v78, 0
  v_mov_b32 v79, 0
  v_mfma_f32_32x32x16_bf16 v[128:143], a[72:75], v[232:235], v[128:143]
  v_mov_b32 v80, 0
  v_mov_b32 v81, 0
  v_mov_b32 v82, 0
  v_mov_b32 v83, 0
  v_mov_b32 v84, 0
  v_mov_b32 v85, 0
  v_mov_b32 v86, 0
  v_mov_b32 v87, 0
  v_mfma_f32_32x32x16_bf16 v[128:143], a[76:79], v[236:239], v[128:143]
  v_mov_b32 v88, 0
  v_mov_b32 v89, 0
  v_mov_b32 v90, 0
  v_mov_b32 v91, 0
  v_mov_b32 v92, 0
  v_mov_b32 v93, 0
  v_mov_b32 v94, 0
  v_mov_b32 v95, 0
  v_mfma_f32_32x32x16_bf16 v[128:143], a[80:83], v[240:243], v[128:143]
  v_mov_b32 v96, 0
  v_mov_b32 v97, 0
  v_mov_b32 v98, 0
  v_mov_b32 v99, 0
  v_mov_b32 v100, 0
  v_mov_b32 v101, 0
  v_mov_b32 v102, 0
  v_mov_b32 v103, 0
  v_mfma_f32_32x32x16_bf16 v[128:143], a[84:87], v[244:247], v[128:143]
  v_mov_b32 v104, 0
  v_mov_b32 v105, 0
  v_mov_b32 v106, 0
  v_mov_b32 v107, 0
  v_mov_b32 v108, 0
  v_mov_b32 v109, 0
  v_mov_b32 v110, 0
  v_mov_b32 v111, 0
  v_mfma_f32_32x32x16_bf16 v[128:143], a[88:91], v[248:251], v[128:143]
  v_mov_b32 v112, 0
  v_mov_b32 v113, 0
  v_mov_b32 v114, 0
  v_mov_b32 v115, 0
  v_mov_b32 v116, 0
  v_mov_b32 v117, 0
  v_mov_b32 v118, 0
  v_mov_b32 v119, 0
  v_mfma_f32_32x32x16_bf16 v[128:143], a[92:95], v[252:255], v[128:143]
  v_mov_b32 v120, 0
  v_mov_b32 v121, 0
  v_mov_b32 v122, 0
  v_mov_b32 v123, 0
  v_mov_b32 v124, 0
  v_mov_b32 v125, 0
  v_mov_b32 v126, 0
  v_mov_b32 v127, 0
  s_add_u32 s5, s5, 8704
  s_sub_u32 s28, s5, s72
  s_cmp_lt_u32 s5, s72
  s_cselect_b32 s5, s5, s28
  s_add_u32 s9, s6, 3
  s_cmp_lt_u32 s4, s9
  s_cbranch_scc1 Llw_slow_108
Llw_back_109:
  v_add_u32 v12, s5, v8
  v_add_u32 v13, s5, v9
  s_add_u32 s5, s5, 8704
  s_sub_u32 s28, s5, s72
  s_cmp_lt_u32 s5, s72
  s_cselect_b32 s5, s5, s28
  v_add_u32 v14, s5, v10
  ds_read_b128 a[64:67], v12 offset:0
  ds_read_b128 a[68:71], v13 offset:0
  ds_read_b128 a[72:75], v12 offset:64
  ds_read_b128 a[76:79], v13 offset:64
  ds_read_b128 a[80:83], v12 offset:128
  ds_read_b128 a[84:87], v13 offset:128
  ds_read_b128 a[88:91], v12 offset:192
  ds_read_b128 a[92:95], v13 offset:192
  ds_read_b64_tr_b16 a[96:97], v14 offset:0
  ds_read_b64_tr_b16 a[98:99], v14 offset:512
  ds_read_b64_tr_b16 a[100:101], v14 offset:64
  ds_read_b64_tr_b16 a[102:103], v14 offset:576
  ds_read_b64_tr_b16 a[104:105], v14 offset:128
  ds_read_b64_tr_b16 a[106:107], v14 offset:640
  ds_read_b64_tr_b16 a[108:109], v14 offset:192
  ds_read_b64_tr_b16 a[110:111], v14 offset:704
  ds_read_b64_tr_b16 a[112:113], v14 offset:4352
  ds_read_b64_tr_b16 a[114:115], v14 offset:4864
  ds_read_b64_tr_b16 a[116:117], v14 offset:4416
  ds_read_b64_tr_b16 a[118:119], v14 offset:4928
  ds_read_b64_tr_b16 a[120:121], v14 offset:4480
  ds_read_b64_tr_b16 a[122:123], v14 offset:4992
  ds_read_b64_tr_b16 a[124:125], v14 offset:4544
  ds_read_b64_tr_b16 a[126:127], v14 offset:5056
  s_add_u32 s5, s5, 8704
  s_sub_u32 s28, s5, s72
  s_cmp_lt_u32 s5, s72
  s_cselect_b32 s5, s5, s28
  s_add_u32 s6, s6, 3
  v_max3_f32 v19, v128, v129, v130
  v_max3_f32 v19, v19, v131, v132
  v_max3_f32 v19, v19, v133, v134
  v_max3_f32 v19, v19, v135, v136
  v_max3_f32 v19, v19, v137, v138
  v_max3_f32 v19, v19, v139, v140
  v_max3_f32 v19, v19, v141, v142
  v_max_f32 v19, v19, v143
  v_mov_b32 v1, v19
  s_nop 1
  v_permlane32_swap_b32 v19, v1
  s_nop 1
  v_max_f32 v19, v19, v1
  v_sub_f32 v128, v128, v19
  v_sub_f32 v129, v129, v19
  v_sub_f32 v130, v130, v19
  v_sub_f32 v131, v131, v19
  v_sub_f32 v132, v132, v19
  v_sub_f32 v133, v133, v19
  v_sub_f32 v134, v134, v19
  v_sub_f32 v135, v135, v19
  v_sub_f32 v136, v136, v19
  v_sub_f32 v137, v137, v19
  v_sub_f32 v138, v138, v19
  v_sub_f32 v139, v139, v19
  v_sub_f32 v140, v140, v19
  v_sub_f32 v141, v141, v19
  v_sub_f32 v142, v142, v19
  v_sub_f32 v143, v143, v19
  v_sub_f32 v48, 0, v19
  v_mov_b32 v49, v48
  v_mov_b32 v50, v48
  v_mov_b32 v51, v48
  v_mov_b32 v52, v48
  v_mov_b32 v53, v48
  v_mov_b32 v54, v48
  v_mov_b32 v55, v48
  v_mov_b32 v56, v48
  v_mov_b32 v57, v48
  v_mov_b32 v58, v48
  v_mov_b32 v59, v48
  v_mov_b32 v60, v48
  v_mov_b32 v61, v48
  v_mov_b32 v62, v48
  v_mov_b32 v63, v48
  s_mov_b32 s76, 0x42
  s_mov_b32 s7, 0
Lattn_111:
  s_waitcnt lgkmcnt(15)
  v_mfma_f32_32x32x16_bf16 v[144:159], a[64:67], v[224:227], v[48:63]
  v_exp_f32 v128, v128
  v_exp_f32 v129, v129
  s_add_u32 s9, s6, 2
  s_cmp_lt_u32 s4, s9
  s_cbranch_scc1 Llw_slow_112
Llw_back_113:
  v_mfma_f32_32x32x16_bf16 v[144:159], a[68:71], v[228:231], v[144:159]
  v_exp_f32 v130, v130
  v_exp_f32 v131, v131
  v_cvt_pk_bf16_f32 v32, v128, v129
  v_add_u32 v12, s5, v8
  s_add_u32 s10, s5, 8704
  v_mfma_f32_32x32x16_bf16 v[144:159], a[72:75], v[232:235], v[144:159]
  v_exp_f32 v132, v132
  v_exp_f32 v133, v133
  v_cvt_pk_bf16_f32 v33, v130, v131
  v_add_u32 v13, s5, v9
  s_cmp_lt_u32 s10, 156672
  v_mfma_f32_32x32x16_bf16 v[144:159], a[76:79], v[236:239], v[144:159]
  v_exp_f32 v134, v134
  v_exp_f32 v135, v135
  v_cvt_pk_bf16_f32 v34, v132, v133
  s_cselect_b32 s10, s10, 0
  v_mov_b32 v21, s6
  v_mfma_f32_32x32x16_bf16 v[144:159], a[80:83], v[240:243], v[144:159]
  v_exp_f32 v136, v136
  v_exp_f32 v137, v137
  v_cvt_pk_bf16_f32 v35, v134, v135
  v_add_u32 v14, s10, v10
  v_mfma_f32_32x32x16_bf16 v[144:159], a[84:87], v[244:247], v[144:159]
  v_exp_f32 v138, v138
  v_exp_f32 v139, v139
  v_cvt_pk_bf16_f32 v36, v136, v137
  s_add_u32 s5, s10, 8704
  v_mfma_f32_32x32x16_bf16 v[144:159], a[88:91], v[248:251], v[144:159]
  v_exp_f32 v140, v140
  v_exp_f32 v141, v141
  v_cvt_pk_bf16_f32 v37, v138, v139
  s_cmp_lt_u32 s5, 156672
  v_mfma_f32_32x32x16_bf16 v[144:159], a[92:95], v[252:255], v[144:159]
  v_exp_f32 v142, v142
  v_exp_f32 v143, v143
  v_cvt_pk_bf16_f32 v38, v140, v141
  v_cvt_pk_bf16_f32 v39, v142, v143
  s_cselect_b32 s5, s5, 0
  s_waitcnt lgkmcnt(0)
  v_mfma_f32_32x32x16_bf16 v[64:79], a[96:99], v[32:35], v[64:79]
  ds_write_b32 v23, v21
  ds_read_b128 a[64:67], v12 offset:0
  ds_read_b128 a[68:71], v13 offset:0
  ds_read_b128 a[72:75], v12 offset:64
  v_add_f32 v17, v17, v128
  v_add_f32 v18, v18, v129
  v_mfma_f32_32x32x16_bf16 v[80:95], a[100:103], v[32:35], v[80:95]
  ds_read_b128 a[76:79], v13 offset:64
  ds_read_b128 a[80:83], v12 offset:128
  ds_read_b128 a[84:87], v13 offset:128
  v_add_f32 v17, v17, v130
  v_add_f32 v18, v18, v131
  s_add_u32 s6, s6, 2
  v_mfma_f32_32x32x16_bf16 v[96:111], a[104:107], v[32:35], v[96:111]
  ds_read_b128 a[88:91], v12 offset:192
  ds_read_b128 a[92:95], v13 offset:192
  ds_read_b64_tr_b16 a[128:129], v14 offset:0
  v_add_f32 v17, v17, v132
  v_add_f32 v18, v18, v133
  v_mfma_f32_32x32x16_bf16 v[112:127], a[108:111], v[32:35], v[112:127]
  ds_read_b64_tr_b16 a[130:131], v14 offset:512
  ds_read_b64_tr_b16 a[132:133], v14 offset:64
  ds_read_b64_tr_b16 a[134:135], v14 offset:576
  v_add_f32 v17, v17, v134
  v_add_f32 v18, v18, v135
  v_max3_f32 v19, v144, v145, v146
  v_mfma_f32_32x32x16_bf16 v[64:79], a[112:115], v[36:39], v[64:79]
  ds_read_b64_tr_b16 a[136:137], v14 offset:128
  ds_read_b64_tr_b16 a[138:139], v14 offset:640
  ds_read_b64_tr_b16 a[140:141], v14 offset:192
  v_add_f32 v17, v17, v136
  v_add_f32 v18, v18, v137
  v_max3_f32 v19, v19, v147, v148
  v_mfma_f32_32x32x16_bf16 v[80:95], a[116:119], v[36:39], v[80:95]
  ds_read_b64_tr_b16 a[142:143], v14 offset:704
  ds_read_b64_tr_b16 a[144:145], v14 offset:4352
  ds_read_b64_tr_b16 a[146:147], v14 offset:4864
  v_add_f32 v17, v17, v138
  v_add_f32 v18, v18, v139
  v_max3_f32 v19, v19, v149, v150
  v_mfma_f32_32x32x16_bf16 v[96:111], a[120:123], v[36:39], v[96:111]
  ds_read_b64_tr_b16 a[148:149], v14 offset:4416
  ds_read_b64_tr_b16 a[150:151], v14 offset:4928
  ds_read_b64_tr_b16 a[152:153], v14 offset:4480
  v_add_f32 v17, v17, v140
  v_add_f32 v18, v18, v141
  v_max3_f32 v19, v19, v151, v152
  v_max3_f32 v19, v19, v153, v154
  v_mfma_f32_32x32x16_bf16 v[112:127], a[124:127], v[36:39], v[112:127]
  ds_read_b64_tr_b16 a[154:155], v14 offset:4992
  ds_read_b64_tr_b16 a[156:157], v14 offset:4544
  ds_read_b64_tr_b16 a[158:159], v14 offset:5056
  v_add_f32 v17, v17, v142
  v_add_f32 v18, v18, v143
  v_max3_f32 v19, v19, v155, v156
  v_max3_f32 v19, v19, v157, v158
  v_max_f32 v19, v19, v159
  v_cmp_lt_f32 vcc, s8, v19
  s_cbranch_vccnz Lrare_114
Lback_115:
  s_waitcnt lgkmcnt(15)
  v_mfma_f32_32x32x16_bf16 v[128:143], a[64:67], v[224:227], v[48:63]
  v_exp_f32 v144, v144
  v_exp_f32 v145, v145
  s_add_u32 s9, s6, 2
  s_cmp_lt_u32 s4, s9
  s_cbranch_scc1 Llw_slow_116
Llw_back_117:
  v_mfma_f32_32x32x16_bf16 v[128:143], a[68:71], v[228:231], v[128:143]
  v_exp_f32 v146, v146
  v_exp_f32 v147, v147
  v_cvt_pk_bf16_f32 v32, v144, v145
  v_add_u32 v12, s5, v8
  s_add_u32 s10, s5, 8704
  v_mfma_f32_32x32x16_bf16 v[128:143], a[72:75], v[232:235], v[128:143]
  v_exp_f32 v148, v148
  v_exp_f32 v149, v149
  v_cvt_pk_bf16_f32 v33, v146, v147
  v_add_u32 v13, s5, v9
  s_cmp_lt_u32 s10, 156672
  v_mfma_f32_32x32x16_bf16 v[128:143], a[76:79], v[236:239], v[128:143]
  v_exp_f32 v150, v150
  v_exp_f32 v151, v151
  v_cvt_pk_bf16_f32 v34, v148, v149
  s_cselect_b32 s10, s10, 0
  v_mov_b32 v21, s6
  v_mfma_f32_32x32x16_bf16 v[128:143], a[80:83], v[240:243], v[128:143]
  v_exp_f32 v152, v152
  v_exp_f32 v153, v153
  v_cvt_pk_bf16_f32 v35, v150, v151
  v_add_u32 v14, s10, v10
  v_mfma_f32_32x32x16_bf16 v[128:143], a[84:87], v[244:247], v[128:143]
  v_exp_f32 v154, v154
  v_exp_f32 v155, v155
  v_cvt_pk_bf16_f32 v36, v152, v153
  s_add_u32 s5, s10, 8704
  v_mfma_f32_32x32x16_bf16 v[128:143], a[88:91], v[248:251], v[128:143]
  v_exp_f32 v156, v156
  v_exp_f32 v157, v157
  v_cvt_pk_bf16_f32 v37, v154, v155
  s_cmp_lt_u32 s5, 156672
  v_mfma_f32_32x32x16_bf16 v[128:143], a[92:95], v[252:255], v[128:143]
  v_exp_f32 v158, v158
  v_exp_f32 v159, v159
  v_cvt_pk_bf16_f32 v38, v156, v157
  v_cvt_pk_bf16_f32 v39, v158, v159
  s_cselect_b32 s5, s5, 0
  s_waitcnt lgkmcnt(0)
  v_mfma_f32_32x32x16_bf16 v[64:79], a[128:131], v[32:35], v[64:79]
  ds_write_b32 v23, v21
  ds_read_b128 a[64:67], v12 offset:0
  ds_read_b128 a[68:71], v13 offset:0
  ds_read_b128 a[72:75], v12 offset:64
  v_add_f32 v17, v17, v144
  v_add_f32 v18, v18, v145
  v_mfma_f32_32x32x16_bf16 v[80:95], a[132:135], v[32:35], v[80:95]
  ds_read_b128 a[76:79], v13 offset:64
  ds_read_b128 a[80:83], v12 offset:128
  ds_read_b128 a[84:87], v13 offset:128
  v_add_f32 v17, v17, v146
  v_add_f32 v18, v18, v147
  s_add_u32 s6, s6, 2
  v_mfma_f32_32x32x16_bf16 v[96:111], a[136:139], v[32:35], v[96:111]
  ds_read_b128 a[88:91], v12 offset:192
  ds_read_b128 a[92:95], v13 offset:192
  ds_read_b64_tr_b16 a[96:97], v14 offset:0
  v_add_f32 v17, v17, v148
  v_add_f32 v18, v18, v149
  v_mfma_f32_32x32x16_bf16 v[112:127], a[140:143], v[32:35], v[112:127]
  ds_read_b64_tr_b16 a[98:99], v14 offset:512
  ds_read_b64_tr_b16 a[100:101], v14 offset:64
  ds_read_b64_tr_b16 a[102:103], v14 offset:576
  v_add_f32 v17, v17, v150
  v_add_f32 v18, v18, v151
  v_max3_f32 v19, v128, v129, v130
  v_mfma_f32_32x32x16_bf16 v[64:79], a[144:147], v[36:39], v[64:79]
  ds_read_b64_tr_b16 a[104:105], v14 offset:128
  ds_read_b64_tr_b16 a[106:107], v14 offset:640
  ds_read_b64_tr_b16 a[108:109], v14 offset:192
  v_add_f32 v17, v17, v152
  v_add_f32 v18, v18, v153
  v_max3_f32 v19, v19, v131, v132
  v_mfma_f32_32x32x16_bf16 v[80:95], a[148:151], v[36:39], v[80:95]
  ds_read_b64_tr_b16 a[110:111], v14 offset:704
  ds_read_b64_tr_b16 a[112:113], v14 offset:4352
  ds_read_b64_tr_b16 a[114:115], v14 offset:4864
  v_add_f32 v17, v17, v154
  v_add_f32 v18, v18, v155
  v_max3_f32 v19, v19, v133, v134
  v_mfma_f32_32x32x16_bf16 v[96:111], a[152:155], v[36:39], v[96:111]
  ds_read_b64_tr_b16 a[116:117], v14 offset:4416
  ds_read_b64_tr_b16 a[118:119], v14 offset:4928
  ds_read_b64_tr_b16 a[120:121], v14 offset:4480
  v_add_f32 v17, v17, v156
  v_add_f32 v18, v18, v157
  v_max3_f32 v19, v19, v135, v136
  v_max3_f32 v19, v19, v137, v138
  v_mfma_f32_32x32x16_bf16 v[112:127], a[156:159], v[36:39], v[112:127]
  ds_read_b64_tr_b16 a[122:123], v14 offset:4992
  ds_read_b64_tr_b16 a[124:125], v14 offset:4544
  ds_read_b64_tr_b16 a[126:127], v14 offset:5056
  v_add_f32 v17, v17, v158
  v_add_f32 v18, v18, v159
  v_max3_f32 v19, v19, v139, v140
  v_max3_f32 v19, v19, v141, v142
  v_max_f32 v19, v19, v143
  v_cmp_lt_f32 vcc, s8, v19
  s_cbranch_vccnz Lrare_118
Lback_119:
  s_cmp_eq_u32 s7, 0
  s_cbranch_scc1 Lchfirst_120
  v_mfma_f32_32x32x16_bf16 v[160:175], a[32:35], a[184:187], v[160:175]
  s_add_u32 s9, s6, 4
  s_cmp_lt_u32 s4, s9
  s_cbranch_scc1 Llw_slow_122
Llw_back_123:
  s_mul_i32 s29, s3, 8704
  s_add_u32 s10, s5, s29
  s_add_u32 s10, s10, 0
  s_sub_u32 s28, s10, s72
  s_cmp_lt_u32 s10, s72
  s_cselect_b32 s10, s10, s28
  v_add_u32 v12, s10, v8
  v_add_u32 v13, s10, v9
  s_add_u32 s5, s5, 26112
  s_sub_u32 s28, s5, s72
  s_cmp_lt_u32 s5, s72
  s_cselect_b32 s5, s5, s28
  v_add_u32 v14, s5, v11
  v_mfma_f32_32x32x16_bf16 v[176:191], a[36:39], a[184:187], v[176:191]
  ds_read_b128 a[160:163], v12 offset:0
  ds_read_b128 a[164:167], v13 offset:0
  ds_read_b128 a[168:171], v12 offset:64
  v_mfma_f32_32x32x16_bf16 v[192:207], a[40:43], a[184:187], v[192:207]
  ds_read_b128 a[172:175], v13 offset:64
  ds_read_b128 a[176:179], v12 offset:128
  ds_read_b128 a[180:183], v13 offset:128
  ds_read_b64_tr_b16 a[0:1], v14 offset:0
  v_mfma_f32_32x32x16_bf16 v[208:223], a[44:47], a[184:187], v[208:223]
  ds_read_b64_tr_b16 a[2:3], v14 offset:256
  ds_read_b64_tr_b16 a[4:5], v14 offset:64
  ds_read_b64_tr_b16 a[6:7], v14 offset:320
  ds_read_b64_tr_b16 a[8:9], v14 offset:128
  v_mfma_f32_32x32x16_bf16 v[160:175], a[48:51], a[188:191], v[160:175]
  ds_read_b128 a[184:187], v12 offset:192
  ds_read_b64_tr_b16 a[10:11], v14 offset:384
  ds_read_b64_tr_b16 a[12:13], v14 offset:192
  ds_read_b64_tr_b16 a[14:15], v14 offset:448
  v_mfma_f32_32x32x16_bf16 v[176:191], a[52:55], a[188:191], v[176:191]
  ds_read_b64_tr_b16 a[16:17], v14 offset:4352
  ds_read_b64_tr_b16 a[18:19], v14 offset:4608
  ds_read_b64_tr_b16 a[20:21], v14 offset:4416
  ds_read_b64_tr_b16 a[22:23], v14 offset:4672
  v_mfma_f32_32x32x16_bf16 v[192:207], a[56:59], a[188:191], v[192:207]
  ds_read_b64_tr_b16 a[24:25], v14 offset:4480
  ds_read_b64_tr_b16 a[26:27], v14 offset:4736
  ds_read_b64_tr_b16 a[28:29], v14 offset:4544
  ds_read_b64_tr_b16 a[30:31], v14 offset:4800
  v_mfma_f32_32x32x16_bf16 v[208:223], a[60:63], a[188:191], v[208:223]
  ds_read_b128 a[188:191], v13 offset:192
  s_add_u32 s5, s5, 8704
  s_cmp_lt_u32 s5, 156672
  s_cselect_b32 s5, s5, 0
  s_add_u32 s6, s6, 4
Lchback_121:
  s_add_u32 s7, s7, 1
  s_bitcmp1_b32 s76, s7
  s_cbranch_scc1 Levstub_124
Levback_125:
  s_waitcnt lgkmcnt(15)
  v_mfma_f32_32x32x16_bf16 v[144:159], a[64:67], v[224:227], v[48:63]
  v_exp_f32 v128, v128
  v_exp_f32 v129, v129
  s_add_u32 s9, s6, 2
  s_cmp_lt_u32 s4, s9
  s_cbranch_scc1 Llw_slow_126
Llw_back_127:
  v_mfma_f32_32x32x16_bf16 v[144:159], a[68:71], v[228:231], v[144:159]
  v_exp_f32 v130, v130
  v_exp_f32 v131, v131
  v_cvt_pk_bf16_f32 v32, v128, v129
  v_add_u32 v12, s5, v8
  s_add_u32 s10, s5, 8704
  v_mfma_f32_32x32x16_bf16 v[144:159], a[72:75], v[232:235], v[144:159]
  v_exp_f32 v132, v132
  v_exp_f32 v133, v133
  v_cvt_pk_bf16_f32 v33, v130, v131
  v_add_u32 v13, s5, v9
  s_cmp_lt_u32 s10, 156672
  v_mfma_f32_32x32x16_bf16 v[144:159], a[76:79], v[236:239], v[144:159]
  v_exp_f32 v134, v134
  v_exp_f32 v135, v135
  v_cvt_pk_bf16_f32 v34, v132, v133
  s_cselect_b32 s10, s10, 0
  v_mov_b32 v21, s6
  v_mfma_f32_32x32x16_bf16 v[144:159], a[80:83], v[240:243], v[144:159]
  v_exp_f32 v136, v136
  v_exp_f32 v137, v137
  v_cvt_pk_bf16_f32 v35, v134, v135
  v_add_u32 v14, s10, v10
  v_mfma_f32_32x32x16_bf16 v[144:159], a[84:87], v[244:247], v[144:159]
  v_exp_f32 v138, v138
  v_exp_f32 v139, v139
  v_cvt_pk_bf16_f32 v36, v136, v137
  s_add_u32 s5, s10, 8704
  v_mfma_f32_32x32x16_bf16 v[144:159], a[88:91], v[248:251], v[144:159]
  v_exp_f32 v140, v140
  v_exp_f32 v141, v141
  v_cvt_pk_bf16_f32 v37, v138, v139
  s_cmp_lt_u32 s5, 156672
  v_mfma_f32_32x32x16_bf16 v[144:159], a[92:95], v[252:255], v[144:159]
  v_exp_f32 v142, v142
  v_exp_f32 v143, v143
  v_cvt_pk_bf16_f32 v38, v140, v141
  v_cvt_pk_bf16_f32 v39, v142, v143
  s_cselect_b32 s5, s5, 0
  s_waitcnt lgkmcnt(0)
  v_mfma_f32_32x32x16_bf16 v[64:79], a[96:99], v[32:35], v[64:79]
  ds_write_b32 v23, v21
  ds_read_b128 a[64:67], v12 offset:0
  ds_read_b128 a[68:71], v13 offset:0
  ds_read_b128 a[72:75], v12 offset:64
  v_add_f32 v17, v17, v128
  v_add_f32 v18, v18, v129
  v_mfma_f32_32x32x16_bf16 v[80:95], a[100:103], v[32:35], v[80:95]
  ds_read_b128 a[76:79], v13 offset:64
  ds_read_b128 a[80:83], v12 offset:128
  ds_read_b128 a[84:87], v13 offset:128
  v_add_f32 v17, v17, v130
  v_add_f32 v18, v18, v131
  s_add_u32 s6, s6, 2
  v_mfma_f32_32x32x16_bf16 v[96:111], a[104:107], v[32:35], v[96:111]
  ds_read_b128 a[88:91], v12 offset:192
  ds_read_b128 a[92:95], v13 offset:192
  ds_read_b64_tr_b16 a[128:129], v14 offset:0
  v_add_f32 v17, v17, v132
  v_add_f32 v18, v18, v133
  v_mfma_f32_32x32x16_bf16 v[112:127], a[108:111], v[32:35], v[112:127]
  ds_read_b64_tr_b16 a[130:131], v14 offset:512
  ds_read_b64_tr_b16 a[132:133], v14 offset:64
  ds_read_b64_tr_b16 a[134:135], v14 offset:576
  v_add_f32 v17, v17, v134
  v_add_f32 v18, v18, v135
  v_max3_f32 v19, v144, v145, v146
  v_mfma_f32_32x32x16_bf16 v[64:79], a[112:115], v[36:39], v[64:79]
  ds_read_b64_tr_b16 a[136:137], v14 offset:128
  ds_read_b64_tr_b16 a[138:139], v14 offset:640
  ds_read_b64_tr_b16 a[140:141], v14 offset:192
  v_add_f32 v17, v17, v136
  v_add_f32 v18, v18, v137
  v_max3_f32 v19, v19, v147, v148
  v_mfma_f32_32x32x16_bf16 v[80:95], a[116:119], v[36:39], v[80:95]
  ds_read_b64_tr_b16 a[142:143], v14 offset:704
  ds_read_b64_tr_b16 a[144:145], v14 offset:4352
  ds_read_b64_tr_b16 a[146:147], v14 offset:4864
  v_add_f32 v17, v17, v138
  v_add_f32 v18, v18, v139
  v_max3_f32 v19, v19, v149, v150
  v_mfma_f32_32x32x16_bf16 v[96:111], a[120:123], v[36:39], v[96:111]
  ds_read_b64_tr_b16 a[148:149], v14 offset:4416
  ds_read_b64_tr_b16 a[150:151], v14 offset:4928
  ds_read_b64_tr_b16 a[152:153], v14 offset:4480
  v_add_f32 v17, v17, v140
  v_add_f32 v18, v18, v141
  v_max3_f32 v19, v19, v151, v152
  v_max3_f32 v19, v19, v153, v154
  v_mfma_f32_32x32x16_bf16 v[112:127], a[124:127], v[36:39], v[112:127]
  ds_read_b64_tr_b16 a[154:155], v14 offset:4992
  ds_read_b64_tr_b16 a[156:157], v14 offset:4544
  ds_read_b64_tr_b16 a[158:159], v14 offset:5056
  v_add_f32 v17, v17, v142
  v_add_f32 v18, v18, v143
  v_max3_f32 v19, v19, v155, v156
  v_max3_f32 v19, v19, v157, v158
  v_max_f32 v19, v19, v159
  v_cmp_lt_f32 vcc, s8, v19
  s_cbranch_vccnz Lrare_128
Lback_129:
  s_waitcnt lgkmcnt(15)
  v_mfma_f32_32x32x16_bf16 v[128:143], a[64:67], v[224:227], v[48:63]
  v_exp_f32 v144, v144
  v_exp_f32 v145, v145
  s_add_u32 s9, s6, 2
  s_cmp_lt_u32 s4, s9
  s_cbranch_scc1 Llw_slow_130
Llw_back_131:
  v_mfma_f32_32x32x16_bf16 v[128:143], a[68:71], v[228:231], v[128:143]
  v_exp_f32 v146, v146
  v_exp_f32 v147, v147
  v_cvt_pk_bf16_f32 v32, v144, v145
  v_add_u32 v12, s5, v8
  s_add_u32 s10, s5, 8704
  v_mfma_f32_32x32x16_bf16 v[128:143], a[72:75], v[232:235], v[128:143]
  v_exp_f32 v148, v148
  v_exp_f32 v149, v149
  v_cvt_pk_bf16_f32 v33, v146, v147
  v_add_u32 v13, s5, v9
  s_cmp_lt_u32 s10, 156672
  v_mfma_f32_32x32x16_bf16 v[128:143], a[76:79], v[236:239], v[128:143]
  v_exp_f32 v150, v150
  v_exp_f32 v151, v151
  v_cvt_pk_bf16_f32 v34, v148, v149
  s_cselect_b32 s10, s10, 0
  v_mov_b32 v21, s6
  v_mfma_f32_32x32x16_bf16 v[128:143], a[80:83], v[240:243], v[128:143]
  v_exp_f32 v152, v152
  v_exp_f32 v153, v153
  v_cvt_pk_bf16_f32 v35, v150, v151
  v_add_u32 v14, s10, v10
  v_mfma_f32_32x32x16_bf16 v[128:143], a[84:87], v[244:247], v[128:143]
  v_exp_f32 v154, v154
  v_exp_f32 v155, v155
  v_cvt_pk_bf16_f32 v36, v152, v153
  s_add_u32 s5, s10, 8704
  v_mfma_f32_32x32x16_bf16 v[128:143], a[88:91], v[248:251], v[128:143]
  v_exp_f32 v156, v156
  v_exp_f32 v157, v157
  v_cvt_pk_bf16_f32 v37, v154, v155
  s_cmp_lt_u32 s5, 156672
  v_mfma_f32_32x32x16_bf16 v[128:143], a[92:95], v[252:255], v[128:143]
  v_exp_f32 v158, v158
  v_exp_f32 v159, v159
  v_cvt_pk_bf16_f32 v38, v156, v157
  v_cvt_pk_bf16_f32 v39, v158, v159
  s_cselect_b32 s5, s5, 0
  s_waitcnt lgkmcnt(0)
  v_mfma_f32_32x32x16_bf16 v[64:79], a[128:131], v[32:35], v[64:79]
  ds_write_b32 v23, v21
  ds_read_b128 a[64:67], v12 offset:0
  ds_read_b128 a[68:71], v13 offset:0
  ds_read_b128 a[72:75], v12 offset:64
  v_add_f32 v17, v17, v144
  v_add_f32 v18, v18, v145
  v_mfma_f32_32x32x16_bf16 v[80:95], a[132:135], v[32:35], v[80:95]
  ds_read_b128 a[76:79], v13 offset:64
  ds_read_b128 a[80:83], v12 offset:128
  ds_read_b128 a[84:87], v13 offset:128
  v_add_f32 v17, v17, v146
  v_add_f32 v18, v18, v147
  s_add_u32 s6, s6, 2
  v_mfma_f32_32x32x16_bf16 v[96:111], a[136:139], v[32:35], v[96:111]
  ds_read_b128 a[88:91], v12 offset:192
  ds_read_b128 a[92:95], v13 offset:192
  ds_read_b64_tr_b16 a[96:97], v14 offset:0
  v_add_f32 v17, v17, v148
  v_add_f32 v18, v18, v149
  v_mfma_f32_32x32x16_bf16 v[112:127], a[140:143], v[32:35], v[112:127]
  ds_read_b64_tr_b16 a[98:99], v14 offset:512
  ds_read_b64_tr_b16 a[100:101], v14 offset:64
  ds_read_b64_tr_b16 a[102:103], v14 offset:576
  v_add_f32 v17, v17, v150
  v_add_f32 v18, v18, v151
  v_max3_f32 v19, v128, v129, v130
  v_mfma_f32_32x32x16_bf16 v[64:79], a[144:147], v[36:39], v[64:79]
  ds_read_b64_tr_b16 a[104:105], v14 offset:128
  ds_read_b64_tr_b16 a[106:107], v14 offset:640
  ds_read_b64_tr_b16 a[108:109], v14 offset:192
  v_add_f32 v17, v17, v152
  v_add_f32 v18, v18, v153
  v_max3_f32 v19, v19, v131, v132
  v_mfma_f32_32x32x16_bf16 v[80:95], a[148:151], v[36:39], v[80:95]
  ds_read_b64_tr_b16 a[110:111], v14 offset:704
  ds_read_b64_tr_b16 a[112:113], v14 offset:4352
  ds_read_b64_tr_b16 a[114:115], v14 offset:4864
  v_add_f32 v17, v17, v154
  v_add_f32 v18, v18, v155
  v_max3_f32 v19, v19, v133, v134
  v_mfma_f32_32x32x16_bf16 v[96:111], a[152:155], v[36:39], v[96:111]
  ds_read_b64_tr_b16 a[116:117], v14 offset:4416
  ds_read_b64_tr_b16 a[118:119], v14 offset:4928
  ds_read_b64_tr_b16 a[120:121], v14 offset:4480
  v_add_f32 v17, v17, v156
  v_add_f32 v18, v18, v157
  v_max3_f32 v19, v19, v135, v136
  v_max3_f32 v19, v19, v137, v138
  v_mfma_f32_32x32x16_bf16 v[112:127], a[156:159], v[36:39], v[112:127]
  ds_read_b64_tr_b16 a[122:123], v14 offset:4992
  ds_read_b64_tr_b16 a[124:125], v14 offset:4544
  ds_read_b64_tr_b16 a[126:127], v14 offset:5056
  v_add_f32 v17, v17, v158
  v_add_f32 v18, v18, v159
  v_max3_f32 v19, v19, v139, v140
  v_max3_f32 v19, v19, v141, v142
  v_max_f32 v19, v19, v143
  v_cmp_lt_f32 vcc, s8, v19
  s_cbranch_vccnz Lrare_132
Lback_133:
  v_mfma_f32_32x32x16_bf16 v[160:175], a[0:3], a[160:163], v[160:175]
  s_add_u32 s9, s6, 1
  s_cmp_lt_u32 s4, s9
  s_cbranch_scc1 Llw_slow_134
Llw_back_135:
  v_add_u32 v14, s5, v11
  v_mfma_f32_32x32x16_bf16 v[176:191], a[4:7], a[160:163], v[176:191]
  ds_read_b64_tr_b16 a[32:33], v14 offset:0
  ds_read_b64_tr_b16 a[34:35], v14 offset:256
  v_mfma_f32_32x32x16_bf16 v[192:207], a[8:11], a[160:163], v[192:207]
  ds_read_b64_tr_b16 a[36:37], v14 offset:64
  ds_read_b64_tr_b16 a[38:39], v14 offset:320
  ds_read_b64_tr_b16 a[40:41], v14 offset:128
  v_mfma_f32_32x32x16_bf16 v[208:223], a[12:15], a[160:163], v[208:223]
  ds_read_b64_tr_b16 a[42:43], v14 offset:384
  ds_read_b64_tr_b16 a[44:45], v14 offset:192
  ds_read_b64_tr_b16 a[46:47], v14 offset:448
  v_mfma_f32_32x32x16_bf16 v[160:175], a[16:19], a[164:167], v[160:175]
  ds_read_b64_tr_b16 a[48:49], v14 offset:4352
  ds_read_b64_tr_b16 a[50:51], v14 offset:4608
  v_mfma_f32_32x32x16_bf16 v[176:191], a[20:23], a[164:167], v[176:191]
  ds_read_b64_tr_b16 a[52:53], v14 offset:4416
  ds_read_b64_tr_b16 a[54:55], v14 offset:4672
  ds_read_b64_tr_b16 a[56:57], v14 offset:4480
  v_mfma_f32_32x32x16_bf16 v[192:207], a[24:27], a[164:167], v[192:207]
  ds_read_b64_tr_b16 a[58:59], v14 offset:4736
  ds_read_b64_tr_b16 a[60:61], v14 offset:4544
  ds_read_b64_tr_b16 a[62:63], v14 offset:4800
  v_mfma_f32_32x32x16_bf16 v[208:223], a[28:31], a[164:167], v[208:223]
  s_add_u32 s5, s5, 8704
  s_cmp_lt_u32 s5, 156672
  s_cselect_b32 s5, s5, 0
  s_add_u32 s6, s6, 1
  s_add_u32 s7, s7, 1
  s_bitcmp1_b32 s76, s7
  s_cbranch_scc1 Levstub_136
Levback_137:
  s_waitcnt lgkmcnt(15)
  v_mfma_f32_32x32x16_bf16 v[144:159], a[64:67], v[224:227], v[48:63]
  v_exp_f32 v128, v128
  v_exp_f32 v129, v129
  s_add_u32 s9, s6, 2
  s_cmp_lt_u32 s4, s9
  s_cbranch_scc1 Llw_slow_138
Llw_back_139:
  v_mfma_f32_32x32x16_bf16 v[144:159], a[68:71], v[228:231], v[144:159]
  v_exp_f32 v130, v130
  v_exp_f32 v131, v131
  v_cvt_pk_bf16_f32 v32, v128, v129
  v_add_u32 v12, s5, v8
  s_add_u32 s10, s5, 8704
  v_mfma_f32_32x32x16_bf16 v[144:159], a[72:75], v[232:235], v[144:159]
  v_exp_f32 v132, v132
  v_exp_f32 v133, v133
  v_cvt_pk_bf16_f32 v33, v130, v131
  v_add_u32 v13, s5, v9
  s_cmp_lt_u32 s10, 156672
  v_mfma_f32_32x32x16_bf16 v[144:159], a[76:79], v[236:239], v[144:159]
  v_exp_f32 v134, v134
  v_exp_f32 v135, v135
  v_cvt_pk_bf16_f32 v34, v132, v133
  s_cselect_b32 s10, s10, 0
  v_mov_b32 v21, s6
  v_mfma_f32_32x32x16_bf16 v[144:159], a[80:83], v[240:243], v[144:159]
  v_exp_f32 v136, v136
  v_exp_f32 v137, v137
  v_cvt_pk_bf16_f32 v35, v134, v135
  v_add_u32 v14, s10, v10
  v_mfma_f32_32x32x16_bf16 v[144:159], a[84:87], v[244:247], v[144:159]
  v_exp_f32 v138, v138
  v_exp_f32 v139, v139
  v_cvt_pk_bf16_f32 v36, v136, v137
  s_add_u32 s5, s10, 8704
  v_mfma_f32_32x32x16_bf16 v[144:159], a[88:91], v[248:251], v[144:159]
  v_exp_f32 v140, v140
  v_exp_f32 v141, v141
  v_cvt_pk_bf16_f32 v37, v138, v139
  s_cmp_lt_u32 s5, 156672
  v_mfma_f32_32x32x16_bf16 v[144:159], a[92:95], v[252:255], v[144:159]
  v_exp_f32 v142, v142
  v_exp_f32 v143, v143
  v_cvt_pk_bf16_f32 v38, v140, v141
  v_cvt_pk_bf16_f32 v39, v142, v143
  s_cselect_b32 s5, s5, 0
  s_waitcnt lgkmcnt(0)
  v_mfma_f32_32x32x16_bf16 v[64:79], a[96:99], v[32:35], v[64:79]
  ds_write_b32 v23, v21
  ds_read_b128 a[64:67], v12 offset:0
  ds_read_b128 a[68:71], v13 offset:0
  ds_read_b128 a[72:75], v12 offset:64
  v_add_f32 v17, v17, v128
  v_add_f32 v18, v18, v129
  v_mfma_f32_32x32x16_bf16 v[80:95], a[100:103], v[32:35], v[80:95]
  ds_read_b128 a[76:79], v13 offset:64
  ds_read_b128 a[80:83], v12 offset:128
  ds_read_b128 a[84:87], v13 offset:128
  v_add_f32 v17, v17, v130
  v_add_f32 v18, v18, v131
  s_add_u32 s6, s6, 2
  v_mfma_f32_32x32x16_bf16 v[96:111], a[104:107], v[32:35], v[96:111]
  ds_read_b128 a[88:91], v12 offset:192
  ds_read_b128 a[92:95], v13 offset:192
  ds_read_b64_tr_b16 a[128:129], v14 offset:0
  v_add_f32 v17, v17, v132
  v_add_f32 v18, v18, v133
  v_mfma_f32_32x32x16_bf16 v[112:127], a[108:111], v[32:35], v[112:127]
  ds_read_b64_tr_b16 a[130:131], v14 offset:512
  ds_read_b64_tr_b16 a[132:133], v14 offset:64
  ds_read_b64_tr_b16 a[134:135], v14 offset:576
  v_add_f32 v17, v17, v134
  v_add_f32 v18, v18, v135
  v_max3_f32 v19, v144, v145, v146
  v_mfma_f32_32x32x16_bf16 v[64:79], a[112:115], v[36:39], v[64:79]
  ds_read_b64_tr_b16 a[136:137], v14 offset:128
  ds_read_b64_tr_b16 a[138:139], v14 offset:640
  ds_read_b64_tr_b16 a[140:141], v14 offset:192
  v_add_f32 v17, v17, v136
  v_add_f32 v18, v18, v137
  v_max3_f32 v19, v19, v147, v148
  v_mfma_f32_32x32x16_bf16 v[80:95], a[116:119], v[36:39], v[80:95]
  ds_read_b64_tr_b16 a[142:143], v14 offset:704
  ds_read_b64_tr_b16 a[144:145], v14 offset:4352
  ds_read_b64_tr_b16 a[146:147], v14 offset:4864
  v_add_f32 v17, v17, v138
  v_add_f32 v18, v18, v139
  v_max3_f32 v19, v19, v149, v150
  v_mfma_f32_32x32x16_bf16 v[96:111], a[120:123], v[36:39], v[96:111]
  ds_read_b64_tr_b16 a[148:149], v14 offset:4416
  ds_read_b64_tr_b16 a[150:151], v14 offset:4928
  ds_read_b64_tr_b16 a[152:153], v14 offset:4480
  v_add_f32 v17, v17, v140
  v_add_f32 v18, v18, v141
  v_max3_f32 v19, v19, v151, v152
  v_max3_f32 v19, v19, v153, v154
  v_mfma_f32_32x32x16_bf16 v[112:127], a[124:127], v[36:39], v[112:127]
  ds_read_b64_tr_b16 a[154:155], v14 offset:4992
  ds_read_b64_tr_b16 a[156:157], v14 offset:4544
  ds_read_b64_tr_b16 a[158:159], v14 offset:5056
  v_add_f32 v17, v17, v142
  v_add_f32 v18, v18, v143
  v_max3_f32 v19, v19, v155, v156
  v_max3_f32 v19, v19, v157, v158
  v_max_f32 v19, v19, v159
  v_cmp_lt_f32 vcc, s8, v19
  s_cbranch_vccnz Lrare_140
Lback_141:
  s_waitcnt lgkmcnt(15)
  v_mfma_f32_32x32x16_bf16 v[128:143], a[64:67], v[224:227], v[48:63]
  v_exp_f32 v144, v144
  v_exp_f32 v145, v145
  s_add_u32 s9, s6, 2
  s_cmp_lt_u32 s4, s9
  s_cbranch_scc1 Llw_slow_142
Llw_back_143:
  v_mfma_f32_32x32x16_bf16 v[128:143], a[68:71], v[228:231], v[128:143]
  v_exp_f32 v146, v146
  v_exp_f32 v147, v147
  v_cvt_pk_bf16_f32 v32, v144, v145
  v_add_u32 v12, s5, v8
  s_add_u32 s10, s5, 8704
  v_mfma_f32_32x32x16_bf16 v[128:143], a[72:75], v[232:235], v[128:143]
  v_exp_f32 v148, v148
  v_exp_f32 v149, v149
  v_cvt_pk_bf16_f32 v33, v146, v147
  v_add_u32 v13, s5, v9
  s_cmp_lt_u32 s10, 156672
  v_mfma_f32_32x32x16_bf16 v[128:143], a[76:79], v[236:239], v[128:143]
  v_exp_f32 v150, v150
  v_exp_f32 v151, v151
  v_cvt_pk_bf16_f32 v34, v148, v149
  s_cselect_b32 s10, s10, 0
  v_mov_b32 v21, s6
  v_mfma_f32_32x32x16_bf16 v[128:143], a[80:83], v[240:243], v[128:143]
  v_exp_f32 v152, v152
  v_exp_f32 v153, v153
  v_cvt_pk_bf16_f32 v35, v150, v151
  v_add_u32 v14, s10, v10
  v_mfma_f32_32x32x16_bf16 v[128:143], a[84:87], v[244:247], v[128:143]
  v_exp_f32 v154, v154
  v_exp_f32 v155, v155
  v_cvt_pk_bf16_f32 v36, v152, v153
  s_add_u32 s5, s10, 8704
  v_mfma_f32_32x32x16_bf16 v[128:143], a[88:91], v[248:251], v[128:143]
  v_exp_f32 v156, v156
  v_exp_f32 v157, v157
  v_cvt_pk_bf16_f32 v37, v154, v155
  s_cmp_lt_u32 s5, 156672
  v_mfma_f32_32x32x16_bf16 v[128:143], a[92:95], v[252:255], v[128:143]
  v_exp_f32 v158, v158
  v_exp_f32 v159, v159
  v_cvt_pk_bf16_f32 v38, v156, v157
  v_cvt_pk_bf16_f32 v39, v158, v159
  s_cselect_b32 s5, s5, 0
  s_waitcnt lgkmcnt(0)
  v_mfma_f32_32x32x16_bf16 v[64:79], a[128:131], v[32:35], v[64:79]
  ds_write_b32 v23, v21
  ds_read_b128 a[64:67], v12 offset:0
  ds_read_b128 a[68:71], v13 offset:0
  ds_read_b128 a[72:75], v12 offset:64
  v_add_f32 v17, v17, v144
  v_add_f32 v18, v18, v145
  v_mfma_f32_32x32x16_bf16 v[80:95], a[132:135], v[32:35], v[80:95]
  ds_read_b128 a[76:79], v13 offset:64
  ds_read_b128 a[80:83], v12 offset:128
  ds_read_b128 a[84:87], v13 offset:128
  v_add_f32 v17, v17, v146
  v_add_f32 v18, v18, v147
  s_add_u32 s6, s6, 2
  v_mfma_f32_32x32x16_bf16 v[96:111], a[136:139], v[32:35], v[96:111]
  ds_read_b128 a[88:91], v12 offset:192
  ds_read_b128 a[92:95], v13 offset:192
  ds_read_b64_tr_b16 a[96:97], v14 offset:0
  v_add_f32 v17, v17, v148
  v_add_f32 v18, v18, v149
  v_mfma_f32_32x32x16_bf16 v[112:127], a[140:143], v[32:35], v[112:127]
  ds_read_b64_tr_b16 a[98:99], v14 offset:512
  ds_read_b64_tr_b16 a[100:101], v14 offset:64
  ds_read_b64_tr_b16 a[102:103], v14 offset:576
  v_add_f32 v17, v17, v150
  v_add_f32 v18, v18, v151
  v_max3_f32 v19, v128, v129, v130
  v_mfma_f32_32x32x16_bf16 v[64:79], a[144:147], v[36:39], v[64:79]
  ds_read_b64_tr_b16 a[104:105], v14 offset:128
  ds_read_b64_tr_b16 a[106:107], v14 offset:640
  ds_read_b64_tr_b16 a[108:109], v14 offset:192
  v_add_f32 v17, v17, v152
  v_add_f32 v18, v18, v153
  v_max3_f32 v19, v19, v131, v132
  v_mfma_f32_32x32x16_bf16 v[80:95], a[148:151], v[36:39], v[80:95]
  ds_read_b64_tr_b16 a[110:111], v14 offset:704
  ds_read_b64_tr_b16 a[112:113], v14 offset:4352
  ds_read_b64_tr_b16 a[114:115], v14 offset:4864
  v_add_f32 v17, v17, v154
  v_add_f32 v18, v18, v155
  v_max3_f32 v19, v19, v133, v134
  v_mfma_f32_32x32x16_bf16 v[96:111], a[152:155], v[36:39], v[96:111]
  ds_read_b64_tr_b16 a[116:117], v14 offset:4416
  ds_read_b64_tr_b16 a[118:119], v14 offset:4928
  ds_read_b64_tr_b16 a[120:121], v14 offset:4480
  v_add_f32 v17, v17, v156
  v_add_f32 v18, v18, v157
  v_max3_f32 v19, v19, v135, v136
  v_max3_f32 v19, v19, v137, v138
  v_mfma_f32_32x32x16_bf16 v[112:127], a[156:159], v[36:39], v[112:127]
  ds_read_b64_tr_b16 a[122:123], v14 offset:4992
  ds_read_b64_tr_b16 a[124:125], v14 offset:4544
  ds_read_b64_tr_b16 a[126:127], v14 offset:5056
  v_add_f32 v17, v17, v158
  v_add_f32 v18, v18, v159
  v_max3_f32 v19, v19, v139, v140
  v_max3_f32 v19, v19, v141, v142
  v_max_f32 v19, v19, v143
  v_cmp_lt_f32 vcc, s8, v19
  s_cbranch_vccnz Lrare_144
Lback_145:
  v_mfma_f32_32x32x16_bf16 v[160:175], a[32:35], a[168:171], v[160:175]
  s_add_u32 s9, s6, 1
  s_cmp_lt_u32 s4, s9
  s_cbranch_scc1 Llw_slow_146
Llw_back_147:
  v_add_u32 v14, s5, v11
  v_mfma_f32_32x32x16_bf16 v[176:191], a[36:39], a[168:171], v[176:191]
  ds_read_b64_tr_b16 a[0:1], v14 offset:0
  ds_read_b64_tr_b16 a[2:3], v14 offset:256
  v_mfma_f32_32x32x16_bf16 v[192:207], a[40:43], a[168:171], v[192:207]
  ds_read_b64_tr_b16 a[4:5], v14 offset:64
  ds_read_b64_tr_b16 a[6:7], v14 offset:320
  ds_read_b64_tr_b16 a[8:9], v14 offset:128
  v_mfma_f32_32x32x16_bf16 v[208:223], a[44:47], a[168:171], v[208:223]
  ds_read_b64_tr_b16 a[10:11], v14 offset:384
  ds_read_b64_tr_b16 a[12:13], v14 offset:192
  ds_read_b64_tr_b16 a[14:15], v14 offset:448
  v_mfma_f32_32x32x16_bf16 v[160:175], a[48:51], a[172:175], v[160:175]
  ds_read_b64_tr_b16 a[16:17], v14 offset:4352
  ds_read_b64_tr_b16 a[18:19], v14 offset:4608
  v_mfma_f32_32x32x16_bf16 v[176:191], a[52:55], a[172:175], v[176:191]
  ds_read_b64_tr_b16 a[20:21], v14 offset:4416
  ds_read_b64_tr_b16 a[22:23], v14 offset:4672
  ds_read_b64_tr_b16 a[24:25], v14 offset:4480
  v_mfma_f32_32x32x16_bf16 v[192:207], a[56:59], a[172:175], v[192:207]
  ds_read_b64_tr_b16 a[26:27], v14 offset:4736
  ds_read_b64_tr_b16 a[28:29], v14 offset:4544
  ds_read_b64_tr_b16 a[30:31], v14 offset:4800
  v_mfma_f32_32x32x16_bf16 v[208:223], a[60:63], a[172:175], v[208:223]
  s_add_u32 s5, s5, 8704
  s_cmp_lt_u32 s5, 156672
  s_cselect_b32 s5, s5, 0
  s_add_u32 s6, s6, 1
  s_add_u32 s7, s7, 1
  s_bitcmp1_b32 s76, s7
  s_cbranch_scc1 Levstub_148
Levback_149:
  s_waitcnt lgkmcnt(15)
  v_mfma_f32_32x32x16_bf16 v[144:159], a[64:67], v[224:227], v[48:63]
  v_exp_f32 v128, v128
  v_exp_f32 v129, v129
  s_add_u32 s9, s6, 2
  s_cmp_lt_u32 s4, s9
  s_cbranch_scc1 Llw_slow_150
Llw_back_151:
  v_mfma_f32_32x32x16_bf16 v[144:159], a[68:71], v[228:231], v[144:159]
  v_exp_f32 v130, v130
  v_exp_f32 v131, v131
  v_cvt_pk_bf16_f32 v32, v128, v129
  v_add_u32 v12, s5, v8
  s_add_u32 s10, s5, 8704
  v_mfma_f32_32x32x16_bf16 v[144:159], a[72:75], v[232:235], v[144:159]
  v_exp_f32 v132, v132
  v_exp_f32 v133, v133
  v_cvt_pk_bf16_f32 v33, v130, v131
  v_add_u32 v13, s5, v9
  s_cmp_lt_u32 s10, 156672
  v_mfma_f32_32x32x16_bf16 v[144:159], a[76:79], v[236:239], v[144:159]
  v_exp_f32 v134, v134
  v_exp_f32 v135, v135
  v_cvt_pk_bf16_f32 v34, v132, v133
  s_cselect_b32 s10, s10, 0
  v_mov_b32 v21, s6
  v_mfma_f32_32x32x16_bf16 v[144:159], a[80:83], v[240:243], v[144:159]
  v_exp_f32 v136, v136
  v_exp_f32 v137, v137
  v_cvt_pk_bf16_f32 v35, v134, v135
  v_add_u32 v14, s10, v10
  v_mfma_f32_32x32x16_bf16 v[144:159], a[84:87], v[244:247], v[144:159]
  v_exp_f32 v138, v138
  v_exp_f32 v139, v139
  v_cvt_pk_bf16_f32 v36, v136, v137
  s_add_u32 s5, s10, 8704
  v_mfma_f32_32x32x16_bf16 v[144:159], a[88:91], v[248:251], v[144:159]
  v_exp_f32 v140, v140
  v_exp_f32 v141, v141
  v_cvt_pk_bf16_f32 v37, v138, v139
  s_cmp_lt_u32 s5, 156672
  v_mfma_f32_32x32x16_bf16 v[144:159], a[92:95], v[252:255], v[144:159]
  v_exp_f32 v142, v142
  v_exp_f32 v143, v143
  v_cvt_pk_bf16_f32 v38, v140, v141
  v_cvt_pk_bf16_f32 v39, v142, v143
  s_cselect_b32 s5, s5, 0
  s_waitcnt lgkmcnt(0)
  v_mfma_f32_32x32x16_bf16 v[64:79], a[96:99], v[32:35], v[64:79]
  ds_write_b32 v23, v21
  ds_read_b128 a[64:67], v12 offset:0
  ds_read_b128 a[68:71], v13 offset:0
  ds_read_b128 a[72:75], v12 offset:64
  v_add_f32 v17, v17, v128
  v_add_f32 v18, v18, v129
  v_mfma_f32_32x32x16_bf16 v[80:95], a[100:103], v[32:35], v[80:95]
  ds_read_b128 a[76:79], v13 offset:64
  ds_read_b128 a[80:83], v12 offset:128
  ds_read_b128 a[84:87], v13 offset:128
  v_add_f32 v17, v17, v130
  v_add_f32 v18, v18, v131
  s_add_u32 s6, s6, 2
  v_mfma_f32_32x32x16_bf16 v[96:111], a[104:107], v[32:35], v[96:111]
  ds_read_b128 a[88:91], v12 offset:192
  ds_read_b128 a[92:95], v13 offset:192
  ds_read_b64_tr_b16 a[128:129], v14 offset:0
  v_add_f32 v17, v17, v132
  v_add_f32 v18, v18, v133
  v_mfma_f32_32x32x16_bf16 v[112:127], a[108:111], v[32:35], v[112:127]
  ds_read_b64_tr_b16 a[130:131], v14 offset:512
  ds_read_b64_tr_b16 a[132:133], v14 offset:64
  ds_read_b64_tr_b16 a[134:135], v14 offset:576
  v_add_f32 v17, v17, v134
  v_add_f32 v18, v18, v135
  v_max3_f32 v19, v144, v145, v146
  v_mfma_f32_32x32x16_bf16 v[64:79], a[112:115], v[36:39], v[64:79]
  ds_read_b64_tr_b16 a[136:137], v14 offset:128
  ds_read_b64_tr_b16 a[138:139], v14 offset:640
  ds_read_b64_tr_b16 a[140:141], v14 offset:192
  v_add_f32 v17, v17, v136
  v_add_f32 v18, v18, v137
  v_max3_f32 v19, v19, v147, v148
  v_mfma_f32_32x32x16_bf16 v[80:95], a[116:119], v[36:39], v[80:95]
  ds_read_b64_tr_b16 a[142:143], v14 offset:704
  ds_read_b64_tr_b16 a[144:145], v14 offset:4352
  ds_read_b64_tr_b16 a[146:147], v14 offset:4864
  v_add_f32 v17, v17, v138
  v_add_f32 v18, v18, v139
  v_max3_f32 v19, v19, v149, v150
  v_mfma_f32_32x32x16_bf16 v[96:111], a[120:123], v[36:39], v[96:111]
  ds_read_b64_tr_b16 a[148:149], v14 offset:4416
  ds_read_b64_tr_b16 a[150:151], v14 offset:4928
  ds_read_b64_tr_b16 a[152:153], v14 offset:4480
  v_add_f32 v17, v17, v140
  v_add_f32 v18, v18, v141
  v_max3_f32 v19, v19, v151, v152
  v_max3_f32 v19, v19, v153, v154
  v_mfma_f32_32x32x16_bf16 v[112:127], a[124:127], v[36:39], v[112:127]
  ds_read_b64_tr_b16 a[154:155], v14 offset:4992
  ds_read_b64_tr_b16 a[156:157], v14 offset:4544
  ds_read_b64_tr_b16 a[158:159], v14 offset:5056
  v_add_f32 v17, v17, v142
  v_add_f32 v18, v18, v143
  v_max3_f32 v19, v19, v155, v156
  v_max3_f32 v19, v19, v157, v158
  v_max_f32 v19, v19, v159
  v_cmp_lt_f32 vcc, s8, v19
  s_cbranch_vccnz Lrare_152
Lback_153:
  s_waitcnt lgkmcnt(15)
  v_mfma_f32_32x32x16_bf16 v[128:143], a[64:67], v[224:227], v[48:63]
  v_exp_f32 v144, v144
  v_exp_f32 v145, v145
  s_add_u32 s9, s6, 2
  s_cmp_lt_u32 s4, s9
  s_cbranch_scc1 Llw_slow_154
Llw_back_155:
  v_mfma_f32_32x32x16_bf16 v[128:143], a[68:71], v[228:231], v[128:143]
  v_exp_f32 v146, v146
  v_exp_f32 v147, v147
  v_cvt_pk_bf16_f32 v32, v144, v145
  v_add_u32 v12, s5, v8
  s_add_u32 s10, s5, 8704
  v_mfma_f32_32x32x16_bf16 v[128:143], a[72:75], v[232:235], v[128:143]
  v_exp_f32 v148, v148
  v_exp_f32 v149, v149
  v_cvt_pk_bf16_f32 v33, v146, v147
  v_add_u32 v13, s5, v9
  s_cmp_lt_u32 s10, 156672
  v_mfma_f32_32x32x16_bf16 v[128:143], a[76:79], v[236:239], v[128:143]
  v_exp_f32 v150, v150
  v_exp_f32 v151, v151
  v_cvt_pk_bf16_f32 v34, v148, v149
  s_cselect_b32 s10, s10, 0
  v_mov_b32 v21, s6
  v_mfma_f32_32x32x16_bf16 v[128:143], a[80:83], v[240:243], v[128:143]
  v_exp_f32 v152, v152
  v_exp_f32 v153, v153
  v_cvt_pk_bf16_f32 v35, v150, v151
  v_add_u32 v14, s10, v10
  v_mfma_f32_32x32x16_bf16 v[128:143], a[84:87], v[244:247], v[128:143]
  v_exp_f32 v154, v154
  v_exp_f32 v155, v155
  v_cvt_pk_bf16_f32 v36, v152, v153
  s_add_u32 s5, s10, 8704
  v_mfma_f32_32x32x16_bf16 v[128:143], a[88:91], v[248:251], v[128:143]
  v_exp_f32 v156, v156
  v_exp_f32 v157, v157
  v_cvt_pk_bf16_f32 v37, v154, v155
  s_cmp_lt_u32 s5, 156672
  v_mfma_f32_32x32x16_bf16 v[128:143], a[92:95], v[252:255], v[128:143]
  v_exp_f32 v158, v158
  v_exp_f32 v159, v159
  v_cvt_pk_bf16_f32 v38, v156, v157
  v_cvt_pk_bf16_f32 v39, v158, v159
  s_cselect_b32 s5, s5, 0
  s_waitcnt lgkmcnt(0)
  v_mfma_f32_32x32x16_bf16 v[64:79], a[128:131], v[32:35], v[64:79]
  ds_write_b32 v23, v21
  ds_read_b128 a[64:67], v12 offset:0
  ds_read_b128 a[68:71], v13 offset:0
  ds_read_b128 a[72:75], v12 offset:64
  v_add_f32 v17, v17, v144
  v_add_f32 v18, v18, v145
  v_mfma_f32_32x32x16_bf16 v[80:95], a[132:135], v[32:35], v[80:95]
  ds_read_b128 a[76:79], v13 offset:64
  ds_read_b128 a[80:83], v12 offset:128
  ds_read_b128 a[84:87], v13 offset:128
  v_add_f32 v17, v17, v146
  v_add_f32 v18, v18, v147
  s_add_u32 s6, s6, 2
  v_mfma_f32_32x32x16_bf16 v[96:111], a[136:139], v[32:35], v[96:111]
  ds_read_b128 a[88:91], v12 offset:192
  ds_read_b128 a[92:95], v13 offset:192
  ds_read_b64_tr_b16 a[96:97], v14 offset:0
  v_add_f32 v17, v17, v148
  v_add_f32 v18, v18, v149
  v_mfma_f32_32x32x16_bf16 v[112:127], a[140:143], v[32:35], v[112:127]
  ds_read_b64_tr_b16 a[98:99], v14 offset:512
  ds_read_b64_tr_b16 a[100:101], v14 offset:64
  ds_read_b64_tr_b16 a[102:103], v14 offset:576
  v_add_f32 v17, v17, v150
  v_add_f32 v18, v18, v151
  v_max3_f32 v19, v128, v129, v130
  v_mfma_f32_32x32x16_bf16 v[64:79], a[144:147], v[36:39], v[64:79]
  ds_read_b64_tr_b16 a[104:105], v14 offset:128
  ds_read_b64_tr_b16 a[106:107], v14 offset:640
  ds_read_b64_tr_b16 a[108:109], v14 offset:192
  v_add_f32 v17, v17, v152
  v_add_f32 v18, v18, v153
  v_max3_f32 v19, v19, v131, v132
  v_mfma_f32_32x32x16_bf16 v[80:95], a[148:151], v[36:39], v[80:95]
  ds_read_b64_tr_b16 a[110:111], v14 offset:704
  ds_read_b64_tr_b16 a[112:113], v14 offset:4352
  ds_read_b64_tr_b16 a[114:115], v14 offset:4864
  v_add_f32 v17, v17, v154
  v_add_f32 v18, v18, v155
  v_max3_f32 v19, v19, v133, v134
  v_mfma_f32_32x32x16_bf16 v[96:111], a[152:155], v[36:39], v[96:111]
  ds_read_b64_tr_b16 a[116:117], v14 offset:4416
  ds_read_b64_tr_b16 a[118:119], v14 offset:4928
  ds_read_b64_tr_b16 a[120:121], v14 offset:4480
  v_add_f32 v17, v17, v156
  v_add_f32 v18, v18, v157
  v_max3_f32 v19, v19, v135, v136
  v_max3_f32 v19, v19, v137, v138
  v_mfma_f32_32x32x16_bf16 v[112:127], a[156:159], v[36:39], v[112:127]
  ds_read_b64_tr_b16 a[122:123], v14 offset:4992
  ds_read_b64_tr_b16 a[124:125], v14 offset:4544
  ds_read_b64_tr_b16 a[126:127], v14 offset:5056
  v_add_f32 v17, v17, v158
  v_add_f32 v18, v18, v159
  v_max3_f32 v19, v19, v139, v140
  v_max3_f32 v19, v19, v141, v142
  v_max_f32 v19, v19, v143
  v_cmp_lt_f32 vcc, s8, v19
  s_cbranch_vccnz Lrare_156
Lback_157:
  v_mfma_f32_32x32x16_bf16 v[160:175], a[0:3], a[176:179], v[160:175]
  s_add_u32 s9, s6, 1
  s_cmp_lt_u32 s4, s9
  s_cbranch_scc1 Llw_slow_158
Llw_back_159:
  v_add_u32 v14, s5, v11
  v_mfma_f32_32x32x16_bf16 v[176:191], a[4:7], a[176:179], v[176:191]
  ds_read_b64_tr_b16 a[32:33], v14 offset:0
  ds_read_b64_tr_b16 a[34:35], v14 offset:256
  v_mfma_f32_32x32x16_bf16 v[192:207], a[8:11], a[176:179], v[192:207]
  ds_read_b64_tr_b16 a[36:37], v14 offset:64
  ds_read_b64_tr_b16 a[38:39], v14 offset:320
  ds_read_b64_tr_b16 a[40:41], v14 offset:128
  v_mfma_f32_32x32x16_bf16 v[208:223], a[12:15], a[176:179], v[208:223]
  ds_read_b64_tr_b16 a[42:43], v14 offset:384
  ds_read_b64_tr_b16 a[44:45], v14 offset:192
  ds_read_b64_tr_b16 a[46:47], v14 offset:448
  v_mfma_f32_32x32x16_bf16 v[160:175], a[16:19], a[180:183], v[160:175]
  ds_read_b64_tr_b16 a[48:49], v14 offset:4352
  ds_read_b64_tr_b16 a[50:51], v14 offset:4608
  v_mfma_f32_32x32x16_bf16 v[176:191], a[20:23], a[180:183], v[176:191]
  ds_read_b64_tr_b16 a[52:53], v14 offset:4416
  ds_read_b64_tr_b16 a[54:55], v14 offset:4672
  ds_read_b64_tr_b16 a[56:57], v14 offset:4480
  v_mfma_f32_32x32x16_bf16 v[192:207], a[24:27], a[180:183], v[192:207]
  ds_read_b64_tr_b16 a[58:59], v14 offset:4736
  ds_read_b64_tr_b16 a[60:61], v14 offset:4544
  ds_read_b64_tr_b16 a[62:63], v14 offset:4800
  v_mfma_f32_32x32x16_bf16 v[208:223], a[28:31], a[180:183], v[208:223]
  s_add_u32 s5, s5, 8704
  s_cmp_lt_u32 s5, 156672
  s_cselect_b32 s5, s5, 0
  s_add_u32 s6, s6, 1
  s_add_u32 s7, s7, 1
  s_bitcmp1_b32 s76, s7
  s_cbranch_scc1 Levstub_160
Levback_161:
  s_cmp_lt_u32 s7, 12
  s_cbranch_scc1 Lattn_111
  s_waitcnt lgkmcnt(15)
  v_mfma_f32_32x32x16_bf16 v[144:159], a[64:67], v[224:227], v[48:63]
  v_exp_f32 v128, v128
  v_exp_f32 v129, v129
  s_add_u32 s9, s6, 2
  s_cmp_lt_u32 s4, s9
  s_cbranch_scc1 Llw_slow_162
Llw_back_163:
  v_mfma_f32_32x32x16_bf16 v[144:159], a[68:71], v[228:231], v[144:159]
  v_exp_f32 v130, v130
  v_exp_f32 v131, v131
  v_cvt_pk_bf16_f32 v32, v128, v129
  v_add_u32 v12, s5, v8
  s_add_u32 s10, s5, 8704
  v_mfma_f32_32x32x16_bf16 v[144:159], a[72:75], v[232:235], v[144:159]
  v_exp_f32 v132, v132
  v_exp_f32 v133, v133
  v_cvt_pk_bf16_f32 v33, v130, v131
  v_add_u32 v13, s5, v9
  s_cmp_lt_u32 s10, 156672
  v_mfma_f32_32x32x16_bf16 v[144:159], a[76:79], v[236:239], v[144:159]
  v_exp_f32 v134, v134
  v_exp_f32 v135, v135
  v_cvt_pk_bf16_f32 v34, v132, v133
  s_cselect_b32 s10, s10, 0
  v_mov_b32 v21, s6
  v_mfma_f32_32x32x16_bf16 v[144:159], a[80:83], v[240:243], v[144:159]
  v_exp_f32 v136, v136
  v_exp_f32 v137, v137
  v_cvt_pk_bf16_f32 v35, v134, v135
  v_add_u32 v14, s10, v10
  v_mfma_f32_32x32x16_bf16 v[144:159], a[84:87], v[244:247], v[144:159]
  v_exp_f32 v138, v138
  v_exp_f32 v139, v139
  v_cvt_pk_bf16_f32 v36, v136, v137
  s_add_u32 s5, s10, 8704
  v_mfma_f32_32x32x16_bf16 v[144:159], a[88:91], v[248:251], v[144:159]
  v_exp_f32 v140, v140
  v_exp_f32 v141, v141
  v_cvt_pk_bf16_f32 v37, v138, v139
  s_cmp_lt_u32 s5, 156672
  v_mfma_f32_32x32x16_bf16 v[144:159], a[92:95], v[252:255], v[144:159]
  v_exp_f32 v142, v142
  v_exp_f32 v143, v143
  v_cvt_pk_bf16_f32 v38, v140, v141
  v_cvt_pk_bf16_f32 v39, v142, v143
  s_cselect_b32 s5, s5, 0
  s_waitcnt lgkmcnt(0)
  v_mfma_f32_32x32x16_bf16 v[64:79], a[96:99], v[32:35], v[64:79]
  ds_write_b32 v23, v21
  ds_read_b128 a[64:67], v12 offset:0
  ds_read_b128 a[68:71], v13 offset:0
  ds_read_b128 a[72:75], v12 offset:64
  v_add_f32 v17, v17, v128
  v_add_f32 v18, v18, v129
  v_mfma_f32_32x32x16_bf16 v[80:95], a[100:103], v[32:35], v[80:95]
  ds_read_b128 a[76:79], v13 offset:64
  ds_read_b128 a[80:83], v12 offset:128
  ds_read_b128 a[84:87], v13 offset:128
  v_add_f32 v17, v17, v130
  v_add_f32 v18, v18, v131
  s_add_u32 s6, s6, 2
  v_mfma_f32_32x32x16_bf16 v[96:111], a[104:107], v[32:35], v[96:111]
  ds_read_b128 a[88:91], v12 offset:192
  ds_read_b128 a[92:95], v13 offset:192
  ds_read_b64_tr_b16 a[128:129], v14 offset:0
  v_add_f32 v17, v17, v132
  v_add_f32 v18, v18, v133
  v_mfma_f32_32x32x16_bf16 v[112:127], a[108:111], v[32:35], v[112:127]
  ds_read_b64_tr_b16 a[130:131], v14 offset:512
  ds_read_b64_tr_b16 a[132:133], v14 offset:64
  ds_read_b64_tr_b16 a[134:135], v14 offset:576
  v_add_f32 v17, v17, v134
  v_add_f32 v18, v18, v135
  v_max3_f32 v19, v144, v145, v146
  v_mfma_f32_32x32x16_bf16 v[64:79], a[112:115], v[36:39], v[64:79]
  ds_read_b64_tr_b16 a[136:137], v14 offset:128
  ds_read_b64_tr_b16 a[138:139], v14 offset:640
  ds_read_b64_tr_b16 a[140:141], v14 offset:192
  v_add_f32 v17, v17, v136
  v_add_f32 v18, v18, v137
  v_max3_f32 v19, v19, v147, v148
  v_mfma_f32_32x32x16_bf16 v[80:95], a[116:119], v[36:39], v[80:95]
  ds_read_b64_tr_b16 a[142:143], v14 offset:704
  ds_read_b64_tr_b16 a[144:145], v14 offset:4352
  ds_read_b64_tr_b16 a[146:147], v14 offset:4864
  v_add_f32 v17, v17, v138
  v_add_f32 v18, v18, v139
  v_max3_f32 v19, v19, v149, v150
  v_mfma_f32_32x32x16_bf16 v[96:111], a[120:123], v[36:39], v[96:111]
  ds_read_b64_tr_b16 a[148:149], v14 offset:4416
  ds_read_b64_tr_b16 a[150:151], v14 offset:4928
  ds_read_b64_tr_b16 a[152:153], v14 offset:4480
  v_add_f32 v17, v17, v140
  v_add_f32 v18, v18, v141
  v_max3_f32 v19, v19, v151, v152
  v_max3_f32 v19, v19, v153, v154
  v_mfma_f32_32x32x16_bf16 v[112:127], a[124:127], v[36:39], v[112:127]
  ds_read_b64_tr_b16 a[154:155], v14 offset:4992
  ds_read_b64_tr_b16 a[156:157], v14 offset:4544
  ds_read_b64_tr_b16 a[158:159], v14 offset:5056
  v_add_f32 v17, v17, v142
  v_add_f32 v18, v18, v143
  v_max3_f32 v19, v19, v155, v156
  v_max3_f32 v19, v19, v157, v158
  v_max_f32 v19, v19, v159
  v_cmp_lt_f32 vcc, s8, v19
  s_cbranch_vccnz Lrare_164
Lback_165:
  s_waitcnt lgkmcnt(15)
  v_mfma_f32_32x32x16_bf16 v[128:143], a[64:67], v[224:227], v[48:63]
  v_exp_f32 v144, v144
  v_exp_f32 v145, v145
  s_add_u32 s9, s6, 2
  s_cmp_lt_u32 s4, s9
  s_cbranch_scc1 Llw_slow_166
Llw_back_167:
  v_mfma_f32_32x32x16_bf16 v[128:143], a[68:71], v[228:231], v[128:143]
  v_exp_f32 v146, v146
  v_exp_f32 v147, v147
  v_cvt_pk_bf16_f32 v32, v144, v145
  v_add_u32 v12, s5, v8
  s_add_u32 s10, s5, 8704
  v_mfma_f32_32x32x16_bf16 v[128:143], a[72:75], v[232:235], v[128:143]
  v_exp_f32 v148, v148
  v_exp_f32 v149, v149
  v_cvt_pk_bf16_f32 v33, v146, v147
  v_add_u32 v13, s5, v9
  s_cmp_lt_u32 s10, 156672
  v_mfma_f32_32x32x16_bf16 v[128:143], a[76:79], v[236:239], v[128:143]
  v_exp_f32 v150, v150
  v_exp_f32 v151, v151
  v_cvt_pk_bf16_f32 v34, v148, v149
  s_cselect_b32 s10, s10, 0
  v_mov_b32 v21, s6
  v_mfma_f32_32x32x16_bf16 v[128:143], a[80:83], v[240:243], v[128:143]
  v_exp_f32 v152, v152
  v_exp_f32 v153, v153
  v_cvt_pk_bf16_f32 v35, v150, v151
  v_add_u32 v14, s10, v10
  v_mfma_f32_32x32x16_bf16 v[128:143], a[84:87], v[244:247], v[128:143]
  v_exp_f32 v154, v154
  v_exp_f32 v155, v155
  v_cvt_pk_bf16_f32 v36, v152, v153
  s_add_u32 s5, s10, 8704
  v_mfma_f32_32x32x16_bf16 v[128:143], a[88:91], v[248:251], v[128:143]
  v_exp_f32 v156, v156
  v_exp_f32 v157, v157
  v_cvt_pk_bf16_f32 v37, v154, v155
  s_cmp_lt_u32 s5, 156672
  v_mfma_f32_32x32x16_bf16 v[128:143], a[92:95], v[252:255], v[128:143]
  v_exp_f32 v158, v158
  v_exp_f32 v159, v159
  v_cvt_pk_bf16_f32 v38, v156, v157
  v_cvt_pk_bf16_f32 v39, v158, v159
  s_cselect_b32 s5, s5, 0
  s_waitcnt lgkmcnt(0)
  v_mfma_f32_32x32x16_bf16 v[64:79], a[128:131], v[32:35], v[64:79]
  ds_write_b32 v23, v21
  ds_read_b128 a[64:67], v12 offset:0
  ds_read_b128 a[68:71], v13 offset:0
  ds_read_b128 a[72:75], v12 offset:64
  v_add_f32 v17, v17, v144
  v_add_f32 v18, v18, v145
  v_mfma_f32_32x32x16_bf16 v[80:95], a[132:135], v[32:35], v[80:95]
  ds_read_b128 a[76:79], v13 offset:64
  ds_read_b128 a[80:83], v12 offset:128
  ds_read_b128 a[84:87], v13 offset:128
  v_add_f32 v17, v17, v146
  v_add_f32 v18, v18, v147
  s_add_u32 s6, s6, 2
  v_mfma_f32_32x32x16_bf16 v[96:111], a[136:139], v[32:35], v[96:111]
  ds_read_b128 a[88:91], v12 offset:192
  ds_read_b128 a[92:95], v13 offset:192
  ds_read_b64_tr_b16 a[96:97], v14 offset:0
  v_add_f32 v17, v17, v148
  v_add_f32 v18, v18, v149
  v_mfma_f32_32x32x16_bf16 v[112:127], a[140:143], v[32:35], v[112:127]
  ds_read_b64_tr_b16 a[98:99], v14 offset:512
  ds_read_b64_tr_b16 a[100:101], v14 offset:64
  ds_read_b64_tr_b16 a[102:103], v14 offset:576
  v_add_f32 v17, v17, v150
  v_add_f32 v18, v18, v151
  v_max3_f32 v19, v128, v129, v130
  v_mfma_f32_32x32x16_bf16 v[64:79], a[144:147], v[36:39], v[64:79]
  ds_read_b64_tr_b16 a[104:105], v14 offset:128
  ds_read_b64_tr_b16 a[106:107], v14 offset:640
  ds_read_b64_tr_b16 a[108:109], v14 offset:192
  v_add_f32 v17, v17, v152
  v_add_f32 v18, v18, v153
  v_max3_f32 v19, v19, v131, v132
  v_mfma_f32_32x32x16_bf16 v[80:95], a[148:151], v[36:39], v[80:95]
  ds_read_b64_tr_b16 a[110:111], v14 offset:704
  ds_read_b64_tr_b16 a[112:113], v14 offset:4352
  ds_read_b64_tr_b16 a[114:115], v14 offset:4864
  v_add_f32 v17, v17, v154
  v_add_f32 v18, v18, v155
  v_max3_f32 v19, v19, v133, v134
  v_mfma_f32_32x32x16_bf16 v[96:111], a[152:155], v[36:39], v[96:111]
  ds_read_b64_tr_b16 a[116:117], v14 offset:4416
  ds_read_b64_tr_b16 a[118:119], v14 offset:4928
  ds_read_b64_tr_b16 a[120:121], v14 offset:4480
  v_add_f32 v17, v17, v156
  v_add_f32 v18, v18, v157
  v_max3_f32 v19, v19, v135, v136
  v_max3_f32 v19, v19, v137, v138
  v_mfma_f32_32x32x16_bf16 v[112:127], a[156:159], v[36:39], v[112:127]
  ds_read_b64_tr_b16 a[122:123], v14 offset:4992
  ds_read_b64_tr_b16 a[124:125], v14 offset:4544
  ds_read_b64_tr_b16 a[126:127], v14 offset:5056
  v_add_f32 v17, v17, v158
  v_add_f32 v18, v18, v159
  v_max3_f32 v19, v19, v139, v140
  v_max3_f32 v19, v19, v141, v142
  v_max_f32 v19, v19, v143
  v_cmp_lt_f32 vcc, s8, v19
  s_cbranch_vccnz Lrare_168
Lback_169:
  v_mfma_f32_32x32x16_bf16 v[160:175], a[32:35], a[184:187], v[160:175]
  s_add_u32 s9, s6, 4
  s_cmp_lt_u32 s4, s9
  s_cbranch_scc1 Llw_slow_170
Llw_back_171:
  s_mul_i32 s29, s3, 8704
  s_add_u32 s10, s5, s29
  s_add_u32 s10, s10, 0
  s_sub_u32 s28, s10, s72
  s_cmp_lt_u32 s10, s72
  s_cselect_b32 s10, s10, s28
  v_add_u32 v12, s10, v8
  v_add_u32 v13, s10, v9
  s_add_u32 s5, s5, 26112
  s_sub_u32 s28, s5, s72
  s_cmp_lt_u32 s5, s72
  s_cselect_b32 s5, s5, s28
  v_add_u32 v14, s5, v11
  v_mfma_f32_32x32x16_bf16 v[176:191], a[36:39], a[184:187], v[176:191]
  ds_read_b128 a[160:163], v12 offset:0
  ds_read_b128 a[164:167], v13 offset:0
  ds_read_b128 a[168:171], v12 offset:64
  v_mfma_f32_32x32x16_bf16 v[192:207], a[40:43], a[184:187], v[192:207]
  ds_read_b128 a[172:175], v13 offset:64
  ds_read_b128 a[176:179], v12 offset:128
  ds_read_b128 a[180:183], v13 offset:128
  ds_read_b64_tr_b16 a[0:1], v14 offset:0
  v_mfma_f32_32x32x16_bf16 v[208:223], a[44:47], a[184:187], v[208:223]
  ds_read_b64_tr_b16 a[2:3], v14 offset:256
  ds_read_b64_tr_b16 a[4:5], v14 offset:64
  ds_read_b64_tr_b16 a[6:7], v14 offset:320
  ds_read_b64_tr_b16 a[8:9], v14 offset:128
  v_mfma_f32_32x32x16_bf16 v[160:175], a[48:51], a[188:191], v[160:175]
  ds_read_b128 a[184:187], v12 offset:192
  ds_read_b64_tr_b16 a[10:11], v14 offset:384
  ds_read_b64_tr_b16 a[12:13], v14 offset:192
  ds_read_b64_tr_b16 a[14:15], v14 offset:448
  v_mfma_f32_32x32x16_bf16 v[176:191], a[52:55], a[188:191], v[176:191]
  ds_read_b64_tr_b16 a[16:17], v14 offset:4352
  ds_read_b64_tr_b16 a[18:19], v14 offset:4608
  ds_read_b64_tr_b16 a[20:21], v14 offset:4416
  ds_read_b64_tr_b16 a[22:23], v14 offset:4672
  v_mfma_f32_32x32x16_bf16 v[192:207], a[56:59], a[188:191], v[192:207]
  ds_read_b64_tr_b16 a[24:25], v14 offset:4480
  ds_read_b64_tr_b16 a[26:27], v14 offset:4736
  ds_read_b64_tr_b16 a[28:29], v14 offset:4544
  ds_read_b64_tr_b16 a[30:31], v14 offset:4800
  v_mfma_f32_32x32x16_bf16 v[208:223], a[60:63], a[188:191], v[208:223]
  ds_read_b128 a[188:191], v13 offset:192
  s_add_u32 s5, s5, 8704
  s_cmp_lt_u32 s5, 156672
  s_cselect_b32 s5, s5, 0
  s_add_u32 s6, s6, 4
  s_add_u32 s7, s7, 1
  s_bitcmp1_b32 s76, s7
  s_cbranch_scc1 Levstub_172
Levback_173:
  s_waitcnt lgkmcnt(15)
  v_mfma_f32_32x32x16_bf16 v[144:159], a[64:67], v[224:227], v[48:63]
  v_exp_f32 v128, v128
  v_exp_f32 v129, v129
  s_add_u32 s9, s6, 2
  s_cmp_lt_u32 s4, s9
  s_cbranch_scc1 Llw_slow_174
Llw_back_175:
  v_mfma_f32_32x32x16_bf16 v[144:159], a[68:71], v[228:231], v[144:159]
  v_exp_f32 v130, v130
  v_exp_f32 v131, v131
  v_cvt_pk_bf16_f32 v32, v128, v129
  v_add_u32 v12, s5, v8
  s_add_u32 s10, s5, 8704
  v_mfma_f32_32x32x16_bf16 v[144:159], a[72:75], v[232:235], v[144:159]
  v_exp_f32 v132, v132
  v_exp_f32 v133, v133
  v_cvt_pk_bf16_f32 v33, v130, v131
  v_add_u32 v13, s5, v9
  s_cmp_lt_u32 s10, 156672
  v_mfma_f32_32x32x16_bf16 v[144:159], a[76:79], v[236:239], v[144:159]
  v_exp_f32 v134, v134
  v_exp_f32 v135, v135
  v_cvt_pk_bf16_f32 v34, v132, v133
  s_cselect_b32 s10, s10, 0
  v_mov_b32 v21, s6
  v_mfma_f32_32x32x16_bf16 v[144:159], a[80:83], v[240:243], v[144:159]
  v_exp_f32 v136, v136
  v_exp_f32 v137, v137
  v_cvt_pk_bf16_f32 v35, v134, v135
  v_add_u32 v14, s10, v10
  v_mfma_f32_32x32x16_bf16 v[144:159], a[84:87], v[244:247], v[144:159]
  v_exp_f32 v138, v138
  v_exp_f32 v139, v139
  v_cvt_pk_bf16_f32 v36, v136, v137
  s_add_u32 s5, s10, 8704
  v_mfma_f32_32x32x16_bf16 v[144:159], a[88:91], v[248:251], v[144:159]
  v_exp_f32 v140, v140
  v_exp_f32 v141, v141
  v_cvt_pk_bf16_f32 v37, v138, v139
  s_cmp_lt_u32 s5, 156672
  v_mfma_f32_32x32x16_bf16 v[144:159], a[92:95], v[252:255], v[144:159]
  v_exp_f32 v142, v142
  v_exp_f32 v143, v143
  v_cvt_pk_bf16_f32 v38, v140, v141
  v_cvt_pk_bf16_f32 v39, v142, v143
  s_cselect_b32 s5, s5, 0
  s_waitcnt lgkmcnt(0)
  v_mfma_f32_32x32x16_bf16 v[64:79], a[96:99], v[32:35], v[64:79]
  ds_write_b32 v23, v21
  ds_read_b128 a[64:67], v12 offset:0
  ds_read_b128 a[68:71], v13 offset:0
  ds_read_b128 a[72:75], v12 offset:64
  v_add_f32 v17, v17, v128
  v_add_f32 v18, v18, v129
  v_mfma_f32_32x32x16_bf16 v[80:95], a[100:103], v[32:35], v[80:95]
  ds_read_b128 a[76:79], v13 offset:64
  ds_read_b128 a[80:83], v12 offset:128
  ds_read_b128 a[84:87], v13 offset:128
  v_add_f32 v17, v17, v130
  v_add_f32 v18, v18, v131
  s_add_u32 s6, s6, 2
  v_mfma_f32_32x32x16_bf16 v[96:111], a[104:107], v[32:35], v[96:111]
  ds_read_b128 a[88:91], v12 offset:192
  ds_read_b128 a[92:95], v13 offset:192
  ds_read_b64_tr_b16 a[128:129], v14 offset:0
  v_add_f32 v17, v17, v132
  v_add_f32 v18, v18, v133
  v_mfma_f32_32x32x16_bf16 v[112:127], a[108:111], v[32:35], v[112:127]
  ds_read_b64_tr_b16 a[130:131], v14 offset:512
  ds_read_b64_tr_b16 a[132:133], v14 offset:64
  ds_read_b64_tr_b16 a[134:135], v14 offset:576
  v_add_f32 v17, v17, v134
  v_add_f32 v18, v18, v135
  v_max3_f32 v19, v144, v145, v146
  v_mfma_f32_32x32x16_bf16 v[64:79], a[112:115], v[36:39], v[64:79]
  ds_read_b64_tr_b16 a[136:137], v14 offset:128
  ds_read_b64_tr_b16 a[138:139], v14 offset:640
  ds_read_b64_tr_b16 a[140:141], v14 offset:192
  v_add_f32 v17, v17, v136
  v_add_f32 v18, v18, v137
  v_max3_f32 v19, v19, v147, v148
  v_mfma_f32_32x32x16_bf16 v[80:95], a[116:119], v[36:39], v[80:95]
  ds_read_b64_tr_b16 a[142:143], v14 offset:704
  ds_read_b64_tr_b16 a[144:145], v14 offset:4352
  ds_read_b64_tr_b16 a[146:147], v14 offset:4864
  v_add_f32 v17, v17, v138
  v_add_f32 v18, v18, v139
  v_max3_f32 v19, v19, v149, v150
  v_mfma_f32_32x32x16_bf16 v[96:111], a[120:123], v[36:39], v[96:111]
  ds_read_b64_tr_b16 a[148:149], v14 offset:4416
  ds_read_b64_tr_b16 a[150:151], v14 offset:4928
  ds_read_b64_tr_b16 a[152:153], v14 offset:4480
  v_add_f32 v17, v17, v140
  v_add_f32 v18, v18, v141
  v_max3_f32 v19, v19, v151, v152
  v_max3_f32 v19, v19, v153, v154
  v_mfma_f32_32x32x16_bf16 v[112:127], a[124:127], v[36:39], v[112:127]
  ds_read_b64_tr_b16 a[154:155], v14 offset:4992
  ds_read_b64_tr_b16 a[156:157], v14 offset:4544
  ds_read_b64_tr_b16 a[158:159], v14 offset:5056
  v_add_f32 v17, v17, v142
  v_add_f32 v18, v18, v143
  v_max3_f32 v19, v19, v155, v156
  v_max3_f32 v19, v19, v157, v158
  v_max_f32 v19, v19, v159
  v_cmp_lt_f32 vcc, s8, v19
  s_cbranch_vccnz Lrare_176
Lback_177:
  s_waitcnt lgkmcnt(15)
  v_mfma_f32_32x32x16_bf16 v[128:143], a[64:67], v[224:227], v[48:63]
  v_exp_f32 v144, v144
  v_exp_f32 v145, v145
  s_add_u32 s9, s6, 2
  s_cmp_lt_u32 s4, s9
  s_cbranch_scc1 Llw_slow_178
Llw_back_179:
  v_mfma_f32_32x32x16_bf16 v[128:143], a[68:71], v[228:231], v[128:143]
  v_exp_f32 v146, v146
  v_exp_f32 v147, v147
  v_cvt_pk_bf16_f32 v32, v144, v145
  v_add_u32 v12, s5, v8
  s_add_u32 s10, s5, 8704
  v_mfma_f32_32x32x16_bf16 v[128:143], a[72:75], v[232:235], v[128:143]
  v_exp_f32 v148, v148
  v_exp_f32 v149, v149
  v_cvt_pk_bf16_f32 v33, v146, v147
  v_add_u32 v13, s5, v9
  s_cmp_lt_u32 s10, 156672
  v_mfma_f32_32x32x16_bf16 v[128:143], a[76:79], v[236:239], v[128:143]
  v_exp_f32 v150, v150
  v_exp_f32 v151, v151
  v_cvt_pk_bf16_f32 v34, v148, v149
  s_cselect_b32 s10, s10, 0
  v_mov_b32 v21, s6
  v_mfma_f32_32x32x16_bf16 v[128:143], a[80:83], v[240:243], v[128:143]
  v_exp_f32 v152, v152
  v_exp_f32 v153, v153
  v_cvt_pk_bf16_f32 v35, v150, v151
  v_add_u32 v14, s10, v10
  v_mfma_f32_32x32x16_bf16 v[128:143], a[84:87], v[244:247], v[128:143]
  v_exp_f32 v154, v154
  v_exp_f32 v155, v155
  v_cvt_pk_bf16_f32 v36, v152, v153
  s_add_u32 s5, s10, 8704
  v_mfma_f32_32x32x16_bf16 v[128:143], a[88:91], v[248:251], v[128:143]
  v_exp_f32 v156, v156
  v_exp_f32 v157, v157
  v_cvt_pk_bf16_f32 v37, v154, v155
  s_cmp_lt_u32 s5, 156672
  v_mfma_f32_32x32x16_bf16 v[128:143], a[92:95], v[252:255], v[128:143]
  v_exp_f32 v158, v158
  v_exp_f32 v159, v159
  v_cvt_pk_bf16_f32 v38, v156, v157
  v_cvt_pk_bf16_f32 v39, v158, v159
  s_cselect_b32 s5, s5, 0
  s_waitcnt lgkmcnt(0)
  v_mfma_f32_32x32x16_bf16 v[64:79], a[128:131], v[32:35], v[64:79]
  ds_write_b32 v23, v21
  ds_read_b128 a[64:67], v12 offset:0
  ds_read_b128 a[68:71], v13 offset:0
  ds_read_b128 a[72:75], v12 offset:64
  v_add_f32 v17, v17, v144
  v_add_f32 v18, v18, v145
  v_mfma_f32_32x32x16_bf16 v[80:95], a[132:135], v[32:35], v[80:95]
  ds_read_b128 a[76:79], v13 offset:64
  ds_read_b128 a[80:83], v12 offset:128
  ds_read_b128 a[84:87], v13 offset:128
  v_add_f32 v17, v17, v146
  v_add_f32 v18, v18, v147
  s_add_u32 s6, s6, 2
  v_mfma_f32_32x32x16_bf16 v[96:111], a[136:139], v[32:35], v[96:111]
  ds_read_b128 a[88:91], v12 offset:192
  ds_read_b128 a[92:95], v13 offset:192
  ds_read_b64_tr_b16 a[96:97], v14 offset:0
  v_add_f32 v17, v17, v148
  v_add_f32 v18, v18, v149
  v_mfma_f32_32x32x16_bf16 v[112:127], a[140:143], v[32:35], v[112:127]
  ds_read_b64_tr_b16 a[98:99], v14 offset:512
  ds_read_b64_tr_b16 a[100:101], v14 offset:64
  ds_read_b64_tr_b16 a[102:103], v14 offset:576
  v_add_f32 v17, v17, v150
  v_add_f32 v18, v18, v151
  v_max3_f32 v19, v128, v129, v130
  v_mfma_f32_32x32x16_bf16 v[64:79], a[144:147], v[36:39], v[64:79]
  ds_read_b64_tr_b16 a[104:105], v14 offset:128
  ds_read_b64_tr_b16 a[106:107], v14 offset:640
  ds_read_b64_tr_b16 a[108:109], v14 offset:192
  v_add_f32 v17, v17, v152
  v_add_f32 v18, v18, v153
  v_max3_f32 v19, v19, v131, v132
  v_mfma_f32_32x32x16_bf16 v[80:95], a[148:151], v[36:39], v[80:95]
  ds_read_b64_tr_b16 a[110:111], v14 offset:704
  ds_read_b64_tr_b16 a[112:113], v14 offset:4352
  ds_read_b64_tr_b16 a[114:115], v14 offset:4864
  v_add_f32 v17, v17, v154
  v_add_f32 v18, v18, v155
  v_max3_f32 v19, v19, v133, v134
  v_mfma_f32_32x32x16_bf16 v[96:111], a[152:155], v[36:39], v[96:111]
  ds_read_b64_tr_b16 a[116:117], v14 offset:4416
  ds_read_b64_tr_b16 a[118:119], v14 offset:4928
  ds_read_b64_tr_b16 a[120:121], v14 offset:4480
  v_add_f32 v17, v17, v156
  v_add_f32 v18, v18, v157
  v_max3_f32 v19, v19, v135, v136
  v_max3_f32 v19, v19, v137, v138
  v_mfma_f32_32x32x16_bf16 v[112:127], a[156:159], v[36:39], v[112:127]
  ds_read_b64_tr_b16 a[122:123], v14 offset:4992
  ds_read_b64_tr_b16 a[124:125], v14 offset:4544
  ds_read_b64_tr_b16 a[126:127], v14 offset:5056
  v_add_f32 v17, v17, v158
  v_add_f32 v18, v18, v159
  v_max3_f32 v19, v19, v139, v140
  v_max3_f32 v19, v19, v141, v142
  v_max_f32 v19, v19, v143
  v_cmp_lt_f32 vcc, s8, v19
  s_cbranch_vccnz Lrare_180
Lback_181:
  v_mfma_f32_32x32x16_bf16 v[160:175], a[0:3], a[160:163], v[160:175]
  s_add_u32 s9, s6, 1
  s_cmp_lt_u32 s4, s9
  s_cbranch_scc1 Llw_slow_182
Llw_back_183:
  v_add_u32 v14, s5, v11
  v_mfma_f32_32x32x16_bf16 v[176:191], a[4:7], a[160:163], v[176:191]
  ds_read_b64_tr_b16 a[32:33], v14 offset:0
  ds_read_b64_tr_b16 a[34:35], v14 offset:256
  v_mfma_f32_32x32x16_bf16 v[192:207], a[8:11], a[160:163], v[192:207]
  ds_read_b64_tr_b16 a[36:37], v14 offset:64
  ds_read_b64_tr_b16 a[38:39], v14 offset:320
  ds_read_b64_tr_b16 a[40:41], v14 offset:128
  v_mfma_f32_32x32x16_bf16 v[208:223], a[12:15], a[160:163], v[208:223]
  ds_read_b64_tr_b16 a[42:43], v14 offset:384
  ds_read_b64_tr_b16 a[44:45], v14 offset:192
  ds_read_b64_tr_b16 a[46:47], v14 offset:448
  v_mfma_f32_32x32x16_bf16 v[160:175], a[16:19], a[164:167], v[160:175]
  ds_read_b64_tr_b16 a[48:49], v14 offset:4352
  ds_read_b64_tr_b16 a[50:51], v14 offset:4608
  v_mfma_f32_32x32x16_bf16 v[176:191], a[20:23], a[164:167], v[176:191]
  ds_read_b64_tr_b16 a[52:53], v14 offset:4416
  ds_read_b64_tr_b16 a[54:55], v14 offset:4672
  ds_read_b64_tr_b16 a[56:57], v14 offset:4480
  v_mfma_f32_32x32x16_bf16 v[192:207], a[24:27], a[164:167], v[192:207]
  ds_read_b64_tr_b16 a[58:59], v14 offset:4736
  ds_read_b64_tr_b16 a[60:61], v14 offset:4544
  ds_read_b64_tr_b16 a[62:63], v14 offset:4800
  v_mfma_f32_32x32x16_bf16 v[208:223], a[28:31], a[164:167], v[208:223]
  s_add_u32 s5, s5, 8704
  s_cmp_lt_u32 s5, 156672
  s_cselect_b32 s5, s5, 0
  s_add_u32 s6, s6, 1
  s_add_u32 s7, s7, 1
  s_bitcmp1_b32 s76, s7
  s_cbranch_scc1 Levstub_184
Levback_185:
  s_waitcnt lgkmcnt(15)
  v_mfma_f32_32x32x16_bf16 v[144:159], a[64:67], v[224:227], v[48:63]
  v_exp_f32 v128, v128
  v_exp_f32 v129, v129
  s_add_u32 s9, s6, 2
  s_cmp_lt_u32 s4, s9
  s_cbranch_scc1 Llw_slow_186
Llw_back_187:
  v_mfma_f32_32x32x16_bf16 v[144:159], a[68:71], v[228:231], v[144:159]
  v_exp_f32 v130, v130
  v_exp_f32 v131, v131
  v_cvt_pk_bf16_f32 v32, v128, v129
  v_add_u32 v12, s5, v8
  s_add_u32 s10, s5, 8704
  v_mfma_f32_32x32x16_bf16 v[144:159], a[72:75], v[232:235], v[144:159]
  v_exp_f32 v132, v132
  v_exp_f32 v133, v133
  v_cvt_pk_bf16_f32 v33, v130, v131
  v_add_u32 v13, s5, v9
  s_cmp_lt_u32 s10, 156672
  v_mfma_f32_32x32x16_bf16 v[144:159], a[76:79], v[236:239], v[144:159]
  v_exp_f32 v134, v134
  v_exp_f32 v135, v135
  v_cvt_pk_bf16_f32 v34, v132, v133
  s_cselect_b32 s10, s10, 0
  v_mov_b32 v21, s6
  v_mfma_f32_32x32x16_bf16 v[144:159], a[80:83], v[240:243], v[144:159]
  v_exp_f32 v136, v136
  v_exp_f32 v137, v137
  v_cvt_pk_bf16_f32 v35, v134, v135
  v_add_u32 v14, s10, v10
  v_mfma_f32_32x32x16_bf16 v[144:159], a[84:87], v[244:247], v[144:159]
  v_exp_f32 v138, v138
  v_exp_f32 v139, v139
  v_cvt_pk_bf16_f32 v36, v136, v137
  s_add_u32 s5, s10, 8704
  v_mfma_f32_32x32x16_bf16 v[144:159], a[88:91], v[248:251], v[144:159]
  v_exp_f32 v140, v140
  v_exp_f32 v141, v141
  v_cvt_pk_bf16_f32 v37, v138, v139
  s_cmp_lt_u32 s5, 156672
  v_mfma_f32_32x32x16_bf16 v[144:159], a[92:95], v[252:255], v[144:159]
  v_exp_f32 v142, v142
  v_exp_f32 v143, v143
  v_cvt_pk_bf16_f32 v38, v140, v141
  v_cvt_pk_bf16_f32 v39, v142, v143
  s_cselect_b32 s5, s5, 0
  s_waitcnt lgkmcnt(0)
  v_mfma_f32_32x32x16_bf16 v[64:79], a[96:99], v[32:35], v[64:79]
  ds_write_b32 v23, v21
  ds_read_b128 a[64:67], v12 offset:0
  ds_read_b128 a[68:71], v13 offset:0
  ds_read_b128 a[72:75], v12 offset:64
  v_add_f32 v17, v17, v128
  v_add_f32 v18, v18, v129
  v_mfma_f32_32x32x16_bf16 v[80:95], a[100:103], v[32:35], v[80:95]
  ds_read_b128 a[76:79], v13 offset:64
  ds_read_b128 a[80:83], v12 offset:128
  ds_read_b128 a[84:87], v13 offset:128
  v_add_f32 v17, v17, v130
  v_add_f32 v18, v18, v131
  s_add_u32 s6, s6, 2
  v_mfma_f32_32x32x16_bf16 v[96:111], a[104:107], v[32:35], v[96:111]
  ds_read_b128 a[88:91], v12 offset:192
  ds_read_b128 a[92:95], v13 offset:192
  ds_read_b64_tr_b16 a[128:129], v14 offset:0
  v_add_f32 v17, v17, v132
  v_add_f32 v18, v18, v133
  v_mfma_f32_32x32x16_bf16 v[112:127], a[108:111], v[32:35], v[112:127]
  ds_read_b64_tr_b16 a[130:131], v14 offset:512
  ds_read_b64_tr_b16 a[132:133], v14 offset:64
  ds_read_b64_tr_b16 a[134:135], v14 offset:576
  v_add_f32 v17, v17, v134
  v_add_f32 v18, v18, v135
  v_max3_f32 v19, v144, v145, v146
  v_mfma_f32_32x32x16_bf16 v[64:79], a[112:115], v[36:39], v[64:79]
  ds_read_b64_tr_b16 a[136:137], v14 offset:128
  ds_read_b64_tr_b16 a[138:139], v14 offset:640
  ds_read_b64_tr_b16 a[140:141], v14 offset:192
  v_add_f32 v17, v17, v136
  v_add_f32 v18, v18, v137
  v_max3_f32 v19, v19, v147, v148
  v_mfma_f32_32x32x16_bf16 v[80:95], a[116:119], v[36:39], v[80:95]
  ds_read_b64_tr_b16 a[142:143], v14 offset:704
  ds_read_b64_tr_b16 a[144:145], v14 offset:4352
  ds_read_b64_tr_b16 a[146:147], v14 offset:4864
  v_add_f32 v17, v17, v138
  v_add_f32 v18, v18, v139
  v_max3_f32 v19, v19, v149, v150
  v_mfma_f32_32x32x16_bf16 v[96:111], a[120:123], v[36:39], v[96:111]
  ds_read_b64_tr_b16 a[148:149], v14 offset:4416
  ds_read_b64_tr_b16 a[150:151], v14 offset:4928
  ds_read_b64_tr_b16 a[152:153], v14 offset:4480
  v_add_f32 v17, v17, v140
  v_add_f32 v18, v18, v141
  v_max3_f32 v19, v19, v151, v152
  v_max3_f32 v19, v19, v153, v154
  v_mfma_f32_32x32x16_bf16 v[112:127], a[124:127], v[36:39], v[112:127]
  ds_read_b64_tr_b16 a[154:155], v14 offset:4992
  ds_read_b64_tr_b16 a[156:157], v14 offset:4544
  ds_read_b64_tr_b16 a[158:159], v14 offset:5056
  v_add_f32 v17, v17, v142
  v_add_f32 v18, v18, v143
  v_max3_f32 v19, v19, v155, v156
  v_max3_f32 v19, v19, v157, v158
  v_max_f32 v19, v19, v159
  v_cmp_lt_f32 vcc, s8, v19
  s_cbranch_vccnz Lrare_188
Lback_189:
  s_waitcnt lgkmcnt(15)
  v_mfma_f32_32x32x16_bf16 v[128:143], a[64:67], v[224:227], v[48:63]
  v_exp_f32 v144, v144
  v_exp_f32 v145, v145
  s_add_u32 s9, s6, 2
  s_cmp_lt_u32 s4, s9
  s_cbranch_scc1 Llw_slow_190
Llw_back_191:
  v_mfma_f32_32x32x16_bf16 v[128:143], a[68:71], v[228:231], v[128:143]
  v_exp_f32 v146, v146
  v_exp_f32 v147, v147
  v_cvt_pk_bf16_f32 v32, v144, v145
  v_add_u32 v12, s5, v8
  s_add_u32 s10, s5, 8704
  v_mfma_f32_32x32x16_bf16 v[128:143], a[72:75], v[232:235], v[128:143]
  v_exp_f32 v148, v148
  v_exp_f32 v149, v149
  v_cvt_pk_bf16_f32 v33, v146, v147
  v_add_u32 v13, s5, v9
  s_cmp_lt_u32 s10, 156672
  v_mfma_f32_32x32x16_bf16 v[128:143], a[76:79], v[236:239], v[128:143]
  v_exp_f32 v150, v150
  v_exp_f32 v151, v151
  v_cvt_pk_bf16_f32 v34, v148, v149
  s_cselect_b32 s10, s10, 0
  v_mov_b32 v21, s6
  v_mfma_f32_32x32x16_bf16 v[128:143], a[80:83], v[240:243], v[128:143]
  v_exp_f32 v152, v152
  v_exp_f32 v153, v153
  v_cvt_pk_bf16_f32 v35, v150, v151
  v_add_u32 v14, s10, v10
  v_mfma_f32_32x32x16_bf16 v[128:143], a[84:87], v[244:247], v[128:143]
  v_exp_f32 v154, v154
  v_exp_f32 v155, v155
  v_cvt_pk_bf16_f32 v36, v152, v153
  s_add_u32 s5, s10, 8704
  v_mfma_f32_32x32x16_bf16 v[128:143], a[88:91], v[248:251], v[128:143]
  v_exp_f32 v156, v156
  v_exp_f32 v157, v157
  v_cvt_pk_bf16_f32 v37, v154, v155
  s_cmp_lt_u32 s5, 156672
  v_mfma_f32_32x32x16_bf16 v[128:143], a[92:95], v[252:255], v[128:143]
  v_exp_f32 v158, v158
  v_exp_f32 v159, v159
  v_cvt_pk_bf16_f32 v38, v156, v157
  v_cvt_pk_bf16_f32 v39, v158, v159
  s_cselect_b32 s5, s5, 0
  s_waitcnt lgkmcnt(0)
  v_mfma_f32_32x32x16_bf16 v[64:79], a[128:131], v[32:35], v[64:79]
  ds_write_b32 v23, v21
  ds_read_b128 a[64:67], v12 offset:0
  ds_read_b128 a[68:71], v13 offset:0
  ds_read_b128 a[72:75], v12 offset:64
  v_add_f32 v17, v17, v144
  v_add_f32 v18, v18, v145
  v_mfma_f32_32x32x16_bf16 v[80:95], a[132:135], v[32:35], v[80:95]
  ds_read_b128 a[76:79], v13 offset:64
  ds_read_b128 a[80:83], v12 offset:128
  ds_read_b128 a[84:87], v13 offset:128
  v_add_f32 v17, v17, v146
  v_add_f32 v18, v18, v147
  s_add_u32 s6, s6, 2
  v_mfma_f32_32x32x16_bf16 v[96:111], a[136:139], v[32:35], v[96:111]
  ds_read_b128 a[88:91], v12 offset:192
  ds_read_b128 a[92:95], v13 offset:192
  ds_read_b64_tr_b16 a[96:97], v14 offset:0
  v_add_f32 v17, v17, v148
  v_add_f32 v18, v18, v149
  v_mfma_f32_32x32x16_bf16 v[112:127], a[140:143], v[32:35], v[112:127]
  ds_read_b64_tr_b16 a[98:99], v14 offset:512
  ds_read_b64_tr_b16 a[100:101], v14 offset:64
  ds_read_b64_tr_b16 a[102:103], v14 offset:576
  v_add_f32 v17, v17, v150
  v_add_f32 v18, v18, v151
  v_max3_f32 v19, v128, v129, v130
  v_mfma_f32_32x32x16_bf16 v[64:79], a[144:147], v[36:39], v[64:79]
  ds_read_b64_tr_b16 a[104:105], v14 offset:128
  ds_read_b64_tr_b16 a[106:107], v14 offset:640
  ds_read_b64_tr_b16 a[108:109], v14 offset:192
  v_add_f32 v17, v17, v152
  v_add_f32 v18, v18, v153
  v_max3_f32 v19, v19, v131, v132
  v_mfma_f32_32x32x16_bf16 v[80:95], a[148:151], v[36:39], v[80:95]
  ds_read_b64_tr_b16 a[110:111], v14 offset:704
  ds_read_b64_tr_b16 a[112:113], v14 offset:4352
  ds_read_b64_tr_b16 a[114:115], v14 offset:4864
  v_add_f32 v17, v17, v154
  v_add_f32 v18, v18, v155
  v_max3_f32 v19, v19, v133, v134
  v_mfma_f32_32x32x16_bf16 v[96:111], a[152:155], v[36:39], v[96:111]
  ds_read_b64_tr_b16 a[116:117], v14 offset:4416
  ds_read_b64_tr_b16 a[118:119], v14 offset:4928
  ds_read_b64_tr_b16 a[120:121], v14 offset:4480
  v_add_f32 v17, v17, v156
  v_add_f32 v18, v18, v157
  v_max3_f32 v19, v19, v135, v136
  v_max3_f32 v19, v19, v137, v138
  v_mfma_f32_32x32x16_bf16 v[112:127], a[156:159], v[36:39], v[112:127]
  ds_read_b64_tr_b16 a[122:123], v14 offset:4992
  ds_read_b64_tr_b16 a[124:125], v14 offset:4544
  ds_read_b64_tr_b16 a[126:127], v14 offset:5056
  v_add_f32 v17, v17, v158
  v_add_f32 v18, v18, v159
  v_max3_f32 v19, v19, v139, v140
  v_max3_f32 v19, v19, v141, v142
  v_max_f32 v19, v19, v143
  v_cmp_lt_f32 vcc, s8, v19
  s_cbranch_vccnz Lrare_192
Lback_193:
  v_mfma_f32_32x32x16_bf16 v[160:175], a[32:35], a[168:171], v[160:175]
  s_add_u32 s9, s6, 2
  s_cmp_lt_u32 s4, s9
  s_cbranch_scc1 Llw_slow_194
Llw_back_195:
  v_add_u32 v14, s5, v11
  v_mfma_f32_32x32x16_bf16 v[176:191], a[36:39], a[168:171], v[176:191]
  ds_read_b64_tr_b16 a[0:1], v14 offset:0
  ds_read_b64_tr_b16 a[2:3], v14 offset:256
  v_mfma_f32_32x32x16_bf16 v[192:207], a[40:43], a[168:171], v[192:207]
  ds_read_b64_tr_b16 a[4:5], v14 offset:64
  ds_read_b64_tr_b16 a[6:7], v14 offset:320
  ds_read_b64_tr_b16 a[8:9], v14 offset:128
  v_mfma_f32_32x32x16_bf16 v[208:223], a[44:47], a[168:171], v[208:223]
  ds_read_b64_tr_b16 a[10:11], v14 offset:384
  ds_read_b64_tr_b16 a[12:13], v14 offset:192
  ds_read_b64_tr_b16 a[14:15], v14 offset:448
  v_mfma_f32_32x32x16_bf16 v[160:175], a[48:51], a[172:175], v[160:175]
  ds_read_b64_tr_b16 a[16:17], v14 offset:4352
  ds_read_b64_tr_b16 a[18:19], v14 offset:4608
  v_mfma_f32_32x32x16_bf16 v[176:191], a[52:55], a[172:175], v[176:191]
  ds_read_b64_tr_b16 a[20:21], v14 offset:4416
  ds_read_b64_tr_b16 a[22:23], v14 offset:4672
  ds_read_b64_tr_b16 a[24:25], v14 offset:4480
  v_mfma_f32_32x32x16_bf16 v[192:207], a[56:59], a[172:175], v[192:207]
  ds_read_b64_tr_b16 a[26:27], v14 offset:4736
  ds_read_b64_tr_b16 a[28:29], v14 offset:4544
  ds_read_b64_tr_b16 a[30:31], v14 offset:4800
  v_mfma_f32_32x32x16_bf16 v[208:223], a[60:63], a[172:175], v[208:223]
  s_add_u32 s5, s5, 8704
  s_cmp_lt_u32 s5, 156672
  s_cselect_b32 s5, s5, 0
  s_add_u32 s6, s6, 1
  v_add_u32 v14, s5, v11
  ds_read_b64_tr_b16 a[224:225], v14 offset:0
  ds_read_b64_tr_b16 a[226:227], v14 offset:256
  ds_read_b64_tr_b16 a[228:229], v14 offset:64
  ds_read_b64_tr_b16 a[230:231], v14 offset:320
  ds_read_b64_tr_b16 a[232:233], v14 offset:128
  ds_read_b64_tr_b16 a[234:235], v14 offset:384
  ds_read_b64_tr_b16 a[236:237], v14 offset:192
  ds_read_b64_tr_b16 a[238:239], v14 offset:448
  ds_read_b64_tr_b16 a[240:241], v14 offset:4352
  ds_read_b64_tr_b16 a[242:243], v14 offset:4608
  ds_read_b64_tr_b16 a[244:245], v14 offset:4416
  ds_read_b64_tr_b16 a[246:247], v14 offset:4672
  ds_read_b64_tr_b16 a[248:249], v14 offset:4480
  ds_read_b64_tr_b16 a[250:251], v14 offset:4736
  ds_read_b64_tr_b16 a[252:253], v14 offset:4544
  ds_read_b64_tr_b16 a[254:255], v14 offset:4800
  s_add_u32 s5, s5, 8704
  s_cmp_lt_u32 s5, 156672
  s_cselect_b32 s5, s5, 0
  s_add_u32 s6, s6, 1
  s_add_u32 s7, s7, 1
  s_bitcmp1_b32 s76, s7
  s_cbranch_scc1 Levstub_196
Levback_197:
  s_waitcnt lgkmcnt(0)
  s_add_u32 s9, s6, 1
  s_cmp_lt_u32 s4, s9
  s_cbranch_scc1 Llw_slow_198
Llw_back_199:
  v_add_u32 v14, s5, v10
  v_mfma_f32_32x32x16_bf16 v[144:159], a[64:67], v[224:227], v[48:63]
  v_exp_f32 v128, v128
  v_exp_f32 v129, v129
  ds_read_b64_tr_b16 a[128:129], v14 offset:0
  ds_read_b64_tr_b16 a[130:131], v14 offset:512
  v_mfma_f32_32x32x16_bf16 v[144:159], a[68:71], v[228:231], v[144:159]
  v_exp_f32 v130, v130
  v_exp_f32 v131, v131
  v_add_f32 v17, v17, v128
  v_add_f32 v18, v18, v129
  v_cvt_pk_bf16_f32 v32, v128, v129
  ds_read_b64_tr_b16 a[132:133], v14 offset:64
  ds_read_b64_tr_b16 a[134:135], v14 offset:576
  v_mfma_f32_32x32x16_bf16 v[144:159], a[72:75], v[232:235], v[144:159]
  v_exp_f32 v132, v132
  v_exp_f32 v133, v133
  v_add_f32 v17, v17, v130
  v_add_f32 v18, v18, v131
  v_cvt_pk_bf16_f32 v33, v130, v131
  ds_read_b64_tr_b16 a[136:137], v14 offset:128
  ds_read_b64_tr_b16 a[138:139], v14 offset:640
  v_mfma_f32_32x32x16_bf16 v[144:159], a[76:79], v[236:239], v[144:159]
  v_exp_f32 v134, v134
  v_exp_f32 v135, v135
  v_add_f32 v17, v17, v132
  v_add_f32 v18, v18, v133
  v_cvt_pk_bf16_f32 v34, v132, v133
  ds_read_b64_tr_b16 a[140:141], v14 offset:192
  ds_read_b64_tr_b16 a[142:143], v14 offset:704
  v_mfma_f32_32x32x16_bf16 v[144:159], a[80:83], v[240:243], v[144:159]
  v_exp_f32 v136, v136
  v_exp_f32 v137, v137
  v_add_f32 v17, v17, v134
  v_add_f32 v18, v18, v135
  v_cvt_pk_bf16_f32 v35, v134, v135
  ds_read_b64_tr_b16 a[144:145], v14 offset:4352
  ds_read_b64_tr_b16 a[146:147], v14 offset:4864
  v_mfma_f32_32x32x16_bf16 v[144:159], a[84:87], v[244:247], v[144:159]
  v_exp_f32 v138, v138
  v_exp_f32 v139, v139
  v_add_f32 v17, v17, v136
  v_add_f32 v18, v18, v137
  v_cvt_pk_bf16_f32 v36, v136, v137
  ds_read_b64_tr_b16 a[148:149], v14 offset:4416
  ds_read_b64_tr_b16 a[150:151], v14 offset:4928
  v_mfma_f32_32x32x16_bf16 v[144:159], a[88:91], v[248:251], v[144:159]
  v_exp_f32 v140, v140
  v_exp_f32 v141, v141
  v_add_f32 v17, v17, v138
  v_add_f32 v18, v18, v139
  v_cvt_pk_bf16_f32 v37, v138, v139
  ds_read_b64_tr_b16 a[152:153], v14 offset:4480
  ds_read_b64_tr_b16 a[154:155], v14 offset:4992
  v_mfma_f32_32x32x16_bf16 v[144:159], a[92:95], v[252:255], v[144:159]
  v_exp_f32 v142, v142
  v_exp_f32 v143, v143
  v_add_f32 v17, v17, v140
  v_add_f32 v18, v18, v141
  v_cvt_pk_bf16_f32 v38, v140, v141
  ds_read_b64_tr_b16 a[156:157], v14 offset:4544
  ds_read_b64_tr_b16 a[158:159], v14 offset:5056
  v_add_f32 v17, v17, v142
  v_add_f32 v18, v18, v143
  v_cvt_pk_bf16_f32 v39, v142, v143
  s_waitcnt lgkmcnt(15)
  v_mfma_f32_32x32x16_bf16 v[64:79], a[96:99], v[32:35], v[64:79]
  v_mfma_f32_32x32x16_bf16 v[80:95], a[100:103], v[32:35], v[80:95]
  v_mfma_f32_32x32x16_bf16 v[96:111], a[104:107], v[32:35], v[96:111]
  v_mfma_f32_32x32x16_bf16 v[112:127], a[108:111], v[32:35], v[112:127]
  v_max3_f32 v19, v144, v145, v146
  v_max3_f32 v19, v19, v147, v148
  v_mfma_f32_32x32x16_bf16 v[64:79], a[112:115], v[36:39], v[64:79]
  v_max3_f32 v19, v19, v149, v150
  v_max3_f32 v19, v19, v151, v152
  s_add_u32 s6, s6, 1
  v_mfma_f32_32x32x16_bf16 v[80:95], a[116:119], v[36:39], v[80:95]
  v_max3_f32 v19, v19, v153, v154
  v_max3_f32 v19, v19, v155, v156
  s_add_u32 s5, s5, 8704
  s_cmp_lt_u32 s5, 156672
  v_mfma_f32_32x32x16_bf16 v[96:111], a[120:123], v[36:39], v[96:111]
  v_max3_f32 v19, v19, v157, v158
  v_max_f32 v19, v19, v159
  s_cselect_b32 s5, s5, 0
  v_mfma_f32_32x32x16_bf16 v[112:127], a[124:127], v[36:39], v[112:127]
  v_cmp_lt_f32 vcc, s8, v19
  s_cbranch_vccnz Lrare_200
Lback_201:
  v_mfma_f32_32x32x16_bf16 v[160:175], a[0:3], a[176:179], v[160:175]
  v_mfma_f32_32x32x16_bf16 v[176:191], a[4:7], a[176:179], v[176:191]
  v_mfma_f32_32x32x16_bf16 v[192:207], a[8:11], a[176:179], v[192:207]
  v_mfma_f32_32x32x16_bf16 v[208:223], a[12:15], a[176:179], v[208:223]
  v_mfma_f32_32x32x16_bf16 v[160:175], a[16:19], a[180:183], v[160:175]
  v_mfma_f32_32x32x16_bf16 v[176:191], a[20:23], a[180:183], v[176:191]
  v_mfma_f32_32x32x16_bf16 v[192:207], a[24:27], a[180:183], v[192:207]
  v_mfma_f32_32x32x16_bf16 v[208:223], a[28:31], a[180:183], v[208:223]
  s_waitcnt lgkmcnt(0)
  v_exp_f32 v144, v144
  v_exp_f32 v145, v145
  v_exp_f32 v146, v146
  v_exp_f32 v147, v147
  v_add_f32 v17, v17, v144
  v_add_f32 v18, v18, v145
  v_cvt_pk_bf16_f32 v32, v144, v145
  v_exp_f32 v148, v148
  v_exp_f32 v149, v149
  v_add_f32 v17, v17, v146
  v_add_f32 v18, v18, v147
  v_cvt_pk_bf16_f32 v33, v146, v147
  v_exp_f32 v150, v150
  v_exp_f32 v151, v151
  v_add_f32 v17, v17, v148
  v_add_f32 v18, v18, v149
  v_cvt_pk_bf16_f32 v34, v148, v149
  v_exp_f32 v152, v152
  v_exp_f32 v153, v153
  v_add_f32 v17, v17, v150
  v_add_f32 v18, v18, v151
  v_cvt_pk_bf16_f32 v35, v150, v151
  v_exp_f32 v154, v154
  v_exp_f32 v155, v155
  v_add_f32 v17, v17, v152
  v_add_f32 v18, v18, v153
  v_cvt_pk_bf16_f32 v36, v152, v153
  v_exp_f32 v156, v156
  v_exp_f32 v157, v157
  v_add_f32 v17, v17, v154
  v_add_f32 v18, v18, v155
  v_cvt_pk_bf16_f32 v37, v154, v155
  v_exp_f32 v158, v158
  v_exp_f32 v159, v159
  v_add_f32 v17, v17, v156
  v_add_f32 v18, v18, v157
  v_cvt_pk_bf16_f32 v38, v156, v157
  v_add_f32 v17, v17, v158
  v_add_f32 v18, v18, v159
  v_cvt_pk_bf16_f32 v39, v158, v159
  v_mov_b32 v21, s6
  ds_write_b32 v23, v21
  v_mfma_f32_32x32x16_bf16 v[64:79], a[128:131], v[32:35], v[64:79]
  v_mfma_f32_32x32x16_bf16 v[80:95], a[132:135], v[32:35], v[80:95]
  v_mfma_f32_32x32x16_bf16 v[96:111], a[136:139], v[32:35], v[96:111]
  v_mfma_f32_32x32x16_bf16 v[112:127], a[140:143], v[32:35], v[112:127]
  v_mfma_f32_32x32x16_bf16 v[64:79], a[144:147], v[36:39], v[64:79]
  v_mfma_f32_32x32x16_bf16 v[80:95], a[148:151], v[36:39], v[80:95]
  v_mfma_f32_32x32x16_bf16 v[96:111], a[152:155], v[36:39], v[96:111]
  v_mfma_f32_32x32x16_bf16 v[112:127], a[156:159], v[36:39], v[112:127]
  v_mfma_f32_32x32x16_bf16 v[160:175], a[224:227], a[184:187], v[160:175]
  v_mfma_f32_32x32x16_bf16 v[176:191], a[228:231], a[184:187], v[176:191]
  v_mfma_f32_32x32x16_bf16 v[192:207], a[232:235], a[184:187], v[192:207]
  v_mfma_f32_32x32x16_bf16 v[208:223], a[236:239], a[184:187], v[208:223]
  v_mfma_f32_32x32x16_bf16 v[160:175], a[240:243], a[188:191], v[160:175]
  v_mfma_f32_32x32x16_bf16 v[176:191], a[244:247], a[188:191], v[176:191]
  v_mfma_f32_32x32x16_bf16 v[192:207], a[248:251], a[188:191], v[192:207]
  v_mfma_f32_32x32x16_bf16 v[208:223], a[252:255], a[188:191], v[208:223]
  v_add_f32 v17, v17, v18
  v_mov_b32 v18, v17
  s_nop 1
  v_permlane32_swap_b32 v17, v18
  s_nop 1
  v_add_f32 v17, v17, v18
  v_rcp_f32 v20, v17
  s_nop 7
  s_nop 3
  s_mov_b32 s29, 0x3e0293ee
  v_mul_f32 v160, s29, v160
  v_mul_f32 v161, s29, v161
  v_cvt_pk_bf16_f32 v160, v160, v161
  v_mul_f32 v162, s29, v162
  v_mul_f32 v163, s29, v163
  v_cvt_pk_bf16_f32 v161, v162, v163
  v_mul_f32 v164, s29, v164
  v_mul_f32 v165, s29, v165
  v_cvt_pk_bf16_f32 v162, v164, v165
  v_mul_f32 v166, s29, v166
  v_mul_f32 v167, s29, v167
  v_cvt_pk_bf16_f32 v163, v166, v167
  v_mul_f32 v168, s29, v168
  v_mul_f32 v169, s29, v169
  v_cvt_pk_bf16_f32 v164, v168, v169
  v_mul_f32 v170, s29, v170
  v_mul_f32 v171, s29, v171
  v_cvt_pk_bf16_f32 v165, v170, v171
  v_mul_f32 v172, s29, v172
  v_mul_f32 v173, s29, v173
  v_cvt_pk_bf16_f32 v166, v172, v173
  v_mul_f32 v174, s29, v174
  v_mul_f32 v175, s29, v175
  v_cvt_pk_bf16_f32 v167, v174, v175
  v_mul_f32 v176, s29, v176
  v_mul_f32 v177, s29, v177
  v_cvt_pk_bf16_f32 v168, v176, v177
  v_mul_f32 v178, s29, v178
  v_mul_f32 v179, s29, v179
  v_cvt_pk_bf16_f32 v169, v178, v179
  v_mul_f32 v180, s29, v180
  v_mul_f32 v181, s29, v181
  v_cvt_pk_bf16_f32 v170, v180, v181
  v_mul_f32 v182, s29, v182
  v_mul_f32 v183, s29, v183
  v_cvt_pk_bf16_f32 v171, v182, v183
  v_mul_f32 v184, s29, v184
  v_mul_f32 v185, s29, v185
  v_cvt_pk_bf16_f32 v172, v184, v185
  v_mul_f32 v186, s29, v186
  v_mul_f32 v187, s29, v187
  v_cvt_pk_bf16_f32 v173, v186, v187
  v_mul_f32 v188, s29, v188
  v_mul_f32 v189, s29, v189
  v_cvt_pk_bf16_f32 v174, v188, v189
  v_mul_f32 v190, s29, v190
  v_mul_f32 v191, s29, v191
  v_cvt_pk_bf16_f32 v175, v190, v191
  v_mul_f32 v192, s29, v192
  v_mul_f32 v193, s29, v193
  v_cvt_pk_bf16_f32 v176, v192, v193
  v_mul_f32 v194, s29, v194
  v_mul_f32 v195, s29, v195
  v_cvt_pk_bf16_f32 v177, v194, v195
  v_mul_f32 v196, s29, v196
  v_mul_f32 v197, s29, v197
  v_cvt_pk_bf16_f32 v178, v196, v197
  v_mul_f32 v198, s29, v198
  v_mul_f32 v199, s29, v199
  v_cvt_pk_bf16_f32 v179, v198, v199
  v_mul_f32 v200, s29, v200
  v_mul_f32 v201, s29, v201
  v_cvt_pk_bf16_f32 v180, v200, v201
  v_mul_f32 v202, s29, v202
  v_mul_f32 v203, s29, v203
  v_cvt_pk_bf16_f32 v181, v202, v203
  v_mul_f32 v204, s29, v204
  v_mul_f32 v205, s29, v205
  v_cvt_pk_bf16_f32 v182, v204, v205
  v_mul_f32 v206, s29, v206
  v_mul_f32 v207, s29, v207
  v_cvt_pk_bf16_f32 v183, v206, v207
  v_mul_f32 v208, s29, v208
  v_mul_f32 v209, s29, v209
  v_cvt_pk_bf16_f32 v184, v208, v209
  v_mul_f32 v210, s29, v210
  v_mul_f32 v211, s29, v211
  v_cvt_pk_bf16_f32 v185, v210, v211
  v_mul_f32 v212, s29, v212
  v_mul_f32 v213, s29, v213
  v_cvt_pk_bf16_f32 v186, v212, v213
  v_mul_f32 v214, s29, v214
  v_mul_f32 v215, s29, v215
  v_cvt_pk_bf16_f32 v187, v214, v215
  v_mul_f32 v216, s29, v216
  v_mul_f32 v217, s29, v217
  v_cvt_pk_bf16_f32 v188, v216, v217
  v_mul_f32 v218, s29, v218
  v_mul_f32 v219, s29, v219
  v_cvt_pk_bf16_f32 v189, v218, v219
  v_mul_f32 v220, s29, v220
  v_mul_f32 v221, s29, v221
  v_cvt_pk_bf16_f32 v190, v220, v221
  v_mul_f32 v222, s29, v222
  v_mul_f32 v223, s29, v223
  v_cvt_pk_bf16_f32 v191, v222, v223
  s_lshl_b32 s29, s24, 2
  s_add_u32 s29, s29, s21
  s_add_u32 s29, s29, 0
  s_mul_i32 s29, s29, 24576
  s_lshl_b32 s30, s3, 13
  s_add_u32 s29, s29, s30
  s_add_u32 s12, s29, 1048576
  s_add_u32 s13, s12, 4096
  s_nop 3
  v_mul_f32 v64, v64, v20
  v_mul_f32 v65, v65, v20
  v_cvt_pk_bf16_f32 v192, v64, v65
  v_mul_f32 v66, v66, v20
  v_mul_f32 v67, v67, v20
  v_cvt_pk_bf16_f32 v193, v66, v67
  v_mul_f32 v68, v68, v20
  v_mul_f32 v69, v69, v20
  v_cvt_pk_bf16_f32 v194, v68, v69
  v_mul_f32 v70, v70, v20
  v_mul_f32 v71, v71, v20
  v_cvt_pk_bf16_f32 v195, v70, v71
  buffer_store_dwordx4 v[192:195], v15, s[64:67], s12 offen offset:0 sc1
  v_mul_f32 v72, v72, v20
  v_mul_f32 v73, v73, v20
  v_cvt_pk_bf16_f32 v196, v72, v73
  v_mul_f32 v74, v74, v20
  v_mul_f32 v75, v75, v20
  v_cvt_pk_bf16_f32 v197, v74, v75
  v_mul_f32 v76, v76, v20
  v_mul_f32 v77, v77, v20
  v_cvt_pk_bf16_f32 v198, v76, v77
  v_mul_f32 v78, v78, v20
  v_mul_f32 v79, v79, v20
  v_cvt_pk_bf16_f32 v199, v78, v79
  buffer_store_dwordx4 v[196:199], v15, s[64:67], s12 offen offset:1024 sc1
  v_mul_f32 v80, v80, v20
  v_mul_f32 v81, v81, v20
  v_cvt_pk_bf16_f32 v200, v80, v81
  v_mul_f32 v82, v82, v20
  v_mul_f32 v83, v83, v20
  v_cvt_pk_bf16_f32 v201, v82, v83
  v_mul_f32 v84, v84, v20
  v_mul_f32 v85, v85, v20
  v_cvt_pk_bf16_f32 v202, v84, v85
  v_mul_f32 v86, v86, v20
  v_mul_f32 v87, v87, v20
  v_cvt_pk_bf16_f32 v203, v86, v87
  buffer_store_dwordx4 v[200:203], v15, s[64:67], s12 offen offset:2048 sc1
  v_mul_f32 v88, v88, v20
  v_mul_f32 v89, v89, v20
  v_cvt_pk_bf16_f32 v204, v88, v89
  v_mul_f32 v90, v90, v20
  v_mul_f32 v91, v91, v20
  v_cvt_pk_bf16_f32 v205, v90, v91
  v_mul_f32 v92, v92, v20
  v_mul_f32 v93, v93, v20
  v_cvt_pk_bf16_f32 v206, v92, v93
  v_mul_f32 v94, v94, v20
  v_mul_f32 v95, v95, v20
  v_cvt_pk_bf16_f32 v207, v94, v95
  buffer_store_dwordx4 v[204:207], v15, s[64:67], s12 offen offset:3072 sc1
  v_mul_f32 v96, v96, v20
  v_mul_f32 v97, v97, v20
  v_cvt_pk_bf16_f32 v208, v96, v97
  v_mul_f32 v98, v98, v20
  v_mul_f32 v99, v99, v20
  v_cvt_pk_bf16_f32 v209, v98, v99
  v_mul_f32 v100, v100, v20
  v_mul_f32 v101, v101, v20
  v_cvt_pk_bf16_f32 v210, v100, v101
  v_mul_f32 v102, v102, v20
  v_mul_f32 v103, v103, v20
  v_cvt_pk_bf16_f32 v211, v102, v103
  buffer_store_dwordx4 v[208:211], v15, s[64:67], s13 offen offset:0 sc1
  v_mul_f32 v104, v104, v20
  v_mul_f32 v105, v105, v20
  v_cvt_pk_bf16_f32 v212, v104, v105
  v_mul_f32 v106, v106, v20
  v_mul_f32 v107, v107, v20
  v_cvt_pk_bf16_f32 v213, v106, v107
  v_mul_f32 v108, v108, v20
  v_mul_f32 v109, v109, v20
  v_cvt_pk_bf16_f32 v214, v108, v109
  v_mul_f32 v110, v110, v20
  v_mul_f32 v111, v111, v20
  v_cvt_pk_bf16_f32 v215, v110, v111
  buffer_store_dwordx4 v[212:215], v15, s[64:67], s13 offen offset:1024 sc1
  v_mul_f32 v112, v112, v20
  v_mul_f32 v113, v113, v20
  v_cvt_pk_bf16_f32 v216, v112, v113
  v_mul_f32 v114, v114, v20
  v_mul_f32 v115, v115, v20
  v_cvt_pk_bf16_f32 v217, v114, v115
  v_mul_f32 v116, v116, v20
  v_mul_f32 v117, v117, v20
  v_cvt_pk_bf16_f32 v218, v116, v117
  v_mul_f32 v118, v118, v20
  v_mul_f32 v119, v119, v20
  v_cvt_pk_bf16_f32 v219, v118, v119
  buffer_store_dwordx4 v[216:219], v15, s[64:67], s13 offen offset:2048 sc1
  v_mul_f32 v120, v120, v20
  v_mul_f32 v121, v121, v20
  v_cvt_pk_bf16_f32 v220, v120, v121
  v_mul_f32 v122, v122, v20
  v_mul_f32 v123, v123, v20
  v_cvt_pk_bf16_f32 v221, v122, v123
  v_mul_f32 v124, v124, v20
  v_mul_f32 v125, v125, v20
  v_cvt_pk_bf16_f32 v222, v124, v125
  v_mul_f32 v126, v126, v20
  v_mul_f32 v127, v127, v20
  v_cvt_pk_bf16_f32 v223, v126, v127
  buffer_store_dwordx4 v[220:223], v15, s[64:67], s13 offen offset:3072 sc1
  v_accvgpr_write_b32 a160, v192
  v_accvgpr_write_b32 a161, v193
  v_accvgpr_write_b32 a162, v194
  v_accvgpr_write_b32 a163, v195
  v_accvgpr_write_b32 a164, v196
  v_accvgpr_write_b32 a165, v197
  v_accvgpr_write_b32 a166, v198
  v_accvgpr_write_b32 a167, v199
  v_accvgpr_write_b32 a168, v200
  v_accvgpr_write_b32 a169, v201
  v_accvgpr_write_b32 a170, v202
  v_accvgpr_write_b32 a171, v203
  v_accvgpr_write_b32 a172, v204
  v_accvgpr_write_b32 a173, v205
  v_accvgpr_write_b32 a174, v206
  v_accvgpr_write_b32 a175, v207
  v_accvgpr_write_b32 a176, v208
  v_accvgpr_write_b32 a177, v209
  v_accvgpr_write_b32 a178, v210
  v_accvgpr_write_b32 a179, v211
  v_accvgpr_write_b32 a180, v212
  v_accvgpr_write_b32 a181, v213
  v_accvgpr_write_b32 a182, v214
  v_accvgpr_write_b32 a183, v215
  v_accvgpr_write_b32 a184, v216
  v_accvgpr_write_b32 a185, v217
  v_accvgpr_write_b32 a186, v218
  v_accvgpr_write_b32 a187, v219
  v_accvgpr_write_b32 a188, v220
  v_accvgpr_write_b32 a189, v221
  v_accvgpr_write_b32 a190, v222
  v_accvgpr_write_b32 a191, v223
  v_mov_b32 v17, 0
  v_mov_b32 v18, 0
  s_add_u32 s9, s6, 1
  s_cmp_lt_u32 s4, s9
  s_cbranch_scc1 Llw_slow_202
Llw_back_203:
  v_add_u32 v12, s5, v8
  v_add_u32 v13, s5, v9
  ds_read_b128 a[64:67], v12 offset:0
  ds_read_b128 a[68:71], v13 offset:0
  ds_read_b128 a[72:75], v12 offset:64
  ds_read_b128 a[76:79], v13 offset:64
  ds_read_b128 a[80:83], v12 offset:128
  ds_read_b128 a[84:87], v13 offset:128
  ds_read_b128 a[88:91], v12 offset:192
  ds_read_b128 a[92:95], v13 offset:192
  s_waitcnt lgkmcnt(0)
  v_mfma_f32_32x32x16_bf16 v[128:143], a[64:67], v[160:163], 0
  v_mov_b32 v64, 0
  v_mov_b32 v65, 0
  v_mov_b32 v66, 0
  v_mov_b32 v67, 0
  v_mov_b32 v68, 0
  v_mov_b32 v69, 0
  v_mov_b32 v70, 0
  v_mov_b32 v71, 0
  v_mfma_f32_32x32x16_bf16 v[128:143], a[68:71], v[164:167], v[128:143]
  v_mov_b32 v72, 0
  v_mov_b32 v73, 0
  v_mov_b32 v74, 0
  v_mov_b32 v75, 0
  v_mov_b32 v76, 0
  v_mov_b32 v77, 0
  v_mov_b32 v78, 0
  v_mov_b32 v79, 0
  v_mfma_f32_32x32x16_bf16 v[128:143], a[72:75], v[168:171], v[128:143]
  v_mov_b32 v80, 0
  v_mov_b32 v81, 0
  v_mov_b32 v82, 0
  v_mov_b32 v83, 0
  v_mov_b32 v84, 0
  v_mov_b32 v85, 0
  v_mov_b32 v86, 0
  v_mov_b32 v87, 0
  v_mfma_f32_32x32x16_bf16 v[128:143], a[76:79], v[172:175], v[128:143]
  v_mov_b32 v88, 0
  v_mov_b32 v89, 0
  v_mov_b32 v90, 0
  v_mov_b32 v91, 0
  v_mov_b32 v92, 0
  v_mov_b32 v93, 0
  v_mov_b32 v94, 0
  v_mov_b32 v95, 0
  v_mfma_f32_32x32x16_bf16 v[128:143], a[80:83], v[176:179], v[128:143]
  v_mov_b32 v96, 0
  v_mov_b32 v97, 0
  v_mov_b32 v98, 0
  v_mov_b32 v99, 0
  v_mov_b32 v100, 0
  v_mov_b32 v101, 0
  v_mov_b32 v102, 0
  v_mov_b32 v103, 0
  v_mfma_f32_32x32x16_bf16 v[128:143], a[84:87], v[180:183], v[128:143]
  v_mov_b32 v104, 0
  v_mov_b32 v105, 0
  v_mov_b32 v106, 0
  v_mov_b32 v107, 0
  v_mov_b32 v108, 0
  v_mov_b32 v109, 0
  v_mov_b32 v110, 0
  v_mov_b32 v111, 0
  v_mfma_f32_32x32x16_bf16 v[128:143], a[88:91], v[184:187], v[128:143]
  v_mov_b32 v112, 0
  v_mov_b32 v113, 0
  v_mov_b32 v114, 0
  v_mov_b32 v115, 0
  v_mov_b32 v116, 0
  v_mov_b32 v117, 0
  v_mov_b32 v118, 0
  v_mov_b32 v119, 0
  v_mfma_f32_32x32x16_bf16 v[128:143], a[92:95], v[188:191], v[128:143]
  v_mov_b32 v120, 0
  v_mov_b32 v121, 0
  v_mov_b32 v122, 0
  v_mov_b32 v123, 0
  v_mov_b32 v124, 0
  v_mov_b32 v125, 0
  v_mov_b32 v126, 0
  v_mov_b32 v127, 0
  s_add_u32 s5, s5, 8704
  s_sub_u32 s28, s5, s72
  s_cmp_lt_u32 s5, s72
  s_cselect_b32 s5, s5, s28
  s_add_u32 s9, s6, 3
  s_cmp_lt_u32 s4, s9
  s_cbranch_scc1 Llw_slow_204
Llw_back_205:
  v_add_u32 v12, s5, v8
  v_add_u32 v13, s5, v9
  s_add_u32 s5, s5, 8704
  s_sub_u32 s28, s5, s72
  s_cmp_lt_u32 s5, s72
  s_cselect_b32 s5, s5, s28
  v_add_u32 v14, s5, v10
  ds_read_b128 a[64:67], v12 offset:0
  ds_read_b128 a[68:71], v13 offset:0
  ds_read_b128 a[72:75], v12 offset:64
  ds_read_b128 a[76:79], v13 offset:64
  ds_read_b128 a[80:83], v12 offset:128
  ds_read_b128 a[84:87], v13 offset:128
  ds_read_b128 a[88:91], v12 offset:192
  ds_read_b128 a[92:95], v13 offset:192
  ds_read_b64_tr_b16 a[96:97], v14 offset:0
  ds_read_b64_tr_b16 a[98:99], v14 offset:512
  ds_read_b64_tr_b16 a[100:101], v14 offset:64
  ds_read_b64_tr_b16 a[102:103], v14 offset:576
  ds_read_b64_tr_b16 a[104:105], v14 offset:128
  ds_read_b64_tr_b16 a[106:107], v14 offset:640
  ds_read_b64_tr_b16 a[108:109], v14 offset:192
  ds_read_b64_tr_b16 a[110:111], v14 offset:704
  ds_read_b64_tr_b16 a[112:113], v14 offset:4352
  ds_read_b64_tr_b16 a[114:115], v14 offset:4864
  ds_read_b64_tr_b16 a[116:117], v14 offset:4416
  ds_read_b64_tr_b16 a[118:119], v14 offset:4928
  ds_read_b64_tr_b16 a[120:121], v14 offset:4480
  ds_read_b64_tr_b16 a[122:123], v14 offset:4992
  ds_read_b64_tr_b16 a[124:125], v14 offset:4544
  ds_read_b64_tr_b16 a[126:127], v14 offset:5056
  s_add_u32 s5, s5, 8704
  s_sub_u32 s28, s5, s72
  s_cmp_lt_u32 s5, s72
  s_cselect_b32 s5, s5, s28
  s_add_u32 s6, s6, 3
  v_max3_f32 v19, v128, v129, v130
  v_max3_f32 v19, v19, v131, v132
  v_max3_f32 v19, v19, v133, v134
  v_max3_f32 v19, v19, v135, v136
  v_max3_f32 v19, v19, v137, v138
  v_max3_f32 v19, v19, v139, v140
  v_max3_f32 v19, v19, v141, v142
  v_max_f32 v19, v19, v143
  v_mov_b32 v1, v19
  s_nop 1
  v_permlane32_swap_b32 v19, v1
  s_nop 1
  v_max_f32 v19, v19, v1
  v_sub_f32 v128, v128, v19
  v_sub_f32 v129, v129, v19
  v_sub_f32 v130, v130, v19
  v_sub_f32 v131, v131, v19
  v_sub_f32 v132, v132, v19
  v_sub_f32 v133, v133, v19
  v_sub_f32 v134, v134, v19
  v_sub_f32 v135, v135, v19
  v_sub_f32 v136, v136, v19
  v_sub_f32 v137, v137, v19
  v_sub_f32 v138, v138, v19
  v_sub_f32 v139, v139, v19
  v_sub_f32 v140, v140, v19
  v_sub_f32 v141, v141, v19
  v_sub_f32 v142, v142, v19
  v_sub_f32 v143, v143, v19
  v_sub_f32 v48, 0, v19
  v_mov_b32 v49, v48
  v_mov_b32 v50, v48
  v_mov_b32 v51, v48
  v_mov_b32 v52, v48
  v_mov_b32 v53, v48
  v_mov_b32 v54, v48
  v_mov_b32 v55, v48
  v_mov_b32 v56, v48
  v_mov_b32 v57, v48
  v_mov_b32 v58, v48
  v_mov_b32 v59, v48
  v_mov_b32 v60, v48
  v_mov_b32 v61, v48
  v_mov_b32 v62, v48
  v_mov_b32 v63, v48
  s_mov_b32 s76, 0x4
  s_mov_b32 s7, 0
Lattn_207:
  s_waitcnt lgkmcnt(15)
  v_mfma_f32_32x32x16_bf16 v[144:159], a[64:67], v[160:163], v[48:63]
  v_exp_f32 v128, v128
  v_exp_f32 v129, v129
  s_add_u32 s9, s6, 2
  s_cmp_lt_u32 s4, s9
  s_cbranch_scc1 Llw_slow_208
Llw_back_209:
  v_mfma_f32_32x32x16_bf16 v[144:159], a[68:71], v[164:167], v[144:159]
  v_exp_f32 v130, v130
  v_exp_f32 v131, v131
  v_cvt_pk_bf16_f32 v32, v128, v129
  v_add_u32 v12, s5, v8
  s_add_u32 s10, s5, 8704
  v_mfma_f32_32x32x16_bf16 v[144:159], a[72:75], v[168:171], v[144:159]
  v_exp_f32 v132, v132
  v_exp_f32 v133, v133
  v_cvt_pk_bf16_f32 v33, v130, v131
  v_add_u32 v13, s5, v9
  s_cmp_lt_u32 s10, 156672
  v_mfma_f32_32x32x16_bf16 v[144:159], a[76:79], v[172:175], v[144:159]
  v_exp_f32 v134, v134
  v_exp_f32 v135, v135
  v_cvt_pk_bf16_f32 v34, v132, v133
  s_cselect_b32 s10, s10, 0
  v_mov_b32 v21, s6
  v_mfma_f32_32x32x16_bf16 v[144:159], a[80:83], v[176:179], v[144:159]
  v_exp_f32 v136, v136
  v_exp_f32 v137, v137
  v_cvt_pk_bf16_f32 v35, v134, v135
  v_add_u32 v14, s10, v10
  v_mfma_f32_32x32x16_bf16 v[144:159], a[84:87], v[180:183], v[144:159]
  v_exp_f32 v138, v138
  v_exp_f32 v139, v139
  v_cvt_pk_bf16_f32 v36, v136, v137
  s_add_u32 s5, s10, 8704
  v_mfma_f32_32x32x16_bf16 v[144:159], a[88:91], v[184:187], v[144:159]
  v_exp_f32 v140, v140
  v_exp_f32 v141, v141
  v_cvt_pk_bf16_f32 v37, v138, v139
  s_cmp_lt_u32 s5, 156672
  v_mfma_f32_32x32x16_bf16 v[144:159], a[92:95], v[188:191], v[144:159]
  v_exp_f32 v142, v142
  v_exp_f32 v143, v143
  v_cvt_pk_bf16_f32 v38, v140, v141
  v_cvt_pk_bf16_f32 v39, v142, v143
  s_cselect_b32 s5, s5, 0
  s_waitcnt lgkmcnt(0)
  v_mfma_f32_32x32x16_bf16 v[64:79], a[96:99], v[32:35], v[64:79]
  ds_write_b32 v23, v21
  ds_read_b128 a[64:67], v12 offset:0
  ds_read_b128 a[68:71], v13 offset:0
  ds_read_b128 a[72:75], v12 offset:64
  v_add_f32 v17, v17, v128
  v_add_f32 v18, v18, v129
  v_mfma_f32_32x32x16_bf16 v[80:95], a[100:103], v[32:35], v[80:95]
  ds_read_b128 a[76:79], v13 offset:64
  ds_read_b128 a[80:83], v12 offset:128
  ds_read_b128 a[84:87], v13 offset:128
  v_add_f32 v17, v17, v130
  v_add_f32 v18, v18, v131
  s_add_u32 s6, s6, 2
  v_mfma_f32_32x32x16_bf16 v[96:111], a[104:107], v[32:35], v[96:111]
  ds_read_b128 a[88:91], v12 offset:192
  ds_read_b128 a[92:95], v13 offset:192
  ds_read_b64_tr_b16 a[128:129], v14 offset:0
  v_add_f32 v17, v17, v132
  v_add_f32 v18, v18, v133
  v_mfma_f32_32x32x16_bf16 v[112:127], a[108:111], v[32:35], v[112:127]
  ds_read_b64_tr_b16 a[130:131], v14 offset:512
  ds_read_b64_tr_b16 a[132:133], v14 offset:64
  ds_read_b64_tr_b16 a[134:135], v14 offset:576
  v_add_f32 v17, v17, v134
  v_add_f32 v18, v18, v135
  v_max3_f32 v19, v144, v145, v146
  v_mfma_f32_32x32x16_bf16 v[64:79], a[112:115], v[36:39], v[64:79]
  ds_read_b64_tr_b16 a[136:137], v14 offset:128
  ds_read_b64_tr_b16 a[138:139], v14 offset:640
  ds_read_b64_tr_b16 a[140:141], v14 offset:192
  v_add_f32 v17, v17, v136
  v_add_f32 v18, v18, v137
  v_max3_f32 v19, v19, v147, v148
  v_mfma_f32_32x32x16_bf16 v[80:95], a[116:119], v[36:39], v[80:95]
  ds_read_b64_tr_b16 a[142:143], v14 offset:704
  ds_read_b64_tr_b16 a[144:145], v14 offset:4352
  ds_read_b64_tr_b16 a[146:147], v14 offset:4864
  v_add_f32 v17, v17, v138
  v_add_f32 v18, v18, v139
  v_max3_f32 v19, v19, v149, v150
  v_mfma_f32_32x32x16_bf16 v[96:111], a[120:123], v[36:39], v[96:111]
  ds_read_b64_tr_b16 a[148:149], v14 offset:4416
  ds_read_b64_tr_b16 a[150:151], v14 offset:4928
  ds_read_b64_tr_b16 a[152:153], v14 offset:4480
  v_add_f32 v17, v17, v140
  v_add_f32 v18, v18, v141
  v_max3_f32 v19, v19, v151, v152
  v_max3_f32 v19, v19, v153, v154
  v_mfma_f32_32x32x16_bf16 v[112:127], a[124:127], v[36:39], v[112:127]
  ds_read_b64_tr_b16 a[154:155], v14 offset:4992
  ds_read_b64_tr_b16 a[156:157], v14 offset:4544
  ds_read_b64_tr_b16 a[158:159], v14 offset:5056
  v_add_f32 v17, v17, v142
  v_add_f32 v18, v18, v143
  v_max3_f32 v19, v19, v155, v156
  v_max3_f32 v19, v19, v157, v158
  v_max_f32 v19, v19, v159
  v_cmp_lt_f32 vcc, s8, v19
  s_cbranch_vccnz Lrare_210
Lback_211:
  s_waitcnt lgkmcnt(15)
  v_mfma_f32_32x32x16_bf16 v[128:143], a[64:67], v[160:163], v[48:63]
  v_exp_f32 v144, v144
  v_exp_f32 v145, v145
  s_add_u32 s9, s6, 2
  s_cmp_lt_u32 s4, s9
  s_cbranch_scc1 Llw_slow_212
Llw_back_213:
  v_mfma_f32_32x32x16_bf16 v[128:143], a[68:71], v[164:167], v[128:143]
  v_exp_f32 v146, v146
  v_exp_f32 v147, v147
  v_cvt_pk_bf16_f32 v32, v144, v145
  v_add_u32 v12, s5, v8
  s_add_u32 s10, s5, 8704
  v_mfma_f32_32x32x16_bf16 v[128:143], a[72:75], v[168:171], v[128:143]
  v_exp_f32 v148, v148
  v_exp_f32 v149, v149
  v_cvt_pk_bf16_f32 v33, v146, v147
  v_add_u32 v13, s5, v9
  s_cmp_lt_u32 s10, 156672
  v_mfma_f32_32x32x16_bf16 v[128:143], a[76:79], v[172:175], v[128:143]
  v_exp_f32 v150, v150
  v_exp_f32 v151, v151
  v_cvt_pk_bf16_f32 v34, v148, v149
  s_cselect_b32 s10, s10, 0
  v_mov_b32 v21, s6
  v_mfma_f32_32x32x16_bf16 v[128:143], a[80:83], v[176:179], v[128:143]
  v_exp_f32 v152, v152
  v_exp_f32 v153, v153
  v_cvt_pk_bf16_f32 v35, v150, v151
  v_add_u32 v14, s10, v10
  v_mfma_f32_32x32x16_bf16 v[128:143], a[84:87], v[180:183], v[128:143]
  v_exp_f32 v154, v154
  v_exp_f32 v155, v155
  v_cvt_pk_bf16_f32 v36, v152, v153
  s_add_u32 s5, s10, 8704
  v_mfma_f32_32x32x16_bf16 v[128:143], a[88:91], v[184:187], v[128:143]
  v_exp_f32 v156, v156
  v_exp_f32 v157, v157
  v_cvt_pk_bf16_f32 v37, v154, v155
  s_cmp_lt_u32 s5, 156672
  v_mfma_f32_32x32x16_bf16 v[128:143], a[92:95], v[188:191], v[128:143]
  v_exp_f32 v158, v158
  v_exp_f32 v159, v159
  v_cvt_pk_bf16_f32 v38, v156, v157
  v_cvt_pk_bf16_f32 v39, v158, v159
  s_cselect_b32 s5, s5, 0
  s_waitcnt lgkmcnt(0)
  v_mfma_f32_32x32x16_bf16 v[64:79], a[128:131], v[32:35], v[64:79]
  ds_write_b32 v23, v21
  ds_read_b128 a[64:67], v12 offset:0
  ds_read_b128 a[68:71], v13 offset:0
  ds_read_b128 a[72:75], v12 offset:64
  v_add_f32 v17, v17, v144
  v_add_f32 v18, v18, v145
  v_mfma_f32_32x32x16_bf16 v[80:95], a[132:135], v[32:35], v[80:95]
  ds_read_b128 a[76:79], v13 offset:64
  ds_read_b128 a[80:83], v12 offset:128
  ds_read_b128 a[84:87], v13 offset:128
  v_add_f32 v17, v17, v146
  v_add_f32 v18, v18, v147
  s_add_u32 s6, s6, 2
  v_mfma_f32_32x32x16_bf16 v[96:111], a[136:139], v[32:35], v[96:111]
  ds_read_b128 a[88:91], v12 offset:192
  ds_read_b128 a[92:95], v13 offset:192
  ds_read_b64_tr_b16 a[96:97], v14 offset:0
  v_add_f32 v17, v17, v148
  v_add_f32 v18, v18, v149
  v_mfma_f32_32x32x16_bf16 v[112:127], a[140:143], v[32:35], v[112:127]
  ds_read_b64_tr_b16 a[98:99], v14 offset:512
  ds_read_b64_tr_b16 a[100:101], v14 offset:64
  ds_read_b64_tr_b16 a[102:103], v14 offset:576
  v_add_f32 v17, v17, v150
  v_add_f32 v18, v18, v151
  v_max3_f32 v19, v128, v129, v130
  v_mfma_f32_32x32x16_bf16 v[64:79], a[144:147], v[36:39], v[64:79]
  ds_read_b64_tr_b16 a[104:105], v14 offset:128
  ds_read_b64_tr_b16 a[106:107], v14 offset:640
  ds_read_b64_tr_b16 a[108:109], v14 offset:192
  v_add_f32 v17, v17, v152
  v_add_f32 v18, v18, v153
  v_max3_f32 v19, v19, v131, v132
  v_mfma_f32_32x32x16_bf16 v[80:95], a[148:151], v[36:39], v[80:95]
  ds_read_b64_tr_b16 a[110:111], v14 offset:704
  ds_read_b64_tr_b16 a[112:113], v14 offset:4352
  ds_read_b64_tr_b16 a[114:115], v14 offset:4864
  v_add_f32 v17, v17, v154
  v_add_f32 v18, v18, v155
  v_max3_f32 v19, v19, v133, v134
  v_mfma_f32_32x32x16_bf16 v[96:111], a[152:155], v[36:39], v[96:111]
  ds_read_b64_tr_b16 a[116:117], v14 offset:4416
  ds_read_b64_tr_b16 a[118:119], v14 offset:4928
  ds_read_b64_tr_b16 a[120:121], v14 offset:4480
  v_add_f32 v17, v17, v156
  v_add_f32 v18, v18, v157
  v_max3_f32 v19, v19, v135, v136
  v_max3_f32 v19, v19, v137, v138
  v_mfma_f32_32x32x16_bf16 v[112:127], a[156:159], v[36:39], v[112:127]
  ds_read_b64_tr_b16 a[122:123], v14 offset:4992
  ds_read_b64_tr_b16 a[124:125], v14 offset:4544
  ds_read_b64_tr_b16 a[126:127], v14 offset:5056
  v_add_f32 v17, v17, v158
  v_add_f32 v18, v18, v159
  v_max3_f32 v19, v19, v139, v140
  v_max3_f32 v19, v19, v141, v142
  v_max_f32 v19, v19, v143
  v_cmp_lt_f32 vcc, s8, v19
  s_cbranch_vccnz Lrare_214
Lback_215:
  s_cmp_eq_u32 s7, 0
  s_cbranch_scc1 Lchfirst_216
  v_mfma_f32_32x32x16_bf16 v[192:207], a[32:35], a[184:187], v[192:207]
  s_add_u32 s9, s6, 4
  s_cmp_lt_u32 s4, s9
  s_cbranch_scc1 Llw_slow_218
Llw_back_219:
  s_mul_i32 s29, s3, 8704
  s_add_u32 s10, s5, s29
  s_add_u32 s10, s10, 0
  s_sub_u32 s28, s10, s72
  s_cmp_lt_u32 s10, s72
  s_cselect_b32 s10, s10, s28
  v_add_u32 v12, s10, v15
  s_add_u32 s5, s5, 26112
  s_sub_u32 s28, s5, s72
  s_cmp_lt_u32 s5, s72
  s_cselect_b32 s5, s5, s28
  v_add_u32 v14, s5, v11
  v_mfma_f32_32x32x16_bf16 v[208:223], a[36:39], a[184:187], v[208:223]
  ds_read_b128 a[160:163], v12 offset:0
  ds_read_b128 a[164:167], v12 offset:1088
  ds_read_b128 a[168:171], v12 offset:2176
  v_mfma_f32_32x32x16_bf16 v[224:239], a[40:43], a[184:187], v[224:239]
  ds_read_b128 a[172:175], v12 offset:3264
  ds_read_b128 a[176:179], v12 offset:4352
  ds_read_b128 a[180:183], v12 offset:5440
  ds_read_b64_tr_b16 a[0:1], v14 offset:0
  v_mfma_f32_32x32x16_bf16 v[240:255], a[44:47], a[184:187], v[240:255]
  ds_read_b64_tr_b16 a[2:3], v14 offset:256
  ds_read_b64_tr_b16 a[4:5], v14 offset:64
  ds_read_b64_tr_b16 a[6:7], v14 offset:320
  ds_read_b64_tr_b16 a[8:9], v14 offset:128
  v_mfma_f32_32x32x16_bf16 v[192:207], a[48:51], a[188:191], v[192:207]
  ds_read_b128 a[184:187], v12 offset:6528
  ds_read_b64_tr_b16 a[10:11], v14 offset:384
  ds_read_b64_tr_b16 a[12:13], v14 offset:192
  ds_read_b64_tr_b16 a[14:15], v14 offset:448
  v_mfma_f32_32x32x16_bf16 v[208:223], a[52:55], a[188:191], v[208:223]
  ds_read_b64_tr_b16 a[16:17], v14 offset:4352
  ds_read_b64_tr_b16 a[18:19], v14 offset:4608
  ds_read_b64_tr_b16 a[20:21], v14 offset:4416
  ds_read_b64_tr_b16 a[22:23], v14 offset:4672
  v_mfma_f32_32x32x16_bf16 v[224:239], a[56:59], a[188:191], v[224:239]
  ds_read_b64_tr_b16 a[24:25], v14 offset:4480
  ds_read_b64_tr_b16 a[26:27], v14 offset:4736
  ds_read_b64_tr_b16 a[28:29], v14 offset:4544
  ds_read_b64_tr_b16 a[30:31], v14 offset:4800
  v_mfma_f32_32x32x16_bf16 v[240:255], a[60:63], a[188:191], v[240:255]
  ds_read_b128 a[188:191], v12 offset:7616
  s_add_u32 s5, s5, 8704
  s_cmp_lt_u32 s5, 156672
  s_cselect_b32 s5, s5, 0
  s_add_u32 s6, s6, 4
Lchback_217:
  s_add_u32 s7, s7, 1
  s_bitcmp1_b32 s76, s7
  s_cbranch_scc1 Levstub_220
Levback_221:
  s_waitcnt lgkmcnt(15)
  v_mfma_f32_32x32x16_bf16 v[144:159], a[64:67], v[160:163], v[48:63]
  v_exp_f32 v128, v128
  v_exp_f32 v129, v129
  s_add_u32 s9, s6, 2
  s_cmp_lt_u32 s4, s9
  s_cbranch_scc1 Llw_slow_222
Llw_back_223:
  v_mfma_f32_32x32x16_bf16 v[144:159], a[68:71], v[164:167], v[144:159]
  v_exp_f32 v130, v130
  v_exp_f32 v131, v131
  v_cvt_pk_bf16_f32 v32, v128, v129
  v_add_u32 v12, s5, v8
  s_add_u32 s10, s5, 8704
  v_mfma_f32_32x32x16_bf16 v[144:159], a[72:75], v[168:171], v[144:159]
  v_exp_f32 v132, v132
  v_exp_f32 v133, v133
  v_cvt_pk_bf16_f32 v33, v130, v131
  v_add_u32 v13, s5, v9
  s_cmp_lt_u32 s10, 156672
  v_mfma_f32_32x32x16_bf16 v[144:159], a[76:79], v[172:175], v[144:159]
  v_exp_f32 v134, v134
  v_exp_f32 v135, v135
  v_cvt_pk_bf16_f32 v34, v132, v133
  s_cselect_b32 s10, s10, 0
  v_mov_b32 v21, s6
  v_mfma_f32_32x32x16_bf16 v[144:159], a[80:83], v[176:179], v[144:159]
  v_exp_f32 v136, v136
  v_exp_f32 v137, v137
  v_cvt_pk_bf16_f32 v35, v134, v135
  v_add_u32 v14, s10, v10
  v_mfma_f32_32x32x16_bf16 v[144:159], a[84:87], v[180:183], v[144:159]
  v_exp_f32 v138, v138
  v_exp_f32 v139, v139
  v_cvt_pk_bf16_f32 v36, v136, v137
  s_add_u32 s5, s10, 8704
  v_mfma_f32_32x32x16_bf16 v[144:159], a[88:91], v[184:187], v[144:159]
  v_exp_f32 v140, v140
  v_exp_f32 v141, v141
  v_cvt_pk_bf16_f32 v37, v138, v139
  s_cmp_lt_u32 s5, 156672
  v_mfma_f32_32x32x16_bf16 v[144:159], a[92:95], v[188:191], v[144:159]
  v_exp_f32 v142, v142
  v_exp_f32 v143, v143
  v_cvt_pk_bf16_f32 v38, v140, v141
  v_cvt_pk_bf16_f32 v39, v142, v143
  s_cselect_b32 s5, s5, 0
  s_waitcnt lgkmcnt(0)
  v_mfma_f32_32x32x16_bf16 v[64:79], a[96:99], v[32:35], v[64:79]
  ds_write_b32 v23, v21
  ds_read_b128 a[64:67], v12 offset:0
  ds_read_b128 a[68:71], v13 offset:0
  ds_read_b128 a[72:75], v12 offset:64
  v_add_f32 v17, v17, v128
  v_add_f32 v18, v18, v129
  v_mfma_f32_32x32x16_bf16 v[80:95], a[100:103], v[32:35], v[80:95]
  ds_read_b128 a[76:79], v13 offset:64
  ds_read_b128 a[80:83], v12 offset:128
  ds_read_b128 a[84:87], v13 offset:128
  v_add_f32 v17, v17, v130
  v_add_f32 v18, v18, v131
  s_add_u32 s6, s6, 2
  v_mfma_f32_32x32x16_bf16 v[96:111], a[104:107], v[32:35], v[96:111]
  ds_read_b128 a[88:91], v12 offset:192
  ds_read_b128 a[92:95], v13 offset:192
  ds_read_b64_tr_b16 a[128:129], v14 offset:0
  v_add_f32 v17, v17, v132
  v_add_f32 v18, v18, v133
  v_mfma_f32_32x32x16_bf16 v[112:127], a[108:111], v[32:35], v[112:127]
  ds_read_b64_tr_b16 a[130:131], v14 offset:512
  ds_read_b64_tr_b16 a[132:133], v14 offset:64
  ds_read_b64_tr_b16 a[134:135], v14 offset:576
  v_add_f32 v17, v17, v134
  v_add_f32 v18, v18, v135
  v_max3_f32 v19, v144, v145, v146
  v_mfma_f32_32x32x16_bf16 v[64:79], a[112:115], v[36:39], v[64:79]
  ds_read_b64_tr_b16 a[136:137], v14 offset:128
  ds_read_b64_tr_b16 a[138:139], v14 offset:640
  ds_read_b64_tr_b16 a[140:141], v14 offset:192
  v_add_f32 v17, v17, v136
  v_add_f32 v18, v18, v137
  v_max3_f32 v19, v19, v147, v148
  v_mfma_f32_32x32x16_bf16 v[80:95], a[116:119], v[36:39], v[80:95]
  ds_read_b64_tr_b16 a[142:143], v14 offset:704
  ds_read_b64_tr_b16 a[144:145], v14 offset:4352
  ds_read_b64_tr_b16 a[146:147], v14 offset:4864
  v_add_f32 v17, v17, v138
  v_add_f32 v18, v18, v139
  v_max3_f32 v19, v19, v149, v150
  v_mfma_f32_32x32x16_bf16 v[96:111], a[120:123], v[36:39], v[96:111]
  ds_read_b64_tr_b16 a[148:149], v14 offset:4416
  ds_read_b64_tr_b16 a[150:151], v14 offset:4928
  ds_read_b64_tr_b16 a[152:153], v14 offset:4480
  v_add_f32 v17, v17, v140
  v_add_f32 v18, v18, v141
  v_max3_f32 v19, v19, v151, v152
  v_max3_f32 v19, v19, v153, v154
  v_mfma_f32_32x32x16_bf16 v[112:127], a[124:127], v[36:39], v[112:127]
  ds_read_b64_tr_b16 a[154:155], v14 offset:4992
  ds_read_b64_tr_b16 a[156:157], v14 offset:4544
  ds_read_b64_tr_b16 a[158:159], v14 offset:5056
  v_add_f32 v17, v17, v142
  v_add_f32 v18, v18, v143
  v_max3_f32 v19, v19, v155, v156
  v_max3_f32 v19, v19, v157, v158
  v_max_f32 v19, v19, v159
  v_cmp_lt_f32 vcc, s8, v19
  s_cbranch_vccnz Lrare_224
Lback_225:
  s_waitcnt lgkmcnt(15)
  v_mfma_f32_32x32x16_bf16 v[128:143], a[64:67], v[160:163], v[48:63]
  v_exp_f32 v144, v144
  v_exp_f32 v145, v145
  s_add_u32 s9, s6, 2
  s_cmp_lt_u32 s4, s9
  s_cbranch_scc1 Llw_slow_226
Llw_back_227:
  v_mfma_f32_32x32x16_bf16 v[128:143], a[68:71], v[164:167], v[128:143]
  v_exp_f32 v146, v146
  v_exp_f32 v147, v147
  v_cvt_pk_bf16_f32 v32, v144, v145
  v_add_u32 v12, s5, v8
  s_add_u32 s10, s5, 8704
  v_mfma_f32_32x32x16_bf16 v[128:143], a[72:75], v[168:171], v[128:143]
  v_exp_f32 v148, v148
  v_exp_f32 v149, v149
  v_cvt_pk_bf16_f32 v33, v146, v147
  v_add_u32 v13, s5, v9
  s_cmp_lt_u32 s10, 156672
  v_mfma_f32_32x32x16_bf16 v[128:143], a[76:79], v[172:175], v[128:143]
  v_exp_f32 v150, v150
  v_exp_f32 v151, v151
  v_cvt_pk_bf16_f32 v34, v148, v149
  s_cselect_b32 s10, s10, 0
  v_mov_b32 v21, s6
  v_mfma_f32_32x32x16_bf16 v[128:143], a[80:83], v[176:179], v[128:143]
  v_exp_f32 v152, v152
  v_exp_f32 v153, v153
  v_cvt_pk_bf16_f32 v35, v150, v151
  v_add_u32 v14, s10, v10
  v_mfma_f32_32x32x16_bf16 v[128:143], a[84:87], v[180:183], v[128:143]
  v_exp_f32 v154, v154
  v_exp_f32 v155, v155
  v_cvt_pk_bf16_f32 v36, v152, v153
  s_add_u32 s5, s10, 8704
  v_mfma_f32_32x32x16_bf16 v[128:143], a[88:91], v[184:187], v[128:143]
  v_exp_f32 v156, v156
  v_exp_f32 v157, v157
  v_cvt_pk_bf16_f32 v37, v154, v155
  s_cmp_lt_u32 s5, 156672
  v_mfma_f32_32x32x16_bf16 v[128:143], a[92:95], v[188:191], v[128:143]
  v_exp_f32 v158, v158
  v_exp_f32 v159, v159
  v_cvt_pk_bf16_f32 v38, v156, v157
  v_cvt_pk_bf16_f32 v39, v158, v159
  s_cselect_b32 s5, s5, 0
  s_waitcnt lgkmcnt(0)
  v_mfma_f32_32x32x16_bf16 v[64:79], a[128:131], v[32:35], v[64:79]
  ds_write_b32 v23, v21
  ds_read_b128 a[64:67], v12 offset:0
  ds_read_b128 a[68:71], v13 offset:0
  ds_read_b128 a[72:75], v12 offset:64
  v_add_f32 v17, v17, v144
  v_add_f32 v18, v18, v145
  v_mfma_f32_32x32x16_bf16 v[80:95], a[132:135], v[32:35], v[80:95]
  ds_read_b128 a[76:79], v13 offset:64
  ds_read_b128 a[80:83], v12 offset:128
  ds_read_b128 a[84:87], v13 offset:128
  v_add_f32 v17, v17, v146
  v_add_f32 v18, v18, v147
  s_add_u32 s6, s6, 2
  v_mfma_f32_32x32x16_bf16 v[96:111], a[136:139], v[32:35], v[96:111]
  ds_read_b128 a[88:91], v12 offset:192
  ds_read_b128 a[92:95], v13 offset:192
  ds_read_b64_tr_b16 a[96:97], v14 offset:0
  v_add_f32 v17, v17, v148
  v_add_f32 v18, v18, v149
  v_mfma_f32_32x32x16_bf16 v[112:127], a[140:143], v[32:35], v[112:127]
  ds_read_b64_tr_b16 a[98:99], v14 offset:512
  ds_read_b64_tr_b16 a[100:101], v14 offset:64
  ds_read_b64_tr_b16 a[102:103], v14 offset:576
  v_add_f32 v17, v17, v150
  v_add_f32 v18, v18, v151
  v_max3_f32 v19, v128, v129, v130
  v_mfma_f32_32x32x16_bf16 v[64:79], a[144:147], v[36:39], v[64:79]
  ds_read_b64_tr_b16 a[104:105], v14 offset:128
  ds_read_b64_tr_b16 a[106:107], v14 offset:640
  ds_read_b64_tr_b16 a[108:109], v14 offset:192
  v_add_f32 v17, v17, v152
  v_add_f32 v18, v18, v153
  v_max3_f32 v19, v19, v131, v132
  v_mfma_f32_32x32x16_bf16 v[80:95], a[148:151], v[36:39], v[80:95]
  ds_read_b64_tr_b16 a[110:111], v14 offset:704
  ds_read_b64_tr_b16 a[112:113], v14 offset:4352
  ds_read_b64_tr_b16 a[114:115], v14 offset:4864
  v_add_f32 v17, v17, v154
  v_add_f32 v18, v18, v155
  v_max3_f32 v19, v19, v133, v134
  v_mfma_f32_32x32x16_bf16 v[96:111], a[152:155], v[36:39], v[96:111]
  ds_read_b64_tr_b16 a[116:117], v14 offset:4416
  ds_read_b64_tr_b16 a[118:119], v14 offset:4928
  ds_read_b64_tr_b16 a[120:121], v14 offset:4480
  v_add_f32 v17, v17, v156
  v_add_f32 v18, v18, v157
  v_max3_f32 v19, v19, v135, v136
  v_max3_f32 v19, v19, v137, v138
  v_mfma_f32_32x32x16_bf16 v[112:127], a[156:159], v[36:39], v[112:127]
  ds_read_b64_tr_b16 a[122:123], v14 offset:4992
  ds_read_b64_tr_b16 a[124:125], v14 offset:4544
  ds_read_b64_tr_b16 a[126:127], v14 offset:5056
  v_add_f32 v17, v17, v158
  v_add_f32 v18, v18, v159
  v_max3_f32 v19, v19, v139, v140
  v_max3_f32 v19, v19, v141, v142
  v_max_f32 v19, v19, v143
  v_cmp_lt_f32 vcc, s8, v19
  s_cbranch_vccnz Lrare_228
Lback_229:
  v_mfma_f32_32x32x16_bf16 v[192:207], a[0:3], a[160:163], v[192:207]
  s_add_u32 s9, s6, 1
  s_cmp_lt_u32 s4, s9
  s_cbranch_scc1 Llw_slow_230
Llw_back_231:
  v_add_u32 v14, s5, v11
  v_mfma_f32_32x32x16_bf16 v[208:223], a[4:7], a[160:163], v[208:223]
  ds_read_b64_tr_b16 a[32:33], v14 offset:0
  ds_read_b64_tr_b16 a[34:35], v14 offset:256
  v_mfma_f32_32x32x16_bf16 v[224:239], a[8:11], a[160:163], v[224:239]
  ds_read_b64_tr_b16 a[36:37], v14 offset:64
  ds_read_b64_tr_b16 a[38:39], v14 offset:320
  ds_read_b64_tr_b16 a[40:41], v14 offset:128
  v_mfma_f32_32x32x16_bf16 v[240:255], a[12:15], a[160:163], v[240:255]
  ds_read_b64_tr_b16 a[42:43], v14 offset:384
  ds_read_b64_tr_b16 a[44:45], v14 offset:192
  ds_read_b64_tr_b16 a[46:47], v14 offset:448
  v_mfma_f32_32x32x16_bf16 v[192:207], a[16:19], a[164:167], v[192:207]
  ds_read_b64_tr_b16 a[48:49], v14 offset:4352
  ds_read_b64_tr_b16 a[50:51], v14 offset:4608
  v_mfma_f32_32x32x16_bf16 v[208:223], a[20:23], a[164:167], v[208:223]
  ds_read_b64_tr_b16 a[52:53], v14 offset:4416
  ds_read_b64_tr_b16 a[54:55], v14 offset:4672
  ds_read_b64_tr_b16 a[56:57], v14 offset:4480
  v_mfma_f32_32x32x16_bf16 v[224:239], a[24:27], a[164:167], v[224:239]
  ds_read_b64_tr_b16 a[58:59], v14 offset:4736
  ds_read_b64_tr_b16 a[60:61], v14 offset:4544
  ds_read_b64_tr_b16 a[62:63], v14 offset:4800
  v_mfma_f32_32x32x16_bf16 v[240:255], a[28:31], a[164:167], v[240:255]
  s_add_u32 s5, s5, 8704
  s_cmp_lt_u32 s5, 156672
  s_cselect_b32 s5, s5, 0
  s_add_u32 s6, s6, 1
  s_add_u32 s7, s7, 1
  s_bitcmp1_b32 s76, s7
  s_cbranch_scc1 Levstub_232
Levback_233:
  s_waitcnt lgkmcnt(15)
  v_mfma_f32_32x32x16_bf16 v[144:159], a[64:67], v[160:163], v[48:63]
  v_exp_f32 v128, v128
  v_exp_f32 v129, v129
  s_add_u32 s9, s6, 2
  s_cmp_lt_u32 s4, s9
  s_cbranch_scc1 Llw_slow_234
Llw_back_235:
  v_mfma_f32_32x32x16_bf16 v[144:159], a[68:71], v[164:167], v[144:159]
  v_exp_f32 v130, v130
  v_exp_f32 v131, v131
  v_cvt_pk_bf16_f32 v32, v128, v129
  v_add_u32 v12, s5, v8
  s_add_u32 s10, s5, 8704
  v_mfma_f32_32x32x16_bf16 v[144:159], a[72:75], v[168:171], v[144:159]
  v_exp_f32 v132, v132
  v_exp_f32 v133, v133
  v_cvt_pk_bf16_f32 v33, v130, v131
  v_add_u32 v13, s5, v9
  s_cmp_lt_u32 s10, 156672
  v_mfma_f32_32x32x16_bf16 v[144:159], a[76:79], v[172:175], v[144:159]
  v_exp_f32 v134, v134
  v_exp_f32 v135, v135
  v_cvt_pk_bf16_f32 v34, v132, v133
  s_cselect_b32 s10, s10, 0
  v_mov_b32 v21, s6
  v_mfma_f32_32x32x16_bf16 v[144:159], a[80:83], v[176:179], v[144:159]
  v_exp_f32 v136, v136
  v_exp_f32 v137, v137
  v_cvt_pk_bf16_f32 v35, v134, v135
  v_add_u32 v14, s10, v10
  v_mfma_f32_32x32x16_bf16 v[144:159], a[84:87], v[180:183], v[144:159]
  v_exp_f32 v138, v138
  v_exp_f32 v139, v139
  v_cvt_pk_bf16_f32 v36, v136, v137
  s_add_u32 s5, s10, 8704
  v_mfma_f32_32x32x16_bf16 v[144:159], a[88:91], v[184:187], v[144:159]
  v_exp_f32 v140, v140
  v_exp_f32 v141, v141
  v_cvt_pk_bf16_f32 v37, v138, v139
  s_cmp_lt_u32 s5, 156672
  v_mfma_f32_32x32x16_bf16 v[144:159], a[92:95], v[188:191], v[144:159]
  v_exp_f32 v142, v142
  v_exp_f32 v143, v143
  v_cvt_pk_bf16_f32 v38, v140, v141
  v_cvt_pk_bf16_f32 v39, v142, v143
  s_cselect_b32 s5, s5, 0
  s_waitcnt lgkmcnt(0)
  v_mfma_f32_32x32x16_bf16 v[64:79], a[96:99], v[32:35], v[64:79]
  ds_write_b32 v23, v21
  ds_read_b128 a[64:67], v12 offset:0
  ds_read_b128 a[68:71], v13 offset:0
  ds_read_b128 a[72:75], v12 offset:64
  v_add_f32 v17, v17, v128
  v_add_f32 v18, v18, v129
  v_mfma_f32_32x32x16_bf16 v[80:95], a[100:103], v[32:35], v[80:95]
  ds_read_b128 a[76:79], v13 offset:64
  ds_read_b128 a[80:83], v12 offset:128
  ds_read_b128 a[84:87], v13 offset:128
  v_add_f32 v17, v17, v130
  v_add_f32 v18, v18, v131
  s_add_u32 s6, s6, 2
  v_mfma_f32_32x32x16_bf16 v[96:111], a[104:107], v[32:35], v[96:111]
  ds_read_b128 a[88:91], v12 offset:192
  ds_read_b128 a[92:95], v13 offset:192
  ds_read_b64_tr_b16 a[128:129], v14 offset:0
  v_add_f32 v17, v17, v132
  v_add_f32 v18, v18, v133
  v_mfma_f32_32x32x16_bf16 v[112:127], a[108:111], v[32:35], v[112:127]
  ds_read_b64_tr_b16 a[130:131], v14 offset:512
  ds_read_b64_tr_b16 a[132:133], v14 offset:64
  ds_read_b64_tr_b16 a[134:135], v14 offset:576
  v_add_f32 v17, v17, v134
  v_add_f32 v18, v18, v135
  v_max3_f32 v19, v144, v145, v146
  v_mfma_f32_32x32x16_bf16 v[64:79], a[112:115], v[36:39], v[64:79]
  ds_read_b64_tr_b16 a[136:137], v14 offset:128
  ds_read_b64_tr_b16 a[138:139], v14 offset:640
  ds_read_b64_tr_b16 a[140:141], v14 offset:192
  v_add_f32 v17, v17, v136
  v_add_f32 v18, v18, v137
  v_max3_f32 v19, v19, v147, v148
  v_mfma_f32_32x32x16_bf16 v[80:95], a[116:119], v[36:39], v[80:95]
  ds_read_b64_tr_b16 a[142:143], v14 offset:704
  ds_read_b64_tr_b16 a[144:145], v14 offset:4352
  ds_read_b64_tr_b16 a[146:147], v14 offset:4864
  v_add_f32 v17, v17, v138
  v_add_f32 v18, v18, v139
  v_max3_f32 v19, v19, v149, v150
  v_mfma_f32_32x32x16_bf16 v[96:111], a[120:123], v[36:39], v[96:111]
  ds_read_b64_tr_b16 a[148:149], v14 offset:4416
  ds_read_b64_tr_b16 a[150:151], v14 offset:4928
  ds_read_b64_tr_b16 a[152:153], v14 offset:4480
  v_add_f32 v17, v17, v140
  v_add_f32 v18, v18, v141
  v_max3_f32 v19, v19, v151, v152
  v_max3_f32 v19, v19, v153, v154
  v_mfma_f32_32x32x16_bf16 v[112:127], a[124:127], v[36:39], v[112:127]
  ds_read_b64_tr_b16 a[154:155], v14 offset:4992
  ds_read_b64_tr_b16 a[156:157], v14 offset:4544
  ds_read_b64_tr_b16 a[158:159], v14 offset:5056
  v_add_f32 v17, v17, v142
  v_add_f32 v18, v18, v143
  v_max3_f32 v19, v19, v155, v156
  v_max3_f32 v19, v19, v157, v158
  v_max_f32 v19, v19, v159
  v_cmp_lt_f32 vcc, s8, v19
  s_cbranch_vccnz Lrare_236
Lback_237:
  s_waitcnt lgkmcnt(15)
  v_mfma_f32_32x32x16_bf16 v[128:143], a[64:67], v[160:163], v[48:63]
  v_exp_f32 v144, v144
  v_exp_f32 v145, v145
  s_add_u32 s9, s6, 2
  s_cmp_lt_u32 s4, s9
  s_cbranch_scc1 Llw_slow_238
Llw_back_239:
  v_mfma_f32_32x32x16_bf16 v[128:143], a[68:71], v[164:167], v[128:143]
  v_exp_f32 v146, v146
  v_exp_f32 v147, v147
  v_cvt_pk_bf16_f32 v32, v144, v145
  v_add_u32 v12, s5, v8
  s_add_u32 s10, s5, 8704
  v_mfma_f32_32x32x16_bf16 v[128:143], a[72:75], v[168:171], v[128:143]
  v_exp_f32 v148, v148
  v_exp_f32 v149, v149
  v_cvt_pk_bf16_f32 v33, v146, v147
  v_add_u32 v13, s5, v9
  s_cmp_lt_u32 s10, 156672
  v_mfma_f32_32x32x16_bf16 v[128:143], a[76:79], v[172:175], v[128:143]
  v_exp_f32 v150, v150
  v_exp_f32 v151, v151
  v_cvt_pk_bf16_f32 v34, v148, v149
  s_cselect_b32 s10, s10, 0
  v_mov_b32 v21, s6
  v_mfma_f32_32x32x16_bf16 v[128:143], a[80:83], v[176:179], v[128:143]
  v_exp_f32 v152, v152
  v_exp_f32 v153, v153
  v_cvt_pk_bf16_f32 v35, v150, v151
  v_add_u32 v14, s10, v10
  v_mfma_f32_32x32x16_bf16 v[128:143], a[84:87], v[180:183], v[128:143]
  v_exp_f32 v154, v154
  v_exp_f32 v155, v155
  v_cvt_pk_bf16_f32 v36, v152, v153
  s_add_u32 s5, s10, 8704
  v_mfma_f32_32x32x16_bf16 v[128:143], a[88:91], v[184:187], v[128:143]
  v_exp_f32 v156, v156
  v_exp_f32 v157, v157
  v_cvt_pk_bf16_f32 v37, v154, v155
  s_cmp_lt_u32 s5, 156672
  v_mfma_f32_32x32x16_bf16 v[128:143], a[92:95], v[188:191], v[128:143]
  v_exp_f32 v158, v158
  v_exp_f32 v159, v159
  v_cvt_pk_bf16_f32 v38, v156, v157
  v_cvt_pk_bf16_f32 v39, v158, v159
  s_cselect_b32 s5, s5, 0
  s_waitcnt lgkmcnt(0)
  v_mfma_f32_32x32x16_bf16 v[64:79], a[128:131], v[32:35], v[64:79]
  ds_write_b32 v23, v21
  ds_read_b128 a[64:67], v12 offset:0
  ds_read_b128 a[68:71], v13 offset:0
  ds_read_b128 a[72:75], v12 offset:64
  v_add_f32 v17, v17, v144
  v_add_f32 v18, v18, v145
  v_mfma_f32_32x32x16_bf16 v[80:95], a[132:135], v[32:35], v[80:95]
  ds_read_b128 a[76:79], v13 offset:64
  ds_read_b128 a[80:83], v12 offset:128
  ds_read_b128 a[84:87], v13 offset:128
  v_add_f32 v17, v17, v146
  v_add_f32 v18, v18, v147
  s_add_u32 s6, s6, 2
  v_mfma_f32_32x32x16_bf16 v[96:111], a[136:139], v[32:35], v[96:111]
  ds_read_b128 a[88:91], v12 offset:192
  ds_read_b128 a[92:95], v13 offset:192
  ds_read_b64_tr_b16 a[96:97], v14 offset:0
  v_add_f32 v17, v17, v148
  v_add_f32 v18, v18, v149
  v_mfma_f32_32x32x16_bf16 v[112:127], a[140:143], v[32:35], v[112:127]
  ds_read_b64_tr_b16 a[98:99], v14 offset:512
  ds_read_b64_tr_b16 a[100:101], v14 offset:64
  ds_read_b64_tr_b16 a[102:103], v14 offset:576
  v_add_f32 v17, v17, v150
  v_add_f32 v18, v18, v151
  v_max3_f32 v19, v128, v129, v130
  v_mfma_f32_32x32x16_bf16 v[64:79], a[144:147], v[36:39], v[64:79]
  ds_read_b64_tr_b16 a[104:105], v14 offset:128
  ds_read_b64_tr_b16 a[106:107], v14 offset:640
  ds_read_b64_tr_b16 a[108:109], v14 offset:192
  v_add_f32 v17, v17, v152
  v_add_f32 v18, v18, v153
  v_max3_f32 v19, v19, v131, v132
  v_mfma_f32_32x32x16_bf16 v[80:95], a[148:151], v[36:39], v[80:95]
  ds_read_b64_tr_b16 a[110:111], v14 offset:704
  ds_read_b64_tr_b16 a[112:113], v14 offset:4352
  ds_read_b64_tr_b16 a[114:115], v14 offset:4864
  v_add_f32 v17, v17, v154
  v_add_f32 v18, v18, v155
  v_max3_f32 v19, v19, v133, v134
  v_mfma_f32_32x32x16_bf16 v[96:111], a[152:155], v[36:39], v[96:111]
  ds_read_b64_tr_b16 a[116:117], v14 offset:4416
  ds_read_b64_tr_b16 a[118:119], v14 offset:4928
  ds_read_b64_tr_b16 a[120:121], v14 offset:4480
  v_add_f32 v17, v17, v156
  v_add_f32 v18, v18, v157
  v_max3_f32 v19, v19, v135, v136
  v_max3_f32 v19, v19, v137, v138
  v_mfma_f32_32x32x16_bf16 v[112:127], a[156:159], v[36:39], v[112:127]
  ds_read_b64_tr_b16 a[122:123], v14 offset:4992
  ds_read_b64_tr_b16 a[124:125], v14 offset:4544
  ds_read_b64_tr_b16 a[126:127], v14 offset:5056
  v_add_f32 v17, v17, v158
  v_add_f32 v18, v18, v159
  v_max3_f32 v19, v19, v139, v140
  v_max3_f32 v19, v19, v141, v142
  v_max_f32 v19, v19, v143
  v_cmp_lt_f32 vcc, s8, v19
  s_cbranch_vccnz Lrare_240
Lback_241:
  v_mfma_f32_32x32x16_bf16 v[192:207], a[32:35], a[168:171], v[192:207]
  s_add_u32 s9, s6, 1
  s_cmp_lt_u32 s4, s9
  s_cbranch_scc1 Llw_slow_242
Llw_back_243:
  v_add_u32 v14, s5, v11
  v_mfma_f32_32x32x16_bf16 v[208:223], a[36:39], a[168:171], v[208:223]
  ds_read_b64_tr_b16 a[0:1], v14 offset:0
  ds_read_b64_tr_b16 a[2:3], v14 offset:256
  v_mfma_f32_32x32x16_bf16 v[224:239], a[40:43], a[168:171], v[224:239]
  ds_read_b64_tr_b16 a[4:5], v14 offset:64
  ds_read_b64_tr_b16 a[6:7], v14 offset:320
  ds_read_b64_tr_b16 a[8:9], v14 offset:128
  v_mfma_f32_32x32x16_bf16 v[240:255], a[44:47], a[168:171], v[240:255]
  ds_read_b64_tr_b16 a[10:11], v14 offset:384
  ds_read_b64_tr_b16 a[12:13], v14 offset:192
  ds_read_b64_tr_b16 a[14:15], v14 offset:448
  v_mfma_f32_32x32x16_bf16 v[192:207], a[48:51], a[172:175], v[192:207]
  ds_read_b64_tr_b16 a[16:17], v14 offset:4352
  ds_read_b64_tr_b16 a[18:19], v14 offset:4608
  v_mfma_f32_32x32x16_bf16 v[208:223], a[52:55], a[172:175], v[208:223]
  ds_read_b64_tr_b16 a[20:21], v14 offset:4416
  ds_read_b64_tr_b16 a[22:23], v14 offset:4672
  ds_read_b64_tr_b16 a[24:25], v14 offset:4480
  v_mfma_f32_32x32x16_bf16 v[224:239], a[56:59], a[172:175], v[224:239]
  ds_read_b64_tr_b16 a[26:27], v14 offset:4736
  ds_read_b64_tr_b16 a[28:29], v14 offset:4544
  ds_read_b64_tr_b16 a[30:31], v14 offset:4800
  v_mfma_f32_32x32x16_bf16 v[240:255], a[60:63], a[172:175], v[240:255]
  s_add_u32 s5, s5, 8704
  s_cmp_lt_u32 s5, 156672
  s_cselect_b32 s5, s5, 0
  s_add_u32 s6, s6, 1
  s_add_u32 s7, s7, 1
  s_bitcmp1_b32 s76, s7
  s_cbranch_scc1 Levstub_244
Levback_245:
  s_waitcnt lgkmcnt(15)
  v_mfma_f32_32x32x16_bf16 v[144:159], a[64:67], v[160:163], v[48:63]
  v_exp_f32 v128, v128
  v_exp_f32 v129, v129
  s_add_u32 s9, s6, 2
  s_cmp_lt_u32 s4, s9
  s_cbranch_scc1 Llw_slow_246
Llw_back_247:
  v_mfma_f32_32x32x16_bf16 v[144:159], a[68:71], v[164:167], v[144:159]
  v_exp_f32 v130, v130
  v_exp_f32 v131, v131
  v_cvt_pk_bf16_f32 v32, v128, v129
  v_add_u32 v12, s5, v8
  s_add_u32 s10, s5, 8704
  v_mfma_f32_32x32x16_bf16 v[144:159], a[72:75], v[168:171], v[144:159]
  v_exp_f32 v132, v132
  v_exp_f32 v133, v133
  v_cvt_pk_bf16_f32 v33, v130, v131
  v_add_u32 v13, s5, v9
  s_cmp_lt_u32 s10, 156672
  v_mfma_f32_32x32x16_bf16 v[144:159], a[76:79], v[172:175], v[144:159]
  v_exp_f32 v134, v134
  v_exp_f32 v135, v135
  v_cvt_pk_bf16_f32 v34, v132, v133
  s_cselect_b32 s10, s10, 0
  v_mov_b32 v21, s6
  v_mfma_f32_32x32x16_bf16 v[144:159], a[80:83], v[176:179], v[144:159]
  v_exp_f32 v136, v136
  v_exp_f32 v137, v137
  v_cvt_pk_bf16_f32 v35, v134, v135
  v_add_u32 v14, s10, v10
  v_mfma_f32_32x32x16_bf16 v[144:159], a[84:87], v[180:183], v[144:159]
  v_exp_f32 v138, v138
  v_exp_f32 v139, v139
  v_cvt_pk_bf16_f32 v36, v136, v137
  s_add_u32 s5, s10, 8704
  v_mfma_f32_32x32x16_bf16 v[144:159], a[88:91], v[184:187], v[144:159]
  v_exp_f32 v140, v140
  v_exp_f32 v141, v141
  v_cvt_pk_bf16_f32 v37, v138, v139
  s_cmp_lt_u32 s5, 156672
  v_mfma_f32_32x32x16_bf16 v[144:159], a[92:95], v[188:191], v[144:159]
  v_exp_f32 v142, v142
  v_exp_f32 v143, v143
  v_cvt_pk_bf16_f32 v38, v140, v141
  v_cvt_pk_bf16_f32 v39, v142, v143
  s_cselect_b32 s5, s5, 0
  s_waitcnt lgkmcnt(0)
  v_mfma_f32_32x32x16_bf16 v[64:79], a[96:99], v[32:35], v[64:79]
  ds_write_b32 v23, v21
  ds_read_b128 a[64:67], v12 offset:0
  ds_read_b128 a[68:71], v13 offset:0
  ds_read_b128 a[72:75], v12 offset:64
  v_add_f32 v17, v17, v128
  v_add_f32 v18, v18, v129
  v_mfma_f32_32x32x16_bf16 v[80:95], a[100:103], v[32:35], v[80:95]
  ds_read_b128 a[76:79], v13 offset:64
  ds_read_b128 a[80:83], v12 offset:128
  ds_read_b128 a[84:87], v13 offset:128
  v_add_f32 v17, v17, v130
  v_add_f32 v18, v18, v131
  s_add_u32 s6, s6, 2
  v_mfma_f32_32x32x16_bf16 v[96:111], a[104:107], v[32:35], v[96:111]
  ds_read_b128 a[88:91], v12 offset:192
  ds_read_b128 a[92:95], v13 offset:192
  ds_read_b64_tr_b16 a[128:129], v14 offset:0
  v_add_f32 v17, v17, v132
  v_add_f32 v18, v18, v133
  v_mfma_f32_32x32x16_bf16 v[112:127], a[108:111], v[32:35], v[112:127]
  ds_read_b64_tr_b16 a[130:131], v14 offset:512
  ds_read_b64_tr_b16 a[132:133], v14 offset:64
  ds_read_b64_tr_b16 a[134:135], v14 offset:576
  v_add_f32 v17, v17, v134
  v_add_f32 v18, v18, v135
  v_max3_f32 v19, v144, v145, v146
  v_mfma_f32_32x32x16_bf16 v[64:79], a[112:115], v[36:39], v[64:79]
  ds_read_b64_tr_b16 a[136:137], v14 offset:128
  ds_read_b64_tr_b16 a[138:139], v14 offset:640
  ds_read_b64_tr_b16 a[140:141], v14 offset:192
  v_add_f32 v17, v17, v136
  v_add_f32 v18, v18, v137
  v_max3_f32 v19, v19, v147, v148
  v_mfma_f32_32x32x16_bf16 v[80:95], a[116:119], v[36:39], v[80:95]
  ds_read_b64_tr_b16 a[142:143], v14 offset:704
  ds_read_b64_tr_b16 a[144:145], v14 offset:4352
  ds_read_b64_tr_b16 a[146:147], v14 offset:4864
  v_add_f32 v17, v17, v138
  v_add_f32 v18, v18, v139
  v_max3_f32 v19, v19, v149, v150
  v_mfma_f32_32x32x16_bf16 v[96:111], a[120:123], v[36:39], v[96:111]
  ds_read_b64_tr_b16 a[148:149], v14 offset:4416
  ds_read_b64_tr_b16 a[150:151], v14 offset:4928
  ds_read_b64_tr_b16 a[152:153], v14 offset:4480
  v_add_f32 v17, v17, v140
  v_add_f32 v18, v18, v141
  v_max3_f32 v19, v19, v151, v152
  v_max3_f32 v19, v19, v153, v154
  v_mfma_f32_32x32x16_bf16 v[112:127], a[124:127], v[36:39], v[112:127]
  ds_read_b64_tr_b16 a[154:155], v14 offset:4992
  ds_read_b64_tr_b16 a[156:157], v14 offset:4544
  ds_read_b64_tr_b16 a[158:159], v14 offset:5056
  v_add_f32 v17, v17, v142
  v_add_f32 v18, v18, v143
  v_max3_f32 v19, v19, v155, v156
  v_max3_f32 v19, v19, v157, v158
  v_max_f32 v19, v19, v159
  v_cmp_lt_f32 vcc, s8, v19
  s_cbranch_vccnz Lrare_248
Lback_249:
  s_waitcnt lgkmcnt(15)
  v_mfma_f32_32x32x16_bf16 v[128:143], a[64:67], v[160:163], v[48:63]
  v_exp_f32 v144, v144
  v_exp_f32 v145, v145
  s_add_u32 s9, s6, 2
  s_cmp_lt_u32 s4, s9
  s_cbranch_scc1 Llw_slow_250
Llw_back_251:
  v_mfma_f32_32x32x16_bf16 v[128:143], a[68:71], v[164:167], v[128:143]
  v_exp_f32 v146, v146
  v_exp_f32 v147, v147
  v_cvt_pk_bf16_f32 v32, v144, v145
  v_add_u32 v12, s5, v8
  s_add_u32 s10, s5, 8704
  v_mfma_f32_32x32x16_bf16 v[128:143], a[72:75], v[168:171], v[128:143]
  v_exp_f32 v148, v148
  v_exp_f32 v149, v149
  v_cvt_pk_bf16_f32 v33, v146, v147
  v_add_u32 v13, s5, v9
  s_cmp_lt_u32 s10, 156672
  v_mfma_f32_32x32x16_bf16 v[128:143], a[76:79], v[172:175], v[128:143]
  v_exp_f32 v150, v150
  v_exp_f32 v151, v151
  v_cvt_pk_bf16_f32 v34, v148, v149
  s_cselect_b32 s10, s10, 0
  v_mov_b32 v21, s6
  v_mfma_f32_32x32x16_bf16 v[128:143], a[80:83], v[176:179], v[128:143]
  v_exp_f32 v152, v152
  v_exp_f32 v153, v153
  v_cvt_pk_bf16_f32 v35, v150, v151
  v_add_u32 v14, s10, v10
  v_mfma_f32_32x32x16_bf16 v[128:143], a[84:87], v[180:183], v[128:143]
  v_exp_f32 v154, v154
  v_exp_f32 v155, v155
  v_cvt_pk_bf16_f32 v36, v152, v153
  s_add_u32 s5, s10, 8704
  v_mfma_f32_32x32x16_bf16 v[128:143], a[88:91], v[184:187], v[128:143]
  v_exp_f32 v156, v156
  v_exp_f32 v157, v157
  v_cvt_pk_bf16_f32 v37, v154, v155
  s_cmp_lt_u32 s5, 156672
  v_mfma_f32_32x32x16_bf16 v[128:143], a[92:95], v[188:191], v[128:143]
  v_exp_f32 v158, v158
  v_exp_f32 v159, v159
  v_cvt_pk_bf16_f32 v38, v156, v157
  v_cvt_pk_bf16_f32 v39, v158, v159
  s_cselect_b32 s5, s5, 0
  s_waitcnt lgkmcnt(0)
  v_mfma_f32_32x32x16_bf16 v[64:79], a[128:131], v[32:35], v[64:79]
  ds_write_b32 v23, v21
  ds_read_b128 a[64:67], v12 offset:0
  ds_read_b128 a[68:71], v13 offset:0
  ds_read_b128 a[72:75], v12 offset:64
  v_add_f32 v17, v17, v144
  v_add_f32 v18, v18, v145
  v_mfma_f32_32x32x16_bf16 v[80:95], a[132:135], v[32:35], v[80:95]
  ds_read_b128 a[76:79], v13 offset:64
  ds_read_b128 a[80:83], v12 offset:128
  ds_read_b128 a[84:87], v13 offset:128
  v_add_f32 v17, v17, v146
  v_add_f32 v18, v18, v147
  s_add_u32 s6, s6, 2
  v_mfma_f32_32x32x16_bf16 v[96:111], a[136:139], v[32:35], v[96:111]
  ds_read_b128 a[88:91], v12 offset:192
  ds_read_b128 a[92:95], v13 offset:192
  ds_read_b64_tr_b16 a[96:97], v14 offset:0
  v_add_f32 v17, v17, v148
  v_add_f32 v18, v18, v149
  v_mfma_f32_32x32x16_bf16 v[112:127], a[140:143], v[32:35], v[112:127]
  ds_read_b64_tr_b16 a[98:99], v14 offset:512
  ds_read_b64_tr_b16 a[100:101], v14 offset:64
  ds_read_b64_tr_b16 a[102:103], v14 offset:576
  v_add_f32 v17, v17, v150
  v_add_f32 v18, v18, v151
  v_max3_f32 v19, v128, v129, v130
  v_mfma_f32_32x32x16_bf16 v[64:79], a[144:147], v[36:39], v[64:79]
  ds_read_b64_tr_b16 a[104:105], v14 offset:128
  ds_read_b64_tr_b16 a[106:107], v14 offset:640
  ds_read_b64_tr_b16 a[108:109], v14 offset:192
  v_add_f32 v17, v17, v152
  v_add_f32 v18, v18, v153
  v_max3_f32 v19, v19, v131, v132
  v_mfma_f32_32x32x16_bf16 v[80:95], a[148:151], v[36:39], v[80:95]
  ds_read_b64_tr_b16 a[110:111], v14 offset:704
  ds_read_b64_tr_b16 a[112:113], v14 offset:4352
  ds_read_b64_tr_b16 a[114:115], v14 offset:4864
  v_add_f32 v17, v17, v154
  v_add_f32 v18, v18, v155
  v_max3_f32 v19, v19, v133, v134
  v_mfma_f32_32x32x16_bf16 v[96:111], a[152:155], v[36:39], v[96:111]
  ds_read_b64_tr_b16 a[116:117], v14 offset:4416
  ds_read_b64_tr_b16 a[118:119], v14 offset:4928
  ds_read_b64_tr_b16 a[120:121], v14 offset:4480
  v_add_f32 v17, v17, v156
  v_add_f32 v18, v18, v157
  v_max3_f32 v19, v19, v135, v136
  v_max3_f32 v19, v19, v137, v138
  v_mfma_f32_32x32x16_bf16 v[112:127], a[156:159], v[36:39], v[112:127]
  ds_read_b64_tr_b16 a[122:123], v14 offset:4992
  ds_read_b64_tr_b16 a[124:125], v14 offset:4544
  ds_read_b64_tr_b16 a[126:127], v14 offset:5056
  v_add_f32 v17, v17, v158
  v_add_f32 v18, v18, v159
  v_max3_f32 v19, v19, v139, v140
  v_max3_f32 v19, v19, v141, v142
  v_max_f32 v19, v19, v143
  v_cmp_lt_f32 vcc, s8, v19
  s_cbranch_vccnz Lrare_252
Lback_253:
  v_mfma_f32_32x32x16_bf16 v[192:207], a[0:3], a[176:179], v[192:207]
  s_add_u32 s9, s6, 1
  s_cmp_lt_u32 s4, s9
  s_cbranch_scc1 Llw_slow_254
Llw_back_255:
  v_add_u32 v14, s5, v11
  v_mfma_f32_32x32x16_bf16 v[208:223], a[4:7], a[176:179], v[208:223]
  ds_read_b64_tr_b16 a[32:33], v14 offset:0
  ds_read_b64_tr_b16 a[34:35], v14 offset:256
  v_mfma_f32_32x32x16_bf16 v[224:239], a[8:11], a[176:179], v[224:239]
  ds_read_b64_tr_b16 a[36:37], v14 offset:64
  ds_read_b64_tr_b16 a[38:39], v14 offset:320
  ds_read_b64_tr_b16 a[40:41], v14 offset:128
  v_mfma_f32_32x32x16_bf16 v[240:255], a[12:15], a[176:179], v[240:255]
  ds_read_b64_tr_b16 a[42:43], v14 offset:384
  ds_read_b64_tr_b16 a[44:45], v14 offset:192
  ds_read_b64_tr_b16 a[46:47], v14 offset:448
  v_mfma_f32_32x32x16_bf16 v[192:207], a[16:19], a[180:183], v[192:207]
  ds_read_b64_tr_b16 a[48:49], v14 offset:4352
  ds_read_b64_tr_b16 a[50:51], v14 offset:4608
  v_mfma_f32_32x32x16_bf16 v[208:223], a[20:23], a[180:183], v[208:223]
  ds_read_b64_tr_b16 a[52:53], v14 offset:4416
  ds_read_b64_tr_b16 a[54:55], v14 offset:4672
  ds_read_b64_tr_b16 a[56:57], v14 offset:4480
  v_mfma_f32_32x32x16_bf16 v[224:239], a[24:27], a[180:183], v[224:239]
  ds_read_b64_tr_b16 a[58:59], v14 offset:4736
  ds_read_b64_tr_b16 a[60:61], v14 offset:4544
  ds_read_b64_tr_b16 a[62:63], v14 offset:4800
  v_mfma_f32_32x32x16_bf16 v[240:255], a[28:31], a[180:183], v[240:255]
  s_add_u32 s5, s5, 8704
  s_cmp_lt_u32 s5, 156672
  s_cselect_b32 s5, s5, 0
  s_add_u32 s6, s6, 1
  s_add_u32 s7, s7, 1
  s_bitcmp1_b32 s76, s7
  s_cbranch_scc1 Levstub_256
Levback_257:
  s_cmp_lt_u32 s7, 12
  s_cbranch_scc1 Lattn_207
  s_waitcnt lgkmcnt(15)
  v_mfma_f32_32x32x16_bf16 v[144:159], a[64:67], v[160:163], v[48:63]
  v_exp_f32 v128, v128
  v_exp_f32 v129, v129
  s_add_u32 s9, s6, 2
  s_cmp_lt_u32 s4, s9
  s_cbranch_scc1 Llw_slow_258
Llw_back_259:
  v_mfma_f32_32x32x16_bf16 v[144:159], a[68:71], v[164:167], v[144:159]
  v_exp_f32 v130, v130
  v_exp_f32 v131, v131
  v_cvt_pk_bf16_f32 v32, v128, v129
  v_add_u32 v12, s5, v8
  s_add_u32 s10, s5, 8704
  v_mfma_f32_32x32x16_bf16 v[144:159], a[72:75], v[168:171], v[144:159]
  v_exp_f32 v132, v132
  v_exp_f32 v133, v133
  v_cvt_pk_bf16_f32 v33, v130, v131
  v_add_u32 v13, s5, v9
  s_cmp_lt_u32 s10, 156672
  v_mfma_f32_32x32x16_bf16 v[144:159], a[76:79], v[172:175], v[144:159]
  v_exp_f32 v134, v134
  v_exp_f32 v135, v135
  v_cvt_pk_bf16_f32 v34, v132, v133
  s_cselect_b32 s10, s10, 0
  v_mov_b32 v21, s6
  v_mfma_f32_32x32x16_bf16 v[144:159], a[80:83], v[176:179], v[144:159]
  v_exp_f32 v136, v136
  v_exp_f32 v137, v137
  v_cvt_pk_bf16_f32 v35, v134, v135
  v_add_u32 v14, s10, v10
  v_mfma_f32_32x32x16_bf16 v[144:159], a[84:87], v[180:183], v[144:159]
  v_exp_f32 v138, v138
  v_exp_f32 v139, v139
  v_cvt_pk_bf16_f32 v36, v136, v137
  s_add_u32 s5, s10, 8704
  v_mfma_f32_32x32x16_bf16 v[144:159], a[88:91], v[184:187], v[144:159]
  v_exp_f32 v140, v140
  v_exp_f32 v141, v141
  v_cvt_pk_bf16_f32 v37, v138, v139
  s_cmp_lt_u32 s5, 156672
  v_mfma_f32_32x32x16_bf16 v[144:159], a[92:95], v[188:191], v[144:159]
  v_exp_f32 v142, v142
  v_exp_f32 v143, v143
  v_cvt_pk_bf16_f32 v38, v140, v141
  v_cvt_pk_bf16_f32 v39, v142, v143
  s_cselect_b32 s5, s5, 0
  s_waitcnt lgkmcnt(0)
  v_mfma_f32_32x32x16_bf16 v[64:79], a[96:99], v[32:35], v[64:79]
  ds_write_b32 v23, v21
  ds_read_b128 a[64:67], v12 offset:0
  ds_read_b128 a[68:71], v13 offset:0
  ds_read_b128 a[72:75], v12 offset:64
  v_add_f32 v17, v17, v128
  v_add_f32 v18, v18, v129
  v_mfma_f32_32x32x16_bf16 v[80:95], a[100:103], v[32:35], v[80:95]
  ds_read_b128 a[76:79], v13 offset:64
  ds_read_b128 a[80:83], v12 offset:128
  ds_read_b128 a[84:87], v13 offset:128
  v_add_f32 v17, v17, v130
  v_add_f32 v18, v18, v131
  s_add_u32 s6, s6, 2
  v_mfma_f32_32x32x16_bf16 v[96:111], a[104:107], v[32:35], v[96:111]
  ds_read_b128 a[88:91], v12 offset:192
  ds_read_b128 a[92:95], v13 offset:192
  ds_read_b64_tr_b16 a[128:129], v14 offset:0
  v_add_f32 v17, v17, v132
  v_add_f32 v18, v18, v133
  v_mfma_f32_32x32x16_bf16 v[112:127], a[108:111], v[32:35], v[112:127]
  ds_read_b64_tr_b16 a[130:131], v14 offset:512
  ds_read_b64_tr_b16 a[132:133], v14 offset:64
  ds_read_b64_tr_b16 a[134:135], v14 offset:576
  v_add_f32 v17, v17, v134
  v_add_f32 v18, v18, v135
  v_max3_f32 v19, v144, v145, v146
  v_mfma_f32_32x32x16_bf16 v[64:79], a[112:115], v[36:39], v[64:79]
  ds_read_b64_tr_b16 a[136:137], v14 offset:128
  ds_read_b64_tr_b16 a[138:139], v14 offset:640
  ds_read_b64_tr_b16 a[140:141], v14 offset:192
  v_add_f32 v17, v17, v136
  v_add_f32 v18, v18, v137
  v_max3_f32 v19, v19, v147, v148
  v_mfma_f32_32x32x16_bf16 v[80:95], a[116:119], v[36:39], v[80:95]
  ds_read_b64_tr_b16 a[142:143], v14 offset:704
  ds_read_b64_tr_b16 a[144:145], v14 offset:4352
  ds_read_b64_tr_b16 a[146:147], v14 offset:4864
  v_add_f32 v17, v17, v138
  v_add_f32 v18, v18, v139
  v_max3_f32 v19, v19, v149, v150
  v_mfma_f32_32x32x16_bf16 v[96:111], a[120:123], v[36:39], v[96:111]
  ds_read_b64_tr_b16 a[148:149], v14 offset:4416
  ds_read_b64_tr_b16 a[150:151], v14 offset:4928
  ds_read_b64_tr_b16 a[152:153], v14 offset:4480
  v_add_f32 v17, v17, v140
  v_add_f32 v18, v18, v141
  v_max3_f32 v19, v19, v151, v152
  v_max3_f32 v19, v19, v153, v154
  v_mfma_f32_32x32x16_bf16 v[112:127], a[124:127], v[36:39], v[112:127]
  ds_read_b64_tr_b16 a[154:155], v14 offset:4992
  ds_read_b64_tr_b16 a[156:157], v14 offset:4544
  ds_read_b64_tr_b16 a[158:159], v14 offset:5056
  v_add_f32 v17, v17, v142
  v_add_f32 v18, v18, v143
  v_max3_f32 v19, v19, v155, v156
  v_max3_f32 v19, v19, v157, v158
  v_max_f32 v19, v19, v159
  v_cmp_lt_f32 vcc, s8, v19
  s_cbranch_vccnz Lrare_260
Lback_261:
  s_waitcnt lgkmcnt(15)
  v_mfma_f32_32x32x16_bf16 v[128:143], a[64:67], v[160:163], v[48:63]
  v_exp_f32 v144, v144
  v_exp_f32 v145, v145
  s_add_u32 s9, s6, 2
  s_cmp_lt_u32 s4, s9
  s_cbranch_scc1 Llw_slow_262
Llw_back_263:
  v_mfma_f32_32x32x16_bf16 v[128:143], a[68:71], v[164:167], v[128:143]
  v_exp_f32 v146, v146
  v_exp_f32 v147, v147
  v_cvt_pk_bf16_f32 v32, v144, v145
  v_add_u32 v12, s5, v8
  s_add_u32 s10, s5, 8704
  v_mfma_f32_32x32x16_bf16 v[128:143], a[72:75], v[168:171], v[128:143]
  v_exp_f32 v148, v148
  v_exp_f32 v149, v149
  v_cvt_pk_bf16_f32 v33, v146, v147
  v_add_u32 v13, s5, v9
  s_cmp_lt_u32 s10, 156672
  v_mfma_f32_32x32x16_bf16 v[128:143], a[76:79], v[172:175], v[128:143]
  v_exp_f32 v150, v150
  v_exp_f32 v151, v151
  v_cvt_pk_bf16_f32 v34, v148, v149
  s_cselect_b32 s10, s10, 0
  v_mov_b32 v21, s6
  v_mfma_f32_32x32x16_bf16 v[128:143], a[80:83], v[176:179], v[128:143]
  v_exp_f32 v152, v152
  v_exp_f32 v153, v153
  v_cvt_pk_bf16_f32 v35, v150, v151
  v_add_u32 v14, s10, v10
  v_mfma_f32_32x32x16_bf16 v[128:143], a[84:87], v[180:183], v[128:143]
  v_exp_f32 v154, v154
  v_exp_f32 v155, v155
  v_cvt_pk_bf16_f32 v36, v152, v153
  s_add_u32 s5, s10, 8704
  v_mfma_f32_32x32x16_bf16 v[128:143], a[88:91], v[184:187], v[128:143]
  v_exp_f32 v156, v156
  v_exp_f32 v157, v157
  v_cvt_pk_bf16_f32 v37, v154, v155
  s_cmp_lt_u32 s5, 156672
  v_mfma_f32_32x32x16_bf16 v[128:143], a[92:95], v[188:191], v[128:143]
  v_exp_f32 v158, v158
  v_exp_f32 v159, v159
  v_cvt_pk_bf16_f32 v38, v156, v157
  v_cvt_pk_bf16_f32 v39, v158, v159
  s_cselect_b32 s5, s5, 0
  s_waitcnt lgkmcnt(0)
  v_mfma_f32_32x32x16_bf16 v[64:79], a[128:131], v[32:35], v[64:79]
  ds_write_b32 v23, v21
  ds_read_b128 a[64:67], v12 offset:0
  ds_read_b128 a[68:71], v13 offset:0
  ds_read_b128 a[72:75], v12 offset:64
  v_add_f32 v17, v17, v144
  v_add_f32 v18, v18, v145
  v_mfma_f32_32x32x16_bf16 v[80:95], a[132:135], v[32:35], v[80:95]
  ds_read_b128 a[76:79], v13 offset:64
  ds_read_b128 a[80:83], v12 offset:128
  ds_read_b128 a[84:87], v13 offset:128
  v_add_f32 v17, v17, v146
  v_add_f32 v18, v18, v147
  s_add_u32 s6, s6, 2
  v_mfma_f32_32x32x16_bf16 v[96:111], a[136:139], v[32:35], v[96:111]
  ds_read_b128 a[88:91], v12 offset:192
  ds_read_b128 a[92:95], v13 offset:192
  ds_read_b64_tr_b16 a[96:97], v14 offset:0
  v_add_f32 v17, v17, v148
  v_add_f32 v18, v18, v149
  v_mfma_f32_32x32x16_bf16 v[112:127], a[140:143], v[32:35], v[112:127]
  ds_read_b64_tr_b16 a[98:99], v14 offset:512
  ds_read_b64_tr_b16 a[100:101], v14 offset:64
  ds_read_b64_tr_b16 a[102:103], v14 offset:576
  v_add_f32 v17, v17, v150
  v_add_f32 v18, v18, v151
  v_max3_f32 v19, v128, v129, v130
  v_mfma_f32_32x32x16_bf16 v[64:79], a[144:147], v[36:39], v[64:79]
  ds_read_b64_tr_b16 a[104:105], v14 offset:128
  ds_read_b64_tr_b16 a[106:107], v14 offset:640
  ds_read_b64_tr_b16 a[108:109], v14 offset:192
  v_add_f32 v17, v17, v152
  v_add_f32 v18, v18, v153
  v_max3_f32 v19, v19, v131, v132
  v_mfma_f32_32x32x16_bf16 v[80:95], a[148:151], v[36:39], v[80:95]
  ds_read_b64_tr_b16 a[110:111], v14 offset:704
  ds_read_b64_tr_b16 a[112:113], v14 offset:4352
  ds_read_b64_tr_b16 a[114:115], v14 offset:4864
  v_add_f32 v17, v17, v154
  v_add_f32 v18, v18, v155
  v_max3_f32 v19, v19, v133, v134
  v_mfma_f32_32x32x16_bf16 v[96:111], a[152:155], v[36:39], v[96:111]
  ds_read_b64_tr_b16 a[116:117], v14 offset:4416
  ds_read_b64_tr_b16 a[118:119], v14 offset:4928
  ds_read_b64_tr_b16 a[120:121], v14 offset:4480
  v_add_f32 v17, v17, v156
  v_add_f32 v18, v18, v157
  v_max3_f32 v19, v19, v135, v136
  v_max3_f32 v19, v19, v137, v138
  v_mfma_f32_32x32x16_bf16 v[112:127], a[156:159], v[36:39], v[112:127]
  ds_read_b64_tr_b16 a[122:123], v14 offset:4992
  ds_read_b64_tr_b16 a[124:125], v14 offset:4544
  ds_read_b64_tr_b16 a[126:127], v14 offset:5056
  v_add_f32 v17, v17, v158
  v_add_f32 v18, v18, v159
  v_max3_f32 v19, v19, v139, v140
  v_max3_f32 v19, v19, v141, v142
  v_max_f32 v19, v19, v143
  v_cmp_lt_f32 vcc, s8, v19
  s_cbranch_vccnz Lrare_264
Lback_265:
  v_mfma_f32_32x32x16_bf16 v[192:207], a[32:35], a[184:187], v[192:207]
  s_add_u32 s9, s6, 4
  s_cmp_lt_u32 s4, s9
  s_cbranch_scc1 Llw_slow_266
Llw_back_267:
  s_mul_i32 s29, s3, 8704
  s_add_u32 s10, s5, s29
  s_add_u32 s10, s10, 0
  s_sub_u32 s28, s10, s72
  s_cmp_lt_u32 s10, s72
  s_cselect_b32 s10, s10, s28
  v_add_u32 v12, s10, v15
  s_add_u32 s5, s5, 26112
  s_sub_u32 s28, s5, s72
  s_cmp_lt_u32 s5, s72
  s_cselect_b32 s5, s5, s28
  v_add_u32 v14, s5, v11
  v_mfma_f32_32x32x16_bf16 v[208:223], a[36:39], a[184:187], v[208:223]
  ds_read_b128 a[160:163], v12 offset:0
  ds_read_b128 a[164:167], v12 offset:1088
  ds_read_b128 a[168:171], v12 offset:2176
  v_mfma_f32_32x32x16_bf16 v[224:239], a[40:43], a[184:187], v[224:239]
  ds_read_b128 a[172:175], v12 offset:3264
  ds_read_b128 a[176:179], v12 offset:4352
  ds_read_b128 a[180:183], v12 offset:5440
  ds_read_b64_tr_b16 a[0:1], v14 offset:0
  v_mfma_f32_32x32x16_bf16 v[240:255], a[44:47], a[184:187], v[240:255]
  ds_read_b64_tr_b16 a[2:3], v14 offset:256
  ds_read_b64_tr_b16 a[4:5], v14 offset:64
  ds_read_b64_tr_b16 a[6:7], v14 offset:320
  ds_read_b64_tr_b16 a[8:9], v14 offset:128
  v_mfma_f32_32x32x16_bf16 v[192:207], a[48:51], a[188:191], v[192:207]
  ds_read_b128 a[184:187], v12 offset:6528
  ds_read_b64_tr_b16 a[10:11], v14 offset:384
  ds_read_b64_tr_b16 a[12:13], v14 offset:192
  ds_read_b64_tr_b16 a[14:15], v14 offset:448
  v_mfma_f32_32x32x16_bf16 v[208:223], a[52:55], a[188:191], v[208:223]
  ds_read_b64_tr_b16 a[16:17], v14 offset:4352
  ds_read_b64_tr_b16 a[18:19], v14 offset:4608
  ds_read_b64_tr_b16 a[20:21], v14 offset:4416
  ds_read_b64_tr_b16 a[22:23], v14 offset:4672
  v_mfma_f32_32x32x16_bf16 v[224:239], a[56:59], a[188:191], v[224:239]
  ds_read_b64_tr_b16 a[24:25], v14 offset:4480
  ds_read_b64_tr_b16 a[26:27], v14 offset:4736
  ds_read_b64_tr_b16 a[28:29], v14 offset:4544
  ds_read_b64_tr_b16 a[30:31], v14 offset:4800
  v_mfma_f32_32x32x16_bf16 v[240:255], a[60:63], a[188:191], v[240:255]
  ds_read_b128 a[188:191], v12 offset:7616
  s_add_u32 s5, s5, 8704
  s_cmp_lt_u32 s5, 156672
  s_cselect_b32 s5, s5, 0
  s_add_u32 s6, s6, 4
  s_add_u32 s7, s7, 1
  s_bitcmp1_b32 s76, s7
  s_cbranch_scc1 Levstub_268
Levback_269:
  s_waitcnt lgkmcnt(15)
  v_mfma_f32_32x32x16_bf16 v[144:159], a[64:67], v[160:163], v[48:63]
  v_exp_f32 v128, v128
  v_exp_f32 v129, v129
  s_add_u32 s9, s6, 2
  s_cmp_lt_u32 s4, s9
  s_cbranch_scc1 Llw_slow_270
Llw_back_271:
  v_mfma_f32_32x32x16_bf16 v[144:159], a[68:71], v[164:167], v[144:159]
  v_exp_f32 v130, v130
  v_exp_f32 v131, v131
  v_cvt_pk_bf16_f32 v32, v128, v129
  v_add_u32 v12, s5, v8
  s_add_u32 s10, s5, 8704
  v_mfma_f32_32x32x16_bf16 v[144:159], a[72:75], v[168:171], v[144:159]
  v_exp_f32 v132, v132
  v_exp_f32 v133, v133
  v_cvt_pk_bf16_f32 v33, v130, v131
  v_add_u32 v13, s5, v9
  s_cmp_lt_u32 s10, 156672
  v_mfma_f32_32x32x16_bf16 v[144:159], a[76:79], v[172:175], v[144:159]
  v_exp_f32 v134, v134
  v_exp_f32 v135, v135
  v_cvt_pk_bf16_f32 v34, v132, v133
  s_cselect_b32 s10, s10, 0
  v_mov_b32 v21, s6
  v_mfma_f32_32x32x16_bf16 v[144:159], a[80:83], v[176:179], v[144:159]
  v_exp_f32 v136, v136
  v_exp_f32 v137, v137
  v_cvt_pk_bf16_f32 v35, v134, v135
  v_add_u32 v14, s10, v10
  v_mfma_f32_32x32x16_bf16 v[144:159], a[84:87], v[180:183], v[144:159]
  v_exp_f32 v138, v138
  v_exp_f32 v139, v139
  v_cvt_pk_bf16_f32 v36, v136, v137
  s_add_u32 s5, s10, 8704
  v_mfma_f32_32x32x16_bf16 v[144:159], a[88:91], v[184:187], v[144:159]
  v_exp_f32 v140, v140
  v_exp_f32 v141, v141
  v_cvt_pk_bf16_f32 v37, v138, v139
  s_cmp_lt_u32 s5, 156672
  v_mfma_f32_32x32x16_bf16 v[144:159], a[92:95], v[188:191], v[144:159]
  v_exp_f32 v142, v142
  v_exp_f32 v143, v143
  v_cvt_pk_bf16_f32 v38, v140, v141
  v_cvt_pk_bf16_f32 v39, v142, v143
  s_cselect_b32 s5, s5, 0
  s_waitcnt lgkmcnt(0)
  v_mfma_f32_32x32x16_bf16 v[64:79], a[96:99], v[32:35], v[64:79]
  ds_write_b32 v23, v21
  ds_read_b128 a[64:67], v12 offset:0
  ds_read_b128 a[68:71], v13 offset:0
  ds_read_b128 a[72:75], v12 offset:64
  v_add_f32 v17, v17, v128
  v_add_f32 v18, v18, v129
  v_mfma_f32_32x32x16_bf16 v[80:95], a[100:103], v[32:35], v[80:95]
  ds_read_b128 a[76:79], v13 offset:64
  ds_read_b128 a[80:83], v12 offset:128
  ds_read_b128 a[84:87], v13 offset:128
  v_add_f32 v17, v17, v130
  v_add_f32 v18, v18, v131
  s_add_u32 s6, s6, 2
  v_mfma_f32_32x32x16_bf16 v[96:111], a[104:107], v[32:35], v[96:111]
  ds_read_b128 a[88:91], v12 offset:192
  ds_read_b128 a[92:95], v13 offset:192
  ds_read_b64_tr_b16 a[128:129], v14 offset:0
  v_add_f32 v17, v17, v132
  v_add_f32 v18, v18, v133
  v_mfma_f32_32x32x16_bf16 v[112:127], a[108:111], v[32:35], v[112:127]
  ds_read_b64_tr_b16 a[130:131], v14 offset:512
  ds_read_b64_tr_b16 a[132:133], v14 offset:64
  ds_read_b64_tr_b16 a[134:135], v14 offset:576
  v_add_f32 v17, v17, v134
  v_add_f32 v18, v18, v135
  v_max3_f32 v19, v144, v145, v146
  v_mfma_f32_32x32x16_bf16 v[64:79], a[112:115], v[36:39], v[64:79]
  ds_read_b64_tr_b16 a[136:137], v14 offset:128
  ds_read_b64_tr_b16 a[138:139], v14 offset:640
  ds_read_b64_tr_b16 a[140:141], v14 offset:192
  v_add_f32 v17, v17, v136
  v_add_f32 v18, v18, v137
  v_max3_f32 v19, v19, v147, v148
  v_mfma_f32_32x32x16_bf16 v[80:95], a[116:119], v[36:39], v[80:95]
  ds_read_b64_tr_b16 a[142:143], v14 offset:704
  ds_read_b64_tr_b16 a[144:145], v14 offset:4352
  ds_read_b64_tr_b16 a[146:147], v14 offset:4864
  v_add_f32 v17, v17, v138
  v_add_f32 v18, v18, v139
  v_max3_f32 v19, v19, v149, v150
  v_mfma_f32_32x32x16_bf16 v[96:111], a[120:123], v[36:39], v[96:111]
  ds_read_b64_tr_b16 a[148:149], v14 offset:4416
  ds_read_b64_tr_b16 a[150:151], v14 offset:4928
  ds_read_b64_tr_b16 a[152:153], v14 offset:4480
  v_add_f32 v17, v17, v140
  v_add_f32 v18, v18, v141
  v_max3_f32 v19, v19, v151, v152
  v_max3_f32 v19, v19, v153, v154
  v_mfma_f32_32x32x16_bf16 v[112:127], a[124:127], v[36:39], v[112:127]
  ds_read_b64_tr_b16 a[154:155], v14 offset:4992
  ds_read_b64_tr_b16 a[156:157], v14 offset:4544
  ds_read_b64_tr_b16 a[158:159], v14 offset:5056
  v_add_f32 v17, v17, v142
  v_add_f32 v18, v18, v143
  v_max3_f32 v19, v19, v155, v156
  v_max3_f32 v19, v19, v157, v158
  v_max_f32 v19, v19, v159
  v_cmp_lt_f32 vcc, s8, v19
  s_cbranch_vccnz Lrare_272
Lback_273:
  s_waitcnt lgkmcnt(15)
  v_mfma_f32_32x32x16_bf16 v[128:143], a[64:67], v[160:163], v[48:63]
  v_exp_f32 v144, v144
  v_exp_f32 v145, v145
  s_add_u32 s9, s6, 2
  s_cmp_lt_u32 s4, s9
  s_cbranch_scc1 Llw_slow_274
Llw_back_275:
  v_mfma_f32_32x32x16_bf16 v[128:143], a[68:71], v[164:167], v[128:143]
  v_exp_f32 v146, v146
  v_exp_f32 v147, v147
  v_cvt_pk_bf16_f32 v32, v144, v145
  v_add_u32 v12, s5, v8
  s_add_u32 s10, s5, 8704
  v_mfma_f32_32x32x16_bf16 v[128:143], a[72:75], v[168:171], v[128:143]
  v_exp_f32 v148, v148
  v_exp_f32 v149, v149
  v_cvt_pk_bf16_f32 v33, v146, v147
  v_add_u32 v13, s5, v9
  s_cmp_lt_u32 s10, 156672
  v_mfma_f32_32x32x16_bf16 v[128:143], a[76:79], v[172:175], v[128:143]
  v_exp_f32 v150, v150
  v_exp_f32 v151, v151
  v_cvt_pk_bf16_f32 v34, v148, v149
  s_cselect_b32 s10, s10, 0
  v_mov_b32 v21, s6
  v_mfma_f32_32x32x16_bf16 v[128:143], a[80:83], v[176:179], v[128:143]
  v_exp_f32 v152, v152
  v_exp_f32 v153, v153
  v_cvt_pk_bf16_f32 v35, v150, v151
  v_add_u32 v14, s10, v10
  v_mfma_f32_32x32x16_bf16 v[128:143], a[84:87], v[180:183], v[128:143]
  v_exp_f32 v154, v154
  v_exp_f32 v155, v155
  v_cvt_pk_bf16_f32 v36, v152, v153
  s_add_u32 s5, s10, 8704
  v_mfma_f32_32x32x16_bf16 v[128:143], a[88:91], v[184:187], v[128:143]
  v_exp_f32 v156, v156
  v_exp_f32 v157, v157
  v_cvt_pk_bf16_f32 v37, v154, v155
  s_cmp_lt_u32 s5, 156672
  v_mfma_f32_32x32x16_bf16 v[128:143], a[92:95], v[188:191], v[128:143]
  v_exp_f32 v158, v158
  v_exp_f32 v159, v159
  v_cvt_pk_bf16_f32 v38, v156, v157
  v_cvt_pk_bf16_f32 v39, v158, v159
  s_cselect_b32 s5, s5, 0
  s_waitcnt lgkmcnt(0)
  v_mfma_f32_32x32x16_bf16 v[64:79], a[128:131], v[32:35], v[64:79]
  ds_write_b32 v23, v21
  ds_read_b128 a[64:67], v12 offset:0
  ds_read_b128 a[68:71], v13 offset:0
  ds_read_b128 a[72:75], v12 offset:64
  v_add_f32 v17, v17, v144
  v_add_f32 v18, v18, v145
  v_mfma_f32_32x32x16_bf16 v[80:95], a[132:135], v[32:35], v[80:95]
  ds_read_b128 a[76:79], v13 offset:64
  ds_read_b128 a[80:83], v12 offset:128
  ds_read_b128 a[84:87], v13 offset:128
  v_add_f32 v17, v17, v146
  v_add_f32 v18, v18, v147
  s_add_u32 s6, s6, 2
  v_mfma_f32_32x32x16_bf16 v[96:111], a[136:139], v[32:35], v[96:111]
  ds_read_b128 a[88:91], v12 offset:192
  ds_read_b128 a[92:95], v13 offset:192
  ds_read_b64_tr_b16 a[96:97], v14 offset:0
  v_add_f32 v17, v17, v148
  v_add_f32 v18, v18, v149
  v_mfma_f32_32x32x16_bf16 v[112:127], a[140:143], v[32:35], v[112:127]
  ds_read_b64_tr_b16 a[98:99], v14 offset:512
  ds_read_b64_tr_b16 a[100:101], v14 offset:64
  ds_read_b64_tr_b16 a[102:103], v14 offset:576
  v_add_f32 v17, v17, v150
  v_add_f32 v18, v18, v151
  v_max3_f32 v19, v128, v129, v130
  v_mfma_f32_32x32x16_bf16 v[64:79], a[144:147], v[36:39], v[64:79]
  ds_read_b64_tr_b16 a[104:105], v14 offset:128
  ds_read_b64_tr_b16 a[106:107], v14 offset:640
  ds_read_b64_tr_b16 a[108:109], v14 offset:192
  v_add_f32 v17, v17, v152
  v_add_f32 v18, v18, v153
  v_max3_f32 v19, v19, v131, v132
  v_mfma_f32_32x32x16_bf16 v[80:95], a[148:151], v[36:39], v[80:95]
  ds_read_b64_tr_b16 a[110:111], v14 offset:704
  ds_read_b64_tr_b16 a[112:113], v14 offset:4352
  ds_read_b64_tr_b16 a[114:115], v14 offset:4864
  v_add_f32 v17, v17, v154
  v_add_f32 v18, v18, v155
  v_max3_f32 v19, v19, v133, v134
  v_mfma_f32_32x32x16_bf16 v[96:111], a[152:155], v[36:39], v[96:111]
  ds_read_b64_tr_b16 a[116:117], v14 offset:4416
  ds_read_b64_tr_b16 a[118:119], v14 offset:4928
  ds_read_b64_tr_b16 a[120:121], v14 offset:4480
  v_add_f32 v17, v17, v156
  v_add_f32 v18, v18, v157
  v_max3_f32 v19, v19, v135, v136
  v_max3_f32 v19, v19, v137, v138
  v_mfma_f32_32x32x16_bf16 v[112:127], a[156:159], v[36:39], v[112:127]
  ds_read_b64_tr_b16 a[122:123], v14 offset:4992
  ds_read_b64_tr_b16 a[124:125], v14 offset:4544
  ds_read_b64_tr_b16 a[126:127], v14 offset:5056
  v_add_f32 v17, v17, v158
  v_add_f32 v18, v18, v159
  v_max3_f32 v19, v19, v139, v140
  v_max3_f32 v19, v19, v141, v142
  v_max_f32 v19, v19, v143
  v_cmp_lt_f32 vcc, s8, v19
  s_cbranch_vccnz Lrare_276
Lback_277:
  v_mfma_f32_32x32x16_bf16 v[192:207], a[0:3], a[160:163], v[192:207]
  s_add_u32 s9, s6, 1
  s_cmp_lt_u32 s4, s9
  s_cbranch_scc1 Llw_slow_278
Llw_back_279:
  v_add_u32 v14, s5, v11
  v_mfma_f32_32x32x16_bf16 v[208:223], a[4:7], a[160:163], v[208:223]
  ds_read_b64_tr_b16 a[32:33], v14 offset:0
  ds_read_b64_tr_b16 a[34:35], v14 offset:256
  v_mfma_f32_32x32x16_bf16 v[224:239], a[8:11], a[160:163], v[224:239]
  ds_read_b64_tr_b16 a[36:37], v14 offset:64
  ds_read_b64_tr_b16 a[38:39], v14 offset:320
  ds_read_b64_tr_b16 a[40:41], v14 offset:128
  v_mfma_f32_32x32x16_bf16 v[240:255], a[12:15], a[160:163], v[240:255]
  ds_read_b64_tr_b16 a[42:43], v14 offset:384
  ds_read_b64_tr_b16 a[44:45], v14 offset:192
  ds_read_b64_tr_b16 a[46:47], v14 offset:448
  v_mfma_f32_32x32x16_bf16 v[192:207], a[16:19], a[164:167], v[192:207]
  ds_read_b64_tr_b16 a[48:49], v14 offset:4352
  ds_read_b64_tr_b16 a[50:51], v14 offset:4608
  v_mfma_f32_32x32x16_bf16 v[208:223], a[20:23], a[164:167], v[208:223]
  ds_read_b64_tr_b16 a[52:53], v14 offset:4416
  ds_read_b64_tr_b16 a[54:55], v14 offset:4672
  ds_read_b64_tr_b16 a[56:57], v14 offset:4480
  v_mfma_f32_32x32x16_bf16 v[224:239], a[24:27], a[164:167], v[224:239]
  ds_read_b64_tr_b16 a[58:59], v14 offset:4736
  ds_read_b64_tr_b16 a[60:61], v14 offset:4544
  ds_read_b64_tr_b16 a[62:63], v14 offset:4800
  v_mfma_f32_32x32x16_bf16 v[240:255], a[28:31], a[164:167], v[240:255]
  s_add_u32 s5, s5, 8704
  s_cmp_lt_u32 s5, 156672
  s_cselect_b32 s5, s5, 0
  s_add_u32 s6, s6, 1
  s_add_u32 s7, s7, 1
  s_bitcmp1_b32 s76, s7
  s_cbranch_scc1 Levstub_280
Levback_281:
  s_waitcnt lgkmcnt(15)
  v_mfma_f32_32x32x16_bf16 v[144:159], a[64:67], v[160:163], v[48:63]
  v_exp_f32 v128, v128
  v_exp_f32 v129, v129
  s_add_u32 s9, s6, 2
  s_cmp_lt_u32 s4, s9
  s_cbranch_scc1 Llw_slow_282
Llw_back_283:
  v_mfma_f32_32x32x16_bf16 v[144:159], a[68:71], v[164:167], v[144:159]
  v_exp_f32 v130, v130
  v_exp_f32 v131, v131
  v_cvt_pk_bf16_f32 v32, v128, v129
  v_add_u32 v12, s5, v8
  s_add_u32 s10, s5, 8704
  v_mfma_f32_32x32x16_bf16 v[144:159], a[72:75], v[168:171], v[144:159]
  v_exp_f32 v132, v132
  v_exp_f32 v133, v133
  v_cvt_pk_bf16_f32 v33, v130, v131
  v_add_u32 v13, s5, v9
  s_cmp_lt_u32 s10, 156672
  v_mfma_f32_32x32x16_bf16 v[144:159], a[76:79], v[172:175], v[144:159]
  v_exp_f32 v134, v134
  v_exp_f32 v135, v135
  v_cvt_pk_bf16_f32 v34, v132, v133
  s_cselect_b32 s10, s10, 0
  v_mov_b32 v21, s6
  v_mfma_f32_32x32x16_bf16 v[144:159], a[80:83], v[176:179], v[144:159]
  v_exp_f32 v136, v136
  v_exp_f32 v137, v137
  v_cvt_pk_bf16_f32 v35, v134, v135
  v_add_u32 v14, s10, v10
  v_mfma_f32_32x32x16_bf16 v[144:159], a[84:87], v[180:183], v[144:159]
  v_exp_f32 v138, v138
  v_exp_f32 v139, v139
  v_cvt_pk_bf16_f32 v36, v136, v137
  s_add_u32 s5, s10, 8704
  v_mfma_f32_32x32x16_bf16 v[144:159], a[88:91], v[184:187], v[144:159]
  v_exp_f32 v140, v140
  v_exp_f32 v141, v141
  v_cvt_pk_bf16_f32 v37, v138, v139
  s_cmp_lt_u32 s5, 156672
  v_mfma_f32_32x32x16_bf16 v[144:159], a[92:95], v[188:191], v[144:159]
  v_exp_f32 v142, v142
  v_exp_f32 v143, v143
  v_cvt_pk_bf16_f32 v38, v140, v141
  v_cvt_pk_bf16_f32 v39, v142, v143
  s_cselect_b32 s5, s5, 0
  s_waitcnt lgkmcnt(0)
  v_mfma_f32_32x32x16_bf16 v[64:79], a[96:99], v[32:35], v[64:79]
  ds_write_b32 v23, v21
  ds_read_b128 a[64:67], v12 offset:0
  ds_read_b128 a[68:71], v13 offset:0
  ds_read_b128 a[72:75], v12 offset:64
  v_add_f32 v17, v17, v128
  v_add_f32 v18, v18, v129
  v_mfma_f32_32x32x16_bf16 v[80:95], a[100:103], v[32:35], v[80:95]
  ds_read_b128 a[76:79], v13 offset:64
  ds_read_b128 a[80:83], v12 offset:128
  ds_read_b128 a[84:87], v13 offset:128
  v_add_f32 v17, v17, v130
  v_add_f32 v18, v18, v131
  s_add_u32 s6, s6, 2
  v_mfma_f32_32x32x16_bf16 v[96:111], a[104:107], v[32:35], v[96:111]
  ds_read_b128 a[88:91], v12 offset:192
  ds_read_b128 a[92:95], v13 offset:192
  ds_read_b64_tr_b16 a[128:129], v14 offset:0
  v_add_f32 v17, v17, v132
  v_add_f32 v18, v18, v133
  v_mfma_f32_32x32x16_bf16 v[112:127], a[108:111], v[32:35], v[112:127]
  ds_read_b64_tr_b16 a[130:131], v14 offset:512
  ds_read_b64_tr_b16 a[132:133], v14 offset:64
  ds_read_b64_tr_b16 a[134:135], v14 offset:576
  v_add_f32 v17, v17, v134
  v_add_f32 v18, v18, v135
  v_max3_f32 v19, v144, v145, v146
  v_mfma_f32_32x32x16_bf16 v[64:79], a[112:115], v[36:39], v[64:79]
  ds_read_b64_tr_b16 a[136:137], v14 offset:128
  ds_read_b64_tr_b16 a[138:139], v14 offset:640
  ds_read_b64_tr_b16 a[140:141], v14 offset:192
  v_add_f32 v17, v17, v136
  v_add_f32 v18, v18, v137
  v_max3_f32 v19, v19, v147, v148
  v_mfma_f32_32x32x16_bf16 v[80:95], a[116:119], v[36:39], v[80:95]
  ds_read_b64_tr_b16 a[142:143], v14 offset:704
  ds_read_b64_tr_b16 a[144:145], v14 offset:4352
  ds_read_b64_tr_b16 a[146:147], v14 offset:4864
  v_add_f32 v17, v17, v138
  v_add_f32 v18, v18, v139
  v_max3_f32 v19, v19, v149, v150
  v_mfma_f32_32x32x16_bf16 v[96:111], a[120:123], v[36:39], v[96:111]
  ds_read_b64_tr_b16 a[148:149], v14 offset:4416
  ds_read_b64_tr_b16 a[150:151], v14 offset:4928
  ds_read_b64_tr_b16 a[152:153], v14 offset:4480
  v_add_f32 v17, v17, v140
  v_add_f32 v18, v18, v141
  v_max3_f32 v19, v19, v151, v152
  v_max3_f32 v19, v19, v153, v154
  v_mfma_f32_32x32x16_bf16 v[112:127], a[124:127], v[36:39], v[112:127]
  ds_read_b64_tr_b16 a[154:155], v14 offset:4992
  ds_read_b64_tr_b16 a[156:157], v14 offset:4544
  ds_read_b64_tr_b16 a[158:159], v14 offset:5056
  v_add_f32 v17, v17, v142
  v_add_f32 v18, v18, v143
  v_max3_f32 v19, v19, v155, v156
  v_max3_f32 v19, v19, v157, v158
  v_max_f32 v19, v19, v159
  v_cmp_lt_f32 vcc, s8, v19
  s_cbranch_vccnz Lrare_284
Lback_285:
  s_waitcnt lgkmcnt(15)
  v_mfma_f32_32x32x16_bf16 v[128:143], a[64:67], v[160:163], v[48:63]
  v_exp_f32 v144, v144
  v_exp_f32 v145, v145
  s_add_u32 s9, s6, 2
  s_cmp_lt_u32 s4, s9
  s_cbranch_scc1 Llw_slow_286
Llw_back_287:
  v_mfma_f32_32x32x16_bf16 v[128:143], a[68:71], v[164:167], v[128:143]
  v_exp_f32 v146, v146
  v_exp_f32 v147, v147
  v_cvt_pk_bf16_f32 v32, v144, v145
  v_add_u32 v12, s5, v8
  s_add_u32 s10, s5, 8704
  v_mfma_f32_32x32x16_bf16 v[128:143], a[72:75], v[168:171], v[128:143]
  v_exp_f32 v148, v148
  v_exp_f32 v149, v149
  v_cvt_pk_bf16_f32 v33, v146, v147
  v_add_u32 v13, s5, v9
  s_cmp_lt_u32 s10, 156672
  v_mfma_f32_32x32x16_bf16 v[128:143], a[76:79], v[172:175], v[128:143]
  v_exp_f32 v150, v150
  v_exp_f32 v151, v151
  v_cvt_pk_bf16_f32 v34, v148, v149
  s_cselect_b32 s10, s10, 0
  v_mov_b32 v21, s6
  v_mfma_f32_32x32x16_bf16 v[128:143], a[80:83], v[176:179], v[128:143]
  v_exp_f32 v152, v152
  v_exp_f32 v153, v153
  v_cvt_pk_bf16_f32 v35, v150, v151
  v_add_u32 v14, s10, v10
  v_mfma_f32_32x32x16_bf16 v[128:143], a[84:87], v[180:183], v[128:143]
  v_exp_f32 v154, v154
  v_exp_f32 v155, v155
  v_cvt_pk_bf16_f32 v36, v152, v153
  s_add_u32 s5, s10, 8704
  v_mfma_f32_32x32x16_bf16 v[128:143], a[88:91], v[184:187], v[128:143]
  v_exp_f32 v156, v156
  v_exp_f32 v157, v157
  v_cvt_pk_bf16_f32 v37, v154, v155
  s_cmp_lt_u32 s5, 156672
  v_mfma_f32_32x32x16_bf16 v[128:143], a[92:95], v[188:191], v[128:143]
  v_exp_f32 v158, v158
  v_exp_f32 v159, v159
  v_cvt_pk_bf16_f32 v38, v156, v157
  v_cvt_pk_bf16_f32 v39, v158, v159
  s_cselect_b32 s5, s5, 0
  s_waitcnt lgkmcnt(0)
  v_mfma_f32_32x32x16_bf16 v[64:79], a[128:131], v[32:35], v[64:79]
  ds_write_b32 v23, v21
  ds_read_b128 a[64:67], v12 offset:0
  ds_read_b128 a[68:71], v13 offset:0
  ds_read_b128 a[72:75], v12 offset:64
  v_add_f32 v17, v17, v144
  v_add_f32 v18, v18, v145
  v_mfma_f32_32x32x16_bf16 v[80:95], a[132:135], v[32:35], v[80:95]
  ds_read_b128 a[76:79], v13 offset:64
  ds_read_b128 a[80:83], v12 offset:128
  ds_read_b128 a[84:87], v13 offset:128
  v_add_f32 v17, v17, v146
  v_add_f32 v18, v18, v147
  s_add_u32 s6, s6, 2
  v_mfma_f32_32x32x16_bf16 v[96:111], a[136:139], v[32:35], v[96:111]
  ds_read_b128 a[88:91], v12 offset:192
  ds_read_b128 a[92:95], v13 offset:192
  ds_read_b64_tr_b16 a[96:97], v14 offset:0
  v_add_f32 v17, v17, v148
  v_add_f32 v18, v18, v149
  v_mfma_f32_32x32x16_bf16 v[112:127], a[140:143], v[32:35], v[112:127]
  ds_read_b64_tr_b16 a[98:99], v14 offset:512
  ds_read_b64_tr_b16 a[100:101], v14 offset:64
  ds_read_b64_tr_b16 a[102:103], v14 offset:576
  v_add_f32 v17, v17, v150
  v_add_f32 v18, v18, v151
  v_max3_f32 v19, v128, v129, v130
  v_mfma_f32_32x32x16_bf16 v[64:79], a[144:147], v[36:39], v[64:79]
  ds_read_b64_tr_b16 a[104:105], v14 offset:128
  ds_read_b64_tr_b16 a[106:107], v14 offset:640
  ds_read_b64_tr_b16 a[108:109], v14 offset:192
  v_add_f32 v17, v17, v152
  v_add_f32 v18, v18, v153
  v_max3_f32 v19, v19, v131, v132
  v_mfma_f32_32x32x16_bf16 v[80:95], a[148:151], v[36:39], v[80:95]
  ds_read_b64_tr_b16 a[110:111], v14 offset:704
  ds_read_b64_tr_b16 a[112:113], v14 offset:4352
  ds_read_b64_tr_b16 a[114:115], v14 offset:4864
  v_add_f32 v17, v17, v154
  v_add_f32 v18, v18, v155
  v_max3_f32 v19, v19, v133, v134
  v_mfma_f32_32x32x16_bf16 v[96:111], a[152:155], v[36:39], v[96:111]
  ds_read_b64_tr_b16 a[116:117], v14 offset:4416
  ds_read_b64_tr_b16 a[118:119], v14 offset:4928
  ds_read_b64_tr_b16 a[120:121], v14 offset:4480
  v_add_f32 v17, v17, v156
  v_add_f32 v18, v18, v157
  v_max3_f32 v19, v19, v135, v136
  v_max3_f32 v19, v19, v137, v138
  v_mfma_f32_32x32x16_bf16 v[112:127], a[156:159], v[36:39], v[112:127]
  ds_read_b64_tr_b16 a[122:123], v14 offset:4992
  ds_read_b64_tr_b16 a[124:125], v14 offset:4544
  ds_read_b64_tr_b16 a[126:127], v14 offset:5056
  v_add_f32 v17, v17, v158
  v_add_f32 v18, v18, v159
  v_max3_f32 v19, v19, v139, v140
  v_max3_f32 v19, v19, v141, v142
  v_max_f32 v19, v19, v143
  v_cmp_lt_f32 vcc, s8, v19
  s_cbranch_vccnz Lrare_288
Lback_289:
  v_mfma_f32_32x32x16_bf16 v[192:207], a[32:35], a[168:171], v[192:207]
  s_add_u32 s9, s6, 2
  s_cmp_lt_u32 s4, s9
  s_cbranch_scc1 Llw_slow_290
Llw_back_291:
  v_add_u32 v14, s5, v11
  v_mfma_f32_32x32x16_bf16 v[208:223], a[36:39], a[168:171], v[208:223]
  ds_read_b64_tr_b16 a[0:1], v14 offset:0
  ds_read_b64_tr_b16 a[2:3], v14 offset:256
  v_mfma_f32_32x32x16_bf16 v[224:239], a[40:43], a[168:171], v[224:239]
  ds_read_b64_tr_b16 a[4:5], v14 offset:64
  ds_read_b64_tr_b16 a[6:7], v14 offset:320
  ds_read_b64_tr_b16 a[8:9], v14 offset:128
  v_mfma_f32_32x32x16_bf16 v[240:255], a[44:47], a[168:171], v[240:255]
  ds_read_b64_tr_b16 a[10:11], v14 offset:384
  ds_read_b64_tr_b16 a[12:13], v14 offset:192
  ds_read_b64_tr_b16 a[14:15], v14 offset:448
  v_mfma_f32_32x32x16_bf16 v[192:207], a[48:51], a[172:175], v[192:207]
  ds_read_b64_tr_b16 a[16:17], v14 offset:4352
  ds_read_b64_tr_b16 a[18:19], v14 offset:4608
  v_mfma_f32_32x32x16_bf16 v[208:223], a[52:55], a[172:175], v[208:223]
  ds_read_b64_tr_b16 a[20:21], v14 offset:4416
  ds_read_b64_tr_b16 a[22:23], v14 offset:4672
  ds_read_b64_tr_b16 a[24:25], v14 offset:4480
  v_mfma_f32_32x32x16_bf16 v[224:239], a[56:59], a[172:175], v[224:239]
  ds_read_b64_tr_b16 a[26:27], v14 offset:4736
  ds_read_b64_tr_b16 a[28:29], v14 offset:4544
  ds_read_b64_tr_b16 a[30:31], v14 offset:4800
  v_mfma_f32_32x32x16_bf16 v[240:255], a[60:63], a[172:175], v[240:255]
  s_add_u32 s5, s5, 8704
  s_cmp_lt_u32 s5, 156672
  s_cselect_b32 s5, s5, 0
  s_add_u32 s6, s6, 1
  v_add_u32 v14, s5, v11
  ds_read_b64_tr_b16 a[224:225], v14 offset:0
  ds_read_b64_tr_b16 a[226:227], v14 offset:256
  ds_read_b64_tr_b16 a[228:229], v14 offset:64
  ds_read_b64_tr_b16 a[230:231], v14 offset:320
  ds_read_b64_tr_b16 a[232:233], v14 offset:128
  ds_read_b64_tr_b16 a[234:235], v14 offset:384
  ds_read_b64_tr_b16 a[236:237], v14 offset:192
  ds_read_b64_tr_b16 a[238:239], v14 offset:448
  ds_read_b64_tr_b16 a[240:241], v14 offset:4352
  ds_read_b64_tr_b16 a[242:243], v14 offset:4608
  ds_read_b64_tr_b16 a[244:245], v14 offset:4416
  ds_read_b64_tr_b16 a[246:247], v14 offset:4672
  ds_read_b64_tr_b16 a[248:249], v14 offset:4480
  ds_read_b64_tr_b16 a[250:251], v14 offset:4736
  ds_read_b64_tr_b16 a[252:253], v14 offset:4544
  ds_read_b64_tr_b16 a[254:255], v14 offset:4800
  s_add_u32 s5, s5, 8704
  s_cmp_lt_u32 s5, 156672
  s_cselect_b32 s5, s5, 0
  s_add_u32 s6, s6, 1
  s_add_u32 s7, s7, 1
  s_bitcmp1_b32 s76, s7
  s_cbranch_scc1 Levstub_292
Levback_293:
  s_waitcnt lgkmcnt(0)
  s_add_u32 s9, s6, 1
  s_cmp_lt_u32 s4, s9
  s_cbranch_scc1 Llw_slow_294
Llw_back_295:
  v_add_u32 v14, s5, v10
  v_mfma_f32_32x32x16_bf16 v[144:159], a[64:67], v[160:163], v[48:63]
  v_exp_f32 v128, v128
  v_exp_f32 v129, v129
  ds_read_b64_tr_b16 a[128:129], v14 offset:0
  ds_read_b64_tr_b16 a[130:131], v14 offset:512
  v_mfma_f32_32x32x16_bf16 v[144:159], a[68:71], v[164:167], v[144:159]
  v_exp_f32 v130, v130
  v_exp_f32 v131, v131
  v_add_f32 v17, v17, v128
  v_add_f32 v18, v18, v129
  v_cvt_pk_bf16_f32 v32, v128, v129
  ds_read_b64_tr_b16 a[132:133], v14 offset:64
  ds_read_b64_tr_b16 a[134:135], v14 offset:576
  v_mfma_f32_32x32x16_bf16 v[144:159], a[72:75], v[168:171], v[144:159]
  v_exp_f32 v132, v132
  v_exp_f32 v133, v133
  v_add_f32 v17, v17, v130
  v_add_f32 v18, v18, v131
  v_cvt_pk_bf16_f32 v33, v130, v131
  ds_read_b64_tr_b16 a[136:137], v14 offset:128
  ds_read_b64_tr_b16 a[138:139], v14 offset:640
  v_mfma_f32_32x32x16_bf16 v[144:159], a[76:79], v[172:175], v[144:159]
  v_exp_f32 v134, v134
  v_exp_f32 v135, v135
  v_add_f32 v17, v17, v132
  v_add_f32 v18, v18, v133
  v_cvt_pk_bf16_f32 v34, v132, v133
  ds_read_b64_tr_b16 a[140:141], v14 offset:192
  ds_read_b64_tr_b16 a[142:143], v14 offset:704
  v_mfma_f32_32x32x16_bf16 v[144:159], a[80:83], v[176:179], v[144:159]
  v_exp_f32 v136, v136
  v_exp_f32 v137, v137
  v_add_f32 v17, v17, v134
  v_add_f32 v18, v18, v135
  v_cvt_pk_bf16_f32 v35, v134, v135
  ds_read_b64_tr_b16 a[144:145], v14 offset:4352
  ds_read_b64_tr_b16 a[146:147], v14 offset:4864
  v_mfma_f32_32x32x16_bf16 v[144:159], a[84:87], v[180:183], v[144:159]
  v_exp_f32 v138, v138
  v_exp_f32 v139, v139
  v_add_f32 v17, v17, v136
  v_add_f32 v18, v18, v137
  v_cvt_pk_bf16_f32 v36, v136, v137
  ds_read_b64_tr_b16 a[148:149], v14 offset:4416
  ds_read_b64_tr_b16 a[150:151], v14 offset:4928
  v_mfma_f32_32x32x16_bf16 v[144:159], a[88:91], v[184:187], v[144:159]
  v_exp_f32 v140, v140
  v_exp_f32 v141, v141
  v_add_f32 v17, v17, v138
  v_add_f32 v18, v18, v139
  v_cvt_pk_bf16_f32 v37, v138, v139
  ds_read_b64_tr_b16 a[152:153], v14 offset:4480
  ds_read_b64_tr_b16 a[154:155], v14 offset:4992
  v_mfma_f32_32x32x16_bf16 v[144:159], a[92:95], v[188:191], v[144:159]
  v_exp_f32 v142, v142
  v_exp_f32 v143, v143
  v_add_f32 v17, v17, v140
  v_add_f32 v18, v18, v141
  v_cvt_pk_bf16_f32 v38, v140, v141
  ds_read_b64_tr_b16 a[156:157], v14 offset:4544
  ds_read_b64_tr_b16 a[158:159], v14 offset:5056
  v_add_f32 v17, v17, v142
  v_add_f32 v18, v18, v143
  v_cvt_pk_bf16_f32 v39, v142, v143
  s_waitcnt lgkmcnt(15)
  v_mfma_f32_32x32x16_bf16 v[64:79], a[96:99], v[32:35], v[64:79]
  v_mfma_f32_32x32x16_bf16 v[80:95], a[100:103], v[32:35], v[80:95]
  v_mfma_f32_32x32x16_bf16 v[96:111], a[104:107], v[32:35], v[96:111]
  v_mfma_f32_32x32x16_bf16 v[112:127], a[108:111], v[32:35], v[112:127]
  v_max3_f32 v19, v144, v145, v146
  v_max3_f32 v19, v19, v147, v148
  v_mfma_f32_32x32x16_bf16 v[64:79], a[112:115], v[36:39], v[64:79]
  v_max3_f32 v19, v19, v149, v150
  v_max3_f32 v19, v19, v151, v152
  s_add_u32 s6, s6, 1
  v_mfma_f32_32x32x16_bf16 v[80:95], a[116:119], v[36:39], v[80:95]
  v_max3_f32 v19, v19, v153, v154
  v_max3_f32 v19, v19, v155, v156
  s_add_u32 s5, s5, 8704
  s_cmp_lt_u32 s5, 156672
  v_mfma_f32_32x32x16_bf16 v[96:111], a[120:123], v[36:39], v[96:111]
  v_max3_f32 v19, v19, v157, v158
  v_max_f32 v19, v19, v159
  s_cselect_b32 s5, s5, 0
  v_mfma_f32_32x32x16_bf16 v[112:127], a[124:127], v[36:39], v[112:127]
  v_cmp_lt_f32 vcc, s8, v19
  s_cbranch_vccnz Lrare_296
Lback_297:
  v_mfma_f32_32x32x16_bf16 v[192:207], a[0:3], a[176:179], v[192:207]
  v_mfma_f32_32x32x16_bf16 v[208:223], a[4:7], a[176:179], v[208:223]
  v_mfma_f32_32x32x16_bf16 v[224:239], a[8:11], a[176:179], v[224:239]
  v_mfma_f32_32x32x16_bf16 v[240:255], a[12:15], a[176:179], v[240:255]
  v_mfma_f32_32x32x16_bf16 v[192:207], a[16:19], a[180:183], v[192:207]
  v_mfma_f32_32x32x16_bf16 v[208:223], a[20:23], a[180:183], v[208:223]
  v_mfma_f32_32x32x16_bf16 v[224:239], a[24:27], a[180:183], v[224:239]
  v_mfma_f32_32x32x16_bf16 v[240:255], a[28:31], a[180:183], v[240:255]
  s_waitcnt lgkmcnt(0)
  v_exp_f32 v144, v144
  v_exp_f32 v145, v145
  v_exp_f32 v146, v146
  v_exp_f32 v147, v147
  v_add_f32 v17, v17, v144
  v_add_f32 v18, v18, v145
  v_cvt_pk_bf16_f32 v32, v144, v145
  v_exp_f32 v148, v148
  v_exp_f32 v149, v149
  v_add_f32 v17, v17, v146
  v_add_f32 v18, v18, v147
  v_cvt_pk_bf16_f32 v33, v146, v147
  v_exp_f32 v150, v150
  v_exp_f32 v151, v151
  v_add_f32 v17, v17, v148
  v_add_f32 v18, v18, v149
  v_cvt_pk_bf16_f32 v34, v148, v149
  v_exp_f32 v152, v152
  v_exp_f32 v153, v153
  v_add_f32 v17, v17, v150
  v_add_f32 v18, v18, v151
  v_cvt_pk_bf16_f32 v35, v150, v151
  v_exp_f32 v154, v154
  v_exp_f32 v155, v155
  v_add_f32 v17, v17, v152
  v_add_f32 v18, v18, v153
  v_cvt_pk_bf16_f32 v36, v152, v153
  v_exp_f32 v156, v156
  v_exp_f32 v157, v157
  v_add_f32 v17, v17, v154
  v_add_f32 v18, v18, v155
  v_cvt_pk_bf16_f32 v37, v154, v155
  v_exp_f32 v158, v158
  v_exp_f32 v159, v159
  v_add_f32 v17, v17, v156
  v_add_f32 v18, v18, v157
  v_cvt_pk_bf16_f32 v38, v156, v157
  v_add_f32 v17, v17, v158
  v_add_f32 v18, v18, v159
  v_cvt_pk_bf16_f32 v39, v158, v159
  v_mov_b32 v21, s6
  ds_write_b32 v23, v21
  v_mfma_f32_32x32x16_bf16 v[64:79], a[128:131], v[32:35], v[64:79]
  v_mfma_f32_32x32x16_bf16 v[80:95], a[132:135], v[32:35], v[80:95]
  v_mfma_f32_32x32x16_bf16 v[96:111], a[136:139], v[32:35], v[96:111]
  v_mfma_f32_32x32x16_bf16 v[112:127], a[140:143], v[32:35], v[112:127]
  v_mfma_f32_32x32x16_bf16 v[64:79], a[144:147], v[36:39], v[64:79]
  v_mfma_f32_32x32x16_bf16 v[80:95], a[148:151], v[36:39], v[80:95]
  v_mfma_f32_32x32x16_bf16 v[96:111], a[152:155], v[36:39], v[96:111]
  v_mfma_f32_32x32x16_bf16 v[112:127], a[156:159], v[36:39], v[112:127]
  v_mfma_f32_32x32x16_bf16 v[192:207], a[224:227], a[184:187], v[192:207]
  v_mfma_f32_32x32x16_bf16 v[208:223], a[228:231], a[184:187], v[208:223]
  v_mfma_f32_32x32x16_bf16 v[224:239], a[232:235], a[184:187], v[224:239]
  v_mfma_f32_32x32x16_bf16 v[240:255], a[236:239], a[184:187], v[240:255]
  v_mfma_f32_32x32x16_bf16 v[192:207], a[240:243], a[188:191], v[192:207]
  v_mfma_f32_32x32x16_bf16 v[208:223], a[244:247], a[188:191], v[208:223]
  v_mfma_f32_32x32x16_bf16 v[224:239], a[248:251], a[188:191], v[224:239]
  v_mfma_f32_32x32x16_bf16 v[240:255], a[252:255], a[188:191], v[240:255]
  v_add_f32 v17, v17, v18
  v_mov_b32 v18, v17
  s_nop 1
  v_permlane32_swap_b32 v17, v18
  s_nop 1
  v_add_f32 v17, v17, v18
  v_rcp_f32 v20, v17
  s_lshl_b32 s29, s24, 2
  s_add_u32 s29, s29, s21
  s_add_u32 s29, s29, 256
  s_mul_i32 s29, s29, 24576
  s_lshl_b32 s30, s3, 13
  s_add_u32 s29, s29, s30
  s_add_u32 s12, s29, 1048576
  s_add_u32 s13, s12, 4096
  s_nop 3
  v_mul_f32 v64, v64, v20
  v_mul_f32 v65, v65, v20
  v_cvt_pk_bf16_f32 v128, v64, v65
  v_mul_f32 v66, v66, v20
  v_mul_f32 v67, v67, v20
  v_cvt_pk_bf16_f32 v129, v66, v67
  v_mul_f32 v68, v68, v20
  v_mul_f32 v69, v69, v20
  v_cvt_pk_bf16_f32 v130, v68, v69
  v_mul_f32 v70, v70, v20
  v_mul_f32 v71, v71, v20
  v_cvt_pk_bf16_f32 v131, v70, v71
  buffer_store_dwordx4 v[128:131], v15, s[64:67], s12 offen offset:0 sc1
  v_mul_f32 v72, v72, v20
  v_mul_f32 v73, v73, v20
  v_cvt_pk_bf16_f32 v132, v72, v73
  v_mul_f32 v74, v74, v20
  v_mul_f32 v75, v75, v20
  v_cvt_pk_bf16_f32 v133, v74, v75
  v_mul_f32 v76, v76, v20
  v_mul_f32 v77, v77, v20
  v_cvt_pk_bf16_f32 v134, v76, v77
  v_mul_f32 v78, v78, v20
  v_mul_f32 v79, v79, v20
  v_cvt_pk_bf16_f32 v135, v78, v79
  buffer_store_dwordx4 v[132:135], v15, s[64:67], s12 offen offset:1024 sc1
  v_mul_f32 v80, v80, v20
  v_mul_f32 v81, v81, v20
  v_cvt_pk_bf16_f32 v136, v80, v81
  v_mul_f32 v82, v82, v20
  v_mul_f32 v83, v83, v20
  v_cvt_pk_bf16_f32 v137, v82, v83
  v_mul_f32 v84, v84, v20
  v_mul_f32 v85, v85, v20
  v_cvt_pk_bf16_f32 v138, v84, v85
  v_mul_f32 v86, v86, v20
  v_mul_f32 v87, v87, v20
  v_cvt_pk_bf16_f32 v139, v86, v87
  buffer_store_dwordx4 v[136:139], v15, s[64:67], s12 offen offset:2048 sc1
  v_mul_f32 v88, v88, v20
  v_mul_f32 v89, v89, v20
  v_cvt_pk_bf16_f32 v140, v88, v89
  v_mul_f32 v90, v90, v20
  v_mul_f32 v91, v91, v20
  v_cvt_pk_bf16_f32 v141, v90, v91
  v_mul_f32 v92, v92, v20
  v_mul_f32 v93, v93, v20
  v_cvt_pk_bf16_f32 v142, v92, v93
  v_mul_f32 v94, v94, v20
  v_mul_f32 v95, v95, v20
  v_cvt_pk_bf16_f32 v143, v94, v95
  buffer_store_dwordx4 v[140:143], v15, s[64:67], s12 offen offset:3072 sc1
  v_mul_f32 v96, v96, v20
  v_mul_f32 v97, v97, v20
  v_cvt_pk_bf16_f32 v144, v96, v97
  v_mul_f32 v98, v98, v20
  v_mul_f32 v99, v99, v20
  v_cvt_pk_bf16_f32 v145, v98, v99
  v_mul_f32 v100, v100, v20
  v_mul_f32 v101, v101, v20
  v_cvt_pk_bf16_f32 v146, v100, v101
  v_mul_f32 v102, v102, v20
  v_mul_f32 v103, v103, v20
  v_cvt_pk_bf16_f32 v147, v102, v103
  buffer_store_dwordx4 v[144:147], v15, s[64:67], s13 offen offset:0 sc1
  v_mul_f32 v104, v104, v20
  v_mul_f32 v105, v105, v20
  v_cvt_pk_bf16_f32 v148, v104, v105
  v_mul_f32 v106, v106, v20
  v_mul_f32 v107, v107, v20
  v_cvt_pk_bf16_f32 v149, v106, v107
  v_mul_f32 v108, v108, v20
  v_mul_f32 v109, v109, v20
  v_cvt_pk_bf16_f32 v150, v108, v109
  v_mul_f32 v110, v110, v20
  v_mul_f32 v111, v111, v20
  v_cvt_pk_bf16_f32 v151, v110, v111
  buffer_store_dwordx4 v[148:151], v15, s[64:67], s13 offen offset:1024 sc1
  v_mul_f32 v112, v112, v20
  v_mul_f32 v113, v113, v20
  v_cvt_pk_bf16_f32 v152, v112, v113
  v_mul_f32 v114, v114, v20
  v_mul_f32 v115, v115, v20
  v_cvt_pk_bf16_f32 v153, v114, v115
  v_mul_f32 v116, v116, v20
  v_mul_f32 v117, v117, v20
  v_cvt_pk_bf16_f32 v154, v116, v117
  v_mul_f32 v118, v118, v20
  v_mul_f32 v119, v119, v20
  v_cvt_pk_bf16_f32 v155, v118, v119
  buffer_store_dwordx4 v[152:155], v15, s[64:67], s13 offen offset:2048 sc1
  v_mul_f32 v120, v120, v20
  v_mul_f32 v121, v121, v20
  v_cvt_pk_bf16_f32 v156, v120, v121
  v_mul_f32 v122, v122, v20
  v_mul_f32 v123, v123, v20
  v_cvt_pk_bf16_f32 v157, v122, v123
  v_mul_f32 v124, v124, v20
  v_mul_f32 v125, v125, v20
  v_cvt_pk_bf16_f32 v158, v124, v125
  v_mul_f32 v126, v126, v20
  v_mul_f32 v127, v127, v20
  v_cvt_pk_bf16_f32 v159, v126, v127
  buffer_store_dwordx4 v[156:159], v15, s[64:67], s13 offen offset:3072 sc1
  s_add_u32 s15, s22, 0
  s_lshl_b32 s15, s15, 2
  s_add_u32 s15, s15, s21
  s_lshl_b32 s15, s15, 3
  s_add_u32 s15, s15, s20
  s_mul_i32 s15, s15, 24576
  s_lshl_b32 s28, s3, 13
  s_add_u32 s15, s15, s28
  s_add_u32 s15, s15, 16777216
  s_add_u32 s29, s15, 4096
  s_nop 3
  v_cvt_pk_bf16_f32 v192, v192, v193
  v_cvt_pk_bf16_f32 v193, v194, v195
  v_cvt_pk_bf16_f32 v194, v196, v197
  v_cvt_pk_bf16_f32 v195, v198, v199
  buffer_store_dwordx4 v[192:195], v15, s[64:67], s15 offen offset:0 sc1
  v_cvt_pk_bf16_f32 v196, v200, v201
  v_cvt_pk_bf16_f32 v197, v202, v203
  v_cvt_pk_bf16_f32 v198, v204, v205
  v_cvt_pk_bf16_f32 v199, v206, v207
  buffer_store_dwordx4 v[196:199], v15, s[64:67], s15 offen offset:1024 sc1
  v_cvt_pk_bf16_f32 v200, v208, v209
  v_cvt_pk_bf16_f32 v201, v210, v211
  v_cvt_pk_bf16_f32 v202, v212, v213
  v_cvt_pk_bf16_f32 v203, v214, v215
  buffer_store_dwordx4 v[200:203], v15, s[64:67], s15 offen offset:2048 sc1
  v_cvt_pk_bf16_f32 v204, v216, v217
  v_cvt_pk_bf16_f32 v205, v218, v219
  v_cvt_pk_bf16_f32 v206, v220, v221
  v_cvt_pk_bf16_f32 v207, v222, v223
  buffer_store_dwordx4 v[204:207], v15, s[64:67], s15 offen offset:3072 sc1
  v_cvt_pk_bf16_f32 v208, v224, v225
  v_cvt_pk_bf16_f32 v209, v226, v227
  v_cvt_pk_bf16_f32 v210, v228, v229
  v_cvt_pk_bf16_f32 v211, v230, v231
  buffer_store_dwordx4 v[208:211], v15, s[64:67], s29 offen offset:0 sc1
  v_cvt_pk_bf16_f32 v212, v232, v233
  v_cvt_pk_bf16_f32 v213, v234, v235
  v_cvt_pk_bf16_f32 v214, v236, v237
  v_cvt_pk_bf16_f32 v215, v238, v239
  buffer_store_dwordx4 v[212:215], v15, s[64:67], s29 offen offset:1024 sc1
  v_cvt_pk_bf16_f32 v216, v240, v241
  v_cvt_pk_bf16_f32 v217, v242, v243
  v_cvt_pk_bf16_f32 v218, v244, v245
  v_cvt_pk_bf16_f32 v219, v246, v247
  buffer_store_dwordx4 v[216:219], v15, s[64:67], s29 offen offset:2048 sc1
  v_cvt_pk_bf16_f32 v220, v248, v249
  v_cvt_pk_bf16_f32 v221, v250, v251
  v_cvt_pk_bf16_f32 v222, v252, v253
  v_cvt_pk_bf16_f32 v223, v254, v255
  buffer_store_dwordx4 v[220:223], v15, s[64:67], s29 offen offset:3072 sc1
  s_add_u32 s9, s6, 1
  s_cmp_lt_u32 s4, s9
  s_cbranch_scc1 Llw_slow_298
Llw_back_299:
  v_add_u32 v14, s5, v11
  ds_read_b64_tr_b16 a[0:1], v14 offset:0
  ds_read_b64_tr_b16 a[2:3], v14 offset:256
  ds_read_b64_tr_b16 a[4:5], v14 offset:64
  ds_read_b64_tr_b16 a[6:7], v14 offset:320
  ds_read_b64_tr_b16 a[8:9], v14 offset:128
  ds_read_b64_tr_b16 a[10:11], v14 offset:384
  ds_read_b64_tr_b16 a[12:13], v14 offset:192
  ds_read_b64_tr_b16 a[14:15], v14 offset:448
  ds_read_b64_tr_b16 a[16:17], v14 offset:4352
  ds_read_b64_tr_b16 a[18:19], v14 offset:4608
  ds_read_b64_tr_b16 a[20:21], v14 offset:4416
  ds_read_b64_tr_b16 a[22:23], v14 offset:4672
  ds_read_b64_tr_b16 a[24:25], v14 offset:4480
  ds_read_b64_tr_b16 a[26:27], v14 offset:4736
  ds_read_b64_tr_b16 a[28:29], v14 offset:4544
  ds_read_b64_tr_b16 a[30:31], v14 offset:4800
  s_add_u32 s6, s6, 1
  s_add_u32 s5, s5, 8704
  s_sub_u32 s28, s5, s72
  s_cmp_lt_u32 s5, s72
  s_cselect_b32 s5, s5, s28
  s_waitcnt lgkmcnt(0)
  v_mfma_f32_32x32x16_bf16 v[64:79], a[0:3], v[128:131], 0
  s_add_u32 s9, s6, 1
  s_cmp_lt_u32 s4, s9
  s_cbranch_scc1 Llw_slow_300
Llw_back_301:
  v_add_u32 v14, s5, v11
  ds_read_b64_tr_b16 a[32:33], v14 offset:0
  ds_read_b64_tr_b16 a[34:35], v14 offset:256
  v_mfma_f32_32x32x16_bf16 v[80:95], a[4:7], v[128:131], 0
  ds_read_b64_tr_b16 a[36:37], v14 offset:64
  ds_read_b64_tr_b16 a[38:39], v14 offset:320
  s_add_u32 s6, s6, 1
  s_add_u32 s5, s5, 8704
  v_mfma_f32_32x32x16_bf16 v[96:111], a[8:11], v[128:131], 0
  ds_read_b64_tr_b16 a[40:41], v14 offset:128
  ds_read_b64_tr_b16 a[42:43], v14 offset:384
  s_sub_u32 s28, s5, s72
  s_cmp_lt_u32 s5, s72
  v_mfma_f32_32x32x16_bf16 v[112:127], a[12:15], v[128:131], 0
  ds_read_b64_tr_b16 a[44:45], v14 offset:192
  ds_read_b64_tr_b16 a[46:47], v14 offset:448
  s_cselect_b32 s5, s5, s28
  v_mfma_f32_32x32x16_bf16 v[64:79], a[16:19], v[132:135], v[64:79]
  ds_read_b64_tr_b16 a[48:49], v14 offset:4352
  ds_read_b64_tr_b16 a[50:51], v14 offset:4608
  v_mfma_f32_32x32x16_bf16 v[80:95], a[20:23], v[132:135], v[80:95]
  ds_read_b64_tr_b16 a[52:53], v14 offset:4416
  ds_read_b64_tr_b16 a[54:55], v14 offset:4672
  v_mfma_f32_32x32x16_bf16 v[96:111], a[24:27], v[132:135], v[96:111]
  ds_read_b64_tr_b16 a[56:57], v14 offset:4480
  ds_read_b64_tr_b16 a[58:59], v14 offset:4736
  v_mfma_f32_32x32x16_bf16 v[112:127], a[28:31], v[132:135], v[112:127]
  ds_read_b64_tr_b16 a[60:61], v14 offset:4544
  ds_read_b64_tr_b16 a[62:63], v14 offset:4800
  s_waitcnt lgkmcnt(12)
  v_mfma_f32_32x32x16_bf16 v[64:79], a[32:35], v[136:139], v[64:79]
  s_add_u32 s9, s6, 1
  s_cmp_lt_u32 s4, s9
  s_cbranch_scc1 Llw_slow_302
Llw_back_303:
  v_add_u32 v14, s5, v11
  ds_read_b64_tr_b16 a[0:1], v14 offset:0
  ds_read_b64_tr_b16 a[2:3], v14 offset:256
  v_mfma_f32_32x32x16_bf16 v[80:95], a[36:39], v[136:139], v[80:95]
  ds_read_b64_tr_b16 a[4:5], v14 offset:64
  ds_read_b64_tr_b16 a[6:7], v14 offset:320
  s_add_u32 s6, s6, 1
  s_add_u32 s5, s5, 8704
  s_waitcnt lgkmcnt(12)
  v_mfma_f32_32x32x16_bf16 v[96:111], a[40:43], v[136:139], v[96:111]
  ds_read_b64_tr_b16 a[8:9], v14 offset:128
  ds_read_b64_tr_b16 a[10:11], v14 offset:384
  s_sub_u32 s28, s5, s72
  s_cmp_lt_u32 s5, s72
  v_mfma_f32_32x32x16_bf16 v[112:127], a[44:47], v[136:139], v[112:127]
  ds_read_b64_tr_b16 a[12:13], v14 offset:192
  ds_read_b64_tr_b16 a[14:15], v14 offset:448
  s_cselect_b32 s5, s5, s28
  s_waitcnt lgkmcnt(12)
  v_mfma_f32_32x32x16_bf16 v[64:79], a[48:51], v[140:143], v[64:79]
  ds_read_b64_tr_b16 a[16:17], v14 offset:4352
  ds_read_b64_tr_b16 a[18:19], v14 offset:4608
  v_mfma_f32_32x32x16_bf16 v[80:95], a[52:55], v[140:143], v[80:95]
  ds_read_b64_tr_b16 a[20:21], v14 offset:4416
  ds_read_b64_tr_b16 a[22:23], v14 offset:4672
  s_waitcnt lgkmcnt(12)
  v_mfma_f32_32x32x16_bf16 v[96:111], a[56:59], v[140:143], v[96:111]
  ds_read_b64_tr_b16 a[24:25], v14 offset:4480
  ds_read_b64_tr_b16 a[26:27], v14 offset:4736
  v_mfma_f32_32x32x16_bf16 v[112:127], a[60:63], v[140:143], v[112:127]
  ds_read_b64_tr_b16 a[28:29], v14 offset:4544
  ds_read_b64_tr_b16 a[30:31], v14 offset:4800
  s_waitcnt lgkmcnt(12)
  v_mfma_f32_32x32x16_bf16 v[64:79], a[0:3], v[144:147], v[64:79]
  s_add_u32 s9, s6, 1
  s_cmp_lt_u32 s4, s9
  s_cbranch_scc1 Llw_slow_304
Llw_back_305:
  v_add_u32 v14, s5, v11
  ds_read_b64_tr_b16 a[32:33], v14 offset:0
  ds_read_b64_tr_b16 a[34:35], v14 offset:256
  v_mfma_f32_32x32x16_bf16 v[80:95], a[4:7], v[144:147], v[80:95]
  ds_read_b64_tr_b16 a[36:37], v14 offset:64
  ds_read_b64_tr_b16 a[38:39], v14 offset:320
  s_add_u32 s6, s6, 1
  s_add_u32 s5, s5, 8704
  s_waitcnt lgkmcnt(12)
  v_mfma_f32_32x32x16_bf16 v[96:111], a[8:11], v[144:147], v[96:111]
  ds_read_b64_tr_b16 a[40:41], v14 offset:128
  ds_read_b64_tr_b16 a[42:43], v14 offset:384
  s_sub_u32 s28, s5, s72
  s_cmp_lt_u32 s5, s72
  v_mfma_f32_32x32x16_bf16 v[112:127], a[12:15], v[144:147], v[112:127]
  ds_read_b64_tr_b16 a[44:45], v14 offset:192
  ds_read_b64_tr_b16 a[46:47], v14 offset:448
  s_cselect_b32 s5, s5, s28
  s_waitcnt lgkmcnt(12)
  v_mfma_f32_32x32x16_bf16 v[64:79], a[16:19], v[148:151], v[64:79]
  ds_read_b64_tr_b16 a[48:49], v14 offset:4352
  ds_read_b64_tr_b16 a[50:51], v14 offset:4608
  v_mfma_f32_32x32x16_bf16 v[80:95], a[20:23], v[148:151], v[80:95]
  ds_read_b64_tr_b16 a[52:53], v14 offset:4416
  ds_read_b64_tr_b16 a[54:55], v14 offset:4672
  s_waitcnt lgkmcnt(12)
  v_mfma_f32_32x32x16_bf16 v[96:111], a[24:27], v[148:151], v[96:111]
  ds_read_b64_tr_b16 a[56:57], v14 offset:4480
  ds_read_b64_tr_b16 a[58:59], v14 offset:4736
  v_mfma_f32_32x32x16_bf16 v[112:127], a[28:31], v[148:151], v[112:127]
  ds_read_b64_tr_b16 a[60:61], v14 offset:4544
  ds_read_b64_tr_b16 a[62:63], v14 offset:4800
  s_waitcnt lgkmcnt(12)
  v_mfma_f32_32x32x16_bf16 v[64:79], a[32:35], v[152:155], v[64:79]
  s_add_u32 s9, s6, 1
  s_cmp_lt_u32 s4, s9
  s_cbranch_scc1 Llw_slow_306
Llw_back_307:
  v_add_u32 v14, s5, v11
  ds_read_b64_tr_b16 a[0:1], v14 offset:0
  ds_read_b64_tr_b16 a[2:3], v14 offset:256
  v_mfma_f32_32x32x16_bf16 v[80:95], a[36:39], v[152:155], v[80:95]
  ds_read_b64_tr_b16 a[4:5], v14 offset:64
  ds_read_b64_tr_b16 a[6:7], v14 offset:320
  s_add_u32 s6, s6, 1
  s_add_u32 s5, s5, 8704
  s_waitcnt lgkmcnt(12)
  v_mfma_f32_32x32x16_bf16 v[96:111], a[40:43], v[152:155], v[96:111]
  ds_read_b64_tr_b16 a[8:9], v14 offset:128
  ds_read_b64_tr_b16 a[10:11], v14 offset:384
  s_sub_u32 s28, s5, s72
  s_cmp_lt_u32 s5, s72
  v_mfma_f32_32x32x16_bf16 v[112:127], a[44:47], v[152:155], v[112:127]
  ds_read_b64_tr_b16 a[12:13], v14 offset:192
  ds_read_b64_tr_b16 a[14:15], v14 offset:448
  s_cselect_b32 s5, s5, s28
  s_waitcnt lgkmcnt(12)
  v_mfma_f32_32x32x16_bf16 v[64:79], a[48:51], v[156:159], v[64:79]
  ds_read_b64_tr_b16 a[16:17], v14 offset:4352
  ds_read_b64_tr_b16 a[18:19], v14 offset:4608
  v_mfma_f32_32x32x16_bf16 v[80:95], a[52:55], v[156:159], v[80:95]
  ds_read_b64_tr_b16 a[20:21], v14 offset:4416
  ds_read_b64_tr_b16 a[22:23], v14 offset:4672
  s_waitcnt lgkmcnt(12)
  v_mfma_f32_32x32x16_bf16 v[96:111], a[56:59], v[156:159], v[96:111]
  ds_read_b64_tr_b16 a[24:25], v14 offset:4480
  ds_read_b64_tr_b16 a[26:27], v14 offset:4736
  v_mfma_f32_32x32x16_bf16 v[112:127], a[60:63], v[156:159], v[112:127]
  ds_read_b64_tr_b16 a[28:29], v14 offset:4544
  ds_read_b64_tr_b16 a[30:31], v14 offset:4800
  s_waitcnt vmcnt(0)
  s_lshl_b32 s14, s24, 2
  s_add_u32 s14, s14, s3
  s_lshl_b32 s14, s14, 7
  s_add_u32 s14, s14, 32768
  s_lshl_b32 s28, s21, 3
  s_add_u32 s14, s14, s28
  v_mov_b32 v2, s16
  v_mov_b32 v3, s17
  v_mov_b32 v1, 0
  s_mov_b64 s[34:35], exec
  s_mov_b64 exec, 1
  buffer_store_dwordx2 v[2:3], v1, s[64:67], s14 offen sc1
  s_mov_b64 exec, s[34:35]
  s_add_u32 s14, s22, 0
  s_lshl_b32 s14, s14, 2
  s_add_u32 s14, s14, s21
  s_lshl_b32 s14, s14, 2
  s_add_u32 s14, s14, s3
  s_lshl_b32 s14, s14, 7
  s_add_u32 s14, s14, 65536
  s_lshl_b32 s28, s20, 3
  s_add_u32 s14, s14, s28
  v_mov_b32 v2, s16
  v_mov_b32 v3, s17
  v_mov_b32 v1, 0
  s_mov_b64 s[34:35], exec
  s_mov_b64 exec, 1
  buffer_store_dwordx2 v[2:3], v1, s[64:67], s14 offen sc1
  s_mov_b64 exec, s[34:35]
  s_lshl_b32 s14, s24, 2
  s_add_u32 s14, s14, s3
  s_lshl_b32 s14, s14, 7
  s_add_u32 s14, s14, 32768
  v_min_u32 v1, 3, v0
  v_lshlrev_b32 v1, 3, v1
Lpoll_308:
  buffer_load_dwordx2 v[2:3], v1, s[64:67], s14 offen sc1
  s_waitcnt vmcnt(0)
  v_cmp_ne_u32 vcc, s16, v2
  v_cmp_ne_u32 s[34:35], s17, v3
  s_sub_u32 s26, s26, 1
  s_cmp_eq_u32 s26, 0
  s_cbranch_scc1 L_end
  s_or_b64 vcc, vcc, s[34:35]
  s_cbranch_scc1 Lpoll_308
  s_lshl_b32 s29, s24, 2
  s_add_u32 s29, s29, 256
  s_mul_i32 s29, s29, 24576
  s_lshl_b32 s30, s3, 13
  s_add_u32 s29, s29, s30
  s_add_u32 s29, s29, 1048576
  s_add_u32 s30, s21, 1
  s_and_b32 s30, s30, 3
  s_mul_i32 s30, s30, 24576
  s_add_u32 s30, s30, s29
  s_add_u32 s31, s30, 4096
  buffer_load_dwordx4 a[64:67], v15, s[64:67], s30 offen offset:0 sc1
  buffer_load_dwordx4 a[68:71], v15, s[64:67], s30 offen offset:1024 sc1
  buffer_load_dwordx4 a[72:75], v15, s[64:67], s30 offen offset:2048 sc1
  buffer_load_dwordx4 a[76:79], v15, s[64:67], s30 offen offset:3072 sc1
  buffer_load_dwordx4 a[80:83], v15, s[64:67], s31 offen offset:0 sc1
  buffer_load_dwordx4 a[84:87], v15, s[64:67], s31 offen offset:1024 sc1
  buffer_load_dwordx4 a[88:91], v15, s[64:67], s31 offen offset:2048 sc1
  buffer_load_dwordx4 a[92:95], v15, s[64:67], s31 offen offset:3072 sc1
  s_add_u32 s30, s21, 2
  s_and_b32 s30, s30, 3
  s_mul_i32 s30, s30, 24576
  s_add_u32 s30, s30, s29
  s_add_u32 s31, s30, 4096
  buffer_load_dwordx4 a[96:99], v15, s[64:67], s30 offen offset:0 sc1
  buffer_load_dwordx4 a[100:103], v15, s[64:67], s30 offen offset:1024 sc1
  buffer_load_dwordx4 a[104:107], v15, s[64:67], s30 offen offset:2048 sc1
  buffer_load_dwordx4 a[108:111], v15, s[64:67], s30 offen offset:3072 sc1
  buffer_load_dwordx4 a[112:115], v15, s[64:67], s31 offen offset:0 sc1
  buffer_load_dwordx4 a[116:119], v15, s[64:67], s31 offen offset:1024 sc1
  buffer_load_dwordx4 a[120:123], v15, s[64:67], s31 offen offset:2048 sc1
  buffer_load_dwordx4 a[124:127], v15, s[64:67], s31 offen offset:3072 sc1
  s_add_u32 s30, s21, 3
  s_and_b32 s30, s30, 3
  s_mul_i32 s30, s30, 24576
  s_add_u32 s30, s30, s29
  s_add_u32 s31, s30, 4096
  buffer_load_dwordx4 a[128:131], v15, s[64:67], s30 offen offset:0 sc1
  buffer_load_dwordx4 a[132:135], v15, s[64:67], s30 offen offset:1024 sc1
  buffer_load_dwordx4 a[136:139], v15, s[64:67], s30 offen offset:2048 sc1
  buffer_load_dwordx4 a[140:143], v15, s[64:67], s30 offen offset:3072 sc1
  buffer_load_dwordx4 a[144:147], v15, s[64:67], s31 offen offset:0 sc1
  buffer_load_dwordx4 a[148:151], v15, s[64:67], s31 offen offset:1024 sc1
  buffer_load_dwordx4 a[152:155], v15, s[64:67], s31 offen offset:2048 sc1
  buffer_load_dwordx4 a[156:159], v15, s[64:67], s31 offen offset:3072 sc1
  s_waitcnt vmcnt(16)
  s_waitcnt lgkmcnt(0)
  v_mfma_f32_32x32x16_bf16 v[64:79], a[0:3], a[64:67], v[64:79]
  s_add_u32 s9, s6, 1
  s_cmp_lt_u32 s4, s9
  s_cbranch_scc1 Llw_slow_309
Llw_back_310:
  v_add_u32 v14, s5, v11
  ds_read_b64_tr_b16 a[32:33], v14 offset:0
  ds_read_b64_tr_b16 a[34:35], v14 offset:256
  v_mfma_f32_32x32x16_bf16 v[80:95], a[4:7], a[64:67], v[80:95]
  ds_read_b64_tr_b16 a[36:37], v14 offset:64
  ds_read_b64_tr_b16 a[38:39], v14 offset:320
  s_add_u32 s6, s6, 1
  s_add_u32 s5, s5, 8704
  v_mfma_f32_32x32x16_bf16 v[96:111], a[8:11], a[64:67], v[96:111]
  ds_read_b64_tr_b16 a[40:41], v14 offset:128
  ds_read_b64_tr_b16 a[42:43], v14 offset:384
  s_sub_u32 s28, s5, s72
  s_cmp_lt_u32 s5, s72
  v_mfma_f32_32x32x16_bf16 v[112:127], a[12:15], a[64:67], v[112:127]
  ds_read_b64_tr_b16 a[44:45], v14 offset:192
  ds_read_b64_tr_b16 a[46:47], v14 offset:448
  s_cselect_b32 s5, s5, s28
  v_mfma_f32_32x32x16_bf16 v[64:79], a[16:19], a[68:71], v[64:79]
  ds_read_b64_tr_b16 a[48:49], v14 offset:4352
  ds_read_b64_tr_b16 a[50:51], v14 offset:4608
  v_mfma_f32_32x32x16_bf16 v[80:95], a[20:23], a[68:71], v[80:95]
  ds_read_b64_tr_b16 a[52:53], v14 offset:4416
  ds_read_b64_tr_b16 a[54:55], v14 offset:4672
  v_mfma_f32_32x32x16_bf16 v[96:111], a[24:27], a[68:71], v[96:111]
  ds_read_b64_tr_b16 a[56:57], v14 offset:4480
  ds_read_b64_tr_b16 a[58:59], v14 offset:4736
  v_mfma_f32_32x32x16_bf16 v[112:127], a[28:31], a[68:71], v[112:127]
  ds_read_b64_tr_b16 a[60:61], v14 offset:4544
  ds_read_b64_tr_b16 a[62:63], v14 offset:4800
  s_waitcnt lgkmcnt(12)
  v_mfma_f32_32x32x16_bf16 v[64:79], a[32:35], a[72:75], v[64:79]
  s_add_u32 s9, s6, 1
  s_cmp_lt_u32 s4, s9
  s_cbranch_scc1 Llw_slow_311
Llw_back_312:
  v_add_u32 v14, s5, v11
  ds_read_b64_tr_b16 a[0:1], v14 offset:0
  ds_read_b64_tr_b16 a[2:3], v14 offset:256
  v_mfma_f32_32x32x16_bf16 v[80:95], a[36:39], a[72:75], v[80:95]
  ds_read_b64_tr_b16 a[4:5], v14 offset:64
  ds_read_b64_tr_b16 a[6:7], v14 offset:320
  s_add_u32 s6, s6, 1
  s_add_u32 s5, s5, 8704
  s_waitcnt lgkmcnt(12)
  v_mfma_f32_32x32x16_bf16 v[96:111], a[40:43], a[72:75], v[96:111]
  ds_read_b64_tr_b16 a[8:9], v14 offset:128
  ds_read_b64_tr_b16 a[10:11], v14 offset:384
  s_sub_u32 s28, s5, s72
  s_cmp_lt_u32 s5, s72
  v_mfma_f32_32x32x16_bf16 v[112:127], a[44:47], a[72:75], v[112:127]
  ds_read_b64_tr_b16 a[12:13], v14 offset:192
  ds_read_b64_tr_b16 a[14:15], v14 offset:448
  s_cselect_b32 s5, s5, s28
  s_waitcnt lgkmcnt(12)
  v_mfma_f32_32x32x16_bf16 v[64:79], a[48:51], a[76:79], v[64:79]
  ds_read_b64_tr_b16 a[16:17], v14 offset:4352
  ds_read_b64_tr_b16 a[18:19], v14 offset:4608
  v_mfma_f32_32x32x16_bf16 v[80:95], a[52:55], a[76:79], v[80:95]
  ds_read_b64_tr_b16 a[20:21], v14 offset:4416
  ds_read_b64_tr_b16 a[22:23], v14 offset:4672
  s_waitcnt lgkmcnt(12)
  v_mfma_f32_32x32x16_bf16 v[96:111], a[56:59], a[76:79], v[96:111]
  ds_read_b64_tr_b16 a[24:25], v14 offset:4480
  ds_read_b64_tr_b16 a[26:27], v14 offset:4736
  v_mfma_f32_32x32x16_bf16 v[112:127], a[60:63], a[76:79], v[112:127]
  ds_read_b64_tr_b16 a[28:29], v14 offset:4544
  ds_read_b64_tr_b16 a[30:31], v14 offset:4800
  s_waitcnt lgkmcnt(12)
  v_mfma_f32_32x32x16_bf16 v[64:79], a[0:3], a[80:83], v[64:79]
  s_add_u32 s9, s6, 1
  s_cmp_lt_u32 s4, s9
  s_cbranch_scc1 Llw_slow_313
Llw_back_314:
  v_add_u32 v14, s5, v11
  ds_read_b64_tr_b16 a[32:33], v14 offset:0
  ds_read_b64_tr_b16 a[34:35], v14 offset:256
  v_mfma_f32_32x32x16_bf16 v[80:95], a[4:7], a[80:83], v[80:95]
  ds_read_b64_tr_b16 a[36:37], v14 offset:64
  ds_read_b64_tr_b16 a[38:39], v14 offset:320
  s_add_u32 s6, s6, 1
  s_add_u32 s5, s5, 8704
  s_waitcnt lgkmcnt(12)
  v_mfma_f32_32x32x16_bf16 v[96:111], a[8:11], a[80:83], v[96:111]
  ds_read_b64_tr_b16 a[40:41], v14 offset:128
  ds_read_b64_tr_b16 a[42:43], v14 offset:384
  s_sub_u32 s28, s5, s72
  s_cmp_lt_u32 s5, s72
  v_mfma_f32_32x32x16_bf16 v[112:127], a[12:15], a[80:83], v[112:127]
  ds_read_b64_tr_b16 a[44:45], v14 offset:192
  ds_read_b64_tr_b16 a[46:47], v14 offset:448
  s_cselect_b32 s5, s5, s28
  s_waitcnt lgkmcnt(12)
  v_mfma_f32_32x32x16_bf16 v[64:79], a[16:19], a[84:87], v[64:79]
  ds_read_b64_tr_b16 a[48:49], v14 offset:4352
  ds_read_b64_tr_b16 a[50:51], v14 offset:4608
  v_mfma_f32_32x32x16_bf16 v[80:95], a[20:23], a[84:87], v[80:95]
  ds_read_b64_tr_b16 a[52:53], v14 offset:4416
  ds_read_b64_tr_b16 a[54:55], v14 offset:4672
  s_waitcnt lgkmcnt(12)
  v_mfma_f32_32x32x16_bf16 v[96:111], a[24:27], a[84:87], v[96:111]
  ds_read_b64_tr_b16 a[56:57], v14 offset:4480
  ds_read_b64_tr_b16 a[58:59], v14 offset:4736
  v_mfma_f32_32x32x16_bf16 v[112:127], a[28:31], a[84:87], v[112:127]
  ds_read_b64_tr_b16 a[60:61], v14 offset:4544
  ds_read_b64_tr_b16 a[62:63], v14 offset:4800
  s_waitcnt lgkmcnt(12)
  v_mfma_f32_32x32x16_bf16 v[64:79], a[32:35], a[88:91], v[64:79]
  s_add_u32 s9, s6, 1
  s_cmp_lt_u32 s4, s9
  s_cbranch_scc1 Llw_slow_315
Llw_back_316:
  v_add_u32 v14, s5, v11
  ds_read_b64_tr_b16 a[0:1], v14 offset:0
  ds_read_b64_tr_b16 a[2:3], v14 offset:256
  v_mfma_f32_32x32x16_bf16 v[80:95], a[36:39], a[88:91], v[80:95]
  ds_read_b64_tr_b16 a[4:5], v14 offset:64
  ds_read_b64_tr_b16 a[6:7], v14 offset:320
  s_add_u32 s6, s6, 1
  s_add_u32 s5, s5, 8704
  s_waitcnt lgkmcnt(12)
  v_mfma_f32_32x32x16_bf16 v[96:111], a[40:43], a[88:91], v[96:111]
  ds_read_b64_tr_b16 a[8:9], v14 offset:128
  ds_read_b64_tr_b16 a[10:11], v14 offset:384
  s_sub_u32 s28, s5, s72
  s_cmp_lt_u32 s5, s72
  v_mfma_f32_32x32x16_bf16 v[112:127], a[44:47], a[88:91], v[112:127]
  ds_read_b64_tr_b16 a[12:13], v14 offset:192
  ds_read_b64_tr_b16 a[14:15], v14 offset:448
  s_cselect_b32 s5, s5, s28
  s_waitcnt lgkmcnt(12)
  v_mfma_f32_32x32x16_bf16 v[64:79], a[48:51], a[92:95], v[64:79]
  ds_read_b64_tr_b16 a[16:17], v14 offset:4352
  ds_read_b64_tr_b16 a[18:19], v14 offset:4608
  v_mfma_f32_32x32x16_bf16 v[80:95], a[52:55], a[92:95], v[80:95]
  ds_read_b64_tr_b16 a[20:21], v14 offset:4416
  ds_read_b64_tr_b16 a[22:23], v14 offset:4672
  s_waitcnt lgkmcnt(12)
  v_mfma_f32_32x32x16_bf16 v[96:111], a[56:59], a[92:95], v[96:111]
  ds_read_b64_tr_b16 a[24:25], v14 offset:4480
  ds_read_b64_tr_b16 a[26:27], v14 offset:4736
  v_mfma_f32_32x32x16_bf16 v[112:127], a[60:63], a[92:95], v[112:127]
  ds_read_b64_tr_b16 a[28:29], v14 offset:4544
  ds_read_b64_tr_b16 a[30:31], v14 offset:4800
  s_waitcnt vmcnt(8)
  s_waitcnt lgkmcnt(0)
  v_mfma_f32_32x32x16_bf16 v[64:79], a[0:3], a[96:99], v[64:79]
  s_add_u32 s9, s6, 1
  s_cmp_lt_u32 s4, s9
  s_cbranch_scc1 Llw_slow_317
Llw_back_318:
  v_add_u32 v14, s5, v11
  ds_read_b64_tr_b16 a[32:33], v14 offset:0
  ds_read_b64_tr_b16 a[34:35], v14 offset:256
  v_mfma_f32_32x32x16_bf16 v[80:95], a[4:7], a[96:99], v[80:95]
  ds_read_b64_tr_b16 a[36:37], v14 offset:64
  ds_read_b64_tr_b16 a[38:39], v14 offset:320
  s_add_u32 s6, s6, 1
  s_add_u32 s5, s5, 8704
  v_mfma_f32_32x32x16_bf16 v[96:111], a[8:11], a[96:99], v[96:111]
  ds_read_b64_tr_b16 a[40:41], v14 offset:128
  ds_read_b64_tr_b16 a[42:43], v14 offset:384
  s_sub_u32 s28, s5, s72
  s_cmp_lt_u32 s5, s72
  v_mfma_f32_32x32x16_bf16 v[112:127], a[12:15], a[96:99], v[112:127]
  ds_read_b64_tr_b16 a[44:45], v14 offset:192
  ds_read_b64_tr_b16 a[46:47], v14 offset:448
  s_cselect_b32 s5, s5, s28
  v_mfma_f32_32x32x16_bf16 v[64:79], a[16:19], a[100:103], v[64:79]
  ds_read_b64_tr_b16 a[48:49], v14 offset:4352
  ds_read_b64_tr_b16 a[50:51], v14 offset:4608
  v_mfma_f32_32x32x16_bf16 v[80:95], a[20:23], a[100:103], v[80:95]
  ds_read_b64_tr_b16 a[52:53], v14 offset:4416
  ds_read_b64_tr_b16 a[54:55], v14 offset:4672
  v_mfma_f32_32x32x16_bf16 v[96:111], a[24:27], a[100:103], v[96:111]
  ds_read_b64_tr_b16 a[56:57], v14 offset:4480
  ds_read_b64_tr_b16 a[58:59], v14 offset:4736
  v_mfma_f32_32x32x16_bf16 v[112:127], a[28:31], a[100:103], v[112:127]
  ds_read_b64_tr_b16 a[60:61], v14 offset:4544
  ds_read_b64_tr_b16 a[62:63], v14 offset:4800
  s_waitcnt lgkmcnt(12)
  v_mfma_f32_32x32x16_bf16 v[64:79], a[32:35], a[104:107], v[64:79]
  s_add_u32 s9, s6, 1
  s_cmp_lt_u32 s4, s9
  s_cbranch_scc1 Llw_slow_319
Llw_back_320:
  v_add_u32 v14, s5, v11
  ds_read_b64_tr_b16 a[0:1], v14 offset:0
  ds_read_b64_tr_b16 a[2:3], v14 offset:256
  v_mfma_f32_32x32x16_bf16 v[80:95], a[36:39], a[104:107], v[80:95]
  ds_read_b64_tr_b16 a[4:5], v14 offset:64
  ds_read_b64_tr_b16 a[6:7], v14 offset:320
  s_add_u32 s6, s6, 1
  s_add_u32 s5, s5, 8704
  s_waitcnt lgkmcnt(12)
  v_mfma_f32_32x32x16_bf16 v[96:111], a[40:43], a[104:107], v[96:111]
  ds_read_b64_tr_b16 a[8:9], v14 offset:128
  ds_read_b64_tr_b16 a[10:11], v14 offset:384
  s_sub_u32 s28, s5, s72
  s_cmp_lt_u32 s5, s72
  v_mfma_f32_32x32x16_bf16 v[112:127], a[44:47], a[104:107], v[112:127]
  ds_read_b64_tr_b16 a[12:13], v14 offset:192
  ds_read_b64_tr_b16 a[14:15], v14 offset:448
  s_cselect_b32 s5, s5, s28
  s_waitcnt lgkmcnt(12)
  v_mfma_f32_32x32x16_bf16 v[64:79], a[48:51], a[108:111], v[64:79]
  ds_read_b64_tr_b16 a[16:17], v14 offset:4352
  ds_read_b64_tr_b16 a[18:19], v14 offset:4608
  v_mfma_f32_32x32x16_bf16 v[80:95], a[52:55], a[108:111], v[80:95]
  ds_read_b64_tr_b16 a[20:21], v14 offset:4416
  ds_read_b64_tr_b16 a[22:23], v14 offset:4672
  s_waitcnt lgkmcnt(12)
  v_mfma_f32_32x32x16_bf16 v[96:111], a[56:59], a[108:111], v[96:111]
  ds_read_b64_tr_b16 a[24:25], v14 offset:4480
  ds_read_b64_tr_b16 a[26:27], v14 offset:4736
  v_mfma_f32_32x32x16_bf16 v[112:127], a[60:63], a[108:111], v[112:127]
  ds_read_b64_tr_b16 a[28:29], v14 offset:4544
  ds_read_b64_tr_b16 a[30:31], v14 offset:4800
  s_waitcnt lgkmcnt(12)
  v_mfma_f32_32x32x16_bf16 v[64:79], a[0:3], a[112:115], v[64:79]
  s_add_u32 s9, s6, 1
  s_cmp_lt_u32 s4, s9
  s_cbranch_scc1 Llw_slow_321
Llw_back_322:
  v_add_u32 v14, s5, v11
  ds_read_b64_tr_b16 a[32:33], v14 offset:0
  ds_read_b64_tr_b16 a[34:35], v14 offset:256
  v_mfma_f32_32x32x16_bf16 v[80:95], a[4:7], a[112:115], v[80:95]
  ds_read_b64_tr_b16 a[36:37], v14 offset:64
  ds_read_b64_tr_b16 a[38:39], v14 offset:320
  s_add_u32 s6, s6, 1
  s_add_u32 s5, s5, 8704
  s_waitcnt lgkmcnt(12)
  v_mfma_f32_32x32x16_bf16 v[96:111], a[8:11], a[112:115], v[96:111]
  ds_read_b64_tr_b16 a[40:41], v14 offset:128
  ds_read_b64_tr_b16 a[42:43], v14 offset:384
  s_sub_u32 s28, s5, s72
  s_cmp_lt_u32 s5, s72
  v_mfma_f32_32x32x16_bf16 v[112:127], a[12:15], a[112:115], v[112:127]
  ds_read_b64_tr_b16 a[44:45], v14 offset:192
  ds_read_b64_tr_b16 a[46:47], v14 offset:448
  s_cselect_b32 s5, s5, s28
  s_waitcnt lgkmcnt(12)
  v_mfma_f32_32x32x16_bf16 v[64:79], a[16:19], a[116:119], v[64:79]
  ds_read_b64_tr_b16 a[48:49], v14 offset:4352
  ds_read_b64_tr_b16 a[50:51], v14 offset:4608
  v_mfma_f32_32x32x16_bf16 v[80:95], a[20:23], a[116:119], v[80:95]
  ds_read_b64_tr_b16 a[52:53], v14 offset:4416
  ds_read_b64_tr_b16 a[54:55], v14 offset:4672
  s_waitcnt lgkmcnt(12)
  v_mfma_f32_32x32x16_bf16 v[96:111], a[24:27], a[116:119], v[96:111]
  ds_read_b64_tr_b16 a[56:57], v14 offset:4480
  ds_read_b64_tr_b16 a[58:59], v14 offset:4736
  v_mfma_f32_32x32x16_bf16 v[112:127], a[28:31], a[116:119], v[112:127]
  ds_read_b64_tr_b16 a[60:61], v14 offset:4544
  ds_read_b64_tr_b16 a[62:63], v14 offset:4800
  s_waitcnt lgkmcnt(12)
  v_mfma_f32_32x32x16_bf16 v[64:79], a[32:35], a[120:123], v[64:79]
  s_add_u32 s9, s6, 1
  s_cmp_lt_u32 s4, s9
  s_cbranch_scc1 Llw_slow_323
Llw_back_324:
  v_add_u32 v14, s5, v11
  ds_read_b64_tr_b16 a[0:1], v14 offset:0
  ds_read_b64_tr_b16 a[2:3], v14 offset:256
  v_mfma_f32_32x32x16_bf16 v[80:95], a[36:39], a[120:123], v[80:95]
  ds_read_b64_tr_b16 a[4:5], v14 offset:64
  ds_read_b64_tr_b16 a[6:7], v14 offset:320
  s_add_u32 s6, s6, 1
  s_add_u32 s5, s5, 8704
  s_waitcnt lgkmcnt(12)
  v_mfma_f32_32x32x16_bf16 v[96:111], a[40:43], a[120:123], v[96:111]
  ds_read_b64_tr_b16 a[8:9], v14 offset:128
  ds_read_b64_tr_b16 a[10:11], v14 offset:384
  s_sub_u32 s28, s5, s72
  s_cmp_lt_u32 s5, s72
  v_mfma_f32_32x32x16_bf16 v[112:127], a[44:47], a[120:123], v[112:127]
  ds_read_b64_tr_b16 a[12:13], v14 offset:192
  ds_read_b64_tr_b16 a[14:15], v14 offset:448
  s_cselect_b32 s5, s5, s28
  s_waitcnt lgkmcnt(12)
  v_mfma_f32_32x32x16_bf16 v[64:79], a[48:51], a[124:127], v[64:79]
  ds_read_b64_tr_b16 a[16:17], v14 offset:4352
  ds_read_b64_tr_b16 a[18:19], v14 offset:4608
  v_mfma_f32_32x32x16_bf16 v[80:95], a[52:55], a[124:127], v[80:95]
  ds_read_b64_tr_b16 a[20:21], v14 offset:4416
  ds_read_b64_tr_b16 a[22:23], v14 offset:4672
  s_waitcnt lgkmcnt(12)
  v_mfma_f32_32x32x16_bf16 v[96:111], a[56:59], a[124:127], v[96:111]
  ds_read_b64_tr_b16 a[24:25], v14 offset:4480
  ds_read_b64_tr_b16 a[26:27], v14 offset:4736
  v_mfma_f32_32x32x16_bf16 v[112:127], a[60:63], a[124:127], v[112:127]
  ds_read_b64_tr_b16 a[28:29], v14 offset:4544
  ds_read_b64_tr_b16 a[30:31], v14 offset:4800
  s_waitcnt vmcnt(0)
  s_waitcnt lgkmcnt(0)
  v_mfma_f32_32x32x16_bf16 v[64:79], a[0:3], a[128:131], v[64:79]
  s_add_u32 s9, s6, 1
  s_cmp_lt_u32 s4, s9
  s_cbranch_scc1 Llw_slow_325
Llw_back_326:
  v_add_u32 v14, s5, v11
  ds_read_b64_tr_b16 a[32:33], v14 offset:0
  ds_read_b64_tr_b16 a[34:35], v14 offset:256
  v_mfma_f32_32x32x16_bf16 v[80:95], a[4:7], a[128:131], v[80:95]
  ds_read_b64_tr_b16 a[36:37], v14 offset:64
  ds_read_b64_tr_b16 a[38:39], v14 offset:320
  s_add_u32 s6, s6, 1
  s_add_u32 s5, s5, 8704
  v_mfma_f32_32x32x16_bf16 v[96:111], a[8:11], a[128:131], v[96:111]
  ds_read_b64_tr_b16 a[40:41], v14 offset:128
  ds_read_b64_tr_b16 a[42:43], v14 offset:384
  s_sub_u32 s28, s5, s72
  s_cmp_lt_u32 s5, s72
  v_mfma_f32_32x32x16_bf16 v[112:127], a[12:15], a[128:131], v[112:127]
  ds_read_b64_tr_b16 a[44:45], v14 offset:192
  ds_read_b64_tr_b16 a[46:47], v14 offset:448
  s_cselect_b32 s5, s5, s28
  v_mfma_f32_32x32x16_bf16 v[64:79], a[16:19], a[132:135], v[64:79]
  ds_read_b64_tr_b16 a[48:49], v14 offset:4352
  ds_read_b64_tr_b16 a[50:51], v14 offset:4608
  v_mfma_f32_32x32x16_bf16 v[80:95], a[20:23], a[132:135], v[80:95]
  ds_read_b64_tr_b16 a[52:53], v14 offset:4416
  ds_read_b64_tr_b16 a[54:55], v14 offset:4672
  v_mfma_f32_32x32x16_bf16 v[96:111], a[24:27], a[132:135], v[96:111]
  ds_read_b64_tr_b16 a[56:57], v14 offset:4480
  ds_read_b64_tr_b16 a[58:59], v14 offset:4736
  v_mfma_f32_32x32x16_bf16 v[112:127], a[28:31], a[132:135], v[112:127]
  ds_read_b64_tr_b16 a[60:61], v14 offset:4544
  ds_read_b64_tr_b16 a[62:63], v14 offset:4800
  s_waitcnt lgkmcnt(12)
  v_mfma_f32_32x32x16_bf16 v[64:79], a[32:35], a[136:139], v[64:79]
  s_add_u32 s9, s6, 1
  s_cmp_lt_u32 s4, s9
  s_cbranch_scc1 Llw_slow_327
Llw_back_328:
  v_add_u32 v14, s5, v11
  ds_read_b64_tr_b16 a[0:1], v14 offset:0
  ds_read_b64_tr_b16 a[2:3], v14 offset:256
  v_mfma_f32_32x32x16_bf16 v[80:95], a[36:39], a[136:139], v[80:95]
  ds_read_b64_tr_b16 a[4:5], v14 offset:64
  ds_read_b64_tr_b16 a[6:7], v14 offset:320
  s_add_u32 s6, s6, 1
  s_add_u32 s5, s5, 8704
  s_waitcnt lgkmcnt(12)
  v_mfma_f32_32x32x16_bf16 v[96:111], a[40:43], a[136:139], v[96:111]
  ds_read_b64_tr_b16 a[8:9], v14 offset:128
  ds_read_b64_tr_b16 a[10:11], v14 offset:384
  s_sub_u32 s28, s5, s72
  s_cmp_lt_u32 s5, s72
  v_mfma_f32_32x32x16_bf16 v[112:127], a[44:47], a[136:139], v[112:127]
  ds_read_b64_tr_b16 a[12:13], v14 offset:192
  ds_read_b64_tr_b16 a[14:15], v14 offset:448
  s_cselect_b32 s5, s5, s28
  s_waitcnt lgkmcnt(12)
  v_mfma_f32_32x32x16_bf16 v[64:79], a[48:51], a[140:143], v[64:79]
  ds_read_b64_tr_b16 a[16:17], v14 offset:4352
  ds_read_b64_tr_b16 a[18:19], v14 offset:4608
  v_mfma_f32_32x32x16_bf16 v[80:95], a[52:55], a[140:143], v[80:95]
  ds_read_b64_tr_b16 a[20:21], v14 offset:4416
  ds_read_b64_tr_b16 a[22:23], v14 offset:4672
  s_waitcnt lgkmcnt(12)
  v_mfma_f32_32x32x16_bf16 v[96:111], a[56:59], a[140:143], v[96:111]
  ds_read_b64_tr_b16 a[24:25], v14 offset:4480
  ds_read_b64_tr_b16 a[26:27], v14 offset:4736
  v_mfma_f32_32x32x16_bf16 v[112:127], a[60:63], a[140:143], v[112:127]
  ds_read_b64_tr_b16 a[28:29], v14 offset:4544
  ds_read_b64_tr_b16 a[30:31], v14 offset:4800
  s_waitcnt lgkmcnt(12)
  v_mfma_f32_32x32x16_bf16 v[64:79], a[0:3], a[144:147], v[64:79]
  s_add_u32 s9, s6, 1
  s_cmp_lt_u32 s4, s9
  s_cbranch_scc1 Llw_slow_329
Llw_back_330:
  v_add_u32 v14, s5, v11
  ds_read_b64_tr_b16 a[32:33], v14 offset:0
  ds_read_b64_tr_b16 a[34:35], v14 offset:256
  v_mfma_f32_32x32x16_bf16 v[80:95], a[4:7], a[144:147], v[80:95]
  ds_read_b64_tr_b16 a[36:37], v14 offset:64
  ds_read_b64_tr_b16 a[38:39], v14 offset:320
  s_add_u32 s6, s6, 1
  s_add_u32 s5, s5, 8704
  s_waitcnt lgkmcnt(12)
  v_mfma_f32_32x32x16_bf16 v[96:111], a[8:11], a[144:147], v[96:111]
  ds_read_b64_tr_b16 a[40:41], v14 offset:128
  ds_read_b64_tr_b16 a[42:43], v14 offset:384
  s_sub_u32 s28, s5, s72
  s_cmp_lt_u32 s5, s72
  v_mfma_f32_32x32x16_bf16 v[112:127], a[12:15], a[144:147], v[112:127]
  ds_read_b64_tr_b16 a[44:45], v14 offset:192
  ds_read_b64_tr_b16 a[46:47], v14 offset:448
  s_cselect_b32 s5, s5, s28
  s_waitcnt lgkmcnt(12)
  v_mfma_f32_32x32x16_bf16 v[64:79], a[16:19], a[148:151], v[64:79]
  ds_read_b64_tr_b16 a[48:49], v14 offset:4352
  ds_read_b64_tr_b16 a[50:51], v14 offset:4608
  v_mfma_f32_32x32x16_bf16 v[80:95], a[20:23], a[148:151], v[80:95]
  ds_read_b64_tr_b16 a[52:53], v14 offset:4416
  ds_read_b64_tr_b16 a[54:55], v14 offset:4672
  s_waitcnt lgkmcnt(12)
  v_mfma_f32_32x32x16_bf16 v[96:111], a[24:27], a[148:151], v[96:111]
  ds_read_b64_tr_b16 a[56:57], v14 offset:4480
  ds_read_b64_tr_b16 a[58:59], v14 offset:4736
  v_mfma_f32_32x32x16_bf16 v[112:127], a[28:31], a[148:151], v[112:127]
  ds_read_b64_tr_b16 a[60:61], v14 offset:4544
  ds_read_b64_tr_b16 a[62:63], v14 offset:4800
  s_waitcnt lgkmcnt(0)
  v_mfma_f32_32x32x16_bf16 v[64:79], a[32:35], a[152:155], v[64:79]
  v_mfma_f32_32x32x16_bf16 v[80:95], a[36:39], a[152:155], v[80:95]
  v_mfma_f32_32x32x16_bf16 v[96:111], a[40:43], a[152:155], v[96:111]
  v_mfma_f32_32x32x16_bf16 v[112:127], a[44:47], a[152:155], v[112:127]
  v_mfma_f32_32x32x16_bf16 v[64:79], a[48:51], a[156:159], v[64:79]
  v_mfma_f32_32x32x16_bf16 v[80:95], a[52:55], a[156:159], v[80:95]
  v_mfma_f32_32x32x16_bf16 v[96:111], a[56:59], a[156:159], v[96:111]
  v_mfma_f32_32x32x16_bf16 v[112:127], a[60:63], a[156:159], v[112:127]
  s_nop 7
  s_add_u32 s15, s22, 8
  s_lshl_b32 s15, s15, 2
  s_add_u32 s15, s15, s21
  s_lshl_b32 s15, s15, 3
  s_add_u32 s15, s15, s20
  s_mul_i32 s15, s15, 24576
  s_lshl_b32 s28, s3, 13
  s_add_u32 s15, s15, s28
  s_add_u32 s15, s15, 16777216
  s_add_u32 s29, s15, 4096
  s_nop 3
  v_cvt_pk_bf16_f32 v64, v64, v65
  v_cvt_pk_bf16_f32 v65, v66, v67
  v_cvt_pk_bf16_f32 v66, v68, v69
  v_cvt_pk_bf16_f32 v67, v70, v71
  buffer_store_dwordx4 v[64:67], v15, s[64:67], s15 offen offset:0 sc1
  v_cvt_pk_bf16_f32 v68, v72, v73
  v_cvt_pk_bf16_f32 v69, v74, v75
  v_cvt_pk_bf16_f32 v70, v76, v77
  v_cvt_pk_bf16_f32 v71, v78, v79
  buffer_store_dwordx4 v[68:71], v15, s[64:67], s15 offen offset:1024 sc1
  v_cvt_pk_bf16_f32 v72, v80, v81
  v_cvt_pk_bf16_f32 v73, v82, v83
  v_cvt_pk_bf16_f32 v74, v84, v85
  v_cvt_pk_bf16_f32 v75, v86, v87
  buffer_store_dwordx4 v[72:75], v15, s[64:67], s15 offen offset:2048 sc1
  v_cvt_pk_bf16_f32 v76, v88, v89
  v_cvt_pk_bf16_f32 v77, v90, v91
  v_cvt_pk_bf16_f32 v78, v92, v93
  v_cvt_pk_bf16_f32 v79, v94, v95
  buffer_store_dwordx4 v[76:79], v15, s[64:67], s15 offen offset:3072 sc1
  v_cvt_pk_bf16_f32 v80, v96, v97
  v_cvt_pk_bf16_f32 v81, v98, v99
  v_cvt_pk_bf16_f32 v82, v100, v101
  v_cvt_pk_bf16_f32 v83, v102, v103
  buffer_store_dwordx4 v[80:83], v15, s[64:67], s29 offen offset:0 sc1
  v_cvt_pk_bf16_f32 v84, v104, v105
  v_cvt_pk_bf16_f32 v85, v106, v107
  v_cvt_pk_bf16_f32 v86, v108, v109
  v_cvt_pk_bf16_f32 v87, v110, v111
  buffer_store_dwordx4 v[84:87], v15, s[64:67], s29 offen offset:1024 sc1
  v_cvt_pk_bf16_f32 v88, v112, v113
  v_cvt_pk_bf16_f32 v89, v114, v115
  v_cvt_pk_bf16_f32 v90, v116, v117
  v_cvt_pk_bf16_f32 v91, v118, v119
  buffer_store_dwordx4 v[88:91], v15, s[64:67], s29 offen offset:2048 sc1
  v_cvt_pk_bf16_f32 v92, v120, v121
  v_cvt_pk_bf16_f32 v93, v122, v123
  v_cvt_pk_bf16_f32 v94, v124, v125
  v_cvt_pk_bf16_f32 v95, v126, v127
  buffer_store_dwordx4 v[92:95], v15, s[64:67], s29 offen offset:3072 sc1
  s_waitcnt vmcnt(0)
  s_add_u32 s14, s22, 8
  s_lshl_b32 s14, s14, 2
  s_add_u32 s14, s14, s21
  s_lshl_b32 s14, s14, 2
  s_add_u32 s14, s14, s3
  s_lshl_b32 s14, s14, 7
  s_add_u32 s14, s14, 65536
  s_lshl_b32 s28, s20, 3
  s_add_u32 s14, s14, s28
  v_mov_b32 v2, s16
  v_mov_b32 v3, s17
  v_mov_b32 v1, 0
  s_mov_b64 s[34:35], exec
  s_mov_b64 exec, 1
  buffer_store_dwordx2 v[2:3], v1, s[64:67], s14 offen sc1
  s_mov_b64 exec, s[34:35]
  s_add_u32 s14, s22, 0
  s_lshl_b32 s14, s14, 2
  s_add_u32 s14, s14, s21
  s_lshl_b32 s14, s14, 2
  s_add_u32 s14, s14, s3
  s_lshl_b32 s14, s14, 7
  s_add_u32 s14, s14, 65536
  v_min_u32 v1, 7, v0
  v_lshlrev_b32 v1, 3, v1
Lpoll_331:
  buffer_load_dwordx2 v[2:3], v1, s[64:67], s14 offen sc1
  s_waitcnt vmcnt(0)
  v_cmp_ne_u32 vcc, s16, v2
  v_cmp_ne_u32 s[34:35], s17, v3
  s_sub_u32 s26, s26, 1
  s_cmp_eq_u32 s26, 0
  s_cbranch_scc1 L_end
  s_or_b64 vcc, vcc, s[34:35]
  s_cbranch_scc1 Lpoll_331
  s_add_u32 s15, s22, 0
  s_lshl_b32 s15, s15, 2
  s_add_u32 s15, s15, s21
  s_lshl_b32 s15, s15, 3
  s_mul_i32 s15, s15, 24576
  s_lshl_b32 s28, s3, 13
  s_add_u32 s15, s15, s28
  s_add_u32 s15, s15, 16777216
  s_lshl_b32 s29, s20, 10
  s_add_u32 s15, s15, s29
  s_add_u32 s29, s15, 0
  buffer_load_dwordx4 v[160:163], v15, s[64:67], s29 offen sc1
  s_add_u32 s29, s15, 24576
  buffer_load_dwordx4 v[164:167], v15, s[64:67], s29 offen sc1
  s_add_u32 s29, s15, 49152
  buffer_load_dwordx4 v[168:171], v15, s[64:67], s29 offen sc1
  s_add_u32 s29, s15, 73728
  buffer_load_dwordx4 v[172:175], v15, s[64:67], s29 offen sc1
  s_add_u32 s29, s15, 98304
  buffer_load_dwordx4 v[176:179], v15, s[64:67], s29 offen sc1
  s_add_u32 s29, s15, 122880
  buffer_load_dwordx4 v[180:183], v15, s[64:67], s29 offen sc1
  s_add_u32 s29, s15, 147456
  buffer_load_dwordx4 v[184:187], v15, s[64:67], s29 offen sc1
  s_add_u32 s29, s15, 172032
  buffer_load_dwordx4 v[188:191], v15, s[64:67], s29 offen sc1
  v_and_b32 v1, 31, v0
  v_lshlrev_b32 v1, 11, v1
  v_lshrrev_b32 v2, 5, v0
  v_lshlrev_b32 v2, 4, v2
  v_add_u32 v1, v1, v2
  s_add_u32 s29, s46, 0
  s_mul_i32 s29, s29, 96
  s_lshl_b32 s30, s3, 5
  s_add_u32 s29, s29, s30
  s_lshl_b32 s29, s29, 11
  s_lshl_b32 s30, s47, 10
  s_add_u32 s29, s29, s30
  s_lshl_b32 s30, s21, 8
  s_add_u32 s29, s29, s30
  s_lshl_b32 s30, s20, 5
  s_add_u32 s29, s29, s30
  s_waitcnt vmcnt(7)
  v_lshlrev_b32 v192, 16, v160
  v_and_b32 v193, 0xffff0000, v160
  v_lshlrev_b32 v194, 16, v161
  v_and_b32 v195, 0xffff0000, v161
  v_lshlrev_b32 v196, 16, v162
  v_and_b32 v197, 0xffff0000, v162
  v_lshlrev_b32 v198, 16, v163
  v_and_b32 v199, 0xffff0000, v163
  s_waitcnt vmcnt(6)
  v_lshlrev_b32 v200, 16, v164
  v_and_b32 v164, 0xffff0000, v164
  v_add_f32 v192, v192, v200
  v_add_f32 v193, v193, v164
  v_lshlrev_b32 v200, 16, v165
  v_and_b32 v165, 0xffff0000, v165
  v_add_f32 v194, v194, v200
  v_add_f32 v195, v195, v165
  v_lshlrev_b32 v200, 16, v166
  v_and_b32 v166, 0xffff0000, v166
  v_add_f32 v196, v196, v200
  v_add_f32 v197, v197, v166
  v_lshlrev_b32 v200, 16, v167
  v_and_b32 v167, 0xffff0000, v167
  v_add_f32 v198, v198, v200
  v_add_f32 v199, v199, v167
  s_waitcnt vmcnt(5)
  v_lshlrev_b32 v200, 16, v168
  v_and_b32 v168, 0xffff0000, v168
  v_add_f32 v192, v192, v200
  v_add_f32 v193, v193, v168
  v_lshlrev_b32 v200, 16, v169
  v_and_b32 v169, 0xffff0000, v169
  v_add_f32 v194, v194, v200
  v_add_f32 v195, v195, v169
  v_lshlrev_b32 v200, 16, v170
  v_and_b32 v170, 0xffff0000, v170
  v_add_f32 v196, v196, v200
  v_add_f32 v197, v197, v170
  v_lshlrev_b32 v200, 16, v171
  v_and_b32 v171, 0xffff0000, v171
  v_add_f32 v198, v198, v200
  v_add_f32 v199, v199, v171
  s_waitcnt vmcnt(4)
  v_lshlrev_b32 v200, 16, v172
  v_and_b32 v172, 0xffff0000, v172
  v_add_f32 v192, v192, v200
  v_add_f32 v193, v193, v172
  v_lshlrev_b32 v200, 16, v173
  v_and_b32 v173, 0xffff0000, v173
  v_add_f32 v194, v194, v200
  v_add_f32 v195, v195, v173
  v_lshlrev_b32 v200, 16, v174
  v_and_b32 v174, 0xffff0000, v174
  v_add_f32 v196, v196, v200
  v_add_f32 v197, v197, v174
  v_lshlrev_b32 v200, 16, v175
  v_and_b32 v175, 0xffff0000, v175
  v_add_f32 v198, v198, v200
  v_add_f32 v199, v199, v175
  s_waitcnt vmcnt(3)
  v_lshlrev_b32 v200, 16, v176
  v_and_b32 v176, 0xffff0000, v176
  v_add_f32 v192, v192, v200
  v_add_f32 v193, v193, v176
  v_lshlrev_b32 v200, 16, v177
  v_and_b32 v177, 0xffff0000, v177
  v_add_f32 v194, v194, v200
  v_add_f32 v195, v195, v177
  v_lshlrev_b32 v200, 16, v178
  v_and_b32 v178, 0xffff0000, v178
  v_add_f32 v196, v196, v200
  v_add_f32 v197, v197, v178
  v_lshlrev_b32 v200, 16, v179
  v_and_b32 v179, 0xffff0000, v179
  v_add_f32 v198, v198, v200
  v_add_f32 v199, v199, v179
  s_waitcnt vmcnt(2)
  v_lshlrev_b32 v200, 16, v180
  v_and_b32 v180, 0xffff0000, v180
  v_add_f32 v192, v192, v200
  v_add_f32 v193, v193, v180
  v_lshlrev_b32 v200, 16, v181
  v_and_b32 v181, 0xffff0000, v181
  v_add_f32 v194, v194, v200
  v_add_f32 v195, v195, v181
  v_lshlrev_b32 v200, 16, v182
  v_and_b32 v182, 0xffff0000, v182
  v_add_f32 v196, v196, v200
  v_add_f32 v197, v197, v182
  v_lshlrev_b32 v200, 16, v183
  v_and_b32 v183, 0xffff0000, v183
  v_add_f32 v198, v198, v200
  v_add_f32 v199, v199, v183
  s_waitcnt vmcnt(1)
  v_lshlrev_b32 v200, 16, v184
  v_and_b32 v184, 0xffff0000, v184
  v_add_f32 v192, v192, v200
  v_add_f32 v193, v193, v184
  v_lshlrev_b32 v200, 16, v185
  v_and_b32 v185, 0xffff0000, v185
  v_add_f32 v194, v194, v200
  v_add_f32 v195, v195, v185
  v_lshlrev_b32 v200, 16, v186
  v_and_b32 v186, 0xffff0000, v186
  v_add_f32 v196, v196, v200
  v_add_f32 v197, v197, v186
  v_lshlrev_b32 v200, 16, v187
  v_and_b32 v187, 0xffff0000, v187
  v_add_f32 v198, v198, v200
  v_add_f32 v199, v199, v187
  s_waitcnt vmcnt(0)
  v_lshlrev_b32 v200, 16, v188
  v_and_b32 v188, 0xffff0000, v188
  v_add_f32 v192, v192, v200
  v_add_f32 v193, v193, v188
  v_lshlrev_b32 v200, 16, v189
  v_and_b32 v189, 0xffff0000, v189
  v_add_f32 v194, v194, v200
  v_add_f32 v195, v195, v189
  v_lshlrev_b32 v200, 16, v190
  v_and_b32 v190, 0xffff0000, v190
  v_add_f32 v196, v196, v200
  v_add_f32 v197, v197, v190
  v_lshlrev_b32 v200, 16, v191
  v_and_b32 v191, 0xffff0000, v191
  v_add_f32 v198, v198, v200
  v_add_f32 v199, v199, v191
  v_cvt_pk_bf16_f32 v4, v192, v193
  v_cvt_pk_bf16_f32 v5, v194, v195
  v_cvt_pk_bf16_f32 v6, v196, v197
  v_cvt_pk_bf16_f32 v7, v198, v199
  buffer_store_dwordx4 v[4:7], v1, s[68:71], s29 offen
  s_add_u32 s14, s22, 8
  s_lshl_b32 s14, s14, 2
  s_add_u32 s14, s14, s21
  s_lshl_b32 s14, s14, 2
  s_add_u32 s14, s14, s3
  s_lshl_b32 s14, s14, 7
  s_add_u32 s14, s14, 65536
  v_min_u32 v1, 7, v0
  v_lshlrev_b32 v1, 3, v1
Lpoll_332:
  buffer_load_dwordx2 v[2:3], v1, s[64:67], s14 offen sc1
  s_waitcnt vmcnt(0)
  v_cmp_ne_u32 vcc, s16, v2
  v_cmp_ne_u32 s[34:35], s17, v3
  s_sub_u32 s26, s26, 1
  s_cmp_eq_u32 s26, 0
  s_cbranch_scc1 L_end
  s_or_b64 vcc, vcc, s[34:35]
  s_cbranch_scc1 Lpoll_332
  s_add_u32 s15, s22, 8
  s_lshl_b32 s15, s15, 2
  s_add_u32 s15, s15, s21
  s_lshl_b32 s15, s15, 3
  s_mul_i32 s15, s15, 24576
  s_lshl_b32 s28, s3, 13
  s_add_u32 s15, s15, s28
  s_add_u32 s15, s15, 16777216
  s_lshl_b32 s29, s20, 10
  s_add_u32 s15, s15, s29
  s_add_u32 s29, s15, 0
  buffer_load_dwordx4 v[160:163], v15, s[64:67], s29 offen sc1
  s_add_u32 s29, s15, 24576
  buffer_load_dwordx4 v[164:167], v15, s[64:67], s29 offen sc1
  s_add_u32 s29, s15, 49152
  buffer_load_dwordx4 v[168:171], v15, s[64:67], s29 offen sc1
  s_add_u32 s29, s15, 73728
  buffer_load_dwordx4 v[172:175], v15, s[64:67], s29 offen sc1
  s_add_u32 s29, s15, 98304
  buffer_load_dwordx4 v[176:179], v15, s[64:67], s29 offen sc1
  s_add_u32 s29, s15, 122880
  buffer_load_dwordx4 v[180:183], v15, s[64:67], s29 offen sc1
  s_add_u32 s29, s15, 147456
  buffer_load_dwordx4 v[184:187], v15, s[64:67], s29 offen sc1
  s_add_u32 s29, s15, 172032
  buffer_load_dwordx4 v[188:191], v15, s[64:67], s29 offen sc1
  v_and_b32 v1, 31, v0
  v_lshlrev_b32 v1, 11, v1
  v_lshrrev_b32 v2, 5, v0
  v_lshlrev_b32 v2, 4, v2
  v_add_u32 v1, v1, v2
  s_add_u32 s29, s46, 4
  s_mul_i32 s29, s29, 96
  s_lshl_b32 s30, s3, 5
  s_add_u32 s29, s29, s30
  s_lshl_b32 s29, s29, 11
  s_lshl_b32 s30, s47, 10
  s_add_u32 s29, s29, s30
  s_lshl_b32 s30, s21, 8
  s_add_u32 s29, s29, s30
  s_lshl_b32 s30, s20, 5
  s_add_u32 s29, s29, s30
  s_waitcnt vmcnt(7)
  v_lshlrev_b32 v192, 16, v160
  v_and_b32 v193, 0xffff0000, v160
  v_lshlrev_b32 v194, 16, v161
  v_and_b32 v195, 0xffff0000, v161
  v_lshlrev_b32 v196, 16, v162
  v_and_b32 v197, 0xffff0000, v162
  v_lshlrev_b32 v198, 16, v163
  v_and_b32 v199, 0xffff0000, v163
  s_waitcnt vmcnt(6)
  v_lshlrev_b32 v200, 16, v164
  v_and_b32 v164, 0xffff0000, v164
  v_add_f32 v192, v192, v200
  v_add_f32 v193, v193, v164
  v_lshlrev_b32 v200, 16, v165
  v_and_b32 v165, 0xffff0000, v165
  v_add_f32 v194, v194, v200
  v_add_f32 v195, v195, v165
  v_lshlrev_b32 v200, 16, v166
  v_and_b32 v166, 0xffff0000, v166
  v_add_f32 v196, v196, v200
  v_add_f32 v197, v197, v166
  v_lshlrev_b32 v200, 16, v167
  v_and_b32 v167, 0xffff0000, v167
  v_add_f32 v198, v198, v200
  v_add_f32 v199, v199, v167
  s_waitcnt vmcnt(5)
  v_lshlrev_b32 v200, 16, v168
  v_and_b32 v168, 0xffff0000, v168
  v_add_f32 v192, v192, v200
  v_add_f32 v193, v193, v168
  v_lshlrev_b32 v200, 16, v169
  v_and_b32 v169, 0xffff0000, v169
  v_add_f32 v194, v194, v200
  v_add_f32 v195, v195, v169
  v_lshlrev_b32 v200, 16, v170
  v_and_b32 v170, 0xffff0000, v170
  v_add_f32 v196, v196, v200
  v_add_f32 v197, v197, v170
  v_lshlrev_b32 v200, 16, v171
  v_and_b32 v171, 0xffff0000, v171
  v_add_f32 v198, v198, v200
  v_add_f32 v199, v199, v171
  s_waitcnt vmcnt(4)
  v_lshlrev_b32 v200, 16, v172
  v_and_b32 v172, 0xffff0000, v172
  v_add_f32 v192, v192, v200
  v_add_f32 v193, v193, v172
  v_lshlrev_b32 v200, 16, v173
  v_and_b32 v173, 0xffff0000, v173
  v_add_f32 v194, v194, v200
  v_add_f32 v195, v195, v173
  v_lshlrev_b32 v200, 16, v174
  v_and_b32 v174, 0xffff0000, v174
  v_add_f32 v196, v196, v200
  v_add_f32 v197, v197, v174
  v_lshlrev_b32 v200, 16, v175
  v_and_b32 v175, 0xffff0000, v175
  v_add_f32 v198, v198, v200
  v_add_f32 v199, v199, v175
  s_waitcnt vmcnt(3)
  v_lshlrev_b32 v200, 16, v176
  v_and_b32 v176, 0xffff0000, v176
  v_add_f32 v192, v192, v200
  v_add_f32 v193, v193, v176
  v_lshlrev_b32 v200, 16, v177
  v_and_b32 v177, 0xffff0000, v177
  v_add_f32 v194, v194, v200
  v_add_f32 v195, v195, v177
  v_lshlrev_b32 v200, 16, v178
  v_and_b32 v178, 0xffff0000, v178
  v_add_f32 v196, v196, v200
  v_add_f32 v197, v197, v178
  v_lshlrev_b32 v200, 16, v179
  v_and_b32 v179, 0xffff0000, v179
  v_add_f32 v198, v198, v200
  v_add_f32 v199, v199, v179
  s_waitcnt vmcnt(2)
  v_lshlrev_b32 v200, 16, v180
  v_and_b32 v180, 0xffff0000, v180
  v_add_f32 v192, v192, v200
  v_add_f32 v193, v193, v180
  v_lshlrev_b32 v200, 16, v181
  v_and_b32 v181, 0xffff0000, v181
  v_add_f32 v194, v194, v200
  v_add_f32 v195, v195, v181
  v_lshlrev_b32 v200, 16, v182
  v_and_b32 v182, 0xffff0000, v182
  v_add_f32 v196, v196, v200
  v_add_f32 v197, v197, v182
  v_lshlrev_b32 v200, 16, v183
  v_and_b32 v183, 0xffff0000, v183
  v_add_f32 v198, v198, v200
  v_add_f32 v199, v199, v183
  s_waitcnt vmcnt(1)
  v_lshlrev_b32 v200, 16, v184
  v_and_b32 v184, 0xffff0000, v184
  v_add_f32 v192, v192, v200
  v_add_f32 v193, v193, v184
  v_lshlrev_b32 v200, 16, v185
  v_and_b32 v185, 0xffff0000, v185
  v_add_f32 v194, v194, v200
  v_add_f32 v195, v195, v185
  v_lshlrev_b32 v200, 16, v186
  v_and_b32 v186, 0xffff0000, v186
  v_add_f32 v196, v196, v200
  v_add_f32 v197, v197, v186
  v_lshlrev_b32 v200, 16, v187
  v_and_b32 v187, 0xffff0000, v187
  v_add_f32 v198, v198, v200
  v_add_f32 v199, v199, v187
  s_waitcnt vmcnt(0)
  v_lshlrev_b32 v200, 16, v188
  v_and_b32 v188, 0xffff0000, v188
  v_add_f32 v192, v192, v200
  v_add_f32 v193, v193, v188
  v_lshlrev_b32 v200, 16, v189
  v_and_b32 v189, 0xffff0000, v189
  v_add_f32 v194, v194, v200
  v_add_f32 v195, v195, v189
  v_lshlrev_b32 v200, 16, v190
  v_and_b32 v190, 0xffff0000, v190
  v_add_f32 v196, v196, v200
  v_add_f32 v197, v197, v190
  v_lshlrev_b32 v200, 16, v191
  v_and_b32 v191, 0xffff0000, v191
  v_add_f32 v198, v198, v200
  v_add_f32 v199, v199, v191
  v_cvt_pk_bf16_f32 v4, v192, v193
  v_cvt_pk_bf16_f32 v5, v194, v195
  v_cvt_pk_bf16_f32 v6, v196, v197
  v_cvt_pk_bf16_f32 v7, v198, v199
  buffer_store_dwordx4 v[4:7], v1, s[68:71], s29 offen
  s_waitcnt vmcnt(0)
L_fin:
L_end:
  s_endpgm
Lrare_114:
  v_mov_b32 v1, v19
  s_nop 1
  v_permlane32_swap_b32 v19, v1
  s_nop 1
  v_max_f32 v19, v19, v1
  v_max_f32 v19, 0, v19
  v_sub_f32 v20, 0, v19
  v_exp_f32 v20, v20
  v_sub_f32 v144, v144, v19
  v_sub_f32 v145, v145, v19
  v_sub_f32 v146, v146, v19
  v_sub_f32 v147, v147, v19
  v_sub_f32 v148, v148, v19
  v_sub_f32 v149, v149, v19
  v_sub_f32 v150, v150, v19
  v_sub_f32 v151, v151, v19
  v_sub_f32 v152, v152, v19
  v_sub_f32 v153, v153, v19
  v_sub_f32 v154, v154, v19
  v_sub_f32 v155, v155, v19
  v_sub_f32 v156, v156, v19
  v_sub_f32 v157, v157, v19
  v_sub_f32 v158, v158, v19
  v_sub_f32 v159, v159, v19
  v_sub_f32 v48, v48, v19
  v_sub_f32 v49, v49, v19
  v_sub_f32 v50, v50, v19
  v_sub_f32 v51, v51, v19
  v_sub_f32 v52, v52, v19
  v_sub_f32 v53, v53, v19
  v_sub_f32 v54, v54, v19
  v_sub_f32 v55, v55, v19
  v_sub_f32 v56, v56, v19
  v_sub_f32 v57, v57, v19
  v_sub_f32 v58, v58, v19
  v_sub_f32 v59, v59, v19
  v_sub_f32 v60, v60, v19
  v_sub_f32 v61, v61, v19
  v_sub_f32 v62, v62, v19
  v_sub_f32 v63, v63, v19
  v_mul_f32 v17, v17, v20
  v_mul_f32 v18, v18, v20
  v_mul_f32 v64, v64, v20
  v_mul_f32 v65, v65, v20
  v_mul_f32 v66, v66, v20
  v_mul_f32 v67, v67, v20
  v_mul_f32 v68, v68, v20
  v_mul_f32 v69, v69, v20
  v_mul_f32 v70, v70, v20
  v_mul_f32 v71, v71, v20
  v_mul_f32 v72, v72, v20
  v_mul_f32 v73, v73, v20
  v_mul_f32 v74, v74, v20
  v_mul_f32 v75, v75, v20
  v_mul_f32 v76, v76, v20
  v_mul_f32 v77, v77, v20
  v_mul_f32 v78, v78, v20
  v_mul_f32 v79, v79, v20
  v_mul_f32 v80, v80, v20
  v_mul_f32 v81, v81, v20
  v_mul_f32 v82, v82, v20
  v_mul_f32 v83, v83, v20
  v_mul_f32 v84, v84, v20
  v_mul_f32 v85, v85, v20
  v_mul_f32 v86, v86, v20
  v_mul_f32 v87, v87, v20
  v_mul_f32 v88, v88, v20
  v_mul_f32 v89, v89, v20
  v_mul_f32 v90, v90, v20
  v_mul_f32 v91, v91, v20
  v_mul_f32 v92, v92, v20
  v_mul_f32 v93, v93, v20
  v_mul_f32 v94, v94, v20
  v_mul_f32 v95, v95, v20
  v_mul_f32 v96, v96, v20
  v_mul_f32 v97, v97, v20
  v_mul_f32 v98, v98, v20
  v_mul_f32 v99, v99, v20
  v_mul_f32 v100, v100, v20
  v_mul_f32 v101, v101, v20
  v_mul_f32 v102, v102, v20
  v_mul_f32 v103, v103, v20
  v_mul_f32 v104, v104, v20
  v_mul_f32 v105, v105, v20
  v_mul_f32 v106, v106, v20
  v_mul_f32 v107, v107, v20
  v_mul_f32 v108, v108, v20
  v_mul_f32 v109, v109, v20
  v_mul_f32 v110, v110, v20
  v_mul_f32 v111, v111, v20
  v_mul_f32 v112, v112, v20
  v_mul_f32 v113, v113, v20
  v_mul_f32 v114, v114, v20
  v_mul_f32 v115, v115, v20
  v_mul_f32 v116, v116, v20
  v_mul_f32 v117, v117, v20
  v_mul_f32 v118, v118, v20
  v_mul_f32 v119, v119, v20
  v_mul_f32 v120, v120, v20
  v_mul_f32 v121, v121, v20
  v_mul_f32 v122, v122, v20
  v_mul_f32 v123, v123, v20
  v_mul_f32 v124, v124, v20
  v_mul_f32 v125, v125, v20
  v_mul_f32 v126, v126, v20
  v_mul_f32 v127, v127, v20
  s_branch Lback_115
Lrare_118:
  v_mov_b32 v1, v19
  s_nop 1
  v_permlane32_swap_b32 v19, v1
  s_nop 1
  v_max_f32 v19, v19, v1
  v_max_f32 v19, 0, v19
  v_sub_f32 v20, 0, v19
  v_exp_f32 v20, v20
  v_sub_f32 v128, v128, v19
  v_sub_f32 v129, v129, v19
  v_sub_f32 v130, v130, v19
  v_sub_f32 v131, v131, v19
  v_sub_f32 v132, v132, v19
  v_sub_f32 v133, v133, v19
  v_sub_f32 v134, v134, v19
  v_sub_f32 v135, v135, v19
  v_sub_f32 v136, v136, v19
  v_sub_f32 v137, v137, v19
  v_sub_f32 v138, v138, v19
  v_sub_f32 v139, v139, v19
  v_sub_f32 v140, v140, v19
  v_sub_f32 v141, v141, v19
  v_sub_f32 v142, v142, v19
  v_sub_f32 v143, v143, v19
  v_sub_f32 v48, v48, v19
  v_sub_f32 v49, v49, v19
  v_sub_f32 v50, v50, v19
  v_sub_f32 v51, v51, v19
  v_sub_f32 v52, v52, v19
  v_sub_f32 v53, v53, v19
  v_sub_f32 v54, v54, v19
  v_sub_f32 v55, v55, v19
  v_sub_f32 v56, v56, v19
  v_sub_f32 v57, v57, v19
  v_sub_f32 v58, v58, v19
  v_sub_f32 v59, v59, v19
  v_sub_f32 v60, v60, v19
  v_sub_f32 v61, v61, v19
  v_sub_f32 v62, v62, v19
  v_sub_f32 v63, v63, v19
  v_mul_f32 v17, v17, v20
  v_mul_f32 v18, v18, v20
  v_mul_f32 v64, v64, v20
  v_mul_f32 v65, v65, v20
  v_mul_f32 v66, v66, v20
  v_mul_f32 v67, v67, v20
  v_mul_f32 v68, v68, v20
  v_mul_f32 v69, v69, v20
  v_mul_f32 v70, v70, v20
  v_mul_f32 v71, v71, v20
  v_mul_f32 v72, v72, v20
  v_mul_f32 v73, v73, v20
  v_mul_f32 v74, v74, v20
  v_mul_f32 v75, v75, v20
  v_mul_f32 v76, v76, v20
  v_mul_f32 v77, v77, v20
  v_mul_f32 v78, v78, v20
  v_mul_f32 v79, v79, v20
  v_mul_f32 v80, v80, v20
  v_mul_f32 v81, v81, v20
  v_mul_f32 v82, v82, v20
  v_mul_f32 v83, v83, v20
  v_mul_f32 v84, v84, v20
  v_mul_f32 v85, v85, v20
  v_mul_f32 v86, v86, v20
  v_mul_f32 v87, v87, v20
  v_mul_f32 v88, v88, v20
  v_mul_f32 v89, v89, v20
  v_mul_f32 v90, v90, v20
  v_mul_f32 v91, v91, v20
  v_mul_f32 v92, v92, v20
  v_mul_f32 v93, v93, v20
  v_mul_f32 v94, v94, v20
  v_mul_f32 v95, v95, v20
  v_mul_f32 v96, v96, v20
  v_mul_f32 v97, v97, v20
  v_mul_f32 v98, v98, v20
  v_mul_f32 v99, v99, v20
  v_mul_f32 v100, v100, v20
  v_mul_f32 v101, v101, v20
  v_mul_f32 v102, v102, v20
  v_mul_f32 v103, v103, v20
  v_mul_f32 v104, v104, v20
  v_mul_f32 v105, v105, v20
  v_mul_f32 v106, v106, v20
  v_mul_f32 v107, v107, v20
  v_mul_f32 v108, v108, v20
  v_mul_f32 v109, v109, v20
  v_mul_f32 v110, v110, v20
  v_mul_f32 v111, v111, v20
  v_mul_f32 v112, v112, v20
  v_mul_f32 v113, v113, v20
  v_mul_f32 v114, v114, v20
  v_mul_f32 v115, v115, v20
  v_mul_f32 v116, v116, v20
  v_mul_f32 v117, v117, v20
  v_mul_f32 v118, v118, v20
  v_mul_f32 v119, v119, v20
  v_mul_f32 v120, v120, v20
  v_mul_f32 v121, v121, v20
  v_mul_f32 v122, v122, v20
  v_mul_f32 v123, v123, v20
  v_mul_f32 v124, v124, v20
  v_mul_f32 v125, v125, v20
  v_mul_f32 v126, v126, v20
  v_mul_f32 v127, v127, v20
  s_branch Lback_119
Lrare_128:
  v_mov_b32 v1, v19
  s_nop 1
  v_permlane32_swap_b32 v19, v1
  s_nop 1
  v_max_f32 v19, v19, v1
  v_max_f32 v19, 0, v19
  v_sub_f32 v20, 0, v19
  v_exp_f32 v20, v20
  v_sub_f32 v144, v144, v19
  v_sub_f32 v145, v145, v19
  v_sub_f32 v146, v146, v19
  v_sub_f32 v147, v147, v19
  v_sub_f32 v148, v148, v19
  v_sub_f32 v149, v149, v19
  v_sub_f32 v150, v150, v19
  v_sub_f32 v151, v151, v19
  v_sub_f32 v152, v152, v19
  v_sub_f32 v153, v153, v19
  v_sub_f32 v154, v154, v19
  v_sub_f32 v155, v155, v19
  v_sub_f32 v156, v156, v19
  v_sub_f32 v157, v157, v19
  v_sub_f32 v158, v158, v19
  v_sub_f32 v159, v159, v19
  v_sub_f32 v48, v48, v19
  v_sub_f32 v49, v49, v19
  v_sub_f32 v50, v50, v19
  v_sub_f32 v51, v51, v19
  v_sub_f32 v52, v52, v19
  v_sub_f32 v53, v53, v19
  v_sub_f32 v54, v54, v19
  v_sub_f32 v55, v55, v19
  v_sub_f32 v56, v56, v19
  v_sub_f32 v57, v57, v19
  v_sub_f32 v58, v58, v19
  v_sub_f32 v59, v59, v19
  v_sub_f32 v60, v60, v19
  v_sub_f32 v61, v61, v19
  v_sub_f32 v62, v62, v19
  v_sub_f32 v63, v63, v19
  v_mul_f32 v17, v17, v20
  v_mul_f32 v18, v18, v20
  v_mul_f32 v64, v64, v20
  v_mul_f32 v65, v65, v20
  v_mul_f32 v66, v66, v20
  v_mul_f32 v67, v67, v20
  v_mul_f32 v68, v68, v20
  v_mul_f32 v69, v69, v20
  v_mul_f32 v70, v70, v20
  v_mul_f32 v71, v71, v20
  v_mul_f32 v72, v72, v20
  v_mul_f32 v73, v73, v20
  v_mul_f32 v74, v74, v20
  v_mul_f32 v75, v75, v20
  v_mul_f32 v76, v76, v20
  v_mul_f32 v77, v77, v20
  v_mul_f32 v78, v78, v20
  v_mul_f32 v79, v79, v20
  v_mul_f32 v80, v80, v20
  v_mul_f32 v81, v81, v20
  v_mul_f32 v82, v82, v20
  v_mul_f32 v83, v83, v20
  v_mul_f32 v84, v84, v20
  v_mul_f32 v85, v85, v20
  v_mul_f32 v86, v86, v20
  v_mul_f32 v87, v87, v20
  v_mul_f32 v88, v88, v20
  v_mul_f32 v89, v89, v20
  v_mul_f32 v90, v90, v20
  v_mul_f32 v91, v91, v20
  v_mul_f32 v92, v92, v20
  v_mul_f32 v93, v93, v20
  v_mul_f32 v94, v94, v20
  v_mul_f32 v95, v95, v20
  v_mul_f32 v96, v96, v20
  v_mul_f32 v97, v97, v20
  v_mul_f32 v98, v98, v20
  v_mul_f32 v99, v99, v20
  v_mul_f32 v100, v100, v20
  v_mul_f32 v101, v101, v20
  v_mul_f32 v102, v102, v20
  v_mul_f32 v103, v103, v20
  v_mul_f32 v104, v104, v20
  v_mul_f32 v105, v105, v20
  v_mul_f32 v106, v106, v20
  v_mul_f32 v107, v107, v20
  v_mul_f32 v108, v108, v20
  v_mul_f32 v109, v109, v20
  v_mul_f32 v110, v110, v20
  v_mul_f32 v111, v111, v20
  v_mul_f32 v112, v112, v20
  v_mul_f32 v113, v113, v20
  v_mul_f32 v114, v114, v20
  v_mul_f32 v115, v115, v20
  v_mul_f32 v116, v116, v20
  v_mul_f32 v117, v117, v20
  v_mul_f32 v118, v118, v20
  v_mul_f32 v119, v119, v20
  v_mul_f32 v120, v120, v20
  v_mul_f32 v121, v121, v20
  v_mul_f32 v122, v122, v20
  v_mul_f32 v123, v123, v20
  v_mul_f32 v124, v124, v20
  v_mul_f32 v125, v125, v20
  v_mul_f32 v126, v126, v20
  v_mul_f32 v127, v127, v20
  s_branch Lback_129
Lrare_132:
  v_mov_b32 v1, v19
  s_nop 1
  v_permlane32_swap_b32 v19, v1
  s_nop 1
  v_max_f32 v19, v19, v1
  v_max_f32 v19, 0, v19
  v_sub_f32 v20, 0, v19
  v_exp_f32 v20, v20
  v_sub_f32 v128, v128, v19
  v_sub_f32 v129, v129, v19
  v_sub_f32 v130, v130, v19
  v_sub_f32 v131, v131, v19
  v_sub_f32 v132, v132, v19
  v_sub_f32 v133, v133, v19
  v_sub_f32 v134, v134, v19
  v_sub_f32 v135, v135, v19
  v_sub_f32 v136, v136, v19
  v_sub_f32 v137, v137, v19
  v_sub_f32 v138, v138, v19
  v_sub_f32 v139, v139, v19
  v_sub_f32 v140, v140, v19
  v_sub_f32 v141, v141, v19
  v_sub_f32 v142, v142, v19
  v_sub_f32 v143, v143, v19
  v_sub_f32 v48, v48, v19
  v_sub_f32 v49, v49, v19
  v_sub_f32 v50, v50, v19
  v_sub_f32 v51, v51, v19
  v_sub_f32 v52, v52, v19
  v_sub_f32 v53, v53, v19
  v_sub_f32 v54, v54, v19
  v_sub_f32 v55, v55, v19
  v_sub_f32 v56, v56, v19
  v_sub_f32 v57, v57, v19
  v_sub_f32 v58, v58, v19
  v_sub_f32 v59, v59, v19
  v_sub_f32 v60, v60, v19
  v_sub_f32 v61, v61, v19
  v_sub_f32 v62, v62, v19
  v_sub_f32 v63, v63, v19
  v_mul_f32 v17, v17, v20
  v_mul_f32 v18, v18, v20
  v_mul_f32 v64, v64, v20
  v_mul_f32 v65, v65, v20
  v_mul_f32 v66, v66, v20
  v_mul_f32 v67, v67, v20
  v_mul_f32 v68, v68, v20
  v_mul_f32 v69, v69, v20
  v_mul_f32 v70, v70, v20
  v_mul_f32 v71, v71, v20
  v_mul_f32 v72, v72, v20
  v_mul_f32 v73, v73, v20
  v_mul_f32 v74, v74, v20
  v_mul_f32 v75, v75, v20
  v_mul_f32 v76, v76, v20
  v_mul_f32 v77, v77, v20
  v_mul_f32 v78, v78, v20
  v_mul_f32 v79, v79, v20
  v_mul_f32 v80, v80, v20
  v_mul_f32 v81, v81, v20
  v_mul_f32 v82, v82, v20
  v_mul_f32 v83, v83, v20
  v_mul_f32 v84, v84, v20
  v_mul_f32 v85, v85, v20
  v_mul_f32 v86, v86, v20
  v_mul_f32 v87, v87, v20
  v_mul_f32 v88, v88, v20
  v_mul_f32 v89, v89, v20
  v_mul_f32 v90, v90, v20
  v_mul_f32 v91, v91, v20
  v_mul_f32 v92, v92, v20
  v_mul_f32 v93, v93, v20
  v_mul_f32 v94, v94, v20
  v_mul_f32 v95, v95, v20
  v_mul_f32 v96, v96, v20
  v_mul_f32 v97, v97, v20
  v_mul_f32 v98, v98, v20
  v_mul_f32 v99, v99, v20
  v_mul_f32 v100, v100, v20
  v_mul_f32 v101, v101, v20
  v_mul_f32 v102, v102, v20
  v_mul_f32 v103, v103, v20
  v_mul_f32 v104, v104, v20
  v_mul_f32 v105, v105, v20
  v_mul_f32 v106, v106, v20
  v_mul_f32 v107, v107, v20
  v_mul_f32 v108, v108, v20
  v_mul_f32 v109, v109, v20
  v_mul_f32 v110, v110, v20
  v_mul_f32 v111, v111, v20
  v_mul_f32 v112, v112, v20
  v_mul_f32 v113, v113, v20
  v_mul_f32 v114, v114, v20
  v_mul_f32 v115, v115, v20
  v_mul_f32 v116, v116, v20
  v_mul_f32 v117, v117, v20
  v_mul_f32 v118, v118, v20
  v_mul_f32 v119, v119, v20
  v_mul_f32 v120, v120, v20
  v_mul_f32 v121, v121, v20
  v_mul_f32 v122, v122, v20
  v_mul_f32 v123, v123, v20
  v_mul_f32 v124, v124, v20
  v_mul_f32 v125, v125, v20
  v_mul_f32 v126, v126, v20
  v_mul_f32 v127, v127, v20
  s_branch Lback_133
Lrare_140:
  v_mov_b32 v1, v19
  s_nop 1
  v_permlane32_swap_b32 v19, v1
  s_nop 1
  v_max_f32 v19, v19, v1
  v_max_f32 v19, 0, v19
  v_sub_f32 v20, 0, v19
  v_exp_f32 v20, v20
  v_sub_f32 v144, v144, v19
  v_sub_f32 v145, v145, v19
  v_sub_f32 v146, v146, v19
  v_sub_f32 v147, v147, v19
  v_sub_f32 v148, v148, v19
  v_sub_f32 v149, v149, v19
  v_sub_f32 v150, v150, v19
  v_sub_f32 v151, v151, v19
  v_sub_f32 v152, v152, v19
  v_sub_f32 v153, v153, v19
  v_sub_f32 v154, v154, v19
  v_sub_f32 v155, v155, v19
  v_sub_f32 v156, v156, v19
  v_sub_f32 v157, v157, v19
  v_sub_f32 v158, v158, v19
  v_sub_f32 v159, v159, v19
  v_sub_f32 v48, v48, v19
  v_sub_f32 v49, v49, v19
  v_sub_f32 v50, v50, v19
  v_sub_f32 v51, v51, v19
  v_sub_f32 v52, v52, v19
  v_sub_f32 v53, v53, v19
  v_sub_f32 v54, v54, v19
  v_sub_f32 v55, v55, v19
  v_sub_f32 v56, v56, v19
  v_sub_f32 v57, v57, v19
  v_sub_f32 v58, v58, v19
  v_sub_f32 v59, v59, v19
  v_sub_f32 v60, v60, v19
  v_sub_f32 v61, v61, v19
  v_sub_f32 v62, v62, v19
  v_sub_f32 v63, v63, v19
  v_mul_f32 v17, v17, v20
  v_mul_f32 v18, v18, v20
  v_mul_f32 v64, v64, v20
  v_mul_f32 v65, v65, v20
  v_mul_f32 v66, v66, v20
  v_mul_f32 v67, v67, v20
  v_mul_f32 v68, v68, v20
  v_mul_f32 v69, v69, v20
  v_mul_f32 v70, v70, v20
  v_mul_f32 v71, v71, v20
  v_mul_f32 v72, v72, v20
  v_mul_f32 v73, v73, v20
  v_mul_f32 v74, v74, v20
  v_mul_f32 v75, v75, v20
  v_mul_f32 v76, v76, v20
  v_mul_f32 v77, v77, v20
  v_mul_f32 v78, v78, v20
  v_mul_f32 v79, v79, v20
  v_mul_f32 v80, v80, v20
  v_mul_f32 v81, v81, v20
  v_mul_f32 v82, v82, v20
  v_mul_f32 v83, v83, v20
  v_mul_f32 v84, v84, v20
  v_mul_f32 v85, v85, v20
  v_mul_f32 v86, v86, v20
  v_mul_f32 v87, v87, v20
  v_mul_f32 v88, v88, v20
  v_mul_f32 v89, v89, v20
  v_mul_f32 v90, v90, v20
  v_mul_f32 v91, v91, v20
  v_mul_f32 v92, v92, v20
  v_mul_f32 v93, v93, v20
  v_mul_f32 v94, v94, v20
  v_mul_f32 v95, v95, v20
  v_mul_f32 v96, v96, v20
  v_mul_f32 v97, v97, v20
  v_mul_f32 v98, v98, v20
  v_mul_f32 v99, v99, v20
  v_mul_f32 v100, v100, v20
  v_mul_f32 v101, v101, v20
  v_mul_f32 v102, v102, v20
  v_mul_f32 v103, v103, v20
  v_mul_f32 v104, v104, v20
  v_mul_f32 v105, v105, v20
  v_mul_f32 v106, v106, v20
  v_mul_f32 v107, v107, v20
  v_mul_f32 v108, v108, v20
  v_mul_f32 v109, v109, v20
  v_mul_f32 v110, v110, v20
  v_mul_f32 v111, v111, v20
  v_mul_f32 v112, v112, v20
  v_mul_f32 v113, v113, v20
  v_mul_f32 v114, v114, v20
  v_mul_f32 v115, v115, v20
  v_mul_f32 v116, v116, v20
  v_mul_f32 v117, v117, v20
  v_mul_f32 v118, v118, v20
  v_mul_f32 v119, v119, v20
  v_mul_f32 v120, v120, v20
  v_mul_f32 v121, v121, v20
  v_mul_f32 v122, v122, v20
  v_mul_f32 v123, v123, v20
  v_mul_f32 v124, v124, v20
  v_mul_f32 v125, v125, v20
  v_mul_f32 v126, v126, v20
  v_mul_f32 v127, v127, v20
  s_branch Lback_141
Lrare_144:
  v_mov_b32 v1, v19
  s_nop 1
  v_permlane32_swap_b32 v19, v1
  s_nop 1
  v_max_f32 v19, v19, v1
  v_max_f32 v19, 0, v19
  v_sub_f32 v20, 0, v19
  v_exp_f32 v20, v20
  v_sub_f32 v128, v128, v19
  v_sub_f32 v129, v129, v19
  v_sub_f32 v130, v130, v19
  v_sub_f32 v131, v131, v19
  v_sub_f32 v132, v132, v19
  v_sub_f32 v133, v133, v19
  v_sub_f32 v134, v134, v19
  v_sub_f32 v135, v135, v19
  v_sub_f32 v136, v136, v19
  v_sub_f32 v137, v137, v19
  v_sub_f32 v138, v138, v19
  v_sub_f32 v139, v139, v19
  v_sub_f32 v140, v140, v19
  v_sub_f32 v141, v141, v19
  v_sub_f32 v142, v142, v19
  v_sub_f32 v143, v143, v19
  v_sub_f32 v48, v48, v19
  v_sub_f32 v49, v49, v19
  v_sub_f32 v50, v50, v19
  v_sub_f32 v51, v51, v19
  v_sub_f32 v52, v52, v19
  v_sub_f32 v53, v53, v19
  v_sub_f32 v54, v54, v19
  v_sub_f32 v55, v55, v19
  v_sub_f32 v56, v56, v19
  v_sub_f32 v57, v57, v19
  v_sub_f32 v58, v58, v19
  v_sub_f32 v59, v59, v19
  v_sub_f32 v60, v60, v19
  v_sub_f32 v61, v61, v19
  v_sub_f32 v62, v62, v19
  v_sub_f32 v63, v63, v19
  v_mul_f32 v17, v17, v20
  v_mul_f32 v18, v18, v20
  v_mul_f32 v64, v64, v20
  v_mul_f32 v65, v65, v20
  v_mul_f32 v66, v66, v20
  v_mul_f32 v67, v67, v20
  v_mul_f32 v68, v68, v20
  v_mul_f32 v69, v69, v20
  v_mul_f32 v70, v70, v20
  v_mul_f32 v71, v71, v20
  v_mul_f32 v72, v72, v20
  v_mul_f32 v73, v73, v20
  v_mul_f32 v74, v74, v20
  v_mul_f32 v75, v75, v20
  v_mul_f32 v76, v76, v20
  v_mul_f32 v77, v77, v20
  v_mul_f32 v78, v78, v20
  v_mul_f32 v79, v79, v20
  v_mul_f32 v80, v80, v20
  v_mul_f32 v81, v81, v20
  v_mul_f32 v82, v82, v20
  v_mul_f32 v83, v83, v20
  v_mul_f32 v84, v84, v20
  v_mul_f32 v85, v85, v20
  v_mul_f32 v86, v86, v20
  v_mul_f32 v87, v87, v20
  v_mul_f32 v88, v88, v20
  v_mul_f32 v89, v89, v20
  v_mul_f32 v90, v90, v20
  v_mul_f32 v91, v91, v20
  v_mul_f32 v92, v92, v20
  v_mul_f32 v93, v93, v20
  v_mul_f32 v94, v94, v20
  v_mul_f32 v95, v95, v20
  v_mul_f32 v96, v96, v20
  v_mul_f32 v97, v97, v20
  v_mul_f32 v98, v98, v20
  v_mul_f32 v99, v99, v20
  v_mul_f32 v100, v100, v20
  v_mul_f32 v101, v101, v20
  v_mul_f32 v102, v102, v20
  v_mul_f32 v103, v103, v20
  v_mul_f32 v104, v104, v20
  v_mul_f32 v105, v105, v20
  v_mul_f32 v106, v106, v20
  v_mul_f32 v107, v107, v20
  v_mul_f32 v108, v108, v20
  v_mul_f32 v109, v109, v20
  v_mul_f32 v110, v110, v20
  v_mul_f32 v111, v111, v20
  v_mul_f32 v112, v112, v20
  v_mul_f32 v113, v113, v20
  v_mul_f32 v114, v114, v20
  v_mul_f32 v115, v115, v20
  v_mul_f32 v116, v116, v20
  v_mul_f32 v117, v117, v20
  v_mul_f32 v118, v118, v20
  v_mul_f32 v119, v119, v20
  v_mul_f32 v120, v120, v20
  v_mul_f32 v121, v121, v20
  v_mul_f32 v122, v122, v20
  v_mul_f32 v123, v123, v20
  v_mul_f32 v124, v124, v20
  v_mul_f32 v125, v125, v20
  v_mul_f32 v126, v126, v20
  v_mul_f32 v127, v127, v20
  s_branch Lback_145
Lrare_152:
  v_mov_b32 v1, v19
  s_nop 1
  v_permlane32_swap_b32 v19, v1
  s_nop 1
  v_max_f32 v19, v19, v1
  v_max_f32 v19, 0, v19
  v_sub_f32 v20, 0, v19
  v_exp_f32 v20, v20
  v_sub_f32 v144, v144, v19
  v_sub_f32 v145, v145, v19
  v_sub_f32 v146, v146, v19
  v_sub_f32 v147, v147, v19
  v_sub_f32 v148, v148, v19
  v_sub_f32 v149, v149, v19
  v_sub_f32 v150, v150, v19
  v_sub_f32 v151, v151, v19
  v_sub_f32 v152, v152, v19
  v_sub_f32 v153, v153, v19
  v_sub_f32 v154, v154, v19
  v_sub_f32 v155, v155, v19
  v_sub_f32 v156, v156, v19
  v_sub_f32 v157, v157, v19
  v_sub_f32 v158, v158, v19
  v_sub_f32 v159, v159, v19
  v_sub_f32 v48, v48, v19
  v_sub_f32 v49, v49, v19
  v_sub_f32 v50, v50, v19
  v_sub_f32 v51, v51, v19
  v_sub_f32 v52, v52, v19
  v_sub_f32 v53, v53, v19
  v_sub_f32 v54, v54, v19
  v_sub_f32 v55, v55, v19
  v_sub_f32 v56, v56, v19
  v_sub_f32 v57, v57, v19
  v_sub_f32 v58, v58, v19
  v_sub_f32 v59, v59, v19
  v_sub_f32 v60, v60, v19
  v_sub_f32 v61, v61, v19
  v_sub_f32 v62, v62, v19
  v_sub_f32 v63, v63, v19
  v_mul_f32 v17, v17, v20
  v_mul_f32 v18, v18, v20
  v_mul_f32 v64, v64, v20
  v_mul_f32 v65, v65, v20
  v_mul_f32 v66, v66, v20
  v_mul_f32 v67, v67, v20
  v_mul_f32 v68, v68, v20
  v_mul_f32 v69, v69, v20
  v_mul_f32 v70, v70, v20
  v_mul_f32 v71, v71, v20
  v_mul_f32 v72, v72, v20
  v_mul_f32 v73, v73, v20
  v_mul_f32 v74, v74, v20
  v_mul_f32 v75, v75, v20
  v_mul_f32 v76, v76, v20
  v_mul_f32 v77, v77, v20
  v_mul_f32 v78, v78, v20
  v_mul_f32 v79, v79, v20
  v_mul_f32 v80, v80, v20
  v_mul_f32 v81, v81, v20
  v_mul_f32 v82, v82, v20
  v_mul_f32 v83, v83, v20
  v_mul_f32 v84, v84, v20
  v_mul_f32 v85, v85, v20
  v_mul_f32 v86, v86, v20
  v_mul_f32 v87, v87, v20
  v_mul_f32 v88, v88, v20
  v_mul_f32 v89, v89, v20
  v_mul_f32 v90, v90, v20
  v_mul_f32 v91, v91, v20
  v_mul_f32 v92, v92, v20
  v_mul_f32 v93, v93, v20
  v_mul_f32 v94, v94, v20
  v_mul_f32 v95, v95, v20
  v_mul_f32 v96, v96, v20
  v_mul_f32 v97, v97, v20
  v_mul_f32 v98, v98, v20
  v_mul_f32 v99, v99, v20
  v_mul_f32 v100, v100, v20
  v_mul_f32 v101, v101, v20
  v_mul_f32 v102, v102, v20
  v_mul_f32 v103, v103, v20
  v_mul_f32 v104, v104, v20
  v_mul_f32 v105, v105, v20
  v_mul_f32 v106, v106, v20
  v_mul_f32 v107, v107, v20
  v_mul_f32 v108, v108, v20
  v_mul_f32 v109, v109, v20
  v_mul_f32 v110, v110, v20
  v_mul_f32 v111, v111, v20
  v_mul_f32 v112, v112, v20
  v_mul_f32 v113, v113, v20
  v_mul_f32 v114, v114, v20
  v_mul_f32 v115, v115, v20
  v_mul_f32 v116, v116, v20
  v_mul_f32 v117, v117, v20
  v_mul_f32 v118, v118, v20
  v_mul_f32 v119, v119, v20
  v_mul_f32 v120, v120, v20
  v_mul_f32 v121, v121, v20
  v_mul_f32 v122, v122, v20
  v_mul_f32 v123, v123, v20
  v_mul_f32 v124, v124, v20
  v_mul_f32 v125, v125, v20
  v_mul_f32 v126, v126, v20
  v_mul_f32 v127, v127, v20
  s_branch Lback_153
Lrare_156:
  v_mov_b32 v1, v19
  s_nop 1
  v_permlane32_swap_b32 v19, v1
  s_nop 1
  v_max_f32 v19, v19, v1
  v_max_f32 v19, 0, v19
  v_sub_f32 v20, 0, v19
  v_exp_f32 v20, v20
  v_sub_f32 v128, v128, v19
  v_sub_f32 v129, v129, v19
  v_sub_f32 v130, v130, v19
  v_sub_f32 v131, v131, v19
  v_sub_f32 v132, v132, v19
  v_sub_f32 v133, v133, v19
  v_sub_f32 v134, v134, v19
  v_sub_f32 v135, v135, v19
  v_sub_f32 v136, v136, v19
  v_sub_f32 v137, v137, v19
  v_sub_f32 v138, v138, v19
  v_sub_f32 v139, v139, v19
  v_sub_f32 v140, v140, v19
  v_sub_f32 v141, v141, v19
  v_sub_f32 v142, v142, v19
  v_sub_f32 v143, v143, v19
  v_sub_f32 v48, v48, v19
  v_sub_f32 v49, v49, v19
  v_sub_f32 v50, v50, v19
  v_sub_f32 v51, v51, v19
  v_sub_f32 v52, v52, v19
  v_sub_f32 v53, v53, v19
  v_sub_f32 v54, v54, v19
  v_sub_f32 v55, v55, v19
  v_sub_f32 v56, v56, v19
  v_sub_f32 v57, v57, v19
  v_sub_f32 v58, v58, v19
  v_sub_f32 v59, v59, v19
  v_sub_f32 v60, v60, v19
  v_sub_f32 v61, v61, v19
  v_sub_f32 v62, v62, v19
  v_sub_f32 v63, v63, v19
  v_mul_f32 v17, v17, v20
  v_mul_f32 v18, v18, v20
  v_mul_f32 v64, v64, v20
  v_mul_f32 v65, v65, v20
  v_mul_f32 v66, v66, v20
  v_mul_f32 v67, v67, v20
  v_mul_f32 v68, v68, v20
  v_mul_f32 v69, v69, v20
  v_mul_f32 v70, v70, v20
  v_mul_f32 v71, v71, v20
  v_mul_f32 v72, v72, v20
  v_mul_f32 v73, v73, v20
  v_mul_f32 v74, v74, v20
  v_mul_f32 v75, v75, v20
  v_mul_f32 v76, v76, v20
  v_mul_f32 v77, v77, v20
  v_mul_f32 v78, v78, v20
  v_mul_f32 v79, v79, v20
  v_mul_f32 v80, v80, v20
  v_mul_f32 v81, v81, v20
  v_mul_f32 v82, v82, v20
  v_mul_f32 v83, v83, v20
  v_mul_f32 v84, v84, v20
  v_mul_f32 v85, v85, v20
  v_mul_f32 v86, v86, v20
  v_mul_f32 v87, v87, v20
  v_mul_f32 v88, v88, v20
  v_mul_f32 v89, v89, v20
  v_mul_f32 v90, v90, v20
  v_mul_f32 v91, v91, v20
  v_mul_f32 v92, v92, v20
  v_mul_f32 v93, v93, v20
  v_mul_f32 v94, v94, v20
  v_mul_f32 v95, v95, v20
  v_mul_f32 v96, v96, v20
  v_mul_f32 v97, v97, v20
  v_mul_f32 v98, v98, v20
  v_mul_f32 v99, v99, v20
  v_mul_f32 v100, v100, v20
  v_mul_f32 v101, v101, v20
  v_mul_f32 v102, v102, v20
  v_mul_f32 v103, v103, v20
  v_mul_f32 v104, v104, v20
  v_mul_f32 v105, v105, v20
  v_mul_f32 v106, v106, v20
  v_mul_f32 v107, v107, v20
  v_mul_f32 v108, v108, v20
  v_mul_f32 v109, v109, v20
  v_mul_f32 v110, v110, v20
  v_mul_f32 v111, v111, v20
  v_mul_f32 v112, v112, v20
  v_mul_f32 v113, v113, v20
  v_mul_f32 v114, v114, v20
  v_mul_f32 v115, v115, v20
  v_mul_f32 v116, v116, v20
  v_mul_f32 v117, v117, v20
  v_mul_f32 v118, v118, v20
  v_mul_f32 v119, v119, v20
  v_mul_f32 v120, v120, v20
  v_mul_f32 v121, v121, v20
  v_mul_f32 v122, v122, v20
  v_mul_f32 v123, v123, v20
  v_mul_f32 v124, v124, v20
  v_mul_f32 v125, v125, v20
  v_mul_f32 v126, v126, v20
  v_mul_f32 v127, v127, v20
  s_branch Lback_157
Lrare_164:
  v_mov_b32 v1, v19
  s_nop 1
  v_permlane32_swap_b32 v19, v1
  s_nop 1
  v_max_f32 v19, v19, v1
  v_max_f32 v19, 0, v19
  v_sub_f32 v20, 0, v19
  v_exp_f32 v20, v20
  v_sub_f32 v144, v144, v19
  v_sub_f32 v145, v145, v19
  v_sub_f32 v146, v146, v19
  v_sub_f32 v147, v147, v19
  v_sub_f32 v148, v148, v19
  v_sub_f32 v149, v149, v19
  v_sub_f32 v150, v150, v19
  v_sub_f32 v151, v151, v19
  v_sub_f32 v152, v152, v19
  v_sub_f32 v153, v153, v19
  v_sub_f32 v154, v154, v19
  v_sub_f32 v155, v155, v19
  v_sub_f32 v156, v156, v19
  v_sub_f32 v157, v157, v19
  v_sub_f32 v158, v158, v19
  v_sub_f32 v159, v159, v19
  v_sub_f32 v48, v48, v19
  v_sub_f32 v49, v49, v19
  v_sub_f32 v50, v50, v19
  v_sub_f32 v51, v51, v19
  v_sub_f32 v52, v52, v19
  v_sub_f32 v53, v53, v19
  v_sub_f32 v54, v54, v19
  v_sub_f32 v55, v55, v19
  v_sub_f32 v56, v56, v19
  v_sub_f32 v57, v57, v19
  v_sub_f32 v58, v58, v19
  v_sub_f32 v59, v59, v19
  v_sub_f32 v60, v60, v19
  v_sub_f32 v61, v61, v19
  v_sub_f32 v62, v62, v19
  v_sub_f32 v63, v63, v19
  v_mul_f32 v17, v17, v20
  v_mul_f32 v18, v18, v20
  v_mul_f32 v64, v64, v20
  v_mul_f32 v65, v65, v20
  v_mul_f32 v66, v66, v20
  v_mul_f32 v67, v67, v20
  v_mul_f32 v68, v68, v20
  v_mul_f32 v69, v69, v20
  v_mul_f32 v70, v70, v20
  v_mul_f32 v71, v71, v20
  v_mul_f32 v72, v72, v20
  v_mul_f32 v73, v73, v20
  v_mul_f32 v74, v74, v20
  v_mul_f32 v75, v75, v20
  v_mul_f32 v76, v76, v20
  v_mul_f32 v77, v77, v20
  v_mul_f32 v78, v78, v20
  v_mul_f32 v79, v79, v20
  v_mul_f32 v80, v80, v20
  v_mul_f32 v81, v81, v20
  v_mul_f32 v82, v82, v20
  v_mul_f32 v83, v83, v20
  v_mul_f32 v84, v84, v20
  v_mul_f32 v85, v85, v20
  v_mul_f32 v86, v86, v20
  v_mul_f32 v87, v87, v20
  v_mul_f32 v88, v88, v20
  v_mul_f32 v89, v89, v20
  v_mul_f32 v90, v90, v20
  v_mul_f32 v91, v91, v20
  v_mul_f32 v92, v92, v20
  v_mul_f32 v93, v93, v20
  v_mul_f32 v94, v94, v20
  v_mul_f32 v95, v95, v20
  v_mul_f32 v96, v96, v20
  v_mul_f32 v97, v97, v20
  v_mul_f32 v98, v98, v20
  v_mul_f32 v99, v99, v20
  v_mul_f32 v100, v100, v20
  v_mul_f32 v101, v101, v20
  v_mul_f32 v102, v102, v20
  v_mul_f32 v103, v103, v20
  v_mul_f32 v104, v104, v20
  v_mul_f32 v105, v105, v20
  v_mul_f32 v106, v106, v20
  v_mul_f32 v107, v107, v20
  v_mul_f32 v108, v108, v20
  v_mul_f32 v109, v109, v20
  v_mul_f32 v110, v110, v20
  v_mul_f32 v111, v111, v20
  v_mul_f32 v112, v112, v20
  v_mul_f32 v113, v113, v20
  v_mul_f32 v114, v114, v20
  v_mul_f32 v115, v115, v20
  v_mul_f32 v116, v116, v20
  v_mul_f32 v117, v117, v20
  v_mul_f32 v118, v118, v20
  v_mul_f32 v119, v119, v20
  v_mul_f32 v120, v120, v20
  v_mul_f32 v121, v121, v20
  v_mul_f32 v122, v122, v20
  v_mul_f32 v123, v123, v20
  v_mul_f32 v124, v124, v20
  v_mul_f32 v125, v125, v20
  v_mul_f32 v126, v126, v20
  v_mul_f32 v127, v127, v20
  s_branch Lback_165
Lrare_168:
  v_mov_b32 v1, v19
  s_nop 1
  v_permlane32_swap_b32 v19, v1
  s_nop 1
  v_max_f32 v19, v19, v1
  v_max_f32 v19, 0, v19
  v_sub_f32 v20, 0, v19
  v_exp_f32 v20, v20
  v_sub_f32 v128, v128, v19
  v_sub_f32 v129, v129, v19
  v_sub_f32 v130, v130, v19
  v_sub_f32 v131, v131, v19
  v_sub_f32 v132, v132, v19
  v_sub_f32 v133, v133, v19
  v_sub_f32 v134, v134, v19
  v_sub_f32 v135, v135, v19
  v_sub_f32 v136, v136, v19
  v_sub_f32 v137, v137, v19
  v_sub_f32 v138, v138, v19
  v_sub_f32 v139, v139, v19
  v_sub_f32 v140, v140, v19
  v_sub_f32 v141, v141, v19
  v_sub_f32 v142, v142, v19
  v_sub_f32 v143, v143, v19
  v_sub_f32 v48, v48, v19
  v_sub_f32 v49, v49, v19
  v_sub_f32 v50, v50, v19
  v_sub_f32 v51, v51, v19
  v_sub_f32 v52, v52, v19
  v_sub_f32 v53, v53, v19
  v_sub_f32 v54, v54, v19
  v_sub_f32 v55, v55, v19
  v_sub_f32 v56, v56, v19
  v_sub_f32 v57, v57, v19
  v_sub_f32 v58, v58, v19
  v_sub_f32 v59, v59, v19
  v_sub_f32 v60, v60, v19
  v_sub_f32 v61, v61, v19
  v_sub_f32 v62, v62, v19
  v_sub_f32 v63, v63, v19
  v_mul_f32 v17, v17, v20
  v_mul_f32 v18, v18, v20
  v_mul_f32 v64, v64, v20
  v_mul_f32 v65, v65, v20
  v_mul_f32 v66, v66, v20
  v_mul_f32 v67, v67, v20
  v_mul_f32 v68, v68, v20
  v_mul_f32 v69, v69, v20
  v_mul_f32 v70, v70, v20
  v_mul_f32 v71, v71, v20
  v_mul_f32 v72, v72, v20
  v_mul_f32 v73, v73, v20
  v_mul_f32 v74, v74, v20
  v_mul_f32 v75, v75, v20
  v_mul_f32 v76, v76, v20
  v_mul_f32 v77, v77, v20
  v_mul_f32 v78, v78, v20
  v_mul_f32 v79, v79, v20
  v_mul_f32 v80, v80, v20
  v_mul_f32 v81, v81, v20
  v_mul_f32 v82, v82, v20
  v_mul_f32 v83, v83, v20
  v_mul_f32 v84, v84, v20
  v_mul_f32 v85, v85, v20
  v_mul_f32 v86, v86, v20
  v_mul_f32 v87, v87, v20
  v_mul_f32 v88, v88, v20
  v_mul_f32 v89, v89, v20
  v_mul_f32 v90, v90, v20
  v_mul_f32 v91, v91, v20
  v_mul_f32 v92, v92, v20
  v_mul_f32 v93, v93, v20
  v_mul_f32 v94, v94, v20
  v_mul_f32 v95, v95, v20
  v_mul_f32 v96, v96, v20
  v_mul_f32 v97, v97, v20
  v_mul_f32 v98, v98, v20
  v_mul_f32 v99, v99, v20
  v_mul_f32 v100, v100, v20
  v_mul_f32 v101, v101, v20
  v_mul_f32 v102, v102, v20
  v_mul_f32 v103, v103, v20
  v_mul_f32 v104, v104, v20
  v_mul_f32 v105, v105, v20
  v_mul_f32 v106, v106, v20
  v_mul_f32 v107, v107, v20
  v_mul_f32 v108, v108, v20
  v_mul_f32 v109, v109, v20
  v_mul_f32 v110, v110, v20
  v_mul_f32 v111, v111, v20
  v_mul_f32 v112, v112, v20
  v_mul_f32 v113, v113, v20
  v_mul_f32 v114, v114, v20
  v_mul_f32 v115, v115, v20
  v_mul_f32 v116, v116, v20
  v_mul_f32 v117, v117, v20
  v_mul_f32 v118, v118, v20
  v_mul_f32 v119, v119, v20
  v_mul_f32 v120, v120, v20
  v_mul_f32 v121, v121, v20
  v_mul_f32 v122, v122, v20
  v_mul_f32 v123, v123, v20
  v_mul_f32 v124, v124, v20
  v_mul_f32 v125, v125, v20
  v_mul_f32 v126, v126, v20
  v_mul_f32 v127, v127, v20
  s_branch Lback_169
Lrare_176:
  v_mov_b32 v1, v19
  s_nop 1
  v_permlane32_swap_b32 v19, v1
  s_nop 1
  v_max_f32 v19, v19, v1
  v_max_f32 v19, 0, v19
  v_sub_f32 v20, 0, v19
  v_exp_f32 v20, v20
  v_sub_f32 v144, v144, v19
  v_sub_f32 v145, v145, v19
  v_sub_f32 v146, v146, v19
  v_sub_f32 v147, v147, v19
  v_sub_f32 v148, v148, v19
  v_sub_f32 v149, v149, v19
  v_sub_f32 v150, v150, v19
  v_sub_f32 v151, v151, v19
  v_sub_f32 v152, v152, v19
  v_sub_f32 v153, v153, v19
  v_sub_f32 v154, v154, v19
  v_sub_f32 v155, v155, v19
  v_sub_f32 v156, v156, v19
  v_sub_f32 v157, v157, v19
  v_sub_f32 v158, v158, v19
  v_sub_f32 v159, v159, v19
  v_sub_f32 v48, v48, v19
  v_sub_f32 v49, v49, v19
  v_sub_f32 v50, v50, v19
  v_sub_f32 v51, v51, v19
  v_sub_f32 v52, v52, v19
  v_sub_f32 v53, v53, v19
  v_sub_f32 v54, v54, v19
  v_sub_f32 v55, v55, v19
  v_sub_f32 v56, v56, v19
  v_sub_f32 v57, v57, v19
  v_sub_f32 v58, v58, v19
  v_sub_f32 v59, v59, v19
  v_sub_f32 v60, v60, v19
  v_sub_f32 v61, v61, v19
  v_sub_f32 v62, v62, v19
  v_sub_f32 v63, v63, v19
  v_mul_f32 v17, v17, v20
  v_mul_f32 v18, v18, v20
  v_mul_f32 v64, v64, v20
  v_mul_f32 v65, v65, v20
  v_mul_f32 v66, v66, v20
  v_mul_f32 v67, v67, v20
  v_mul_f32 v68, v68, v20
  v_mul_f32 v69, v69, v20
  v_mul_f32 v70, v70, v20
  v_mul_f32 v71, v71, v20
  v_mul_f32 v72, v72, v20
  v_mul_f32 v73, v73, v20
  v_mul_f32 v74, v74, v20
  v_mul_f32 v75, v75, v20
  v_mul_f32 v76, v76, v20
  v_mul_f32 v77, v77, v20
  v_mul_f32 v78, v78, v20
  v_mul_f32 v79, v79, v20
  v_mul_f32 v80, v80, v20
  v_mul_f32 v81, v81, v20
  v_mul_f32 v82, v82, v20
  v_mul_f32 v83, v83, v20
  v_mul_f32 v84, v84, v20
  v_mul_f32 v85, v85, v20
  v_mul_f32 v86, v86, v20
  v_mul_f32 v87, v87, v20
  v_mul_f32 v88, v88, v20
  v_mul_f32 v89, v89, v20
  v_mul_f32 v90, v90, v20
  v_mul_f32 v91, v91, v20
  v_mul_f32 v92, v92, v20
  v_mul_f32 v93, v93, v20
  v_mul_f32 v94, v94, v20
  v_mul_f32 v95, v95, v20
  v_mul_f32 v96, v96, v20
  v_mul_f32 v97, v97, v20
  v_mul_f32 v98, v98, v20
  v_mul_f32 v99, v99, v20
  v_mul_f32 v100, v100, v20
  v_mul_f32 v101, v101, v20
  v_mul_f32 v102, v102, v20
  v_mul_f32 v103, v103, v20
  v_mul_f32 v104, v104, v20
  v_mul_f32 v105, v105, v20
  v_mul_f32 v106, v106, v20
  v_mul_f32 v107, v107, v20
  v_mul_f32 v108, v108, v20
  v_mul_f32 v109, v109, v20
  v_mul_f32 v110, v110, v20
  v_mul_f32 v111, v111, v20
  v_mul_f32 v112, v112, v20
  v_mul_f32 v113, v113, v20
  v_mul_f32 v114, v114, v20
  v_mul_f32 v115, v115, v20
  v_mul_f32 v116, v116, v20
  v_mul_f32 v117, v117, v20
  v_mul_f32 v118, v118, v20
  v_mul_f32 v119, v119, v20
  v_mul_f32 v120, v120, v20
  v_mul_f32 v121, v121, v20
  v_mul_f32 v122, v122, v20
  v_mul_f32 v123, v123, v20
  v_mul_f32 v124, v124, v20
  v_mul_f32 v125, v125, v20
  v_mul_f32 v126, v126, v20
  v_mul_f32 v127, v127, v20
  s_branch Lback_177
Lrare_180:
  v_mov_b32 v1, v19
  s_nop 1
  v_permlane32_swap_b32 v19, v1
  s_nop 1
  v_max_f32 v19, v19, v1
  v_max_f32 v19, 0, v19
  v_sub_f32 v20, 0, v19
  v_exp_f32 v20, v20
  v_sub_f32 v128, v128, v19
  v_sub_f32 v129, v129, v19
  v_sub_f32 v130, v130, v19
  v_sub_f32 v131, v131, v19
  v_sub_f32 v132, v132, v19
  v_sub_f32 v133, v133, v19
  v_sub_f32 v134, v134, v19
  v_sub_f32 v135, v135, v19
  v_sub_f32 v136, v136, v19
  v_sub_f32 v137, v137, v19
  v_sub_f32 v138, v138, v19
  v_sub_f32 v139, v139, v19
  v_sub_f32 v140, v140, v19
  v_sub_f32 v141, v141, v19
  v_sub_f32 v142, v142, v19
  v_sub_f32 v143, v143, v19
  v_sub_f32 v48, v48, v19
  v_sub_f32 v49, v49, v19
  v_sub_f32 v50, v50, v19
  v_sub_f32 v51, v51, v19
  v_sub_f32 v52, v52, v19
  v_sub_f32 v53, v53, v19
  v_sub_f32 v54, v54, v19
  v_sub_f32 v55, v55, v19
  v_sub_f32 v56, v56, v19
  v_sub_f32 v57, v57, v19
  v_sub_f32 v58, v58, v19
  v_sub_f32 v59, v59, v19
  v_sub_f32 v60, v60, v19
  v_sub_f32 v61, v61, v19
  v_sub_f32 v62, v62, v19
  v_sub_f32 v63, v63, v19
  v_mul_f32 v17, v17, v20
  v_mul_f32 v18, v18, v20
  v_mul_f32 v64, v64, v20
  v_mul_f32 v65, v65, v20
  v_mul_f32 v66, v66, v20
  v_mul_f32 v67, v67, v20
  v_mul_f32 v68, v68, v20
  v_mul_f32 v69, v69, v20
  v_mul_f32 v70, v70, v20
  v_mul_f32 v71, v71, v20
  v_mul_f32 v72, v72, v20
  v_mul_f32 v73, v73, v20
  v_mul_f32 v74, v74, v20
  v_mul_f32 v75, v75, v20
  v_mul_f32 v76, v76, v20
  v_mul_f32 v77, v77, v20
  v_mul_f32 v78, v78, v20
  v_mul_f32 v79, v79, v20
  v_mul_f32 v80, v80, v20
  v_mul_f32 v81, v81, v20
  v_mul_f32 v82, v82, v20
  v_mul_f32 v83, v83, v20
  v_mul_f32 v84, v84, v20
  v_mul_f32 v85, v85, v20
  v_mul_f32 v86, v86, v20
  v_mul_f32 v87, v87, v20
  v_mul_f32 v88, v88, v20
  v_mul_f32 v89, v89, v20
  v_mul_f32 v90, v90, v20
  v_mul_f32 v91, v91, v20
  v_mul_f32 v92, v92, v20
  v_mul_f32 v93, v93, v20
  v_mul_f32 v94, v94, v20
  v_mul_f32 v95, v95, v20
  v_mul_f32 v96, v96, v20
  v_mul_f32 v97, v97, v20
  v_mul_f32 v98, v98, v20
  v_mul_f32 v99, v99, v20
  v_mul_f32 v100, v100, v20
  v_mul_f32 v101, v101, v20
  v_mul_f32 v102, v102, v20
  v_mul_f32 v103, v103, v20
  v_mul_f32 v104, v104, v20
  v_mul_f32 v105, v105, v20
  v_mul_f32 v106, v106, v20
  v_mul_f32 v107, v107, v20
  v_mul_f32 v108, v108, v20
  v_mul_f32 v109, v109, v20
  v_mul_f32 v110, v110, v20
  v_mul_f32 v111, v111, v20
  v_mul_f32 v112, v112, v20
  v_mul_f32 v113, v113, v20
  v_mul_f32 v114, v114, v20
  v_mul_f32 v115, v115, v20
  v_mul_f32 v116, v116, v20
  v_mul_f32 v117, v117, v20
  v_mul_f32 v118, v118, v20
  v_mul_f32 v119, v119, v20
  v_mul_f32 v120, v120, v20
  v_mul_f32 v121, v121, v20
  v_mul_f32 v122, v122, v20
  v_mul_f32 v123, v123, v20
  v_mul_f32 v124, v124, v20
  v_mul_f32 v125, v125, v20
  v_mul_f32 v126, v126, v20
  v_mul_f32 v127, v127, v20
  s_branch Lback_181
Lrare_188:
  v_mov_b32 v1, v19
  s_nop 1
  v_permlane32_swap_b32 v19, v1
  s_nop 1
  v_max_f32 v19, v19, v1
  v_max_f32 v19, 0, v19
  v_sub_f32 v20, 0, v19
  v_exp_f32 v20, v20
  v_sub_f32 v144, v144, v19
  v_sub_f32 v145, v145, v19
  v_sub_f32 v146, v146, v19
  v_sub_f32 v147, v147, v19
  v_sub_f32 v148, v148, v19
  v_sub_f32 v149, v149, v19
  v_sub_f32 v150, v150, v19
  v_sub_f32 v151, v151, v19
  v_sub_f32 v152, v152, v19
  v_sub_f32 v153, v153, v19
  v_sub_f32 v154, v154, v19
  v_sub_f32 v155, v155, v19
  v_sub_f32 v156, v156, v19
  v_sub_f32 v157, v157, v19
  v_sub_f32 v158, v158, v19
  v_sub_f32 v159, v159, v19
  v_sub_f32 v48, v48, v19
  v_sub_f32 v49, v49, v19
  v_sub_f32 v50, v50, v19
  v_sub_f32 v51, v51, v19
  v_sub_f32 v52, v52, v19
  v_sub_f32 v53, v53, v19
  v_sub_f32 v54, v54, v19
  v_sub_f32 v55, v55, v19
  v_sub_f32 v56, v56, v19
  v_sub_f32 v57, v57, v19
  v_sub_f32 v58, v58, v19
  v_sub_f32 v59, v59, v19
  v_sub_f32 v60, v60, v19
  v_sub_f32 v61, v61, v19
  v_sub_f32 v62, v62, v19
  v_sub_f32 v63, v63, v19
  v_mul_f32 v17, v17, v20
  v_mul_f32 v18, v18, v20
  v_mul_f32 v64, v64, v20
  v_mul_f32 v65, v65, v20
  v_mul_f32 v66, v66, v20
  v_mul_f32 v67, v67, v20
  v_mul_f32 v68, v68, v20
  v_mul_f32 v69, v69, v20
  v_mul_f32 v70, v70, v20
  v_mul_f32 v71, v71, v20
  v_mul_f32 v72, v72, v20
  v_mul_f32 v73, v73, v20
  v_mul_f32 v74, v74, v20
  v_mul_f32 v75, v75, v20
  v_mul_f32 v76, v76, v20
  v_mul_f32 v77, v77, v20
  v_mul_f32 v78, v78, v20
  v_mul_f32 v79, v79, v20
  v_mul_f32 v80, v80, v20
  v_mul_f32 v81, v81, v20
  v_mul_f32 v82, v82, v20
  v_mul_f32 v83, v83, v20
  v_mul_f32 v84, v84, v20
  v_mul_f32 v85, v85, v20
  v_mul_f32 v86, v86, v20
  v_mul_f32 v87, v87, v20
  v_mul_f32 v88, v88, v20
  v_mul_f32 v89, v89, v20
  v_mul_f32 v90, v90, v20
  v_mul_f32 v91, v91, v20
  v_mul_f32 v92, v92, v20
  v_mul_f32 v93, v93, v20
  v_mul_f32 v94, v94, v20
  v_mul_f32 v95, v95, v20
  v_mul_f32 v96, v96, v20
  v_mul_f32 v97, v97, v20
  v_mul_f32 v98, v98, v20
  v_mul_f32 v99, v99, v20
  v_mul_f32 v100, v100, v20
  v_mul_f32 v101, v101, v20
  v_mul_f32 v102, v102, v20
  v_mul_f32 v103, v103, v20
  v_mul_f32 v104, v104, v20
  v_mul_f32 v105, v105, v20
  v_mul_f32 v106, v106, v20
  v_mul_f32 v107, v107, v20
  v_mul_f32 v108, v108, v20
  v_mul_f32 v109, v109, v20
  v_mul_f32 v110, v110, v20
  v_mul_f32 v111, v111, v20
  v_mul_f32 v112, v112, v20
  v_mul_f32 v113, v113, v20
  v_mul_f32 v114, v114, v20
  v_mul_f32 v115, v115, v20
  v_mul_f32 v116, v116, v20
  v_mul_f32 v117, v117, v20
  v_mul_f32 v118, v118, v20
  v_mul_f32 v119, v119, v20
  v_mul_f32 v120, v120, v20
  v_mul_f32 v121, v121, v20
  v_mul_f32 v122, v122, v20
  v_mul_f32 v123, v123, v20
  v_mul_f32 v124, v124, v20
  v_mul_f32 v125, v125, v20
  v_mul_f32 v126, v126, v20
  v_mul_f32 v127, v127, v20
  s_branch Lback_189
Lrare_192:
  v_mov_b32 v1, v19
  s_nop 1
  v_permlane32_swap_b32 v19, v1
  s_nop 1
  v_max_f32 v19, v19, v1
  v_max_f32 v19, 0, v19
  v_sub_f32 v20, 0, v19
  v_exp_f32 v20, v20
  v_sub_f32 v128, v128, v19
  v_sub_f32 v129, v129, v19
  v_sub_f32 v130, v130, v19
  v_sub_f32 v131, v131, v19
  v_sub_f32 v132, v132, v19
  v_sub_f32 v133, v133, v19
  v_sub_f32 v134, v134, v19
  v_sub_f32 v135, v135, v19
  v_sub_f32 v136, v136, v19
  v_sub_f32 v137, v137, v19
  v_sub_f32 v138, v138, v19
  v_sub_f32 v139, v139, v19
  v_sub_f32 v140, v140, v19
  v_sub_f32 v141, v141, v19
  v_sub_f32 v142, v142, v19
  v_sub_f32 v143, v143, v19
  v_sub_f32 v48, v48, v19
  v_sub_f32 v49, v49, v19
  v_sub_f32 v50, v50, v19
  v_sub_f32 v51, v51, v19
  v_sub_f32 v52, v52, v19
  v_sub_f32 v53, v53, v19
  v_sub_f32 v54, v54, v19
  v_sub_f32 v55, v55, v19
  v_sub_f32 v56, v56, v19
  v_sub_f32 v57, v57, v19
  v_sub_f32 v58, v58, v19
  v_sub_f32 v59, v59, v19
  v_sub_f32 v60, v60, v19
  v_sub_f32 v61, v61, v19
  v_sub_f32 v62, v62, v19
  v_sub_f32 v63, v63, v19
  v_mul_f32 v17, v17, v20
  v_mul_f32 v18, v18, v20
  v_mul_f32 v64, v64, v20
  v_mul_f32 v65, v65, v20
  v_mul_f32 v66, v66, v20
  v_mul_f32 v67, v67, v20
  v_mul_f32 v68, v68, v20
  v_mul_f32 v69, v69, v20
  v_mul_f32 v70, v70, v20
  v_mul_f32 v71, v71, v20
  v_mul_f32 v72, v72, v20
  v_mul_f32 v73, v73, v20
  v_mul_f32 v74, v74, v20
  v_mul_f32 v75, v75, v20
  v_mul_f32 v76, v76, v20
  v_mul_f32 v77, v77, v20
  v_mul_f32 v78, v78, v20
  v_mul_f32 v79, v79, v20
  v_mul_f32 v80, v80, v20
  v_mul_f32 v81, v81, v20
  v_mul_f32 v82, v82, v20
  v_mul_f32 v83, v83, v20
  v_mul_f32 v84, v84, v20
  v_mul_f32 v85, v85, v20
  v_mul_f32 v86, v86, v20
  v_mul_f32 v87, v87, v20
  v_mul_f32 v88, v88, v20
  v_mul_f32 v89, v89, v20
  v_mul_f32 v90, v90, v20
  v_mul_f32 v91, v91, v20
  v_mul_f32 v92, v92, v20
  v_mul_f32 v93, v93, v20
  v_mul_f32 v94, v94, v20
  v_mul_f32 v95, v95, v20
  v_mul_f32 v96, v96, v20
  v_mul_f32 v97, v97, v20
  v_mul_f32 v98, v98, v20
  v_mul_f32 v99, v99, v20
  v_mul_f32 v100, v100, v20
  v_mul_f32 v101, v101, v20
  v_mul_f32 v102, v102, v20
  v_mul_f32 v103, v103, v20
  v_mul_f32 v104, v104, v20
  v_mul_f32 v105, v105, v20
  v_mul_f32 v106, v106, v20
  v_mul_f32 v107, v107, v20
  v_mul_f32 v108, v108, v20
  v_mul_f32 v109, v109, v20
  v_mul_f32 v110, v110, v20
  v_mul_f32 v111, v111, v20
  v_mul_f32 v112, v112, v20
  v_mul_f32 v113, v113, v20
  v_mul_f32 v114, v114, v20
  v_mul_f32 v115, v115, v20
  v_mul_f32 v116, v116, v20
  v_mul_f32 v117, v117, v20
  v_mul_f32 v118, v118, v20
  v_mul_f32 v119, v119, v20
  v_mul_f32 v120, v120, v20
  v_mul_f32 v121, v121, v20
  v_mul_f32 v122, v122, v20
  v_mul_f32 v123, v123, v20
  v_mul_f32 v124, v124, v20
  v_mul_f32 v125, v125, v20
  v_mul_f32 v126, v126, v20
  v_mul_f32 v127, v127, v20
  s_branch Lback_193
Lrare_200:
  v_mov_b32 v1, v19
  s_nop 1
  v_permlane32_swap_b32 v19, v1
  s_nop 1
  v_max_f32 v19, v19, v1
  v_max_f32 v19, 0, v19
  v_sub_f32 v20, 0, v19
  v_exp_f32 v20, v20
  v_sub_f32 v144, v144, v19
  v_sub_f32 v145, v145, v19
  v_sub_f32 v146, v146, v19
  v_sub_f32 v147, v147, v19
  v_sub_f32 v148, v148, v19
  v_sub_f32 v149, v149, v19
  v_sub_f32 v150, v150, v19
  v_sub_f32 v151, v151, v19
  v_sub_f32 v152, v152, v19
  v_sub_f32 v153, v153, v19
  v_sub_f32 v154, v154, v19
  v_sub_f32 v155, v155, v19
  v_sub_f32 v156, v156, v19
  v_sub_f32 v157, v157, v19
  v_sub_f32 v158, v158, v19
  v_sub_f32 v159, v159, v19
  v_sub_f32 v48, v48, v19
  v_sub_f32 v49, v49, v19
  v_sub_f32 v50, v50, v19
  v_sub_f32 v51, v51, v19
  v_sub_f32 v52, v52, v19
  v_sub_f32 v53, v53, v19
  v_sub_f32 v54, v54, v19
  v_sub_f32 v55, v55, v19
  v_sub_f32 v56, v56, v19
  v_sub_f32 v57, v57, v19
  v_sub_f32 v58, v58, v19
  v_sub_f32 v59, v59, v19
  v_sub_f32 v60, v60, v19
  v_sub_f32 v61, v61, v19
  v_sub_f32 v62, v62, v19
  v_sub_f32 v63, v63, v19
  v_mul_f32 v17, v17, v20
  v_mul_f32 v18, v18, v20
  v_mul_f32 v64, v64, v20
  v_mul_f32 v65, v65, v20
  v_mul_f32 v66, v66, v20
  v_mul_f32 v67, v67, v20
  v_mul_f32 v68, v68, v20
  v_mul_f32 v69, v69, v20
  v_mul_f32 v70, v70, v20
  v_mul_f32 v71, v71, v20
  v_mul_f32 v72, v72, v20
  v_mul_f32 v73, v73, v20
  v_mul_f32 v74, v74, v20
  v_mul_f32 v75, v75, v20
  v_mul_f32 v76, v76, v20
  v_mul_f32 v77, v77, v20
  v_mul_f32 v78, v78, v20
  v_mul_f32 v79, v79, v20
  v_mul_f32 v80, v80, v20
  v_mul_f32 v81, v81, v20
  v_mul_f32 v82, v82, v20
  v_mul_f32 v83, v83, v20
  v_mul_f32 v84, v84, v20
  v_mul_f32 v85, v85, v20
  v_mul_f32 v86, v86, v20
  v_mul_f32 v87, v87, v20
  v_mul_f32 v88, v88, v20
  v_mul_f32 v89, v89, v20
  v_mul_f32 v90, v90, v20
  v_mul_f32 v91, v91, v20
  v_mul_f32 v92, v92, v20
  v_mul_f32 v93, v93, v20
  v_mul_f32 v94, v94, v20
  v_mul_f32 v95, v95, v20
  v_mul_f32 v96, v96, v20
  v_mul_f32 v97, v97, v20
  v_mul_f32 v98, v98, v20
  v_mul_f32 v99, v99, v20
  v_mul_f32 v100, v100, v20
  v_mul_f32 v101, v101, v20
  v_mul_f32 v102, v102, v20
  v_mul_f32 v103, v103, v20
  v_mul_f32 v104, v104, v20
  v_mul_f32 v105, v105, v20
  v_mul_f32 v106, v106, v20
  v_mul_f32 v107, v107, v20
  v_mul_f32 v108, v108, v20
  v_mul_f32 v109, v109, v20
  v_mul_f32 v110, v110, v20
  v_mul_f32 v111, v111, v20
  v_mul_f32 v112, v112, v20
  v_mul_f32 v113, v113, v20
  v_mul_f32 v114, v114, v20
  v_mul_f32 v115, v115, v20
  v_mul_f32 v116, v116, v20
  v_mul_f32 v117, v117, v20
  v_mul_f32 v118, v118, v20
  v_mul_f32 v119, v119, v20
  v_mul_f32 v120, v120, v20
  v_mul_f32 v121, v121, v20
  v_mul_f32 v122, v122, v20
  v_mul_f32 v123, v123, v20
  v_mul_f32 v124, v124, v20
  v_mul_f32 v125, v125, v20
  v_mul_f32 v126, v126, v20
  v_mul_f32 v127, v127, v20
  s_branch Lback_201
Lrare_210:
  v_mov_b32 v1, v19
  s_nop 1
  v_permlane32_swap_b32 v19, v1
  s_nop 1
  v_max_f32 v19, v19, v1
  v_max_f32 v19, 0, v19
  v_sub_f32 v20, 0, v19
  v_exp_f32 v20, v20
  v_sub_f32 v144, v144, v19
  v_sub_f32 v145, v145, v19
  v_sub_f32 v146, v146, v19
  v_sub_f32 v147, v147, v19
  v_sub_f32 v148, v148, v19
  v_sub_f32 v149, v149, v19
  v_sub_f32 v150, v150, v19
  v_sub_f32 v151, v151, v19
  v_sub_f32 v152, v152, v19
  v_sub_f32 v153, v153, v19
  v_sub_f32 v154, v154, v19
  v_sub_f32 v155, v155, v19
  v_sub_f32 v156, v156, v19
  v_sub_f32 v157, v157, v19
  v_sub_f32 v158, v158, v19
  v_sub_f32 v159, v159, v19
  v_sub_f32 v48, v48, v19
  v_sub_f32 v49, v49, v19
  v_sub_f32 v50, v50, v19
  v_sub_f32 v51, v51, v19
  v_sub_f32 v52, v52, v19
  v_sub_f32 v53, v53, v19
  v_sub_f32 v54, v54, v19
  v_sub_f32 v55, v55, v19
  v_sub_f32 v56, v56, v19
  v_sub_f32 v57, v57, v19
  v_sub_f32 v58, v58, v19
  v_sub_f32 v59, v59, v19
  v_sub_f32 v60, v60, v19
  v_sub_f32 v61, v61, v19
  v_sub_f32 v62, v62, v19
  v_sub_f32 v63, v63, v19
  v_mul_f32 v17, v17, v20
  v_mul_f32 v18, v18, v20
  v_mul_f32 v64, v64, v20
  v_mul_f32 v65, v65, v20
  v_mul_f32 v66, v66, v20
  v_mul_f32 v67, v67, v20
  v_mul_f32 v68, v68, v20
  v_mul_f32 v69, v69, v20
  v_mul_f32 v70, v70, v20
  v_mul_f32 v71, v71, v20
  v_mul_f32 v72, v72, v20
  v_mul_f32 v73, v73, v20
  v_mul_f32 v74, v74, v20
  v_mul_f32 v75, v75, v20
  v_mul_f32 v76, v76, v20
  v_mul_f32 v77, v77, v20
  v_mul_f32 v78, v78, v20
  v_mul_f32 v79, v79, v20
  v_mul_f32 v80, v80, v20
  v_mul_f32 v81, v81, v20
  v_mul_f32 v82, v82, v20
  v_mul_f32 v83, v83, v20
  v_mul_f32 v84, v84, v20
  v_mul_f32 v85, v85, v20
  v_mul_f32 v86, v86, v20
  v_mul_f32 v87, v87, v20
  v_mul_f32 v88, v88, v20
  v_mul_f32 v89, v89, v20
  v_mul_f32 v90, v90, v20
  v_mul_f32 v91, v91, v20
  v_mul_f32 v92, v92, v20
  v_mul_f32 v93, v93, v20
  v_mul_f32 v94, v94, v20
  v_mul_f32 v95, v95, v20
  v_mul_f32 v96, v96, v20
  v_mul_f32 v97, v97, v20
  v_mul_f32 v98, v98, v20
  v_mul_f32 v99, v99, v20
  v_mul_f32 v100, v100, v20
  v_mul_f32 v101, v101, v20
  v_mul_f32 v102, v102, v20
  v_mul_f32 v103, v103, v20
  v_mul_f32 v104, v104, v20
  v_mul_f32 v105, v105, v20
  v_mul_f32 v106, v106, v20
  v_mul_f32 v107, v107, v20
  v_mul_f32 v108, v108, v20
  v_mul_f32 v109, v109, v20
  v_mul_f32 v110, v110, v20
  v_mul_f32 v111, v111, v20
  v_mul_f32 v112, v112, v20
  v_mul_f32 v113, v113, v20
  v_mul_f32 v114, v114, v20
  v_mul_f32 v115, v115, v20
  v_mul_f32 v116, v116, v20
  v_mul_f32 v117, v117, v20
  v_mul_f32 v118, v118, v20
  v_mul_f32 v119, v119, v20
  v_mul_f32 v120, v120, v20
  v_mul_f32 v121, v121, v20
  v_mul_f32 v122, v122, v20
  v_mul_f32 v123, v123, v20
  v_mul_f32 v124, v124, v20
  v_mul_f32 v125, v125, v20
  v_mul_f32 v126, v126, v20
  v_mul_f32 v127, v127, v20
  s_branch Lback_211
Lrare_214:
  v_mov_b32 v1, v19
  s_nop 1
  v_permlane32_swap_b32 v19, v1
  s_nop 1
  v_max_f32 v19, v19, v1
  v_max_f32 v19, 0, v19
  v_sub_f32 v20, 0, v19
  v_exp_f32 v20, v20
  v_sub_f32 v128, v128, v19
  v_sub_f32 v129, v129, v19
  v_sub_f32 v130, v130, v19
  v_sub_f32 v131, v131, v19
  v_sub_f32 v132, v132, v19
  v_sub_f32 v133, v133, v19
  v_sub_f32 v134, v134, v19
  v_sub_f32 v135, v135, v19
  v_sub_f32 v136, v136, v19
  v_sub_f32 v137, v137, v19
  v_sub_f32 v138, v138, v19
  v_sub_f32 v139, v139, v19
  v_sub_f32 v140, v140, v19
  v_sub_f32 v141, v141, v19
  v_sub_f32 v142, v142, v19
  v_sub_f32 v143, v143, v19
  v_sub_f32 v48, v48, v19
  v_sub_f32 v49, v49, v19
  v_sub_f32 v50, v50, v19
  v_sub_f32 v51, v51, v19
  v_sub_f32 v52, v52, v19
  v_sub_f32 v53, v53, v19
  v_sub_f32 v54, v54, v19
  v_sub_f32 v55, v55, v19
  v_sub_f32 v56, v56, v19
  v_sub_f32 v57, v57, v19
  v_sub_f32 v58, v58, v19
  v_sub_f32 v59, v59, v19
  v_sub_f32 v60, v60, v19
  v_sub_f32 v61, v61, v19
  v_sub_f32 v62, v62, v19
  v_sub_f32 v63, v63, v19
  v_mul_f32 v17, v17, v20
  v_mul_f32 v18, v18, v20
  v_mul_f32 v64, v64, v20
  v_mul_f32 v65, v65, v20
  v_mul_f32 v66, v66, v20
  v_mul_f32 v67, v67, v20
  v_mul_f32 v68, v68, v20
  v_mul_f32 v69, v69, v20
  v_mul_f32 v70, v70, v20
  v_mul_f32 v71, v71, v20
  v_mul_f32 v72, v72, v20
  v_mul_f32 v73, v73, v20
  v_mul_f32 v74, v74, v20
  v_mul_f32 v75, v75, v20
  v_mul_f32 v76, v76, v20
  v_mul_f32 v77, v77, v20
  v_mul_f32 v78, v78, v20
  v_mul_f32 v79, v79, v20
  v_mul_f32 v80, v80, v20
  v_mul_f32 v81, v81, v20
  v_mul_f32 v82, v82, v20
  v_mul_f32 v83, v83, v20
  v_mul_f32 v84, v84, v20
  v_mul_f32 v85, v85, v20
  v_mul_f32 v86, v86, v20
  v_mul_f32 v87, v87, v20
  v_mul_f32 v88, v88, v20
  v_mul_f32 v89, v89, v20
  v_mul_f32 v90, v90, v20
  v_mul_f32 v91, v91, v20
  v_mul_f32 v92, v92, v20
  v_mul_f32 v93, v93, v20
  v_mul_f32 v94, v94, v20
  v_mul_f32 v95, v95, v20
  v_mul_f32 v96, v96, v20
  v_mul_f32 v97, v97, v20
  v_mul_f32 v98, v98, v20
  v_mul_f32 v99, v99, v20
  v_mul_f32 v100, v100, v20
  v_mul_f32 v101, v101, v20
  v_mul_f32 v102, v102, v20
  v_mul_f32 v103, v103, v20
  v_mul_f32 v104, v104, v20
  v_mul_f32 v105, v105, v20
  v_mul_f32 v106, v106, v20
  v_mul_f32 v107, v107, v20
  v_mul_f32 v108, v108, v20
  v_mul_f32 v109, v109, v20
  v_mul_f32 v110, v110, v20
  v_mul_f32 v111, v111, v20
  v_mul_f32 v112, v112, v20
  v_mul_f32 v113, v113, v20
  v_mul_f32 v114, v114, v20
  v_mul_f32 v115, v115, v20
  v_mul_f32 v116, v116, v20
  v_mul_f32 v117, v117, v20
  v_mul_f32 v118, v118, v20
  v_mul_f32 v119, v119, v20
  v_mul_f32 v120, v120, v20
  v_mul_f32 v121, v121, v20
  v_mul_f32 v122, v122, v20
  v_mul_f32 v123, v123, v20
  v_mul_f32 v124, v124, v20
  v_mul_f32 v125, v125, v20
  v_mul_f32 v126, v126, v20
  v_mul_f32 v127, v127, v20
  s_branch Lback_215
Lrare_224:
  v_mov_b32 v1, v19
  s_nop 1
  v_permlane32_swap_b32 v19, v1
  s_nop 1
  v_max_f32 v19, v19, v1
  v_max_f32 v19, 0, v19
  v_sub_f32 v20, 0, v19
  v_exp_f32 v20, v20
  v_sub_f32 v144, v144, v19
  v_sub_f32 v145, v145, v19
  v_sub_f32 v146, v146, v19
  v_sub_f32 v147, v147, v19
  v_sub_f32 v148, v148, v19
  v_sub_f32 v149, v149, v19
  v_sub_f32 v150, v150, v19
  v_sub_f32 v151, v151, v19
  v_sub_f32 v152, v152, v19
  v_sub_f32 v153, v153, v19
  v_sub_f32 v154, v154, v19
  v_sub_f32 v155, v155, v19
  v_sub_f32 v156, v156, v19
  v_sub_f32 v157, v157, v19
  v_sub_f32 v158, v158, v19
  v_sub_f32 v159, v159, v19
  v_sub_f32 v48, v48, v19
  v_sub_f32 v49, v49, v19
  v_sub_f32 v50, v50, v19
  v_sub_f32 v51, v51, v19
  v_sub_f32 v52, v52, v19
  v_sub_f32 v53, v53, v19
  v_sub_f32 v54, v54, v19
  v_sub_f32 v55, v55, v19
  v_sub_f32 v56, v56, v19
  v_sub_f32 v57, v57, v19
  v_sub_f32 v58, v58, v19
  v_sub_f32 v59, v59, v19
  v_sub_f32 v60, v60, v19
  v_sub_f32 v61, v61, v19
  v_sub_f32 v62, v62, v19
  v_sub_f32 v63, v63, v19
  v_mul_f32 v17, v17, v20
  v_mul_f32 v18, v18, v20
  v_mul_f32 v64, v64, v20
  v_mul_f32 v65, v65, v20
  v_mul_f32 v66, v66, v20
  v_mul_f32 v67, v67, v20
  v_mul_f32 v68, v68, v20
  v_mul_f32 v69, v69, v20
  v_mul_f32 v70, v70, v20
  v_mul_f32 v71, v71, v20
  v_mul_f32 v72, v72, v20
  v_mul_f32 v73, v73, v20
  v_mul_f32 v74, v74, v20
  v_mul_f32 v75, v75, v20
  v_mul_f32 v76, v76, v20
  v_mul_f32 v77, v77, v20
  v_mul_f32 v78, v78, v20
  v_mul_f32 v79, v79, v20
  v_mul_f32 v80, v80, v20
  v_mul_f32 v81, v81, v20
  v_mul_f32 v82, v82, v20
  v_mul_f32 v83, v83, v20
  v_mul_f32 v84, v84, v20
  v_mul_f32 v85, v85, v20
  v_mul_f32 v86, v86, v20
  v_mul_f32 v87, v87, v20
  v_mul_f32 v88, v88, v20
  v_mul_f32 v89, v89, v20
  v_mul_f32 v90, v90, v20
  v_mul_f32 v91, v91, v20
  v_mul_f32 v92, v92, v20
  v_mul_f32 v93, v93, v20
  v_mul_f32 v94, v94, v20
  v_mul_f32 v95, v95, v20
  v_mul_f32 v96, v96, v20
  v_mul_f32 v97, v97, v20
  v_mul_f32 v98, v98, v20
  v_mul_f32 v99, v99, v20
  v_mul_f32 v100, v100, v20
  v_mul_f32 v101, v101, v20
  v_mul_f32 v102, v102, v20
  v_mul_f32 v103, v103, v20
  v_mul_f32 v104, v104, v20
  v_mul_f32 v105, v105, v20
  v_mul_f32 v106, v106, v20
  v_mul_f32 v107, v107, v20
  v_mul_f32 v108, v108, v20
  v_mul_f32 v109, v109, v20
  v_mul_f32 v110, v110, v20
  v_mul_f32 v111, v111, v20
  v_mul_f32 v112, v112, v20
  v_mul_f32 v113, v113, v20
  v_mul_f32 v114, v114, v20
  v_mul_f32 v115, v115, v20
  v_mul_f32 v116, v116, v20
  v_mul_f32 v117, v117, v20
  v_mul_f32 v118, v118, v20
  v_mul_f32 v119, v119, v20
  v_mul_f32 v120, v120, v20
  v_mul_f32 v121, v121, v20
  v_mul_f32 v122, v122, v20
  v_mul_f32 v123, v123, v20
  v_mul_f32 v124, v124, v20
  v_mul_f32 v125, v125, v20
  v_mul_f32 v126, v126, v20
  v_mul_f32 v127, v127, v20
  s_branch Lback_225
Lrare_228:
  v_mov_b32 v1, v19
  s_nop 1
  v_permlane32_swap_b32 v19, v1
  s_nop 1
  v_max_f32 v19, v19, v1
  v_max_f32 v19, 0, v19
  v_sub_f32 v20, 0, v19
  v_exp_f32 v20, v20
  v_sub_f32 v128, v128, v19
  v_sub_f32 v129, v129, v19
  v_sub_f32 v130, v130, v19
  v_sub_f32 v131, v131, v19
  v_sub_f32 v132, v132, v19
  v_sub_f32 v133, v133, v19
  v_sub_f32 v134, v134, v19
  v_sub_f32 v135, v135, v19
  v_sub_f32 v136, v136, v19
  v_sub_f32 v137, v137, v19
  v_sub_f32 v138, v138, v19
  v_sub_f32 v139, v139, v19
  v_sub_f32 v140, v140, v19
  v_sub_f32 v141, v141, v19
  v_sub_f32 v142, v142, v19
  v_sub_f32 v143, v143, v19
  v_sub_f32 v48, v48, v19
  v_sub_f32 v49, v49, v19
  v_sub_f32 v50, v50, v19
  v_sub_f32 v51, v51, v19
  v_sub_f32 v52, v52, v19
  v_sub_f32 v53, v53, v19
  v_sub_f32 v54, v54, v19
  v_sub_f32 v55, v55, v19
  v_sub_f32 v56, v56, v19
  v_sub_f32 v57, v57, v19
  v_sub_f32 v58, v58, v19
  v_sub_f32 v59, v59, v19
  v_sub_f32 v60, v60, v19
  v_sub_f32 v61, v61, v19
  v_sub_f32 v62, v62, v19
  v_sub_f32 v63, v63, v19
  v_mul_f32 v17, v17, v20
  v_mul_f32 v18, v18, v20
  v_mul_f32 v64, v64, v20
  v_mul_f32 v65, v65, v20
  v_mul_f32 v66, v66, v20
  v_mul_f32 v67, v67, v20
  v_mul_f32 v68, v68, v20
  v_mul_f32 v69, v69, v20
  v_mul_f32 v70, v70, v20
  v_mul_f32 v71, v71, v20
  v_mul_f32 v72, v72, v20
  v_mul_f32 v73, v73, v20
  v_mul_f32 v74, v74, v20
  v_mul_f32 v75, v75, v20
  v_mul_f32 v76, v76, v20
  v_mul_f32 v77, v77, v20
  v_mul_f32 v78, v78, v20
  v_mul_f32 v79, v79, v20
  v_mul_f32 v80, v80, v20
  v_mul_f32 v81, v81, v20
  v_mul_f32 v82, v82, v20
  v_mul_f32 v83, v83, v20
  v_mul_f32 v84, v84, v20
  v_mul_f32 v85, v85, v20
  v_mul_f32 v86, v86, v20
  v_mul_f32 v87, v87, v20
  v_mul_f32 v88, v88, v20
  v_mul_f32 v89, v89, v20
  v_mul_f32 v90, v90, v20
  v_mul_f32 v91, v91, v20
  v_mul_f32 v92, v92, v20
  v_mul_f32 v93, v93, v20
  v_mul_f32 v94, v94, v20
  v_mul_f32 v95, v95, v20
  v_mul_f32 v96, v96, v20
  v_mul_f32 v97, v97, v20
  v_mul_f32 v98, v98, v20
  v_mul_f32 v99, v99, v20
  v_mul_f32 v100, v100, v20
  v_mul_f32 v101, v101, v20
  v_mul_f32 v102, v102, v20
  v_mul_f32 v103, v103, v20
  v_mul_f32 v104, v104, v20
  v_mul_f32 v105, v105, v20
  v_mul_f32 v106, v106, v20
  v_mul_f32 v107, v107, v20
  v_mul_f32 v108, v108, v20
  v_mul_f32 v109, v109, v20
  v_mul_f32 v110, v110, v20
  v_mul_f32 v111, v111, v20
  v_mul_f32 v112, v112, v20
  v_mul_f32 v113, v113, v20
  v_mul_f32 v114, v114, v20
  v_mul_f32 v115, v115, v20
  v_mul_f32 v116, v116, v20
  v_mul_f32 v117, v117, v20
  v_mul_f32 v118, v118, v20
  v_mul_f32 v119, v119, v20
  v_mul_f32 v120, v120, v20
  v_mul_f32 v121, v121, v20
  v_mul_f32 v122, v122, v20
  v_mul_f32 v123, v123, v20
  v_mul_f32 v124, v124, v20
  v_mul_f32 v125, v125, v20
  v_mul_f32 v126, v126, v20
  v_mul_f32 v127, v127, v20
  s_branch Lback_229
Lrare_236:
  v_mov_b32 v1, v19
  s_nop 1
  v_permlane32_swap_b32 v19, v1
  s_nop 1
  v_max_f32 v19, v19, v1
  v_max_f32 v19, 0, v19
  v_sub_f32 v20, 0, v19
  v_exp_f32 v20, v20
  v_sub_f32 v144, v144, v19
  v_sub_f32 v145, v145, v19
  v_sub_f32 v146, v146, v19
  v_sub_f32 v147, v147, v19
  v_sub_f32 v148, v148, v19
  v_sub_f32 v149, v149, v19
  v_sub_f32 v150, v150, v19
  v_sub_f32 v151, v151, v19
  v_sub_f32 v152, v152, v19
  v_sub_f32 v153, v153, v19
  v_sub_f32 v154, v154, v19
  v_sub_f32 v155, v155, v19
  v_sub_f32 v156, v156, v19
  v_sub_f32 v157, v157, v19
  v_sub_f32 v158, v158, v19
  v_sub_f32 v159, v159, v19
  v_sub_f32 v48, v48, v19
  v_sub_f32 v49, v49, v19
  v_sub_f32 v50, v50, v19
  v_sub_f32 v51, v51, v19
  v_sub_f32 v52, v52, v19
  v_sub_f32 v53, v53, v19
  v_sub_f32 v54, v54, v19
  v_sub_f32 v55, v55, v19
  v_sub_f32 v56, v56, v19
  v_sub_f32 v57, v57, v19
  v_sub_f32 v58, v58, v19
  v_sub_f32 v59, v59, v19
  v_sub_f32 v60, v60, v19
  v_sub_f32 v61, v61, v19
  v_sub_f32 v62, v62, v19
  v_sub_f32 v63, v63, v19
  v_mul_f32 v17, v17, v20
  v_mul_f32 v18, v18, v20
  v_mul_f32 v64, v64, v20
  v_mul_f32 v65, v65, v20
  v_mul_f32 v66, v66, v20
  v_mul_f32 v67, v67, v20
  v_mul_f32 v68, v68, v20
  v_mul_f32 v69, v69, v20
  v_mul_f32 v70, v70, v20
  v_mul_f32 v71, v71, v20
  v_mul_f32 v72, v72, v20
  v_mul_f32 v73, v73, v20
  v_mul_f32 v74, v74, v20
  v_mul_f32 v75, v75, v20
  v_mul_f32 v76, v76, v20
  v_mul_f32 v77, v77, v20
  v_mul_f32 v78, v78, v20
  v_mul_f32 v79, v79, v20
  v_mul_f32 v80, v80, v20
  v_mul_f32 v81, v81, v20
  v_mul_f32 v82, v82, v20
  v_mul_f32 v83, v83, v20
  v_mul_f32 v84, v84, v20
  v_mul_f32 v85, v85, v20
  v_mul_f32 v86, v86, v20
  v_mul_f32 v87, v87, v20
  v_mul_f32 v88, v88, v20
  v_mul_f32 v89, v89, v20
  v_mul_f32 v90, v90, v20
  v_mul_f32 v91, v91, v20
  v_mul_f32 v92, v92, v20
  v_mul_f32 v93, v93, v20
  v_mul_f32 v94, v94, v20
  v_mul_f32 v95, v95, v20
  v_mul_f32 v96, v96, v20
  v_mul_f32 v97, v97, v20
  v_mul_f32 v98, v98, v20
  v_mul_f32 v99, v99, v20
  v_mul_f32 v100, v100, v20
  v_mul_f32 v101, v101, v20
  v_mul_f32 v102, v102, v20
  v_mul_f32 v103, v103, v20
  v_mul_f32 v104, v104, v20
  v_mul_f32 v105, v105, v20
  v_mul_f32 v106, v106, v20
  v_mul_f32 v107, v107, v20
  v_mul_f32 v108, v108, v20
  v_mul_f32 v109, v109, v20
  v_mul_f32 v110, v110, v20
  v_mul_f32 v111, v111, v20
  v_mul_f32 v112, v112, v20
  v_mul_f32 v113, v113, v20
  v_mul_f32 v114, v114, v20
  v_mul_f32 v115, v115, v20
  v_mul_f32 v116, v116, v20
  v_mul_f32 v117, v117, v20
  v_mul_f32 v118, v118, v20
  v_mul_f32 v119, v119, v20
  v_mul_f32 v120, v120, v20
  v_mul_f32 v121, v121, v20
  v_mul_f32 v122, v122, v20
  v_mul_f32 v123, v123, v20
  v_mul_f32 v124, v124, v20
  v_mul_f32 v125, v125, v20
  v_mul_f32 v126, v126, v20
  v_mul_f32 v127, v127, v20
  s_branch Lback_237
Lrare_240:
  v_mov_b32 v1, v19
  s_nop 1
  v_permlane32_swap_b32 v19, v1
  s_nop 1
  v_max_f32 v19, v19, v1
  v_max_f32 v19, 0, v19
  v_sub_f32 v20, 0, v19
  v_exp_f32 v20, v20
  v_sub_f32 v128, v128, v19
  v_sub_f32 v129, v129, v19
  v_sub_f32 v130, v130, v19
  v_sub_f32 v131, v131, v19
  v_sub_f32 v132, v132, v19
  v_sub_f32 v133, v133, v19
  v_sub_f32 v134, v134, v19
  v_sub_f32 v135, v135, v19
  v_sub_f32 v136, v136, v19
  v_sub_f32 v137, v137, v19
  v_sub_f32 v138, v138, v19
  v_sub_f32 v139, v139, v19
  v_sub_f32 v140, v140, v19
  v_sub_f32 v141, v141, v19
  v_sub_f32 v142, v142, v19
  v_sub_f32 v143, v143, v19
  v_sub_f32 v48, v48, v19
  v_sub_f32 v49, v49, v19
  v_sub_f32 v50, v50, v19
  v_sub_f32 v51, v51, v19
  v_sub_f32 v52, v52, v19
  v_sub_f32 v53, v53, v19
  v_sub_f32 v54, v54, v19
  v_sub_f32 v55, v55, v19
  v_sub_f32 v56, v56, v19
  v_sub_f32 v57, v57, v19
  v_sub_f32 v58, v58, v19
  v_sub_f32 v59, v59, v19
  v_sub_f32 v60, v60, v19
  v_sub_f32 v61, v61, v19
  v_sub_f32 v62, v62, v19
  v_sub_f32 v63, v63, v19
  v_mul_f32 v17, v17, v20
  v_mul_f32 v18, v18, v20
  v_mul_f32 v64, v64, v20
  v_mul_f32 v65, v65, v20
  v_mul_f32 v66, v66, v20
  v_mul_f32 v67, v67, v20
  v_mul_f32 v68, v68, v20
  v_mul_f32 v69, v69, v20
  v_mul_f32 v70, v70, v20
  v_mul_f32 v71, v71, v20
  v_mul_f32 v72, v72, v20
  v_mul_f32 v73, v73, v20
  v_mul_f32 v74, v74, v20
  v_mul_f32 v75, v75, v20
  v_mul_f32 v76, v76, v20
  v_mul_f32 v77, v77, v20
  v_mul_f32 v78, v78, v20
  v_mul_f32 v79, v79, v20
  v_mul_f32 v80, v80, v20
  v_mul_f32 v81, v81, v20
  v_mul_f32 v82, v82, v20
  v_mul_f32 v83, v83, v20
  v_mul_f32 v84, v84, v20
  v_mul_f32 v85, v85, v20
  v_mul_f32 v86, v86, v20
  v_mul_f32 v87, v87, v20
  v_mul_f32 v88, v88, v20
  v_mul_f32 v89, v89, v20
  v_mul_f32 v90, v90, v20
  v_mul_f32 v91, v91, v20
  v_mul_f32 v92, v92, v20
  v_mul_f32 v93, v93, v20
  v_mul_f32 v94, v94, v20
  v_mul_f32 v95, v95, v20
  v_mul_f32 v96, v96, v20
  v_mul_f32 v97, v97, v20
  v_mul_f32 v98, v98, v20
  v_mul_f32 v99, v99, v20
  v_mul_f32 v100, v100, v20
  v_mul_f32 v101, v101, v20
  v_mul_f32 v102, v102, v20
  v_mul_f32 v103, v103, v20
  v_mul_f32 v104, v104, v20
  v_mul_f32 v105, v105, v20
  v_mul_f32 v106, v106, v20
  v_mul_f32 v107, v107, v20
  v_mul_f32 v108, v108, v20
  v_mul_f32 v109, v109, v20
  v_mul_f32 v110, v110, v20
  v_mul_f32 v111, v111, v20
  v_mul_f32 v112, v112, v20
  v_mul_f32 v113, v113, v20
  v_mul_f32 v114, v114, v20
  v_mul_f32 v115, v115, v20
  v_mul_f32 v116, v116, v20
  v_mul_f32 v117, v117, v20
  v_mul_f32 v118, v118, v20
  v_mul_f32 v119, v119, v20
  v_mul_f32 v120, v120, v20
  v_mul_f32 v121, v121, v20
  v_mul_f32 v122, v122, v20
  v_mul_f32 v123, v123, v20
  v_mul_f32 v124, v124, v20
  v_mul_f32 v125, v125, v20
  v_mul_f32 v126, v126, v20
  v_mul_f32 v127, v127, v20
  s_branch Lback_241
Lrare_248:
  v_mov_b32 v1, v19
  s_nop 1
  v_permlane32_swap_b32 v19, v1
  s_nop 1
  v_max_f32 v19, v19, v1
  v_max_f32 v19, 0, v19
  v_sub_f32 v20, 0, v19
  v_exp_f32 v20, v20
  v_sub_f32 v144, v144, v19
  v_sub_f32 v145, v145, v19
  v_sub_f32 v146, v146, v19
  v_sub_f32 v147, v147, v19
  v_sub_f32 v148, v148, v19
  v_sub_f32 v149, v149, v19
  v_sub_f32 v150, v150, v19
  v_sub_f32 v151, v151, v19
  v_sub_f32 v152, v152, v19
  v_sub_f32 v153, v153, v19
  v_sub_f32 v154, v154, v19
  v_sub_f32 v155, v155, v19
  v_sub_f32 v156, v156, v19
  v_sub_f32 v157, v157, v19
  v_sub_f32 v158, v158, v19
  v_sub_f32 v159, v159, v19
  v_sub_f32 v48, v48, v19
  v_sub_f32 v49, v49, v19
  v_sub_f32 v50, v50, v19
  v_sub_f32 v51, v51, v19
  v_sub_f32 v52, v52, v19
  v_sub_f32 v53, v53, v19
  v_sub_f32 v54, v54, v19
  v_sub_f32 v55, v55, v19
  v_sub_f32 v56, v56, v19
  v_sub_f32 v57, v57, v19
  v_sub_f32 v58, v58, v19
  v_sub_f32 v59, v59, v19
  v_sub_f32 v60, v60, v19
  v_sub_f32 v61, v61, v19
  v_sub_f32 v62, v62, v19
  v_sub_f32 v63, v63, v19
  v_mul_f32 v17, v17, v20
  v_mul_f32 v18, v18, v20
  v_mul_f32 v64, v64, v20
  v_mul_f32 v65, v65, v20
  v_mul_f32 v66, v66, v20
  v_mul_f32 v67, v67, v20
  v_mul_f32 v68, v68, v20
  v_mul_f32 v69, v69, v20
  v_mul_f32 v70, v70, v20
  v_mul_f32 v71, v71, v20
  v_mul_f32 v72, v72, v20
  v_mul_f32 v73, v73, v20
  v_mul_f32 v74, v74, v20
  v_mul_f32 v75, v75, v20
  v_mul_f32 v76, v76, v20
  v_mul_f32 v77, v77, v20
  v_mul_f32 v78, v78, v20
  v_mul_f32 v79, v79, v20
  v_mul_f32 v80, v80, v20
  v_mul_f32 v81, v81, v20
  v_mul_f32 v82, v82, v20
  v_mul_f32 v83, v83, v20
  v_mul_f32 v84, v84, v20
  v_mul_f32 v85, v85, v20
  v_mul_f32 v86, v86, v20
  v_mul_f32 v87, v87, v20
  v_mul_f32 v88, v88, v20
  v_mul_f32 v89, v89, v20
  v_mul_f32 v90, v90, v20
  v_mul_f32 v91, v91, v20
  v_mul_f32 v92, v92, v20
  v_mul_f32 v93, v93, v20
  v_mul_f32 v94, v94, v20
  v_mul_f32 v95, v95, v20
  v_mul_f32 v96, v96, v20
  v_mul_f32 v97, v97, v20
  v_mul_f32 v98, v98, v20
  v_mul_f32 v99, v99, v20
  v_mul_f32 v100, v100, v20
  v_mul_f32 v101, v101, v20
  v_mul_f32 v102, v102, v20
  v_mul_f32 v103, v103, v20
  v_mul_f32 v104, v104, v20
  v_mul_f32 v105, v105, v20
  v_mul_f32 v106, v106, v20
  v_mul_f32 v107, v107, v20
  v_mul_f32 v108, v108, v20
  v_mul_f32 v109, v109, v20
  v_mul_f32 v110, v110, v20
  v_mul_f32 v111, v111, v20
  v_mul_f32 v112, v112, v20
  v_mul_f32 v113, v113, v20
  v_mul_f32 v114, v114, v20
  v_mul_f32 v115, v115, v20
  v_mul_f32 v116, v116, v20
  v_mul_f32 v117, v117, v20
  v_mul_f32 v118, v118, v20
  v_mul_f32 v119, v119, v20
  v_mul_f32 v120, v120, v20
  v_mul_f32 v121, v121, v20
  v_mul_f32 v122, v122, v20
  v_mul_f32 v123, v123, v20
  v_mul_f32 v124, v124, v20
  v_mul_f32 v125, v125, v20
  v_mul_f32 v126, v126, v20
  v_mul_f32 v127, v127, v20
  s_branch Lback_249
Lrare_252:
  v_mov_b32 v1, v19
  s_nop 1
  v_permlane32_swap_b32 v19, v1
  s_nop 1
  v_max_f32 v19, v19, v1
  v_max_f32 v19, 0, v19
  v_sub_f32 v20, 0, v19
  v_exp_f32 v20, v20
  v_sub_f32 v128, v128, v19
  v_sub_f32 v129, v129, v19
  v_sub_f32 v130, v130, v19
  v_sub_f32 v131, v131, v19
  v_sub_f32 v132, v132, v19
  v_sub_f32 v133, v133, v19
  v_sub_f32 v134, v134, v19
  v_sub_f32 v135, v135, v19
  v_sub_f32 v136, v136, v19
  v_sub_f32 v137, v137, v19
  v_sub_f32 v138, v138, v19
  v_sub_f32 v139, v139, v19
  v_sub_f32 v140, v140, v19
  v_sub_f32 v141, v141, v19
  v_sub_f32 v142, v142, v19
  v_sub_f32 v143, v143, v19
  v_sub_f32 v48, v48, v19
  v_sub_f32 v49, v49, v19
  v_sub_f32 v50, v50, v19
  v_sub_f32 v51, v51, v19
  v_sub_f32 v52, v52, v19
  v_sub_f32 v53, v53, v19
  v_sub_f32 v54, v54, v19
  v_sub_f32 v55, v55, v19
  v_sub_f32 v56, v56, v19
  v_sub_f32 v57, v57, v19
  v_sub_f32 v58, v58, v19
  v_sub_f32 v59, v59, v19
  v_sub_f32 v60, v60, v19
  v_sub_f32 v61, v61, v19
  v_sub_f32 v62, v62, v19
  v_sub_f32 v63, v63, v19
  v_mul_f32 v17, v17, v20
  v_mul_f32 v18, v18, v20
  v_mul_f32 v64, v64, v20
  v_mul_f32 v65, v65, v20
  v_mul_f32 v66, v66, v20
  v_mul_f32 v67, v67, v20
  v_mul_f32 v68, v68, v20
  v_mul_f32 v69, v69, v20
  v_mul_f32 v70, v70, v20
  v_mul_f32 v71, v71, v20
  v_mul_f32 v72, v72, v20
  v_mul_f32 v73, v73, v20
  v_mul_f32 v74, v74, v20
  v_mul_f32 v75, v75, v20
  v_mul_f32 v76, v76, v20
  v_mul_f32 v77, v77, v20
  v_mul_f32 v78, v78, v20
  v_mul_f32 v79, v79, v20
  v_mul_f32 v80, v80, v20
  v_mul_f32 v81, v81, v20
  v_mul_f32 v82, v82, v20
  v_mul_f32 v83, v83, v20
  v_mul_f32 v84, v84, v20
  v_mul_f32 v85, v85, v20
  v_mul_f32 v86, v86, v20
  v_mul_f32 v87, v87, v20
  v_mul_f32 v88, v88, v20
  v_mul_f32 v89, v89, v20
  v_mul_f32 v90, v90, v20
  v_mul_f32 v91, v91, v20
  v_mul_f32 v92, v92, v20
  v_mul_f32 v93, v93, v20
  v_mul_f32 v94, v94, v20
  v_mul_f32 v95, v95, v20
  v_mul_f32 v96, v96, v20
  v_mul_f32 v97, v97, v20
  v_mul_f32 v98, v98, v20
  v_mul_f32 v99, v99, v20
  v_mul_f32 v100, v100, v20
  v_mul_f32 v101, v101, v20
  v_mul_f32 v102, v102, v20
  v_mul_f32 v103, v103, v20
  v_mul_f32 v104, v104, v20
  v_mul_f32 v105, v105, v20
  v_mul_f32 v106, v106, v20
  v_mul_f32 v107, v107, v20
  v_mul_f32 v108, v108, v20
  v_mul_f32 v109, v109, v20
  v_mul_f32 v110, v110, v20
  v_mul_f32 v111, v111, v20
  v_mul_f32 v112, v112, v20
  v_mul_f32 v113, v113, v20
  v_mul_f32 v114, v114, v20
  v_mul_f32 v115, v115, v20
  v_mul_f32 v116, v116, v20
  v_mul_f32 v117, v117, v20
  v_mul_f32 v118, v118, v20
  v_mul_f32 v119, v119, v20
  v_mul_f32 v120, v120, v20
  v_mul_f32 v121, v121, v20
  v_mul_f32 v122, v122, v20
  v_mul_f32 v123, v123, v20
  v_mul_f32 v124, v124, v20
  v_mul_f32 v125, v125, v20
  v_mul_f32 v126, v126, v20
  v_mul_f32 v127, v127, v20
  s_branch Lback_253
Lrare_260:
  v_mov_b32 v1, v19
  s_nop 1
  v_permlane32_swap_b32 v19, v1
  s_nop 1
  v_max_f32 v19, v19, v1
  v_max_f32 v19, 0, v19
  v_sub_f32 v20, 0, v19
  v_exp_f32 v20, v20
  v_sub_f32 v144, v144, v19
  v_sub_f32 v145, v145, v19
  v_sub_f32 v146, v146, v19
  v_sub_f32 v147, v147, v19
  v_sub_f32 v148, v148, v19
  v_sub_f32 v149, v149, v19
  v_sub_f32 v150, v150, v19
  v_sub_f32 v151, v151, v19
  v_sub_f32 v152, v152, v19
  v_sub_f32 v153, v153, v19
  v_sub_f32 v154, v154, v19
  v_sub_f32 v155, v155, v19
  v_sub_f32 v156, v156, v19
  v_sub_f32 v157, v157, v19
  v_sub_f32 v158, v158, v19
  v_sub_f32 v159, v159, v19
  v_sub_f32 v48, v48, v19
  v_sub_f32 v49, v49, v19
  v_sub_f32 v50, v50, v19
  v_sub_f32 v51, v51, v19
  v_sub_f32 v52, v52, v19
  v_sub_f32 v53, v53, v19
  v_sub_f32 v54, v54, v19
  v_sub_f32 v55, v55, v19
  v_sub_f32 v56, v56, v19
  v_sub_f32 v57, v57, v19
  v_sub_f32 v58, v58, v19
  v_sub_f32 v59, v59, v19
  v_sub_f32 v60, v60, v19
  v_sub_f32 v61, v61, v19
  v_sub_f32 v62, v62, v19
  v_sub_f32 v63, v63, v19
  v_mul_f32 v17, v17, v20
  v_mul_f32 v18, v18, v20
  v_mul_f32 v64, v64, v20
  v_mul_f32 v65, v65, v20
  v_mul_f32 v66, v66, v20
  v_mul_f32 v67, v67, v20
  v_mul_f32 v68, v68, v20
  v_mul_f32 v69, v69, v20
  v_mul_f32 v70, v70, v20
  v_mul_f32 v71, v71, v20
  v_mul_f32 v72, v72, v20
  v_mul_f32 v73, v73, v20
  v_mul_f32 v74, v74, v20
  v_mul_f32 v75, v75, v20
  v_mul_f32 v76, v76, v20
  v_mul_f32 v77, v77, v20
  v_mul_f32 v78, v78, v20
  v_mul_f32 v79, v79, v20
  v_mul_f32 v80, v80, v20
  v_mul_f32 v81, v81, v20
  v_mul_f32 v82, v82, v20
  v_mul_f32 v83, v83, v20
  v_mul_f32 v84, v84, v20
  v_mul_f32 v85, v85, v20
  v_mul_f32 v86, v86, v20
  v_mul_f32 v87, v87, v20
  v_mul_f32 v88, v88, v20
  v_mul_f32 v89, v89, v20
  v_mul_f32 v90, v90, v20
  v_mul_f32 v91, v91, v20
  v_mul_f32 v92, v92, v20
  v_mul_f32 v93, v93, v20
  v_mul_f32 v94, v94, v20
  v_mul_f32 v95, v95, v20
  v_mul_f32 v96, v96, v20
  v_mul_f32 v97, v97, v20
  v_mul_f32 v98, v98, v20
  v_mul_f32 v99, v99, v20
  v_mul_f32 v100, v100, v20
  v_mul_f32 v101, v101, v20
  v_mul_f32 v102, v102, v20
  v_mul_f32 v103, v103, v20
  v_mul_f32 v104, v104, v20
  v_mul_f32 v105, v105, v20
  v_mul_f32 v106, v106, v20
  v_mul_f32 v107, v107, v20
  v_mul_f32 v108, v108, v20
  v_mul_f32 v109, v109, v20
  v_mul_f32 v110, v110, v20
  v_mul_f32 v111, v111, v20
  v_mul_f32 v112, v112, v20
  v_mul_f32 v113, v113, v20
  v_mul_f32 v114, v114, v20
  v_mul_f32 v115, v115, v20
  v_mul_f32 v116, v116, v20
  v_mul_f32 v117, v117, v20
  v_mul_f32 v118, v118, v20
  v_mul_f32 v119, v119, v20
  v_mul_f32 v120, v120, v20
  v_mul_f32 v121, v121, v20
  v_mul_f32 v122, v122, v20
  v_mul_f32 v123, v123, v20
  v_mul_f32 v124, v124, v20
  v_mul_f32 v125, v125, v20
  v_mul_f32 v126, v126, v20
  v_mul_f32 v127, v127, v20
  s_branch Lback_261
Lrare_264:
  v_mov_b32 v1, v19
  s_nop 1
  v_permlane32_swap_b32 v19, v1
  s_nop 1
  v_max_f32 v19, v19, v1
  v_max_f32 v19, 0, v19
  v_sub_f32 v20, 0, v19
  v_exp_f32 v20, v20
  v_sub_f32 v128, v128, v19
  v_sub_f32 v129, v129, v19
  v_sub_f32 v130, v130, v19
  v_sub_f32 v131, v131, v19
  v_sub_f32 v132, v132, v19
  v_sub_f32 v133, v133, v19
  v_sub_f32 v134, v134, v19
  v_sub_f32 v135, v135, v19
  v_sub_f32 v136, v136, v19
  v_sub_f32 v137, v137, v19
  v_sub_f32 v138, v138, v19
  v_sub_f32 v139, v139, v19
  v_sub_f32 v140, v140, v19
  v_sub_f32 v141, v141, v19
  v_sub_f32 v142, v142, v19
  v_sub_f32 v143, v143, v19
  v_sub_f32 v48, v48, v19
  v_sub_f32 v49, v49, v19
  v_sub_f32 v50, v50, v19
  v_sub_f32 v51, v51, v19
  v_sub_f32 v52, v52, v19
  v_sub_f32 v53, v53, v19
  v_sub_f32 v54, v54, v19
  v_sub_f32 v55, v55, v19
  v_sub_f32 v56, v56, v19
  v_sub_f32 v57, v57, v19
  v_sub_f32 v58, v58, v19
  v_sub_f32 v59, v59, v19
  v_sub_f32 v60, v60, v19
  v_sub_f32 v61, v61, v19
  v_sub_f32 v62, v62, v19
  v_sub_f32 v63, v63, v19
  v_mul_f32 v17, v17, v20
  v_mul_f32 v18, v18, v20
  v_mul_f32 v64, v64, v20
  v_mul_f32 v65, v65, v20
  v_mul_f32 v66, v66, v20
  v_mul_f32 v67, v67, v20
  v_mul_f32 v68, v68, v20
  v_mul_f32 v69, v69, v20
  v_mul_f32 v70, v70, v20
  v_mul_f32 v71, v71, v20
  v_mul_f32 v72, v72, v20
  v_mul_f32 v73, v73, v20
  v_mul_f32 v74, v74, v20
  v_mul_f32 v75, v75, v20
  v_mul_f32 v76, v76, v20
  v_mul_f32 v77, v77, v20
  v_mul_f32 v78, v78, v20
  v_mul_f32 v79, v79, v20
  v_mul_f32 v80, v80, v20
  v_mul_f32 v81, v81, v20
  v_mul_f32 v82, v82, v20
  v_mul_f32 v83, v83, v20
  v_mul_f32 v84, v84, v20
  v_mul_f32 v85, v85, v20
  v_mul_f32 v86, v86, v20
  v_mul_f32 v87, v87, v20
  v_mul_f32 v88, v88, v20
  v_mul_f32 v89, v89, v20
  v_mul_f32 v90, v90, v20
  v_mul_f32 v91, v91, v20
  v_mul_f32 v92, v92, v20
  v_mul_f32 v93, v93, v20
  v_mul_f32 v94, v94, v20
  v_mul_f32 v95, v95, v20
  v_mul_f32 v96, v96, v20
  v_mul_f32 v97, v97, v20
  v_mul_f32 v98, v98, v20
  v_mul_f32 v99, v99, v20
  v_mul_f32 v100, v100, v20
  v_mul_f32 v101, v101, v20
  v_mul_f32 v102, v102, v20
  v_mul_f32 v103, v103, v20
  v_mul_f32 v104, v104, v20
  v_mul_f32 v105, v105, v20
  v_mul_f32 v106, v106, v20
  v_mul_f32 v107, v107, v20
  v_mul_f32 v108, v108, v20
  v_mul_f32 v109, v109, v20
  v_mul_f32 v110, v110, v20
  v_mul_f32 v111, v111, v20
  v_mul_f32 v112, v112, v20
  v_mul_f32 v113, v113, v20
  v_mul_f32 v114, v114, v20
  v_mul_f32 v115, v115, v20
  v_mul_f32 v116, v116, v20
  v_mul_f32 v117, v117, v20
  v_mul_f32 v118, v118, v20
  v_mul_f32 v119, v119, v20
  v_mul_f32 v120, v120, v20
  v_mul_f32 v121, v121, v20
  v_mul_f32 v122, v122, v20
  v_mul_f32 v123, v123, v20
  v_mul_f32 v124, v124, v20
  v_mul_f32 v125, v125, v20
  v_mul_f32 v126, v126, v20
  v_mul_f32 v127, v127, v20
  s_branch Lback_265
Lrare_272:
  v_mov_b32 v1, v19
  s_nop 1
  v_permlane32_swap_b32 v19, v1
  s_nop 1
  v_max_f32 v19, v19, v1
  v_max_f32 v19, 0, v19
  v_sub_f32 v20, 0, v19
  v_exp_f32 v20, v20
  v_sub_f32 v144, v144, v19
  v_sub_f32 v145, v145, v19
  v_sub_f32 v146, v146, v19
  v_sub_f32 v147, v147, v19
  v_sub_f32 v148, v148, v19
  v_sub_f32 v149, v149, v19
  v_sub_f32 v150, v150, v19
  v_sub_f32 v151, v151, v19
  v_sub_f32 v152, v152, v19
  v_sub_f32 v153, v153, v19
  v_sub_f32 v154, v154, v19
  v_sub_f32 v155, v155, v19
  v_sub_f32 v156, v156, v19
  v_sub_f32 v157, v157, v19
  v_sub_f32 v158, v158, v19
  v_sub_f32 v159, v159, v19
  v_sub_f32 v48, v48, v19
  v_sub_f32 v49, v49, v19
  v_sub_f32 v50, v50, v19
  v_sub_f32 v51, v51, v19
  v_sub_f32 v52, v52, v19
  v_sub_f32 v53, v53, v19
  v_sub_f32 v54, v54, v19
  v_sub_f32 v55, v55, v19
  v_sub_f32 v56, v56, v19
  v_sub_f32 v57, v57, v19
  v_sub_f32 v58, v58, v19
  v_sub_f32 v59, v59, v19
  v_sub_f32 v60, v60, v19
  v_sub_f32 v61, v61, v19
  v_sub_f32 v62, v62, v19
  v_sub_f32 v63, v63, v19
  v_mul_f32 v17, v17, v20
  v_mul_f32 v18, v18, v20
  v_mul_f32 v64, v64, v20
  v_mul_f32 v65, v65, v20
  v_mul_f32 v66, v66, v20
  v_mul_f32 v67, v67, v20
  v_mul_f32 v68, v68, v20
  v_mul_f32 v69, v69, v20
  v_mul_f32 v70, v70, v20
  v_mul_f32 v71, v71, v20
  v_mul_f32 v72, v72, v20
  v_mul_f32 v73, v73, v20
  v_mul_f32 v74, v74, v20
  v_mul_f32 v75, v75, v20
  v_mul_f32 v76, v76, v20
  v_mul_f32 v77, v77, v20
  v_mul_f32 v78, v78, v20
  v_mul_f32 v79, v79, v20
  v_mul_f32 v80, v80, v20
  v_mul_f32 v81, v81, v20
  v_mul_f32 v82, v82, v20
  v_mul_f32 v83, v83, v20
  v_mul_f32 v84, v84, v20
  v_mul_f32 v85, v85, v20
  v_mul_f32 v86, v86, v20
  v_mul_f32 v87, v87, v20
  v_mul_f32 v88, v88, v20
  v_mul_f32 v89, v89, v20
  v_mul_f32 v90, v90, v20
  v_mul_f32 v91, v91, v20
  v_mul_f32 v92, v92, v20
  v_mul_f32 v93, v93, v20
  v_mul_f32 v94, v94, v20
  v_mul_f32 v95, v95, v20
  v_mul_f32 v96, v96, v20
  v_mul_f32 v97, v97, v20
  v_mul_f32 v98, v98, v20
  v_mul_f32 v99, v99, v20
  v_mul_f32 v100, v100, v20
  v_mul_f32 v101, v101, v20
  v_mul_f32 v102, v102, v20
  v_mul_f32 v103, v103, v20
  v_mul_f32 v104, v104, v20
  v_mul_f32 v105, v105, v20
  v_mul_f32 v106, v106, v20
  v_mul_f32 v107, v107, v20
  v_mul_f32 v108, v108, v20
  v_mul_f32 v109, v109, v20
  v_mul_f32 v110, v110, v20
  v_mul_f32 v111, v111, v20
  v_mul_f32 v112, v112, v20
  v_mul_f32 v113, v113, v20
  v_mul_f32 v114, v114, v20
  v_mul_f32 v115, v115, v20
  v_mul_f32 v116, v116, v20
  v_mul_f32 v117, v117, v20
  v_mul_f32 v118, v118, v20
  v_mul_f32 v119, v119, v20
  v_mul_f32 v120, v120, v20
  v_mul_f32 v121, v121, v20
  v_mul_f32 v122, v122, v20
  v_mul_f32 v123, v123, v20
  v_mul_f32 v124, v124, v20
  v_mul_f32 v125, v125, v20
  v_mul_f32 v126, v126, v20
  v_mul_f32 v127, v127, v20
  s_branch Lback_273
Lrare_276:
  v_mov_b32 v1, v19
  s_nop 1
  v_permlane32_swap_b32 v19, v1
  s_nop 1
  v_max_f32 v19, v19, v1
  v_max_f32 v19, 0, v19
  v_sub_f32 v20, 0, v19
  v_exp_f32 v20, v20
  v_sub_f32 v128, v128, v19
  v_sub_f32 v129, v129, v19
  v_sub_f32 v130, v130, v19
  v_sub_f32 v131, v131, v19
  v_sub_f32 v132, v132, v19
  v_sub_f32 v133, v133, v19
  v_sub_f32 v134, v134, v19
  v_sub_f32 v135, v135, v19
  v_sub_f32 v136, v136, v19
  v_sub_f32 v137, v137, v19
  v_sub_f32 v138, v138, v19
  v_sub_f32 v139, v139, v19
  v_sub_f32 v140, v140, v19
  v_sub_f32 v141, v141, v19
  v_sub_f32 v142, v142, v19
  v_sub_f32 v143, v143, v19
  v_sub_f32 v48, v48, v19
  v_sub_f32 v49, v49, v19
  v_sub_f32 v50, v50, v19
  v_sub_f32 v51, v51, v19
  v_sub_f32 v52, v52, v19
  v_sub_f32 v53, v53, v19
  v_sub_f32 v54, v54, v19
  v_sub_f32 v55, v55, v19
  v_sub_f32 v56, v56, v19
  v_sub_f32 v57, v57, v19
  v_sub_f32 v58, v58, v19
  v_sub_f32 v59, v59, v19
  v_sub_f32 v60, v60, v19
  v_sub_f32 v61, v61, v19
  v_sub_f32 v62, v62, v19
  v_sub_f32 v63, v63, v19
  v_mul_f32 v17, v17, v20
  v_mul_f32 v18, v18, v20
  v_mul_f32 v64, v64, v20
  v_mul_f32 v65, v65, v20
  v_mul_f32 v66, v66, v20
  v_mul_f32 v67, v67, v20
  v_mul_f32 v68, v68, v20
  v_mul_f32 v69, v69, v20
  v_mul_f32 v70, v70, v20
  v_mul_f32 v71, v71, v20
  v_mul_f32 v72, v72, v20
  v_mul_f32 v73, v73, v20
  v_mul_f32 v74, v74, v20
  v_mul_f32 v75, v75, v20
  v_mul_f32 v76, v76, v20
  v_mul_f32 v77, v77, v20
  v_mul_f32 v78, v78, v20
  v_mul_f32 v79, v79, v20
  v_mul_f32 v80, v80, v20
  v_mul_f32 v81, v81, v20
  v_mul_f32 v82, v82, v20
  v_mul_f32 v83, v83, v20
  v_mul_f32 v84, v84, v20
  v_mul_f32 v85, v85, v20
  v_mul_f32 v86, v86, v20
  v_mul_f32 v87, v87, v20
  v_mul_f32 v88, v88, v20
  v_mul_f32 v89, v89, v20
  v_mul_f32 v90, v90, v20
  v_mul_f32 v91, v91, v20
  v_mul_f32 v92, v92, v20
  v_mul_f32 v93, v93, v20
  v_mul_f32 v94, v94, v20
  v_mul_f32 v95, v95, v20
  v_mul_f32 v96, v96, v20
  v_mul_f32 v97, v97, v20
  v_mul_f32 v98, v98, v20
  v_mul_f32 v99, v99, v20
  v_mul_f32 v100, v100, v20
  v_mul_f32 v101, v101, v20
  v_mul_f32 v102, v102, v20
  v_mul_f32 v103, v103, v20
  v_mul_f32 v104, v104, v20
  v_mul_f32 v105, v105, v20
  v_mul_f32 v106, v106, v20
  v_mul_f32 v107, v107, v20
  v_mul_f32 v108, v108, v20
  v_mul_f32 v109, v109, v20
  v_mul_f32 v110, v110, v20
  v_mul_f32 v111, v111, v20
  v_mul_f32 v112, v112, v20
  v_mul_f32 v113, v113, v20
  v_mul_f32 v114, v114, v20
  v_mul_f32 v115, v115, v20
  v_mul_f32 v116, v116, v20
  v_mul_f32 v117, v117, v20
  v_mul_f32 v118, v118, v20
  v_mul_f32 v119, v119, v20
  v_mul_f32 v120, v120, v20
  v_mul_f32 v121, v121, v20
  v_mul_f32 v122, v122, v20
  v_mul_f32 v123, v123, v20
  v_mul_f32 v124, v124, v20
  v_mul_f32 v125, v125, v20
  v_mul_f32 v126, v126, v20
  v_mul_f32 v127, v127, v20
  s_branch Lback_277
Lrare_284:
  v_mov_b32 v1, v19
  s_nop 1
  v_permlane32_swap_b32 v19, v1
  s_nop 1
  v_max_f32 v19, v19, v1
  v_max_f32 v19, 0, v19
  v_sub_f32 v20, 0, v19
  v_exp_f32 v20, v20
  v_sub_f32 v144, v144, v19
  v_sub_f32 v145, v145, v19
  v_sub_f32 v146, v146, v19
  v_sub_f32 v147, v147, v19
  v_sub_f32 v148, v148, v19
  v_sub_f32 v149, v149, v19
  v_sub_f32 v150, v150, v19
  v_sub_f32 v151, v151, v19
  v_sub_f32 v152, v152, v19
  v_sub_f32 v153, v153, v19
  v_sub_f32 v154, v154, v19
  v_sub_f32 v155, v155, v19
  v_sub_f32 v156, v156, v19
  v_sub_f32 v157, v157, v19
  v_sub_f32 v158, v158, v19
  v_sub_f32 v159, v159, v19
  v_sub_f32 v48, v48, v19
  v_sub_f32 v49, v49, v19
  v_sub_f32 v50, v50, v19
  v_sub_f32 v51, v51, v19
  v_sub_f32 v52, v52, v19
  v_sub_f32 v53, v53, v19
  v_sub_f32 v54, v54, v19
  v_sub_f32 v55, v55, v19
  v_sub_f32 v56, v56, v19
  v_sub_f32 v57, v57, v19
  v_sub_f32 v58, v58, v19
  v_sub_f32 v59, v59, v19
  v_sub_f32 v60, v60, v19
  v_sub_f32 v61, v61, v19
  v_sub_f32 v62, v62, v19
  v_sub_f32 v63, v63, v19
  v_mul_f32 v17, v17, v20
  v_mul_f32 v18, v18, v20
  v_mul_f32 v64, v64, v20
  v_mul_f32 v65, v65, v20
  v_mul_f32 v66, v66, v20
  v_mul_f32 v67, v67, v20
  v_mul_f32 v68, v68, v20
  v_mul_f32 v69, v69, v20
  v_mul_f32 v70, v70, v20
  v_mul_f32 v71, v71, v20
  v_mul_f32 v72, v72, v20
  v_mul_f32 v73, v73, v20
  v_mul_f32 v74, v74, v20
  v_mul_f32 v75, v75, v20
  v_mul_f32 v76, v76, v20
  v_mul_f32 v77, v77, v20
  v_mul_f32 v78, v78, v20
  v_mul_f32 v79, v79, v20
  v_mul_f32 v80, v80, v20
  v_mul_f32 v81, v81, v20
  v_mul_f32 v82, v82, v20
  v_mul_f32 v83, v83, v20
  v_mul_f32 v84, v84, v20
  v_mul_f32 v85, v85, v20
  v_mul_f32 v86, v86, v20
  v_mul_f32 v87, v87, v20
  v_mul_f32 v88, v88, v20
  v_mul_f32 v89, v89, v20
  v_mul_f32 v90, v90, v20
  v_mul_f32 v91, v91, v20
  v_mul_f32 v92, v92, v20
  v_mul_f32 v93, v93, v20
  v_mul_f32 v94, v94, v20
  v_mul_f32 v95, v95, v20
  v_mul_f32 v96, v96, v20
  v_mul_f32 v97, v97, v20
  v_mul_f32 v98, v98, v20
  v_mul_f32 v99, v99, v20
  v_mul_f32 v100, v100, v20
  v_mul_f32 v101, v101, v20
  v_mul_f32 v102, v102, v20
  v_mul_f32 v103, v103, v20
  v_mul_f32 v104, v104, v20
  v_mul_f32 v105, v105, v20
  v_mul_f32 v106, v106, v20
  v_mul_f32 v107, v107, v20
  v_mul_f32 v108, v108, v20
  v_mul_f32 v109, v109, v20
  v_mul_f32 v110, v110, v20
  v_mul_f32 v111, v111, v20
  v_mul_f32 v112, v112, v20
  v_mul_f32 v113, v113, v20
  v_mul_f32 v114, v114, v20
  v_mul_f32 v115, v115, v20
  v_mul_f32 v116, v116, v20
  v_mul_f32 v117, v117, v20
  v_mul_f32 v118, v118, v20
  v_mul_f32 v119, v119, v20
  v_mul_f32 v120, v120, v20
  v_mul_f32 v121, v121, v20
  v_mul_f32 v122, v122, v20
  v_mul_f32 v123, v123, v20
  v_mul_f32 v124, v124, v20
  v_mul_f32 v125, v125, v20
  v_mul_f32 v126, v126, v20
  v_mul_f32 v127, v127, v20
  s_branch Lback_285
Lrare_288:
  v_mov_b32 v1, v19
  s_nop 1
  v_permlane32_swap_b32 v19, v1
  s_nop 1
  v_max_f32 v19, v19, v1
  v_max_f32 v19, 0, v19
  v_sub_f32 v20, 0, v19
  v_exp_f32 v20, v20
  v_sub_f32 v128, v128, v19
  v_sub_f32 v129, v129, v19
  v_sub_f32 v130, v130, v19
  v_sub_f32 v131, v131, v19
  v_sub_f32 v132, v132, v19
  v_sub_f32 v133, v133, v19
  v_sub_f32 v134, v134, v19
  v_sub_f32 v135, v135, v19
  v_sub_f32 v136, v136, v19
  v_sub_f32 v137, v137, v19
  v_sub_f32 v138, v138, v19
  v_sub_f32 v139, v139, v19
  v_sub_f32 v140, v140, v19
  v_sub_f32 v141, v141, v19
  v_sub_f32 v142, v142, v19
  v_sub_f32 v143, v143, v19
  v_sub_f32 v48, v48, v19
  v_sub_f32 v49, v49, v19
  v_sub_f32 v50, v50, v19
  v_sub_f32 v51, v51, v19
  v_sub_f32 v52, v52, v19
  v_sub_f32 v53, v53, v19
  v_sub_f32 v54, v54, v19
  v_sub_f32 v55, v55, v19
  v_sub_f32 v56, v56, v19
  v_sub_f32 v57, v57, v19
  v_sub_f32 v58, v58, v19
  v_sub_f32 v59, v59, v19
  v_sub_f32 v60, v60, v19
  v_sub_f32 v61, v61, v19
  v_sub_f32 v62, v62, v19
  v_sub_f32 v63, v63, v19
  v_mul_f32 v17, v17, v20
  v_mul_f32 v18, v18, v20
  v_mul_f32 v64, v64, v20
  v_mul_f32 v65, v65, v20
  v_mul_f32 v66, v66, v20
  v_mul_f32 v67, v67, v20
  v_mul_f32 v68, v68, v20
  v_mul_f32 v69, v69, v20
  v_mul_f32 v70, v70, v20
  v_mul_f32 v71, v71, v20
  v_mul_f32 v72, v72, v20
  v_mul_f32 v73, v73, v20
  v_mul_f32 v74, v74, v20
  v_mul_f32 v75, v75, v20
  v_mul_f32 v76, v76, v20
  v_mul_f32 v77, v77, v20
  v_mul_f32 v78, v78, v20
  v_mul_f32 v79, v79, v20
  v_mul_f32 v80, v80, v20
  v_mul_f32 v81, v81, v20
  v_mul_f32 v82, v82, v20
  v_mul_f32 v83, v83, v20
  v_mul_f32 v84, v84, v20
  v_mul_f32 v85, v85, v20
  v_mul_f32 v86, v86, v20
  v_mul_f32 v87, v87, v20
  v_mul_f32 v88, v88, v20
  v_mul_f32 v89, v89, v20
  v_mul_f32 v90, v90, v20
  v_mul_f32 v91, v91, v20
  v_mul_f32 v92, v92, v20
  v_mul_f32 v93, v93, v20
  v_mul_f32 v94, v94, v20
  v_mul_f32 v95, v95, v20
  v_mul_f32 v96, v96, v20
  v_mul_f32 v97, v97, v20
  v_mul_f32 v98, v98, v20
  v_mul_f32 v99, v99, v20
  v_mul_f32 v100, v100, v20
  v_mul_f32 v101, v101, v20
  v_mul_f32 v102, v102, v20
  v_mul_f32 v103, v103, v20
  v_mul_f32 v104, v104, v20
  v_mul_f32 v105, v105, v20
  v_mul_f32 v106, v106, v20
  v_mul_f32 v107, v107, v20
  v_mul_f32 v108, v108, v20
  v_mul_f32 v109, v109, v20
  v_mul_f32 v110, v110, v20
  v_mul_f32 v111, v111, v20
  v_mul_f32 v112, v112, v20
  v_mul_f32 v113, v113, v20
  v_mul_f32 v114, v114, v20
  v_mul_f32 v115, v115, v20
  v_mul_f32 v116, v116, v20
  v_mul_f32 v117, v117, v20
  v_mul_f32 v118, v118, v20
  v_mul_f32 v119, v119, v20
  v_mul_f32 v120, v120, v20
  v_mul_f32 v121, v121, v20
  v_mul_f32 v122, v122, v20
  v_mul_f32 v123, v123, v20
  v_mul_f32 v124, v124, v20
  v_mul_f32 v125, v125, v20
  v_mul_f32 v126, v126, v20
  v_mul_f32 v127, v127, v20
  s_branch Lback_289
Lrare_296:
  v_mov_b32 v1, v19
  s_nop 1
  v_permlane32_swap_b32 v19, v1
  s_nop 1
  v_max_f32 v19, v19, v1
  v_max_f32 v19, 0, v19
  v_sub_f32 v20, 0, v19
  v_exp_f32 v20, v20
  v_sub_f32 v144, v144, v19
  v_sub_f32 v145, v145, v19
  v_sub_f32 v146, v146, v19
  v_sub_f32 v147, v147, v19
  v_sub_f32 v148, v148, v19
  v_sub_f32 v149, v149, v19
  v_sub_f32 v150, v150, v19
  v_sub_f32 v151, v151, v19
  v_sub_f32 v152, v152, v19
  v_sub_f32 v153, v153, v19
  v_sub_f32 v154, v154, v19
  v_sub_f32 v155, v155, v19
  v_sub_f32 v156, v156, v19
  v_sub_f32 v157, v157, v19
  v_sub_f32 v158, v158, v19
  v_sub_f32 v159, v159, v19
  v_sub_f32 v48, v48, v19
  v_sub_f32 v49, v49, v19
  v_sub_f32 v50, v50, v19
  v_sub_f32 v51, v51, v19
  v_sub_f32 v52, v52, v19
  v_sub_f32 v53, v53, v19
  v_sub_f32 v54, v54, v19
  v_sub_f32 v55, v55, v19
  v_sub_f32 v56, v56, v19
  v_sub_f32 v57, v57, v19
  v_sub_f32 v58, v58, v19
  v_sub_f32 v59, v59, v19
  v_sub_f32 v60, v60, v19
  v_sub_f32 v61, v61, v19
  v_sub_f32 v62, v62, v19
  v_sub_f32 v63, v63, v19
  v_mul_f32 v17, v17, v20
  v_mul_f32 v18, v18, v20
  v_mul_f32 v64, v64, v20
  v_mul_f32 v65, v65, v20
  v_mul_f32 v66, v66, v20
  v_mul_f32 v67, v67, v20
  v_mul_f32 v68, v68, v20
  v_mul_f32 v69, v69, v20
  v_mul_f32 v70, v70, v20
  v_mul_f32 v71, v71, v20
  v_mul_f32 v72, v72, v20
  v_mul_f32 v73, v73, v20
  v_mul_f32 v74, v74, v20
  v_mul_f32 v75, v75, v20
  v_mul_f32 v76, v76, v20
  v_mul_f32 v77, v77, v20
  v_mul_f32 v78, v78, v20
  v_mul_f32 v79, v79, v20
  v_mul_f32 v80, v80, v20
  v_mul_f32 v81, v81, v20
  v_mul_f32 v82, v82, v20
  v_mul_f32 v83, v83, v20
  v_mul_f32 v84, v84, v20
  v_mul_f32 v85, v85, v20
  v_mul_f32 v86, v86, v20
  v_mul_f32 v87, v87, v20
  v_mul_f32 v88, v88, v20
  v_mul_f32 v89, v89, v20
  v_mul_f32 v90, v90, v20
  v_mul_f32 v91, v91, v20
  v_mul_f32 v92, v92, v20
  v_mul_f32 v93, v93, v20
  v_mul_f32 v94, v94, v20
  v_mul_f32 v95, v95, v20
  v_mul_f32 v96, v96, v20
  v_mul_f32 v97, v97, v20
  v_mul_f32 v98, v98, v20
  v_mul_f32 v99, v99, v20
  v_mul_f32 v100, v100, v20
  v_mul_f32 v101, v101, v20
  v_mul_f32 v102, v102, v20
  v_mul_f32 v103, v103, v20
  v_mul_f32 v104, v104, v20
  v_mul_f32 v105, v105, v20
  v_mul_f32 v106, v106, v20
  v_mul_f32 v107, v107, v20
  v_mul_f32 v108, v108, v20
  v_mul_f32 v109, v109, v20
  v_mul_f32 v110, v110, v20
  v_mul_f32 v111, v111, v20
  v_mul_f32 v112, v112, v20
  v_mul_f32 v113, v113, v20
  v_mul_f32 v114, v114, v20
  v_mul_f32 v115, v115, v20
  v_mul_f32 v116, v116, v20
  v_mul_f32 v117, v117, v20
  v_mul_f32 v118, v118, v20
  v_mul_f32 v119, v119, v20
  v_mul_f32 v120, v120, v20
  v_mul_f32 v121, v121, v20
  v_mul_f32 v122, v122, v20
  v_mul_f32 v123, v123, v20
  v_mul_f32 v124, v124, v20
  v_mul_f32 v125, v125, v20
  v_mul_f32 v126, v126, v20
  v_mul_f32 v127, v127, v20
  s_branch Lback_297
Levdisp_110:
  s_cmp_eq_u32 s7, 1
  s_cbranch_scc0 Lnoev_333
  v_mov_b32 v1, 0
  global_load_dwordx2 v[26:27], v1, s[58:59] sc1
Lnoev_333:
  s_cmp_eq_u32 s7, 6
  s_cbranch_scc0 Lnoev_334
  s_waitcnt vmcnt(0)
  v_readfirstlane_b32 s16, v26
  v_readfirstlane_b32 s17, v27
  s_nop 3
  s_cmp_lg_u32 s16, 0
  s_cbranch_scc1 Lnok_335
Lnonce_336:
  v_mov_b32 v1, 0
  global_load_dwordx2 v[2:3], v1, s[58:59] sc1
  s_waitcnt vmcnt(0)
  v_readfirstlane_b32 s16, v2
  v_readfirstlane_b32 s17, v3
  s_sub_u32 s26, s26, 1
  s_cmp_eq_u32 s26, 0
  s_cbranch_scc1 L_end
  s_cmp_eq_u32 s16, 0
  s_cbranch_scc1 Lnonce_336
Lnok_335:
Lnoev_334:
  s_setpc_b64 s[18:19]
Levdisp_206:
  s_cmp_eq_u32 s7, 2
  s_cbranch_scc0 Lnoev_337
  s_waitcnt vmcnt(0)
  s_lshl_b32 s14, s24, 2
  s_add_u32 s14, s14, s3
  s_lshl_b32 s14, s14, 7
  s_add_u32 s14, s14, 0
  s_lshl_b32 s28, s21, 3
  s_add_u32 s14, s14, s28
  v_mov_b32 v2, s16
  v_mov_b32 v3, s17
  v_mov_b32 v1, 0
  s_mov_b64 s[34:35], exec
  s_mov_b64 exec, 1
  buffer_store_dwordx2 v[2:3], v1, s[64:67], s14 offen sc1
  s_mov_b64 exec, s[34:35]
Lnoev_337:
  s_setpc_b64 s[18:19]
Levstub_124:
  s_call_b64 s[18:19], Levdisp_110
  s_branch Levback_125
Levstub_136:
  s_call_b64 s[18:19], Levdisp_110
  s_branch Levback_137
Levstub_148:
  s_call_b64 s[18:19], Levdisp_110
  s_branch Levback_149
Levstub_160:
  s_call_b64 s[18:19], Levdisp_110
  s_branch Levback_161
Levstub_172:
  s_call_b64 s[18:19], Levdisp_110
  s_branch Levback_173
Levstub_184:
  s_call_b64 s[18:19], Levdisp_110
  s_branch Levback_185
Levstub_196:
  s_call_b64 s[18:19], Levdisp_110
  s_branch Levback_197
Levstub_220:
  s_call_b64 s[18:19], Levdisp_206
  s_branch Levback_221
Levstub_232:
  s_call_b64 s[18:19], Levdisp_206
  s_branch Levback_233
Levstub_244:
  s_call_b64 s[18:19], Levdisp_206
  s_branch Levback_245
Levstub_256:
  s_call_b64 s[18:19], Levdisp_206
  s_branch Levback_257
Levstub_268:
  s_call_b64 s[18:19], Levdisp_206
  s_branch Levback_269
Levstub_280:
  s_call_b64 s[18:19], Levdisp_206
  s_branch Levback_281
Levstub_292:
  s_call_b64 s[18:19], Levdisp_206
  s_branch Levback_293
Lchfirst_120:
  s_add_u32 s9, s6, 4
  s_cmp_lt_u32 s4, s9
  s_cbranch_scc1 Llw_slow_338
Llw_back_339:
  s_mul_i32 s29, s3, 8704
  s_add_u32 s10, s5, s29
  s_add_u32 s10, s10, 0
  s_sub_u32 s28, s10, s72
  s_cmp_lt_u32 s10, s72
  s_cselect_b32 s10, s10, s28
  v_add_u32 v12, s10, v8
  v_add_u32 v13, s10, v9
  s_add_u32 s5, s5, 26112
  s_sub_u32 s28, s5, s72
  s_cmp_lt_u32 s5, s72
  s_cselect_b32 s5, s5, s28
  v_add_u32 v14, s5, v11
  ds_read_b128 a[160:163], v12 offset:0
  v_mov_b32 v160, 0
  v_mov_b32 v161, 0
  ds_read_b128 a[164:167], v13 offset:0
  v_mov_b32 v162, 0
  v_mov_b32 v163, 0
  ds_read_b128 a[168:171], v12 offset:64
  v_mov_b32 v164, 0
  v_mov_b32 v165, 0
  ds_read_b128 a[172:175], v13 offset:64
  v_mov_b32 v166, 0
  v_mov_b32 v167, 0
  ds_read_b128 a[176:179], v12 offset:128
  v_mov_b32 v168, 0
  v_mov_b32 v169, 0
  ds_read_b128 a[180:183], v13 offset:128
  v_mov_b32 v170, 0
  v_mov_b32 v171, 0
  ds_read_b64_tr_b16 a[0:1], v14 offset:0
  v_mov_b32 v172, 0
  v_mov_b32 v173, 0
  ds_read_b64_tr_b16 a[2:3], v14 offset:256
  v_mov_b32 v174, 0
  v_mov_b32 v175, 0
  ds_read_b64_tr_b16 a[4:5], v14 offset:64
  v_mov_b32 v176, 0
  v_mov_b32 v177, 0
  ds_read_b64_tr_b16 a[6:7], v14 offset:320
  v_mov_b32 v178, 0
  v_mov_b32 v179, 0
  ds_read_b64_tr_b16 a[8:9], v14 offset:128
  v_mov_b32 v180, 0
  v_mov_b32 v181, 0
  ds_read_b64_tr_b16 a[10:11], v14 offset:384
  v_mov_b32 v182, 0
  v_mov_b32 v183, 0
  ds_read_b64_tr_b16 a[12:13], v14 offset:192
  v_mov_b32 v184, 0
  v_mov_b32 v185, 0
  ds_read_b64_tr_b16 a[14:15], v14 offset:448
  v_mov_b32 v186, 0
  v_mov_b32 v187, 0
  ds_read_b64_tr_b16 a[16:17], v14 offset:4352
  v_mov_b32 v188, 0
  v_mov_b32 v189, 0
  ds_read_b64_tr_b16 a[18:19], v14 offset:4608
  v_mov_b32 v190, 0
  v_mov_b32 v191, 0
  ds_read_b64_tr_b16 a[20:21], v14 offset:4416
  v_mov_b32 v192, 0
  v_mov_b32 v193, 0
  ds_read_b64_tr_b16 a[22:23], v14 offset:4672
  v_mov_b32 v194, 0
  v_mov_b32 v195, 0
  ds_read_b64_tr_b16 a[24:25], v14 offset:4480
  v_mov_b32 v196, 0
  v_mov_b32 v197, 0
  ds_read_b64_tr_b16 a[26:27], v14 offset:4736
  v_mov_b32 v198, 0
  v_mov_b32 v199, 0
  ds_read_b64_tr_b16 a[28:29], v14 offset:4544
  v_mov_b32 v200, 0
  v_mov_b32 v201, 0
  ds_read_b64_tr_b16 a[30:31], v14 offset:4800
  v_mov_b32 v202, 0
  v_mov_b32 v203, 0
  ds_read_b128 a[184:187], v12 offset:192
  v_mov_b32 v204, 0
  v_mov_b32 v205, 0
  ds_read_b128 a[188:191], v13 offset:192
  v_mov_b32 v206, 0
  v_mov_b32 v207, 0
  v_mov_b32 v208, 0
  v_mov_b32 v209, 0
  v_mov_b32 v210, 0
  v_mov_b32 v211, 0
  v_mov_b32 v212, 0
  v_mov_b32 v213, 0
  v_mov_b32 v214, 0
  v_mov_b32 v215, 0
  v_mov_b32 v216, 0
  v_mov_b32 v217, 0
  v_mov_b32 v218, 0
  v_mov_b32 v219, 0
  v_mov_b32 v220, 0
  v_mov_b32 v221, 0
  v_mov_b32 v222, 0
  v_mov_b32 v223, 0
  s_add_u32 s5, s5, 8704
  s_cmp_lt_u32 s5, 156672
  s_cselect_b32 s5, s5, 0
  s_add_u32 s6, s6, 4
  s_branch Lchback_121
Lchfirst_216:
  s_add_u32 s9, s6, 1
  s_cmp_lt_u32 s4, s9
  s_cbranch_scc1 Llw_slow_340
Llw_back_341:
  v_add_u32 v14, s5, v11
  ds_read_b64_tr_b16 a[0:1], v14 offset:0
  v_mov_b32 v192, 0
  v_mov_b32 v193, 0
  ds_read_b64_tr_b16 a[2:3], v14 offset:256
  v_mov_b32 v194, 0
  v_mov_b32 v195, 0
  ds_read_b64_tr_b16 a[4:5], v14 offset:64
  v_mov_b32 v196, 0
  v_mov_b32 v197, 0
  ds_read_b64_tr_b16 a[6:7], v14 offset:320
  v_mov_b32 v198, 0
  v_mov_b32 v199, 0
  ds_read_b64_tr_b16 a[8:9], v14 offset:128
  v_mov_b32 v200, 0
  v_mov_b32 v201, 0
  ds_read_b64_tr_b16 a[10:11], v14 offset:384
  v_mov_b32 v202, 0
  v_mov_b32 v203, 0
  ds_read_b64_tr_b16 a[12:13], v14 offset:192
  v_mov_b32 v204, 0
  v_mov_b32 v205, 0
  ds_read_b64_tr_b16 a[14:15], v14 offset:448
  v_mov_b32 v206, 0
  v_mov_b32 v207, 0
  ds_read_b64_tr_b16 a[16:17], v14 offset:4352
  v_mov_b32 v208, 0
  v_mov_b32 v209, 0
  ds_read_b64_tr_b16 a[18:19], v14 offset:4608
  v_mov_b32 v210, 0
  v_mov_b32 v211, 0
  ds_read_b64_tr_b16 a[20:21], v14 offset:4416
  v_mov_b32 v212, 0
  v_mov_b32 v213, 0
  ds_read_b64_tr_b16 a[22:23], v14 offset:4672
  v_mov_b32 v214, 0
  v_mov_b32 v215, 0
  ds_read_b64_tr_b16 a[24:25], v14 offset:4480
  v_mov_b32 v216, 0
  v_mov_b32 v217, 0
  ds_read_b64_tr_b16 a[26:27], v14 offset:4736
  v_mov_b32 v218, 0
  v_mov_b32 v219, 0
  ds_read_b64_tr_b16 a[28:29], v14 offset:4544
  v_mov_b32 v220, 0
  v_mov_b32 v221, 0
  ds_read_b64_tr_b16 a[30:31], v14 offset:4800
  v_mov_b32 v222, 0
  v_mov_b32 v223, 0
  v_mov_b32 v224, 0
  v_mov_b32 v225, 0
  v_mov_b32 v226, 0
  v_mov_b32 v227, 0
  v_mov_b32 v228, 0
  v_mov_b32 v229, 0
  v_mov_b32 v230, 0
  v_mov_b32 v231, 0
  v_mov_b32 v232, 0
  v_mov_b32 v233, 0
  v_mov_b32 v234, 0
  v_mov_b32 v235, 0
  v_mov_b32 v236, 0
  v_mov_b32 v237, 0
  v_mov_b32 v238, 0
  v_mov_b32 v239, 0
  v_mov_b32 v240, 0
  v_mov_b32 v241, 0
  v_mov_b32 v242, 0
  v_mov_b32 v243, 0
  v_mov_b32 v244, 0
  v_mov_b32 v245, 0
  v_mov_b32 v246, 0
  v_mov_b32 v247, 0
  v_mov_b32 v248, 0
  v_mov_b32 v249, 0
  v_mov_b32 v250, 0
  v_mov_b32 v251, 0
  v_mov_b32 v252, 0
  v_mov_b32 v253, 0
  v_mov_b32 v254, 0
  v_mov_b32 v255, 0
  s_add_u32 s5, s5, 8704
  s_cmp_lt_u32 s5, 156672
  s_cselect_b32 s5, s5, 0
  s_add_u32 s6, s6, 1
  s_branch Lchback_217
Llw_slow_74:
  ds_read_b32 v24, v22
  s_waitcnt lgkmcnt(0)
  v_readfirstlane_b32 s4, v24
  s_sub_u32 s26, s26, 1
  s_cmp_eq_u32 s26, 0
  s_cbranch_scc1 L_end
  s_cmp_lt_u32 s4, s9
  s_cbranch_scc1 Llw_slow_74
  s_branch Llw_back_75
Llw_slow_76:
  ds_read_b32 v24, v22
  s_waitcnt lgkmcnt(0)
  v_readfirstlane_b32 s4, v24
  s_sub_u32 s26, s26, 1
  s_cmp_eq_u32 s26, 0
  s_cbranch_scc1 L_end
  s_cmp_lt_u32 s4, s9
  s_cbranch_scc1 Llw_slow_76
  s_branch Llw_back_77
Llw_slow_78:
  ds_read_b32 v24, v22
  s_waitcnt lgkmcnt(0)
  v_readfirstlane_b32 s4, v24
  s_sub_u32 s26, s26, 1
  s_cmp_eq_u32 s26, 0
  s_cbranch_scc1 L_end
  s_cmp_lt_u32 s4, s9
  s_cbranch_scc1 Llw_slow_78
  s_branch Llw_back_79
Llw_slow_80:
  ds_read_b32 v24, v22
  s_waitcnt lgkmcnt(0)
  v_readfirstlane_b32 s4, v24
  s_sub_u32 s26, s26, 1
  s_cmp_eq_u32 s26, 0
  s_cbranch_scc1 L_end
  s_cmp_lt_u32 s4, s9
  s_cbranch_scc1 Llw_slow_80
  s_branch Llw_back_81
Llw_slow_82:
  ds_read_b32 v24, v22
  s_waitcnt lgkmcnt(0)
  v_readfirstlane_b32 s4, v24
  s_sub_u32 s26, s26, 1
  s_cmp_eq_u32 s26, 0
  s_cbranch_scc1 L_end
  s_cmp_lt_u32 s4, s9
  s_cbranch_scc1 Llw_slow_82
  s_branch Llw_back_83
Llw_slow_84:
  ds_read_b32 v24, v22
  s_waitcnt lgkmcnt(0)
  v_readfirstlane_b32 s4, v24
  s_sub_u32 s26, s26, 1
  s_cmp_eq_u32 s26, 0
  s_cbranch_scc1 L_end
  s_cmp_lt_u32 s4, s9
  s_cbranch_scc1 Llw_slow_84
  s_branch Llw_back_85
Llw_slow_86:
  ds_read_b32 v24, v22
  s_waitcnt lgkmcnt(0)
  v_readfirstlane_b32 s4, v24
  s_sub_u32 s26, s26, 1
  s_cmp_eq_u32 s26, 0
  s_cbranch_scc1 L_end
  s_cmp_lt_u32 s4, s9
  s_cbranch_scc1 Llw_slow_86
  s_branch Llw_back_87
Llw_slow_88:
  ds_read_b32 v24, v22
  s_waitcnt lgkmcnt(0)
  v_readfirstlane_b32 s4, v24
  s_sub_u32 s26, s26, 1
  s_cmp_eq_u32 s26, 0
  s_cbranch_scc1 L_end
  s_cmp_lt_u32 s4, s9
  s_cbranch_scc1 Llw_slow_88
  s_branch Llw_back_89
Llw_slow_90:
  ds_read_b32 v24, v22
  s_waitcnt lgkmcnt(0)
  v_readfirstlane_b32 s4, v24
  s_sub_u32 s26, s26, 1
  s_cmp_eq_u32 s26, 0
  s_cbranch_scc1 L_end
  s_cmp_lt_u32 s4, s9
  s_cbranch_scc1 Llw_slow_90
  s_branch Llw_back_91
Llw_slow_92:
  ds_read_b32 v24, v22
  s_waitcnt lgkmcnt(0)
  v_readfirstlane_b32 s4, v24
  s_sub_u32 s26, s26, 1
  s_cmp_eq_u32 s26, 0
  s_cbranch_scc1 L_end
  s_cmp_lt_u32 s4, s9
  s_cbranch_scc1 Llw_slow_92
  s_branch Llw_back_93
Llw_slow_94:
  ds_read_b32 v24, v22
  s_waitcnt lgkmcnt(0)
  v_readfirstlane_b32 s4, v24
  s_sub_u32 s26, s26, 1
  s_cmp_eq_u32 s26, 0
  s_cbranch_scc1 L_end
  s_cmp_lt_u32 s4, s9
  s_cbranch_scc1 Llw_slow_94
  s_branch Llw_back_95
Llw_slow_96:
  ds_read_b32 v24, v22
  s_waitcnt lgkmcnt(0)
  v_readfirstlane_b32 s4, v24
  s_sub_u32 s26, s26, 1
  s_cmp_eq_u32 s26, 0
  s_cbranch_scc1 L_end
  s_cmp_lt_u32 s4, s9
  s_cbranch_scc1 Llw_slow_96
  s_branch Llw_back_97
Llw_slow_98:
  ds_read_b32 v24, v22
  s_waitcnt lgkmcnt(0)
  v_readfirstlane_b32 s4, v24
  s_sub_u32 s26, s26, 1
  s_cmp_eq_u32 s26, 0
  s_cbranch_scc1 L_end
  s_cmp_lt_u32 s4, s9
  s_cbranch_scc1 Llw_slow_98
  s_branch Llw_back_99
Llw_slow_100:
  ds_read_b32 v24, v22
  s_waitcnt lgkmcnt(0)
  v_readfirstlane_b32 s4, v24
  s_sub_u32 s26, s26, 1
  s_cmp_eq_u32 s26, 0
  s_cbranch_scc1 L_end
  s_cmp_lt_u32 s4, s9
  s_cbranch_scc1 Llw_slow_100
  s_branch Llw_back_101
Llw_slow_102:
  ds_read_b32 v24, v22
  s_waitcnt lgkmcnt(0)
  v_readfirstlane_b32 s4, v24
  s_sub_u32 s26, s26, 1
  s_cmp_eq_u32 s26, 0
  s_cbranch_scc1 L_end
  s_cmp_lt_u32 s4, s9
  s_cbranch_scc1 Llw_slow_102
  s_branch Llw_back_103
Llw_slow_104:
  ds_read_b32 v24, v22
  s_waitcnt lgkmcnt(0)
  v_readfirstlane_b32 s4, v24
  s_sub_u32 s26, s26, 1
  s_cmp_eq_u32 s26, 0
  s_cbranch_scc1 L_end
  s_cmp_lt_u32 s4, s9
  s_cbranch_scc1 Llw_slow_104
  s_branch Llw_back_105
Llw_slow_106:
  ds_read_b32 v24, v22
  s_waitcnt lgkmcnt(0)
  v_readfirstlane_b32 s4, v24
  s_sub_u32 s26, s26, 1
  s_cmp_eq_u32 s26, 0
  s_cbranch_scc1 L_end
  s_cmp_lt_u32 s4, s9
  s_cbranch_scc1 Llw_slow_106
  s_branch Llw_back_107
Llw_slow_108:
  ds_read_b32 v24, v22
  s_waitcnt lgkmcnt(0)
  v_readfirstlane_b32 s4, v24
  s_sub_u32 s26, s26, 1
  s_cmp_eq_u32 s26, 0
  s_cbranch_scc1 L_end
  s_cmp_lt_u32 s4, s9
  s_cbranch_scc1 Llw_slow_108
  s_branch Llw_back_109
Llw_slow_112:
  ds_read_b32 v24, v22
  s_waitcnt lgkmcnt(0)
  v_readfirstlane_b32 s4, v24
  s_sub_u32 s26, s26, 1
  s_cmp_eq_u32 s26, 0
  s_cbranch_scc1 L_end
  s_cmp_lt_u32 s4, s9
  s_cbranch_scc1 Llw_slow_112
  s_branch Llw_back_113
Llw_slow_116:
  ds_read_b32 v24, v22
  s_waitcnt lgkmcnt(0)
  v_readfirstlane_b32 s4, v24
  s_sub_u32 s26, s26, 1
  s_cmp_eq_u32 s26, 0
  s_cbranch_scc1 L_end
  s_cmp_lt_u32 s4, s9
  s_cbranch_scc1 Llw_slow_116
  s_branch Llw_back_117
Llw_slow_122:
  ds_read_b32 v24, v22
  s_waitcnt lgkmcnt(0)
  v_readfirstlane_b32 s4, v24
  s_sub_u32 s26, s26, 1
  s_cmp_eq_u32 s26, 0
  s_cbranch_scc1 L_end
  s_cmp_lt_u32 s4, s9
  s_cbranch_scc1 Llw_slow_122
  s_branch Llw_back_123
Llw_slow_126:
  ds_read_b32 v24, v22
  s_waitcnt lgkmcnt(0)
  v_readfirstlane_b32 s4, v24
  s_sub_u32 s26, s26, 1
  s_cmp_eq_u32 s26, 0
  s_cbranch_scc1 L_end
  s_cmp_lt_u32 s4, s9
  s_cbranch_scc1 Llw_slow_126
  s_branch Llw_back_127
Llw_slow_130:
  ds_read_b32 v24, v22
  s_waitcnt lgkmcnt(0)
  v_readfirstlane_b32 s4, v24
  s_sub_u32 s26, s26, 1
  s_cmp_eq_u32 s26, 0
  s_cbranch_scc1 L_end
  s_cmp_lt_u32 s4, s9
  s_cbranch_scc1 Llw_slow_130
  s_branch Llw_back_131
Llw_slow_134:
  ds_read_b32 v24, v22
  s_waitcnt lgkmcnt(0)
  v_readfirstlane_b32 s4, v24
  s_sub_u32 s26, s26, 1
  s_cmp_eq_u32 s26, 0
  s_cbranch_scc1 L_end
  s_cmp_lt_u32 s4, s9
  s_cbranch_scc1 Llw_slow_134
  s_branch Llw_back_135
Llw_slow_138:
  ds_read_b32 v24, v22
  s_waitcnt lgkmcnt(0)
  v_readfirstlane_b32 s4, v24
  s_sub_u32 s26, s26, 1
  s_cmp_eq_u32 s26, 0
  s_cbranch_scc1 L_end
  s_cmp_lt_u32 s4, s9
  s_cbranch_scc1 Llw_slow_138
  s_branch Llw_back_139
Llw_slow_142:
  ds_read_b32 v24, v22
  s_waitcnt lgkmcnt(0)
  v_readfirstlane_b32 s4, v24
  s_sub_u32 s26, s26, 1
  s_cmp_eq_u32 s26, 0
  s_cbranch_scc1 L_end
  s_cmp_lt_u32 s4, s9
  s_cbranch_scc1 Llw_slow_142
  s_branch Llw_back_143
Llw_slow_146:
  ds_read_b32 v24, v22
  s_waitcnt lgkmcnt(0)
  v_readfirstlane_b32 s4, v24
  s_sub_u32 s26, s26, 1
  s_cmp_eq_u32 s26, 0
  s_cbranch_scc1 L_end
  s_cmp_lt_u32 s4, s9
  s_cbranch_scc1 Llw_slow_146
  s_branch Llw_back_147
Llw_slow_150:
  ds_read_b32 v24, v22
  s_waitcnt lgkmcnt(0)
  v_readfirstlane_b32 s4, v24
  s_sub_u32 s26, s26, 1
  s_cmp_eq_u32 s26, 0
  s_cbranch_scc1 L_end
  s_cmp_lt_u32 s4, s9
  s_cbranch_scc1 Llw_slow_150
  s_branch Llw_back_151
Llw_slow_154:
  ds_read_b32 v24, v22
  s_waitcnt lgkmcnt(0)
  v_readfirstlane_b32 s4, v24
  s_sub_u32 s26, s26, 1
  s_cmp_eq_u32 s26, 0
  s_cbranch_scc1 L_end
  s_cmp_lt_u32 s4, s9
  s_cbranch_scc1 Llw_slow_154
  s_branch Llw_back_155
Llw_slow_158:
  ds_read_b32 v24, v22
  s_waitcnt lgkmcnt(0)
  v_readfirstlane_b32 s4, v24
  s_sub_u32 s26, s26, 1
  s_cmp_eq_u32 s26, 0
  s_cbranch_scc1 L_end
  s_cmp_lt_u32 s4, s9
  s_cbranch_scc1 Llw_slow_158
  s_branch Llw_back_159
Llw_slow_162:
  ds_read_b32 v24, v22
  s_waitcnt lgkmcnt(0)
  v_readfirstlane_b32 s4, v24
  s_sub_u32 s26, s26, 1
  s_cmp_eq_u32 s26, 0
  s_cbranch_scc1 L_end
  s_cmp_lt_u32 s4, s9
  s_cbranch_scc1 Llw_slow_162
  s_branch Llw_back_163
Llw_slow_166:
  ds_read_b32 v24, v22
  s_waitcnt lgkmcnt(0)
  v_readfirstlane_b32 s4, v24
  s_sub_u32 s26, s26, 1
  s_cmp_eq_u32 s26, 0
  s_cbranch_scc1 L_end
  s_cmp_lt_u32 s4, s9
  s_cbranch_scc1 Llw_slow_166
  s_branch Llw_back_167
Llw_slow_170:
  ds_read_b32 v24, v22
  s_waitcnt lgkmcnt(0)
  v_readfirstlane_b32 s4, v24
  s_sub_u32 s26, s26, 1
  s_cmp_eq_u32 s26, 0
  s_cbranch_scc1 L_end
  s_cmp_lt_u32 s4, s9
  s_cbranch_scc1 Llw_slow_170
  s_branch Llw_back_171
Llw_slow_174:
  ds_read_b32 v24, v22
  s_waitcnt lgkmcnt(0)
  v_readfirstlane_b32 s4, v24
  s_sub_u32 s26, s26, 1
  s_cmp_eq_u32 s26, 0
  s_cbranch_scc1 L_end
  s_cmp_lt_u32 s4, s9
  s_cbranch_scc1 Llw_slow_174
  s_branch Llw_back_175
Llw_slow_178:
  ds_read_b32 v24, v22
  s_waitcnt lgkmcnt(0)
  v_readfirstlane_b32 s4, v24
  s_sub_u32 s26, s26, 1
  s_cmp_eq_u32 s26, 0
  s_cbranch_scc1 L_end
  s_cmp_lt_u32 s4, s9
  s_cbranch_scc1 Llw_slow_178
  s_branch Llw_back_179
Llw_slow_182:
  ds_read_b32 v24, v22
  s_waitcnt lgkmcnt(0)
  v_readfirstlane_b32 s4, v24
  s_sub_u32 s26, s26, 1
  s_cmp_eq_u32 s26, 0
  s_cbranch_scc1 L_end
  s_cmp_lt_u32 s4, s9
  s_cbranch_scc1 Llw_slow_182
  s_branch Llw_back_183
Llw_slow_186:
  ds_read_b32 v24, v22
  s_waitcnt lgkmcnt(0)
  v_readfirstlane_b32 s4, v24
  s_sub_u32 s26, s26, 1
  s_cmp_eq_u32 s26, 0
  s_cbranch_scc1 L_end
  s_cmp_lt_u32 s4, s9
  s_cbranch_scc1 Llw_slow_186
  s_branch Llw_back_187
Llw_slow_190:
  ds_read_b32 v24, v22
  s_waitcnt lgkmcnt(0)
  v_readfirstlane_b32 s4, v24
  s_sub_u32 s26, s26, 1
  s_cmp_eq_u32 s26, 0
  s_cbranch_scc1 L_end
  s_cmp_lt_u32 s4, s9
  s_cbranch_scc1 Llw_slow_190
  s_branch Llw_back_191
Llw_slow_194:
  ds_read_b32 v24, v22
  s_waitcnt lgkmcnt(0)
  v_readfirstlane_b32 s4, v24
  s_sub_u32 s26, s26, 1
  s_cmp_eq_u32 s26, 0
  s_cbranch_scc1 L_end
  s_cmp_lt_u32 s4, s9
  s_cbranch_scc1 Llw_slow_194
  s_branch Llw_back_195
Llw_slow_198:
  ds_read_b32 v24, v22
  s_waitcnt lgkmcnt(0)
  v_readfirstlane_b32 s4, v24
  s_sub_u32 s26, s26, 1
  s_cmp_eq_u32 s26, 0
  s_cbranch_scc1 L_end
  s_cmp_lt_u32 s4, s9
  s_cbranch_scc1 Llw_slow_198
  s_branch Llw_back_199
Llw_slow_202:
  ds_read_b32 v24, v22
  s_waitcnt lgkmcnt(0)
  v_readfirstlane_b32 s4, v24
  s_sub_u32 s26, s26, 1
  s_cmp_eq_u32 s26, 0
  s_cbranch_scc1 L_end
  s_cmp_lt_u32 s4, s9
  s_cbranch_scc1 Llw_slow_202
  s_branch Llw_back_203
Llw_slow_204:
  ds_read_b32 v24, v22
  s_waitcnt lgkmcnt(0)
  v_readfirstlane_b32 s4, v24
  s_sub_u32 s26, s26, 1
  s_cmp_eq_u32 s26, 0
  s_cbranch_scc1 L_end
  s_cmp_lt_u32 s4, s9
  s_cbranch_scc1 Llw_slow_204
  s_branch Llw_back_205
Llw_slow_208:
  ds_read_b32 v24, v22
  s_waitcnt lgkmcnt(0)
  v_readfirstlane_b32 s4, v24
  s_sub_u32 s26, s26, 1
  s_cmp_eq_u32 s26, 0
  s_cbranch_scc1 L_end
  s_cmp_lt_u32 s4, s9
  s_cbranch_scc1 Llw_slow_208
  s_branch Llw_back_209
Llw_slow_212:
  ds_read_b32 v24, v22
  s_waitcnt lgkmcnt(0)
  v_readfirstlane_b32 s4, v24
  s_sub_u32 s26, s26, 1
  s_cmp_eq_u32 s26, 0
  s_cbranch_scc1 L_end
  s_cmp_lt_u32 s4, s9
  s_cbranch_scc1 Llw_slow_212
  s_branch Llw_back_213
Llw_slow_218:
  ds_read_b32 v24, v22
  s_waitcnt lgkmcnt(0)
  v_readfirstlane_b32 s4, v24
  s_sub_u32 s26, s26, 1
  s_cmp_eq_u32 s26, 0
  s_cbranch_scc1 L_end
  s_cmp_lt_u32 s4, s9
  s_cbranch_scc1 Llw_slow_218
  s_branch Llw_back_219
Llw_slow_222:
  ds_read_b32 v24, v22
  s_waitcnt lgkmcnt(0)
  v_readfirstlane_b32 s4, v24
  s_sub_u32 s26, s26, 1
  s_cmp_eq_u32 s26, 0
  s_cbranch_scc1 L_end
  s_cmp_lt_u32 s4, s9
  s_cbranch_scc1 Llw_slow_222
  s_branch Llw_back_223
Llw_slow_226:
  ds_read_b32 v24, v22
  s_waitcnt lgkmcnt(0)
  v_readfirstlane_b32 s4, v24
  s_sub_u32 s26, s26, 1
  s_cmp_eq_u32 s26, 0
  s_cbranch_scc1 L_end
  s_cmp_lt_u32 s4, s9
  s_cbranch_scc1 Llw_slow_226
  s_branch Llw_back_227
Llw_slow_230:
  ds_read_b32 v24, v22
  s_waitcnt lgkmcnt(0)
  v_readfirstlane_b32 s4, v24
  s_sub_u32 s26, s26, 1
  s_cmp_eq_u32 s26, 0
  s_cbranch_scc1 L_end
  s_cmp_lt_u32 s4, s9
  s_cbranch_scc1 Llw_slow_230
  s_branch Llw_back_231
Llw_slow_234:
  ds_read_b32 v24, v22
  s_waitcnt lgkmcnt(0)
  v_readfirstlane_b32 s4, v24
  s_sub_u32 s26, s26, 1
  s_cmp_eq_u32 s26, 0
  s_cbranch_scc1 L_end
  s_cmp_lt_u32 s4, s9
  s_cbranch_scc1 Llw_slow_234
  s_branch Llw_back_235
Llw_slow_238:
  ds_read_b32 v24, v22
  s_waitcnt lgkmcnt(0)
  v_readfirstlane_b32 s4, v24
  s_sub_u32 s26, s26, 1
  s_cmp_eq_u32 s26, 0
  s_cbranch_scc1 L_end
  s_cmp_lt_u32 s4, s9
  s_cbranch_scc1 Llw_slow_238
  s_branch Llw_back_239
Llw_slow_242:
  ds_read_b32 v24, v22
  s_waitcnt lgkmcnt(0)
  v_readfirstlane_b32 s4, v24
  s_sub_u32 s26, s26, 1
  s_cmp_eq_u32 s26, 0
  s_cbranch_scc1 L_end
  s_cmp_lt_u32 s4, s9
  s_cbranch_scc1 Llw_slow_242
  s_branch Llw_back_243
Llw_slow_246:
  ds_read_b32 v24, v22
  s_waitcnt lgkmcnt(0)
  v_readfirstlane_b32 s4, v24
  s_sub_u32 s26, s26, 1
  s_cmp_eq_u32 s26, 0
  s_cbranch_scc1 L_end
  s_cmp_lt_u32 s4, s9
  s_cbranch_scc1 Llw_slow_246
  s_branch Llw_back_247
Llw_slow_250:
  ds_read_b32 v24, v22
  s_waitcnt lgkmcnt(0)
  v_readfirstlane_b32 s4, v24
  s_sub_u32 s26, s26, 1
  s_cmp_eq_u32 s26, 0
  s_cbranch_scc1 L_end
  s_cmp_lt_u32 s4, s9
  s_cbranch_scc1 Llw_slow_250
  s_branch Llw_back_251
Llw_slow_254:
  ds_read_b32 v24, v22
  s_waitcnt lgkmcnt(0)
  v_readfirstlane_b32 s4, v24
  s_sub_u32 s26, s26, 1
  s_cmp_eq_u32 s26, 0
  s_cbranch_scc1 L_end
  s_cmp_lt_u32 s4, s9
  s_cbranch_scc1 Llw_slow_254
  s_branch Llw_back_255
Llw_slow_258:
  ds_read_b32 v24, v22
  s_waitcnt lgkmcnt(0)
  v_readfirstlane_b32 s4, v24
  s_sub_u32 s26, s26, 1
  s_cmp_eq_u32 s26, 0
  s_cbranch_scc1 L_end
  s_cmp_lt_u32 s4, s9
  s_cbranch_scc1 Llw_slow_258
  s_branch Llw_back_259
Llw_slow_262:
  ds_read_b32 v24, v22
  s_waitcnt lgkmcnt(0)
  v_readfirstlane_b32 s4, v24
  s_sub_u32 s26, s26, 1
  s_cmp_eq_u32 s26, 0
  s_cbranch_scc1 L_end
  s_cmp_lt_u32 s4, s9
  s_cbranch_scc1 Llw_slow_262
  s_branch Llw_back_263
Llw_slow_266:
  ds_read_b32 v24, v22
  s_waitcnt lgkmcnt(0)
  v_readfirstlane_b32 s4, v24
  s_sub_u32 s26, s26, 1
  s_cmp_eq_u32 s26, 0
  s_cbranch_scc1 L_end
  s_cmp_lt_u32 s4, s9
  s_cbranch_scc1 Llw_slow_266
  s_branch Llw_back_267
Llw_slow_270:
  ds_read_b32 v24, v22
  s_waitcnt lgkmcnt(0)
  v_readfirstlane_b32 s4, v24
  s_sub_u32 s26, s26, 1
  s_cmp_eq_u32 s26, 0
  s_cbranch_scc1 L_end
  s_cmp_lt_u32 s4, s9
  s_cbranch_scc1 Llw_slow_270
  s_branch Llw_back_271
Llw_slow_274:
  ds_read_b32 v24, v22
  s_waitcnt lgkmcnt(0)
  v_readfirstlane_b32 s4, v24
  s_sub_u32 s26, s26, 1
  s_cmp_eq_u32 s26, 0
  s_cbranch_scc1 L_end
  s_cmp_lt_u32 s4, s9
  s_cbranch_scc1 Llw_slow_274
  s_branch Llw_back_275
Llw_slow_278:
  ds_read_b32 v24, v22
  s_waitcnt lgkmcnt(0)
  v_readfirstlane_b32 s4, v24
  s_sub_u32 s26, s26, 1
  s_cmp_eq_u32 s26, 0
  s_cbranch_scc1 L_end
  s_cmp_lt_u32 s4, s9
  s_cbranch_scc1 Llw_slow_278
  s_branch Llw_back_279
Llw_slow_282:
  ds_read_b32 v24, v22
  s_waitcnt lgkmcnt(0)
  v_readfirstlane_b32 s4, v24
  s_sub_u32 s26, s26, 1
  s_cmp_eq_u32 s26, 0
  s_cbranch_scc1 L_end
  s_cmp_lt_u32 s4, s9
  s_cbranch_scc1 Llw_slow_282
  s_branch Llw_back_283
Llw_slow_286:
  ds_read_b32 v24, v22
  s_waitcnt lgkmcnt(0)
  v_readfirstlane_b32 s4, v24
  s_sub_u32 s26, s26, 1
  s_cmp_eq_u32 s26, 0
  s_cbranch_scc1 L_end
  s_cmp_lt_u32 s4, s9
  s_cbranch_scc1 Llw_slow_286
  s_branch Llw_back_287
Llw_slow_290:
  ds_read_b32 v24, v22
  s_waitcnt lgkmcnt(0)
  v_readfirstlane_b32 s4, v24
  s_sub_u32 s26, s26, 1
  s_cmp_eq_u32 s26, 0
  s_cbranch_scc1 L_end
  s_cmp_lt_u32 s4, s9
  s_cbranch_scc1 Llw_slow_290
  s_branch Llw_back_291
Llw_slow_294:
  ds_read_b32 v24, v22
  s_waitcnt lgkmcnt(0)
  v_readfirstlane_b32 s4, v24
  s_sub_u32 s26, s26, 1
  s_cmp_eq_u32 s26, 0
  s_cbranch_scc1 L_end
  s_cmp_lt_u32 s4, s9
  s_cbranch_scc1 Llw_slow_294
  s_branch Llw_back_295
Llw_slow_298:
  ds_read_b32 v24, v22
  s_waitcnt lgkmcnt(0)
  v_readfirstlane_b32 s4, v24
  s_sub_u32 s26, s26, 1
  s_cmp_eq_u32 s26, 0
  s_cbranch_scc1 L_end
  s_cmp_lt_u32 s4, s9
  s_cbranch_scc1 Llw_slow_298
  s_branch Llw_back_299
Llw_slow_300:
  ds_read_b32 v24, v22
  s_waitcnt lgkmcnt(0)
  v_readfirstlane_b32 s4, v24
  s_sub_u32 s26, s26, 1
  s_cmp_eq_u32 s26, 0
  s_cbranch_scc1 L_end
  s_cmp_lt_u32 s4, s9
  s_cbranch_scc1 Llw_slow_300
  s_branch Llw_back_301
Llw_slow_302:
  ds_read_b32 v24, v22
  s_waitcnt lgkmcnt(0)
  v_readfirstlane_b32 s4, v24
  s_sub_u32 s26, s26, 1
  s_cmp_eq_u32 s26, 0
  s_cbranch_scc1 L_end
  s_cmp_lt_u32 s4, s9
  s_cbranch_scc1 Llw_slow_302
  s_branch Llw_back_303
Llw_slow_304:
  ds_read_b32 v24, v22
  s_waitcnt lgkmcnt(0)
  v_readfirstlane_b32 s4, v24
  s_sub_u32 s26, s26, 1
  s_cmp_eq_u32 s26, 0
  s_cbranch_scc1 L_end
  s_cmp_lt_u32 s4, s9
  s_cbranch_scc1 Llw_slow_304
  s_branch Llw_back_305
Llw_slow_306:
  ds_read_b32 v24, v22
  s_waitcnt lgkmcnt(0)
  v_readfirstlane_b32 s4, v24
  s_sub_u32 s26, s26, 1
  s_cmp_eq_u32 s26, 0
  s_cbranch_scc1 L_end
  s_cmp_lt_u32 s4, s9
  s_cbranch_scc1 Llw_slow_306
  s_branch Llw_back_307
Llw_slow_309:
  ds_read_b32 v24, v22
  s_waitcnt lgkmcnt(0)
  v_readfirstlane_b32 s4, v24
  s_sub_u32 s26, s26, 1
  s_cmp_eq_u32 s26, 0
  s_cbranch_scc1 L_end
  s_cmp_lt_u32 s4, s9
  s_cbranch_scc1 Llw_slow_309
  s_branch Llw_back_310
Llw_slow_311:
  ds_read_b32 v24, v22
  s_waitcnt lgkmcnt(0)
  v_readfirstlane_b32 s4, v24
  s_sub_u32 s26, s26, 1
  s_cmp_eq_u32 s26, 0
  s_cbranch_scc1 L_end
  s_cmp_lt_u32 s4, s9
  s_cbranch_scc1 Llw_slow_311
  s_branch Llw_back_312
Llw_slow_313:
  ds_read_b32 v24, v22
  s_waitcnt lgkmcnt(0)
  v_readfirstlane_b32 s4, v24
  s_sub_u32 s26, s26, 1
  s_cmp_eq_u32 s26, 0
  s_cbranch_scc1 L_end
  s_cmp_lt_u32 s4, s9
  s_cbranch_scc1 Llw_slow_313
  s_branch Llw_back_314
Llw_slow_315:
  ds_read_b32 v24, v22
  s_waitcnt lgkmcnt(0)
  v_readfirstlane_b32 s4, v24
  s_sub_u32 s26, s26, 1
  s_cmp_eq_u32 s26, 0
  s_cbranch_scc1 L_end
  s_cmp_lt_u32 s4, s9
  s_cbranch_scc1 Llw_slow_315
  s_branch Llw_back_316
Llw_slow_317:
  ds_read_b32 v24, v22
  s_waitcnt lgkmcnt(0)
  v_readfirstlane_b32 s4, v24
  s_sub_u32 s26, s26, 1
  s_cmp_eq_u32 s26, 0
  s_cbranch_scc1 L_end
  s_cmp_lt_u32 s4, s9
  s_cbranch_scc1 Llw_slow_317
  s_branch Llw_back_318
Llw_slow_319:
  ds_read_b32 v24, v22
  s_waitcnt lgkmcnt(0)
  v_readfirstlane_b32 s4, v24
  s_sub_u32 s26, s26, 1
  s_cmp_eq_u32 s26, 0
  s_cbranch_scc1 L_end
  s_cmp_lt_u32 s4, s9
  s_cbranch_scc1 Llw_slow_319
  s_branch Llw_back_320
Llw_slow_321:
  ds_read_b32 v24, v22
  s_waitcnt lgkmcnt(0)
  v_readfirstlane_b32 s4, v24
  s_sub_u32 s26, s26, 1
  s_cmp_eq_u32 s26, 0
  s_cbranch_scc1 L_end
  s_cmp_lt_u32 s4, s9
  s_cbranch_scc1 Llw_slow_321
  s_branch Llw_back_322
Llw_slow_323:
  ds_read_b32 v24, v22
  s_waitcnt lgkmcnt(0)
  v_readfirstlane_b32 s4, v24
  s_sub_u32 s26, s26, 1
  s_cmp_eq_u32 s26, 0
  s_cbranch_scc1 L_end
  s_cmp_lt_u32 s4, s9
  s_cbranch_scc1 Llw_slow_323
  s_branch Llw_back_324
Llw_slow_325:
  ds_read_b32 v24, v22
  s_waitcnt lgkmcnt(0)
  v_readfirstlane_b32 s4, v24
  s_sub_u32 s26, s26, 1
  s_cmp_eq_u32 s26, 0
  s_cbranch_scc1 L_end
  s_cmp_lt_u32 s4, s9
  s_cbranch_scc1 Llw_slow_325
  s_branch Llw_back_326
Llw_slow_327:
  ds_read_b32 v24, v22
  s_waitcnt lgkmcnt(0)
  v_readfirstlane_b32 s4, v24
  s_sub_u32 s26, s26, 1
  s_cmp_eq_u32 s26, 0
  s_cbranch_scc1 L_end
  s_cmp_lt_u32 s4, s9
  s_cbranch_scc1 Llw_slow_327
  s_branch Llw_back_328
Llw_slow_329:
  ds_read_b32 v24, v22
  s_waitcnt lgkmcnt(0)
  v_readfirstlane_b32 s4, v24
  s_sub_u32 s26, s26, 1
  s_cmp_eq_u32 s26, 0
  s_cbranch_scc1 L_end
  s_cmp_lt_u32 s4, s9
  s_cbranch_scc1 Llw_slow_329
  s_branch Llw_back_330
Llw_slow_338:
  ds_read_b32 v24, v22
  s_waitcnt lgkmcnt(0)
  v_readfirstlane_b32 s4, v24
  s_sub_u32 s26, s26, 1
  s_cmp_eq_u32 s26, 0
  s_cbranch_scc1 L_end
  s_cmp_lt_u32 s4, s9
  s_cbranch_scc1 Llw_slow_338
  s_branch Llw_back_339
Llw_slow_340:
  ds_read_b32 v24, v22
  s_waitcnt lgkmcnt(0)
  v_readfirstlane_b32 s4, v24
  s_sub_u32 s26, s26, 1
  s_cmp_eq_u32 s26, 0
  s_cbranch_scc1 L_end
  s_cmp_lt_u32 s4, s9
  s_cbranch_scc1 Llw_slow_340
  s_branch Llw_back_341
.section .rodata,"a"
.p2align 6
.amdhsa_kernel concat_heads__mha_block_cached__gqa_block_cached__near_ridge_kernel
  .amdhsa_next_free_vgpr 512
  .amdhsa_next_free_sgpr 102
  .amdhsa_accum_offset 256
  .amdhsa_group_segment_fixed_size 0
  .amdhsa_kernarg_size 104
  .amdhsa_user_sgpr_count 2
  .amdhsa_user_sgpr_kernarg_segment_ptr 1
  .amdhsa_system_sgpr_workgroup_id_x 1
.end_amdhsa_kernel
```
